```python
import torch

def _softmax(x, axis=-1):
    return torch.softmax(x, dim=axis)
def _gelu(x):
    return torch.nn.functional.gelu(x, approximate="tanh")
def _silu(x):
    return torch.nn.functional.silu(x)
def _sigmoid(x):
    return torch.sigmoid(x)
def _layernorm(x, axis=-1, eps=1e-5):
    m = x.mean(dim=axis, keepdim=True)
    v = x.var(dim=axis, keepdim=True, unbiased=False)
    return (x - m) / torch.sqrt(v + eps)
def _scatter_add(tgt, idx, src, axis=0):
    return tgt.clone().index_add_(axis, idx, src)
def _segment_sum(src, seg, n):
    out = torch.zeros((n,) + src.shape[1:], dtype=src.dtype)
    return out.index_add_(0, seg, src)
def _pad(x, pw):
    flat = tuple(v for pair in reversed(pw) for v in pair)
    return torch.nn.functional.pad(x, flat)

kernel_name = 'parallel_sum__compressed_kv_cla__glu_gated_geglu__prompt'

def setup_inputs():

    _w = (lambda a: (lambda t: t.to(torch.bfloat16) if t.is_floating_point() else t)(torch.as_tensor(a)))
    def _A_setup():
        B, H, Sq, Sk, D, M = 1, 32, 2048, 2048, 128, 512
        Dc = 4 * D
        return {
            "x": _w((lambda *s: torch.randn(*s, dtype=torch.bfloat16) * 0.05)(B, Sq, M)),
            "c_kv": _w((lambda *s: torch.randn(*s, dtype=torch.bfloat16) * 0.4)(B, Sk, Dc)),
            "w_q": _w((lambda *s: torch.randn(*s, dtype=torch.bfloat16) * 3.2)(M, H, D) * (M ** -0.5)),
            "w_uk": _w((lambda *s: torch.randn(*s, dtype=torch.bfloat16) * 3.2)(Dc, H, D) * (Dc ** -0.5)),
            "w_uv": _w((lambda *s: torch.randn(*s, dtype=torch.bfloat16) * 0.4)(Dc, H, D) * (Dc ** -0.5)),
            "w_o": _w((lambda *s: torch.randn(*s, dtype=torch.bfloat16) * 0.4)(H, D, M) * ((H * D) ** -0.5)),
        }
    _A_in = _A_setup()

    def _B_setup():
        B, S, Dm, Df = 1, 2048, 512, 1792
        return {
            "x": _w((lambda *s: torch.randn(*s, dtype=torch.bfloat16) * 0.05)(B, S, Dm)),
            "w_gate": _w((lambda *s: torch.randn(*s, dtype=torch.bfloat16) * 0.4)(Dm, Df) * (Dm ** -0.5)),
            "w_up": _w((lambda *s: torch.randn(*s, dtype=torch.bfloat16) * 0.4)(Dm, Df) * (Dm ** -0.5)),
            "w_down": _w((lambda *s: torch.randn(*s, dtype=torch.bfloat16) * 0.4)(Df, Dm) * (Df ** -0.5)),
        }
    _B_in = _B_setup()

    return {
        "A_x": _A_in["x"],
        "A_c_kv": _A_in["c_kv"],
        "A_w_q": _A_in["w_q"],
        "A_w_uk": _A_in["w_uk"],
        "A_w_uv": _A_in["w_uv"],
        "A_w_o": _A_in["w_o"],
        "B_x": _B_in["x"],
        "B_w_gate": _B_in["w_gate"],
        "B_w_up": _B_in["w_up"],
        "B_w_down": _B_in["w_down"],
    }

def reference(A_x, A_c_kv, A_w_q, A_w_uk, A_w_uv, A_w_o, B_x, B_w_gate, B_w_up, B_w_down):
    def _A_ref(x, c_kv, w_q, w_uk, w_uv, w_o):
        B, Sq, M = x.shape[0], x.shape[1], x.shape[2]
        Sk = c_kv.shape[1]
        H, D = w_q.shape[1], w_q.shape[2]
        q = torch.einsum("bqm,mhd->bhqd", x, w_q)
        k = torch.einsum("bkc,chd->bhkd", c_kv, w_uk)
        v = torch.einsum("bkc,chd->bhkd", c_kv, w_uv)
        scores = torch.einsum("bhqd,bhkd->bhqk", q, k) * (D ** -0.5)
        off = Sk - Sq
        qi = torch.arange(Sq)[:, None]
        kj = torch.arange(Sk)[None, :]
        cmask = kj <= (qi + off)
        scores = torch.where(cmask[None, None], scores, -1e9)
        p = _softmax(scores, axis=-1)
        ctx = torch.einsum("bhqk,bhkd->bhqd", p, v)
        return torch.einsum("bhqd,hdm->bqm", ctx, w_o)

    def _B_ref(x, w_gate, w_up, w_down):
        g = torch.einsum("bsd,df->bsf", x, w_gate)
        u = torch.einsum("bsd,df->bsf", x, w_up)
        h = _gelu(g) * u
        return torch.einsum("bsf,fd->bsd", h, w_down)

    x = A_x
    xn = _layernorm(x, axis=-1)
    return x + _A_ref(xn, A_c_kv, A_w_q, A_w_uk, A_w_uv, A_w_o) + _B_ref(xn, B_w_gate, B_w_up, B_w_down)
```

```asm
; @launch grid=(256,1,1) block=(256,1,1) lds=163840
.amdgcn_target "amdgcn-amd-amdhsa--gfx950"
.text
.globl parallel_sum__compressed_kv_cla__glu_gated_geglu__prompt_kernel
.p2align 8
.type parallel_sum__compressed_kv_cla__glu_gated_geglu__prompt_kernel,@function
parallel_sum__compressed_kv_cla__glu_gated_geglu__prompt_kernel:
s_cmp_ge_u32 s2, 256
s_cbranch_scc1 L_end
s_load_dwordx16 s[4:19], s[0:1], 0
s_load_dwordx8 s[20:27], s[0:1], 64
s_load_dwordx2 s[28:29], s[0:1], 96
v_lshrrev_b32 v1, 6, v0
v_and_b32 v127, 63, v0
v_readfirstlane_b32 s30, v1
v_lshlrev_b32 v15, 4, v127
s_getpc_b64 s[60:61]
L_pc:
s_lshr_b32 s35, s2, 3
s_lshl_b32 s35, s35, 12
v_lshl_add_u32 v8, v0, 4, s35
v_min_u32 v8, L_end-L_pc, v8
global_load_dword v7, v8, s[60:61]
s_and_b32 s31, s2, 7
s_lshl_b32 s31, s31, 2
s_bfe_u32 s35, s2, 0x20003
s_add_u32 s31, s31, s35
s_lshr_b32 s32, s2, 5
s_lshr_b32 s33, s30, 1
s_and_b32 s34, s30, 1
s_sub_u32 s59, 14, s32
s_cmp_lt_u32 s31, 16
s_cselect_b32 s59, s32, s59
s_lshl_b32 s59, s59, 6
s_lshl_b32 s35, s31, 2
s_add_u32 s35, s35, s30
s_add_u32 s35, s35, s59
s_lshl_b32 s35, s35, 11
v_and_b32 v48, 0x200, v15
v_add3_u32 v48, v48, v15, s35
s_lshl_b32 s59, s32, 2
s_add_u32 s59, s59, s30
s_lshl_b32 s59, s59, 6
s_lshl_b32 s63, s31, 1
s_add_u32 s63, s63, s34
s_lshl_b32 s63, s63, 7
s_lshl_b32 s35, s33, 18
s_add_u32 s63, s63, s35
v_lshrrev_b32 v56, 3, v127
v_and_b32 v57, 7, v127
v_lshrrev_b32 v58, 4, v127
v_xor_b32 v1, v57, v58
v_lshlrev_b32 v1, 4, v1
v_add_u32 v2, s59, v56
v_lshl_add_u32 v1, v2, 10, v1
v_xor_b32 v2, 64, v1
v_and_b32 v58, 1, v58
v_lshlrev_b32 v58, 1, v58
v_xor_b32 v57, v57, v58
v_lshlrev_b32 v57, 4, v57
v_lshlrev_b32 v56, 13, v56
v_add3_u32 v3, v56, v57, s63
v_xor_b32 v4, 64, v3
s_lshl_b32 s57, s30, 12
s_add_u32 s57, s57, 98304
s_lshl_b32 s58, s30, 13
s_mov_b32 s50, 0x200000
s_mov_b32 s51, 0x20000
s_mov_b32 s38, 0x200000
s_mov_b32 s39, 0x20000
s_mov_b32 s42, 0x400000
s_mov_b32 s43, 0x20000
s_and_b32 s35, s32, 1
s_lshl_b32 s80, s35, 7
s_xor_b32 s81, s80, 128
s_lshl_b32 s82, s80, 12
s_lshl_b32 s83, s81, 12
v_and_b32 v61, 15, v127
v_lshrrev_b32 v58, 4, v127
v_lshrrev_b32 v60, 1, v61
v_xor_b32 v60, v60, v58
v_lshlrev_b32 v60, 4, v60
v_lshl_add_u32 v5, v61, 7, v60
s_lshl_b32 s35, s33, 14
v_add_u32 v5, s35, v5
v_xor_b32 v6, 64, v5
v_and_b32 v56, 3, v127
v_bfe_u32 v57, v127, 2, 2
v_lshl_add_u32 v59, v58, 3, v57
v_lshlrev_b32 v59, 7, v59
v_lshl_add_u32 v59, v56, 3, v59
v_lshrrev_b32 v60, 1, v57
v_and_b32 v58, 1, v58
v_lshl_add_u32 v60, v58, 1, v60
v_lshl_add_u32 v59, v60, 5, v59
s_lshl_b32 s35, s34, 12
s_add_u32 s35, s35, 98304
v_add_u32 v9, s35, v59
v_xor_b32 v10, 32, v9
v_xor_b32 v11, 64, v9
v_xor_b32 v12, 96, v9
s_lshl_b32 s35, s34, 6
v_xor_b32 v59, s35, v59
v_add_u32 v13, 98304, v59
v_xor_b32 v14, 32, v13
s_waitcnt lgkmcnt(0)
s_mov_b32 s48, s4
s_mov_b32 s49, s5
s_mov_b32 s36, s6
s_mov_b32 s37, s7
s_mov_b32 s40, s10
s_mov_b32 s41, s11
s_add_u32 m0, s58, 0
s_add_u32 s55, s80, 0
buffer_load_dwordx4 v1, s[36:39], s55 offen offset:0  lds
s_add_u32 s55, s80, 7168
buffer_load_dwordx4 v2, s[36:39], s55 offen offset:1024  lds
s_add_u32 s55, s80, 14336
buffer_load_dwordx4 v1, s[36:39], s55 offen offset:2048  lds
s_add_u32 s55, s80, 21504
buffer_load_dwordx4 v2, s[36:39], s55 offen offset:3072  lds
buffer_load_dwordx4 v[16:19], v48, s[48:51], 0 offen
buffer_load_dwordx4 v[20:23], v48, s[48:51], 0 offen offset:512
s_add_u32 m0, s57, 0
s_add_u32 s52, s82, 0
buffer_load_dwordx4 v3, s[40:43], s52 offen offset:0  lds
s_add_u32 s52, s82, 64512
buffer_load_dwordx4 v4, s[40:43], s52 offen offset:1024  lds
s_add_u32 s52, s82, 129024
buffer_load_dwordx4 v3, s[40:43], s52 offen offset:2048  lds
s_add_u32 s52, s82, 193536
buffer_load_dwordx4 v4, s[40:43], s52 offen offset:3072  lds
s_add_u32 s16, s28, 2097152
s_addc_u32 s17, s29, 0
s_mov_b32 s64, s12
s_mov_b32 s65, s13
s_mov_b32 s66, 4194304
s_mov_b32 s67, 0x20000
s_lshr_b32 s70, s31, 3
s_mul_i32 s70, s70, 896
s_mul_i32 s35, s33, 114688
s_add_u32 s70, s70, s35
s_and_b32 s62, s31, 3
s_lshl_b32 s35, s62, 7
s_xor_b32 s62, s62, 1
s_mul_i32 s69, s62, 96
s_add_u32 s69, s69, 512
s_lshl_b32 s73, s34, 13
s_mul_i32 s74, s34, 96
s_lshl_b32 s75, s34, 6
s_xor_b32 s75, s75, 96
s_bitcmp1_b32 s2, 0
s_cselect_b32 s35, s69, s35
s_cselect_b32 s69, 5, 7
s_cselect_b32 s62, s62, 0
s_cselect_b32 s73, s73, 0
s_cselect_b32 s74, s74, 0
s_cselect_b32 s75, s75, 0
s_add_u32 s70, s70, s35
s_and_b32 s62, s62, 1
s_lshl_b32 s62, s62, 1
s_add_u32 s71, s69, 1
v_lshrrev_b32 v60, 3, v127
v_mul_u32_u24 v60, 3584, v60
v_add_u32 v60, s70, v60
v_bfe_u32 v61, v3, 4, 3
v_min_u32 v61, s69, v61
v_add_u32 v61, s62, v61
v_subrev_u32 v62, s71, v61
v_min_u32 v61, v61, v62
v_lshl_add_u32 v61, v61, 4, v60
v_xor_b32 v61, v61, v3
v_accvgpr_write_b32 a250, v61
v_bfe_u32 v61, v4, 4, 3
v_min_u32 v61, s69, v61
v_add_u32 v61, s62, v61
v_subrev_u32 v62, s71, v61
v_min_u32 v61, v61, v62
v_lshl_add_u32 v61, v61, 4, v60
v_xor_b32 v61, v61, v4
v_accvgpr_write_b32 a251, v61
s_sub_u32 s68, 15, s32
s_cmp_lt_u32 s30, 2
s_cselect_b32 s68, s68, s32
s_lshl_b32 s68, s68, 1
s_add_u32 s68, s68, s34
s_lshl_b32 s68, s68, 6
s_sub_u32 s68, s68, 0
s_lshl_b32 s68, s68, 10
s_lshl_b32 s35, s31, 20
s_add_u32 s35, s35, 4194304
s_add_u32 s44, s28, s35
s_addc_u32 s45, s29, 0
s_mov_b32 s46, 1048576
s_mov_b32 s47, 0x20000
s_lshl_b32 s72, s32, 1
s_add_u32 s72, s72, s33
s_lshl_b32 s72, s72, 16
s_lshl_b32 s35, s34, 11
s_add_u32 s72, s72, s35
s_lshl_b32 s26, s2, 2
s_add_u32 s26, s26, s30
s_lshl_b32 s26, s26, 11
s_mov_b32 s79, 0x20000
s_mov_b64 exec, 0
s_cmp_eq_u32 s30, 0
s_cbranch_scc1 L_t0
s_cmp_eq_u32 s30, 1
s_cbranch_scc1 L_t1
s_cmp_eq_u32 s30, 2
s_cbranch_scc1 L_t2
s_cmp_eq_u32 s30, 3
s_cbranch_scc1 L_t3
L_r0:
s_mov_b64 exec, -1
s_add_u32 m0, s58, 4096
s_add_u32 s55, s80, 32768
buffer_load_dwordx4 v1, s[36:39], s55 offen offset:0  lds
s_add_u32 s55, s80, 39936
buffer_load_dwordx4 v2, s[36:39], s55 offen offset:1024  lds
s_add_u32 s55, s80, 47104
buffer_load_dwordx4 v1, s[36:39], s55 offen offset:2048  lds
s_add_u32 s55, s80, 54272
buffer_load_dwordx4 v2, s[36:39], s55 offen offset:3072  lds
s_mov_b64 exec, 0
s_cmp_eq_u32 s30, 0
s_cbranch_scc1 L_t4
s_cmp_eq_u32 s30, 1
s_cbranch_scc1 L_t5
s_cmp_eq_u32 s30, 2
s_cbranch_scc1 L_t6
s_cmp_eq_u32 s30, 3
s_cbranch_scc1 L_t7
L_r1:
s_mov_b64 exec, -1
s_waitcnt vmcnt(8)
v_lshlrev_b32 v24, 16, v16
v_and_b32 v25, 0xffff0000, v16
v_lshlrev_b32 v26, 16, v17
v_and_b32 v27, 0xffff0000, v17
v_lshlrev_b32 v28, 16, v18
v_and_b32 v29, 0xffff0000, v18
v_lshlrev_b32 v30, 16, v19
v_and_b32 v31, 0xffff0000, v19
v_lshlrev_b32 v32, 16, v20
v_and_b32 v33, 0xffff0000, v20
v_lshlrev_b32 v34, 16, v21
v_and_b32 v35, 0xffff0000, v21
v_lshlrev_b32 v36, 16, v22
v_and_b32 v37, 0xffff0000, v22
v_lshlrev_b32 v38, 16, v23
s_add_u32 m0, s57, 16384
s_add_u32 s52, s82, 0
buffer_load_dwordx4 v3, s[64:67], s52 offen offset:0  lds
v_and_b32 v39, 0xffff0000, v23
v_pk_add_f32 v[64:65], v[24:25], v[32:33]
v_pk_add_f32 v[66:67], v[26:27], v[34:35]
v_pk_add_f32 v[68:69], v[28:29], v[36:37]
v_pk_add_f32 v[70:71], v[30:31], v[38:39]
v_pk_add_f32 v[64:65], v[64:65], v[68:69]
v_pk_add_f32 v[66:67], v[66:67], v[70:71]
v_pk_add_f32 v[64:65], v[64:65], v[66:67]
v_add_f32 v40, v64, v65
s_nop 1
v_add_f32_dpp v40, v40, v40 quad_perm:[1,0,3,2] row_mask:0xf bank_mask:0xf
s_nop 1
v_add_f32_dpp v40, v40, v40 quad_perm:[2,3,0,1] row_mask:0xf bank_mask:0xf
s_nop 1
v_add_f32_dpp v40, v40, v40 row_half_mirror row_mask:0xf bank_mask:0xf
s_nop 1
s_add_u32 s52, s82, 64512
buffer_load_dwordx4 v4, s[64:67], s52 offen offset:1024  lds
v_add_f32_dpp v40, v40, v40 row_mirror row_mask:0xf bank_mask:0xf
v_mov_b32 v41, v40
s_nop 1
v_permlane16_swap_b32 v40, v41
v_add_f32 v40, v40, v41
v_mul_f32 v40, 0xbb000000, v40
v_mov_b32 v41, v40
v_pk_add_f32 v[64:65], v[24:25], v[40:41]
v_pk_add_f32 v[66:67], v[26:27], v[40:41]
v_pk_add_f32 v[68:69], v[28:29], v[40:41]
v_pk_add_f32 v[70:71], v[30:31], v[40:41]
v_pk_add_f32 v[72:73], v[32:33], v[40:41]
v_pk_add_f32 v[74:75], v[34:35], v[40:41]
v_pk_add_f32 v[76:77], v[36:37], v[40:41]
v_pk_add_f32 v[78:79], v[38:39], v[40:41]
v_pk_mul_f32 v[42:43], v[64:65], v[64:65]
s_add_u32 s52, s82, 129024
buffer_load_dwordx4 v3, s[64:67], s52 offen offset:2048  lds
v_pk_mul_f32 v[44:45], v[66:67], v[66:67]
v_pk_fma_f32 v[42:43], v[68:69], v[68:69], v[42:43]
v_pk_fma_f32 v[44:45], v[70:71], v[70:71], v[44:45]
v_pk_fma_f32 v[42:43], v[72:73], v[72:73], v[42:43]
v_pk_fma_f32 v[44:45], v[74:75], v[74:75], v[44:45]
v_pk_fma_f32 v[42:43], v[76:77], v[76:77], v[42:43]
v_pk_fma_f32 v[44:45], v[78:79], v[78:79], v[44:45]
v_pk_add_f32 v[42:43], v[42:43], v[44:45]
v_add_f32 v42, v42, v43
s_nop 1
v_add_f32_dpp v42, v42, v42 quad_perm:[1,0,3,2] row_mask:0xf bank_mask:0xf
s_nop 1
v_add_f32_dpp v42, v42, v42 quad_perm:[2,3,0,1] row_mask:0xf bank_mask:0xf
s_nop 1
v_add_f32_dpp v42, v42, v42 row_half_mirror row_mask:0xf bank_mask:0xf
s_nop 1
s_add_u32 s52, s82, 193536
buffer_load_dwordx4 v4, s[64:67], s52 offen offset:3072  lds
v_add_f32_dpp v42, v42, v42 row_mirror row_mask:0xf bank_mask:0xf
v_mov_b32 v43, v42
s_nop 1
v_permlane16_swap_b32 v42, v43
v_add_f32 v42, v42, v43
v_mul_f32 v42, 0x3b000000, v42
v_cvt_pk_bf16_f32 v40, v40, v40
v_lshlrev_b32 v40, 16, v40
v_cvt_pk_bf16_f32 v42, v42, v42
v_lshlrev_b32 v42, 16, v42
v_mov_b32 v41, v40
v_add_f32 v42, 0x3727c5ac, v42
v_cvt_pk_bf16_f32 v42, v42, v42
v_lshlrev_b32 v42, 16, v42
v_sqrt_f32 v42, v42
v_pk_add_f32 v[24:25], v[24:25], v[40:41]
s_add_u32 m0, s58, 32768
s_add_u32 s55, s81, 0
buffer_load_dwordx4 v1, s[36:39], s55 offen offset:0  lds
v_pk_add_f32 v[26:27], v[26:27], v[40:41]
v_pk_add_f32 v[28:29], v[28:29], v[40:41]
v_pk_add_f32 v[30:31], v[30:31], v[40:41]
v_pk_add_f32 v[32:33], v[32:33], v[40:41]
v_pk_add_f32 v[34:35], v[34:35], v[40:41]
v_pk_add_f32 v[36:37], v[36:37], v[40:41]
v_pk_add_f32 v[38:39], v[38:39], v[40:41]
v_cvt_pk_bf16_f32 v42, v42, v42
v_lshlrev_b32 v42, 16, v42
v_rcp_f32 v42, v42
v_cvt_pk_bf16_f32 v16, v24, v25
v_cvt_pk_bf16_f32 v17, v26, v27
v_cvt_pk_bf16_f32 v18, v28, v29
v_cvt_pk_bf16_f32 v19, v30, v31
v_cvt_pk_bf16_f32 v20, v32, v33
v_cvt_pk_bf16_f32 v21, v34, v35
s_add_u32 s55, s81, 7168
buffer_load_dwordx4 v2, s[36:39], s55 offen offset:1024  lds
v_cvt_pk_bf16_f32 v22, v36, v37
v_cvt_pk_bf16_f32 v23, v38, v39
v_mov_b32 v43, v42
v_lshlrev_b32 v24, 16, v16
v_and_b32 v25, 0xffff0000, v16
v_lshlrev_b32 v26, 16, v17
v_and_b32 v27, 0xffff0000, v17
v_lshlrev_b32 v28, 16, v18
v_and_b32 v29, 0xffff0000, v18
v_lshlrev_b32 v30, 16, v19
v_and_b32 v31, 0xffff0000, v19
v_lshlrev_b32 v32, 16, v20
v_and_b32 v33, 0xffff0000, v20
v_lshlrev_b32 v34, 16, v21
v_and_b32 v35, 0xffff0000, v21
v_lshlrev_b32 v36, 16, v22
s_add_u32 s55, s81, 14336
buffer_load_dwordx4 v1, s[36:39], s55 offen offset:2048  lds
v_and_b32 v37, 0xffff0000, v22
v_lshlrev_b32 v38, 16, v23
v_and_b32 v39, 0xffff0000, v23
v_pk_mul_f32 v[24:25], v[24:25], v[42:43]
v_pk_mul_f32 v[26:27], v[26:27], v[42:43]
v_pk_mul_f32 v[28:29], v[28:29], v[42:43]
v_pk_mul_f32 v[30:31], v[30:31], v[42:43]
v_pk_mul_f32 v[32:33], v[32:33], v[42:43]
v_pk_mul_f32 v[34:35], v[34:35], v[42:43]
v_pk_mul_f32 v[36:37], v[36:37], v[42:43]
v_pk_mul_f32 v[38:39], v[38:39], v[42:43]
v_cvt_pk_bf16_f32 v16, v24, v25
v_cvt_pk_bf16_f32 v17, v26, v27
v_cvt_pk_bf16_f32 v18, v28, v29
v_cvt_pk_bf16_f32 v19, v30, v31
v_cvt_pk_bf16_f32 v20, v32, v33
s_add_u32 s55, s81, 21504
buffer_load_dwordx4 v2, s[36:39], s55 offen offset:3072  lds
v_cvt_pk_bf16_f32 v21, v34, v35
v_cvt_pk_bf16_f32 v22, v36, v37
v_cvt_pk_bf16_f32 v23, v38, v39
s_mov_b32 s48, s28
s_mov_b32 s49, s29
v_accvgpr_write_b32 a240, v16
v_accvgpr_write_b32 a241, v17
v_accvgpr_write_b32 a242, v18
v_accvgpr_write_b32 a243, v19
v_accvgpr_write_b32 a244, v20
v_accvgpr_write_b32 a245, v21
v_accvgpr_write_b32 a246, v22
v_accvgpr_write_b32 a247, v23
v_bfe_u32 v40, v48, 11, 3
v_bfe_u32 v41, v48, 4, 3
v_xor_b32 v40, v40, v41
v_and_b32 v41, 0xffffe000, v48
v_lshl_add_u32 v40, v40, 4, v41
v_bfe_u32 v41, v48, 10, 3
v_lshl_add_u32 v40, v41, 7, v40
v_bfe_u32 v41, v48, 7, 2
v_lshl_add_u32 v8, v41, 10, v40
s_waitcnt vmcnt(8)
s_barrier
ds_read_b64_tr_b16 a[0:1], v9 offset:0
ds_read_b64_tr_b16 a[2:3], v9 offset:512
ds_read_b128 a[32:35], v5 offset:0
ds_read_b64_tr_b16 a[16:17], v9 offset:8192
ds_read_b64_tr_b16 a[18:19], v9 offset:8704
ds_read_b128 a[48:51], v6 offset:0
ds_read_b64_tr_b16 a[4:5], v10 offset:0
ds_read_b64_tr_b16 a[6:7], v10 offset:512
ds_read_b128 a[36:39], v5 offset:2048
ds_read_b64_tr_b16 a[20:21], v10 offset:8192
ds_read_b64_tr_b16 a[22:23], v10 offset:8704
ds_read_b128 a[52:55], v6 offset:2048
ds_read_b64_tr_b16 a[8:9], v11 offset:0
ds_read_b64_tr_b16 a[10:11], v11 offset:512
ds_read_b128 a[40:43], v5 offset:4096
ds_read_b64_tr_b16 a[24:25], v11 offset:8192
ds_read_b64_tr_b16 a[26:27], v11 offset:8704
ds_read_b128 a[56:59], v6 offset:4096
ds_read_b64_tr_b16 a[12:13], v12 offset:0
ds_read_b64_tr_b16 a[14:15], v12 offset:512
ds_read_b128 a[44:47], v5 offset:6144
ds_read_b64_tr_b16 a[28:29], v12 offset:8192
ds_read_b64_tr_b16 a[30:31], v12 offset:8704
ds_read_b128 a[60:63], v6 offset:6144
s_add_u32 m0, s58, 36864
s_add_u32 s55, s81, 32768
buffer_load_dwordx4 v1, s[36:39], s55 offen offset:0  lds
s_add_u32 s55, s81, 39936
buffer_load_dwordx4 v2, s[36:39], s55 offen offset:1024  lds
s_add_u32 s55, s81, 47104
buffer_load_dwordx4 v1, s[36:39], s55 offen offset:2048  lds
s_add_u32 s55, s81, 54272
buffer_load_dwordx4 v2, s[36:39], s55 offen offset:3072  lds
s_and_b32 s35, s2, 1
s_lshl2_add_u32 s35, s35, s30
s_mov_b64 exec, 0
s_cmp_eq_u32 s35, 0
s_cbranch_scc1 L_t9
s_cmp_eq_u32 s35, 4
s_cbranch_scc1 L_t8
s_cmp_eq_u32 s35, 1
s_cbranch_scc1 L_t10
s_cmp_eq_u32 s35, 5
s_cbranch_scc1 L_t11
s_cmp_eq_u32 s30, 2
s_cbranch_scc1 L_t12
s_cmp_eq_u32 s30, 3
s_cbranch_scc1 L_t13
L_r2:
s_mov_b64 exec, -1
s_add_u32 m0, s57, 32768
s_add_u32 s52, s83, 0
buffer_load_dwordx4 v3, s[40:43], s52 offen offset:0  lds
s_add_u32 s52, s83, 64512
buffer_load_dwordx4 v4, s[40:43], s52 offen offset:1024  lds
s_add_u32 s52, s83, 129024
buffer_load_dwordx4 v3, s[40:43], s52 offen offset:2048  lds
s_add_u32 s52, s83, 193536
buffer_load_dwordx4 v4, s[40:43], s52 offen offset:3072  lds
s_waitcnt vmcnt(12) lgkmcnt(0)
s_barrier
v_mfma_f32_16x16x32_bf16 v[128:131], a[0:3], a[32:35], 0
s_add_u32 m0, s57, 49152
s_add_u32 s52, s83, 0
v_mfma_f32_16x16x32_bf16 v[128:131], a[16:19], a[48:51], v[128:131]
buffer_load_dwordx4 v3, s[64:67], s52 offen offset:0  lds
v_mfma_f32_16x16x32_bf16 v[136:139], a[20:23], a[48:51], 0
ds_read_b128 a[64:67], v5 offset:8192
ds_read_b128 a[80:83], v6 offset:8192
v_mfma_f32_16x16x32_bf16 v[136:139], a[4:7], a[32:35], v[136:139]
v_mfma_f32_16x16x32_bf16 v[132:135], a[8:11], a[32:35], 0
ds_read_b128 a[68:71], v5 offset:10240
v_mfma_f32_16x16x32_bf16 v[132:135], a[24:27], a[48:51], v[132:135]
s_add_u32 s52, s83, 64512
v_mfma_f32_16x16x32_bf16 v[140:143], a[28:31], a[48:51], 0
buffer_load_dwordx4 v4, s[64:67], s52 offen offset:1024  lds
v_mfma_f32_16x16x32_bf16 v[140:143], a[12:15], a[32:35], v[140:143]
v_mfma_f32_16x16x32_bf16 v[144:147], a[12:15], a[36:39], 0
ds_read_b128 a[84:87], v6 offset:10240
v_mfma_f32_16x16x32_bf16 v[144:147], a[28:31], a[52:55], v[144:147]
v_mfma_f32_16x16x32_bf16 v[16:19], a[24:27], a[52:55], 0
ds_read_b128 a[72:75], v5 offset:12288
v_mfma_f32_16x16x32_bf16 v[16:19], a[8:11], a[36:39], v[16:19]
s_add_u32 s52, s83, 129024
v_mfma_f32_16x16x32_bf16 v[148:151], a[4:7], a[36:39], 0
buffer_load_dwordx4 v3, s[64:67], s52 offen offset:2048  lds
v_mfma_f32_16x16x32_bf16 v[148:151], a[20:23], a[52:55], v[148:151]
v_mfma_f32_16x16x32_bf16 v[20:23], a[16:19], a[52:55], 0
ds_read_b128 a[88:91], v6 offset:12288
v_mfma_f32_16x16x32_bf16 v[20:23], a[0:3], a[36:39], v[20:23]
v_mfma_f32_16x16x32_bf16 a[128:131], a[0:3], a[40:43], 0
ds_read_b128 a[76:79], v5 offset:14336
v_mfma_f32_16x16x32_bf16 a[128:131], a[16:19], a[56:59], a[128:131]
s_add_u32 s52, s83, 193536
v_mfma_f32_16x16x32_bf16 a[132:135], a[20:23], a[56:59], 0
buffer_load_dwordx4 v4, s[64:67], s52 offen offset:3072  lds
v_mfma_f32_16x16x32_bf16 a[132:135], a[4:7], a[40:43], a[132:135]
v_mfma_f32_16x16x32_bf16 a[136:139], a[8:11], a[40:43], 0
ds_read_b128 a[92:95], v6 offset:14336
v_mfma_f32_16x16x32_bf16 a[136:139], a[24:27], a[56:59], a[136:139]
v_mfma_f32_16x16x32_bf16 a[140:143], a[28:31], a[56:59], 0
v_mfma_f32_16x16x32_bf16 a[140:143], a[12:15], a[40:43], a[140:143]
s_add_u32 m0, s58, 65536
s_add_u32 s55, s80, 512
v_mfma_f32_16x16x32_bf16 v[152:155], a[12:15], a[44:47], 0
buffer_load_dwordx4 v1, s[36:39], s55 offen offset:0  lds
v_mfma_f32_16x16x32_bf16 v[152:155], a[28:31], a[60:63], v[152:155]
s_add_u32 s55, s80, 7680
v_mfma_f32_16x16x32_bf16 v[24:27], a[24:27], a[60:63], 0
buffer_load_dwordx4 v2, s[36:39], s55 offen offset:1024  lds
v_mfma_f32_16x16x32_bf16 v[24:27], a[8:11], a[44:47], v[24:27]
v_mfma_f32_16x16x32_bf16 v[156:159], a[4:7], a[44:47], 0
ds_read_b64_tr_b16 a[96:97], v13 offset:16384
ds_read_b64_tr_b16 a[98:99], v13 offset:16896
v_mfma_f32_16x16x32_bf16 v[156:159], a[20:23], a[60:63], v[156:159]
s_branch L_t0
.p2align 12
L_t0:
s_cbranch_execz L_r0
v_mfma_f32_16x16x32_bf16 v[28:31], a[16:19], a[60:63], 0
s_waitcnt lgkmcnt(2)
ds_read_b64_tr_b16 a[112:113], v13 offset:24576
ds_read_b64_tr_b16 a[114:115], v13 offset:25088
v_mfma_f32_16x16x32_bf16 v[28:31], a[0:3], a[44:47], v[28:31]
s_add_u32 s55, s80, 14848
v_mfma_f32_16x16x32_bf16 v[32:35], a[0:3], a[64:67], 0
buffer_load_dwordx4 v1, s[36:39], s55 offen offset:2048  lds
v_mfma_f32_16x16x32_bf16 v[32:35], a[16:19], a[80:83], v[32:35]
v_mfma_f32_16x16x32_bf16 v[160:163], a[20:23], a[80:83], 0
ds_read_b64_tr_b16 a[100:101], v14 offset:16384
ds_read_b64_tr_b16 a[102:103], v14 offset:16896
v_mfma_f32_16x16x32_bf16 v[160:163], a[4:7], a[64:67], v[160:163]
v_mfma_f32_16x16x32_bf16 v[36:39], a[8:11], a[64:67], 0
ds_read_b64_tr_b16 a[116:117], v14 offset:24576
ds_read_b64_tr_b16 a[118:119], v14 offset:25088
v_mfma_f32_16x16x32_bf16 v[36:39], a[24:27], a[80:83], v[36:39]
s_add_u32 s55, s80, 22016
v_mfma_f32_16x16x32_bf16 v[164:167], a[28:31], a[80:83], 0
buffer_load_dwordx4 v2, s[36:39], s55 offen offset:3072  lds
v_mfma_f32_16x16x32_bf16 v[164:167], a[12:15], a[64:67], v[164:167]
v_mfma_f32_16x16x32_bf16 v[168:171], a[12:15], a[68:71], 0
ds_read_b64_tr_b16 a[104:105], v13 offset:20480
ds_read_b64_tr_b16 a[106:107], v13 offset:20992
v_mfma_f32_16x16x32_bf16 v[168:171], a[28:31], a[84:87], v[168:171]
v_mfma_f32_16x16x32_bf16 v[40:43], a[24:27], a[84:87], 0
ds_read_b64_tr_b16 a[120:121], v13 offset:28672
ds_read_b64_tr_b16 a[122:123], v13 offset:29184
v_mfma_f32_16x16x32_bf16 v[40:43], a[8:11], a[68:71], v[40:43]
s_add_u32 m0, s58, 69632
s_add_u32 s55, s80, 33280
v_mfma_f32_16x16x32_bf16 v[172:175], a[4:7], a[68:71], 0
buffer_load_dwordx4 v1, s[36:39], s55 offen offset:0  lds
v_mfma_f32_16x16x32_bf16 v[172:175], a[20:23], a[84:87], v[172:175]
v_mfma_f32_16x16x32_bf16 v[44:47], a[16:19], a[84:87], 0
ds_read_b64_tr_b16 a[108:109], v14 offset:20480
ds_read_b64_tr_b16 a[110:111], v14 offset:20992
v_mfma_f32_16x16x32_bf16 v[44:47], a[0:3], a[68:71], v[44:47]
v_mfma_f32_16x16x32_bf16 v[48:51], a[0:3], a[72:75], 0
ds_read_b64_tr_b16 a[124:125], v14 offset:28672
ds_read_b64_tr_b16 a[126:127], v14 offset:29184
v_mfma_f32_16x16x32_bf16 v[48:51], a[16:19], a[88:91], v[48:51]
s_add_u32 s55, s80, 40448
v_mfma_f32_16x16x32_bf16 v[176:179], a[20:23], a[88:91], 0
buffer_load_dwordx4 v2, s[36:39], s55 offen offset:1024  lds
v_mfma_f32_16x16x32_bf16 v[176:179], a[4:7], a[72:75], v[176:179]
s_add_u32 s55, s80, 47616
v_mfma_f32_16x16x32_bf16 v[52:55], a[8:11], a[72:75], 0
buffer_load_dwordx4 v1, s[36:39], s55 offen offset:2048  lds
v_mfma_f32_16x16x32_bf16 v[52:55], a[24:27], a[88:91], v[52:55]
s_add_u32 s55, s80, 54784
v_mfma_f32_16x16x32_bf16 v[180:183], a[28:31], a[88:91], 0
buffer_load_dwordx4 v2, s[36:39], s55 offen offset:3072  lds
v_mfma_f32_16x16x32_bf16 v[180:183], a[12:15], a[72:75], v[180:183]
v_mfma_f32_16x16x32_bf16 v[184:187], a[12:15], a[76:79], 0
v_mfma_f32_16x16x32_bf16 v[184:187], a[28:31], a[92:95], v[184:187]
v_mfma_f32_16x16x32_bf16 v[56:59], a[24:27], a[92:95], 0
v_mfma_f32_16x16x32_bf16 v[56:59], a[8:11], a[76:79], v[56:59]
v_mfma_f32_16x16x32_bf16 v[188:191], a[4:7], a[76:79], 0
v_mfma_f32_16x16x32_bf16 v[188:191], a[20:23], a[92:95], v[188:191]
v_mfma_f32_16x16x32_bf16 v[60:63], a[16:19], a[92:95], 0
s_waitcnt vmcnt(12) lgkmcnt(0)
v_mfma_f32_16x16x32_bf16 v[60:63], a[0:3], a[76:79], v[60:63]
s_barrier
v_mfma_f32_16x16x32_bf16 v[64:67], a[64:67], a[96:99], 0
v_mfma_f32_16x16x32_bf16 v[64:67], a[80:83], a[112:115], v[64:67]
v_mfma_f32_16x16x32_bf16 v[192:195], a[84:87], a[112:115], 0
s_load_dword s3, s[16:17], 0
ds_read_b64_tr_b16 a[0:1], v9 offset:32768
ds_read_b64_tr_b16 a[2:3], v9 offset:33280
v_mfma_f32_16x16x32_bf16 v[192:195], a[68:71], a[96:99], v[192:195]
v_mfma_f32_16x16x32_bf16 v[68:71], a[72:75], a[96:99], 0
ds_read_b64_tr_b16 a[16:17], v9 offset:40960
ds_read_b64_tr_b16 a[18:19], v9 offset:41472
v_mfma_f32_16x16x32_bf16 v[68:71], a[88:91], a[112:115], v[68:71]
s_add_u32 m0, s57, 0
s_add_u32 s52, s82, 2097152
v_mfma_f32_16x16x32_bf16 v[196:199], a[92:95], a[112:115], 0
buffer_load_dwordx4 v3, s[40:43], s52 offen offset:0  lds
v_mfma_f32_16x16x32_bf16 v[196:199], a[76:79], a[96:99], v[196:199]
v_mfma_f32_16x16x32_bf16 v[200:203], a[76:79], a[100:103], 0
ds_read_b64_tr_b16 a[4:5], v10 offset:32768
ds_read_b64_tr_b16 a[6:7], v10 offset:33280
v_mfma_f32_16x16x32_bf16 v[200:203], a[92:95], a[116:119], v[200:203]
v_mfma_f32_16x16x32_bf16 v[72:75], a[88:91], a[116:119], 0
ds_read_b64_tr_b16 a[20:21], v10 offset:40960
ds_read_b64_tr_b16 a[22:23], v10 offset:41472
v_mfma_f32_16x16x32_bf16 v[72:75], a[72:75], a[100:103], v[72:75]
s_add_u32 s52, s82, 2161664
v_mfma_f32_16x16x32_bf16 v[204:207], a[68:71], a[100:103], 0
buffer_load_dwordx4 v4, s[40:43], s52 offen offset:1024  lds
v_mfma_f32_16x16x32_bf16 v[204:207], a[84:87], a[116:119], v[204:207]
v_mfma_f32_16x16x32_bf16 v[76:79], a[80:83], a[116:119], 0
ds_read_b64_tr_b16 a[8:9], v11 offset:32768
ds_read_b64_tr_b16 a[10:11], v11 offset:33280
v_mfma_f32_16x16x32_bf16 v[76:79], a[64:67], a[100:103], v[76:79]
v_mfma_f32_16x16x32_bf16 v[80:83], a[64:67], a[104:107], 0
ds_read_b64_tr_b16 a[24:25], v11 offset:40960
ds_read_b64_tr_b16 a[26:27], v11 offset:41472
v_mfma_f32_16x16x32_bf16 v[80:83], a[80:83], a[120:123], v[80:83]
s_add_u32 s52, s82, 2226176
v_mfma_f32_16x16x32_bf16 v[208:211], a[84:87], a[120:123], 0
buffer_load_dwordx4 v3, s[40:43], s52 offen offset:2048  lds
v_mfma_f32_16x16x32_bf16 v[208:211], a[68:71], a[104:107], v[208:211]
v_mfma_f32_16x16x32_bf16 v[84:87], a[72:75], a[104:107], 0
ds_read_b64_tr_b16 a[12:13], v12 offset:32768
ds_read_b64_tr_b16 a[14:15], v12 offset:33280
v_mfma_f32_16x16x32_bf16 v[84:87], a[88:91], a[120:123], v[84:87]
v_mfma_f32_16x16x32_bf16 v[212:215], a[92:95], a[120:123], 0
ds_read_b64_tr_b16 a[28:29], v12 offset:40960
ds_read_b64_tr_b16 a[30:31], v12 offset:41472
v_mfma_f32_16x16x32_bf16 v[212:215], a[76:79], a[104:107], v[212:215]
s_add_u32 s52, s82, 2290688
v_mfma_f32_16x16x32_bf16 v[216:219], a[76:79], a[108:111], 0
buffer_load_dwordx4 v4, s[40:43], s52 offen offset:3072  lds
v_mfma_f32_16x16x32_bf16 v[216:219], a[92:95], a[124:127], v[216:219]
v_mfma_f32_16x16x32_bf16 v[88:91], a[88:91], a[124:127], 0
v_mfma_f32_16x16x32_bf16 v[88:91], a[72:75], a[108:111], v[88:91]
v_mfma_f32_16x16x32_bf16 v[220:223], a[68:71], a[108:111], 0
v_mfma_f32_16x16x32_bf16 v[220:223], a[84:87], a[124:127], v[220:223]
v_mfma_f32_16x16x32_bf16 v[92:95], a[80:83], a[124:127], 0
v_mfma_f32_16x16x32_bf16 v[92:95], a[64:67], a[108:111], v[92:95]
s_add_u32 m0, s57, 16384
s_add_u32 s52, s82, 2097152
v_mfma_f32_16x16x32_bf16 v[96:99], a[32:35], a[108:111], 0
buffer_load_dwordx4 v3, s[64:67], s52 offen offset:0  lds
v_mfma_f32_16x16x32_bf16 v[96:99], a[48:51], a[124:127], v[96:99]
v_mfma_f32_16x16x32_bf16 v[224:227], a[52:55], a[124:127], 0
ds_read_b128 a[64:67], v5 offset:32768
ds_read_b128 a[80:83], v6 offset:32768
v_mfma_f32_16x16x32_bf16 v[224:227], a[36:39], a[108:111], v[224:227]
v_mfma_f32_16x16x32_bf16 v[100:103], a[40:43], a[108:111], 0
ds_read_b128 a[68:71], v5 offset:34816
v_mfma_f32_16x16x32_bf16 v[100:103], a[56:59], a[124:127], v[100:103]
s_add_u32 s52, s82, 2161664
v_mfma_f32_16x16x32_bf16 v[228:231], a[60:63], a[124:127], 0
buffer_load_dwordx4 v4, s[64:67], s52 offen offset:1024  lds
v_mfma_f32_16x16x32_bf16 v[228:231], a[44:47], a[108:111], v[228:231]
v_mfma_f32_16x16x32_bf16 v[232:235], a[44:47], a[104:107], 0
ds_read_b128 a[84:87], v6 offset:34816
ds_read_b128 a[72:75], v5 offset:36864
v_mfma_f32_16x16x32_bf16 v[232:235], a[60:63], a[120:123], v[232:235]
v_mfma_f32_16x16x32_bf16 v[104:107], a[56:59], a[120:123], 0
ds_read_b128 a[88:91], v6 offset:36864
v_mfma_f32_16x16x32_bf16 v[104:107], a[40:43], a[104:107], v[104:107]
s_add_u32 s52, s82, 2226176
v_mfma_f32_16x16x32_bf16 v[236:239], a[36:39], a[104:107], 0
buffer_load_dwordx4 v3, s[64:67], s52 offen offset:2048  lds
v_mfma_f32_16x16x32_bf16 v[236:239], a[52:55], a[120:123], v[236:239]
v_mfma_f32_16x16x32_bf16 v[108:111], a[48:51], a[120:123], 0
ds_read_b128 a[76:79], v5 offset:38912
v_mfma_f32_16x16x32_bf16 v[108:111], a[32:35], a[104:107], v[108:111]
v_mfma_f32_16x16x32_bf16 v[112:115], a[32:35], a[100:103], 0
ds_read_b128 a[92:95], v6 offset:38912
v_mfma_f32_16x16x32_bf16 v[112:115], a[48:51], a[116:119], v[112:115]
s_add_u32 s52, s82, 2290688
v_mfma_f32_16x16x32_bf16 v[240:243], a[52:55], a[116:119], 0
buffer_load_dwordx4 v4, s[64:67], s52 offen offset:3072  lds
v_mfma_f32_16x16x32_bf16 v[240:243], a[36:39], a[100:103], v[240:243]
v_mfma_f32_16x16x32_bf16 v[116:119], a[40:43], a[100:103], 0
v_mfma_f32_16x16x32_bf16 v[116:119], a[56:59], a[116:119], v[116:119]
v_mfma_f32_16x16x32_bf16 v[244:247], a[60:63], a[116:119], 0
v_mfma_f32_16x16x32_bf16 v[244:247], a[44:47], a[100:103], v[244:247]
v_mfma_f32_16x16x32_bf16 v[248:251], a[44:47], a[96:99], 0
v_mfma_f32_16x16x32_bf16 v[248:251], a[60:63], a[112:115], v[248:251]
v_mfma_f32_16x16x32_bf16 v[120:123], a[56:59], a[112:115], 0
v_mfma_f32_16x16x32_bf16 v[120:123], a[40:43], a[96:99], v[120:123]
v_mfma_f32_16x16x32_bf16 v[252:255], a[36:39], a[96:99], 0
v_mfma_f32_16x16x32_bf16 v[252:255], a[52:55], a[112:115], v[252:255]
v_mfma_f32_16x16x32_bf16 v[124:127], a[48:51], a[112:115], 0
s_waitcnt vmcnt(16) lgkmcnt(0)
v_mfma_f32_16x16x32_bf16 v[124:127], a[32:35], a[96:99], v[124:127]
s_barrier
v_mfma_f32_16x16x32_bf16 v[128:131], a[0:3], a[64:67], v[128:131]
s_mul_i32 s3, s3, 1664525
v_mfma_f32_16x16x32_bf16 v[128:131], a[16:19], a[80:83], v[128:131]
s_add_u32 s3, s3, 1013904223
v_mfma_f32_16x16x32_bf16 v[136:139], a[20:23], a[80:83], v[136:139]
ds_read_b128 a[32:35], v5 offset:40960
ds_read_b128 a[48:51], v6 offset:40960
v_mfma_f32_16x16x32_bf16 v[136:139], a[4:7], a[64:67], v[136:139]
v_mfma_f32_16x16x32_bf16 v[132:135], a[8:11], a[64:67], v[132:135]
ds_read_b128 a[36:39], v5 offset:43008
v_mfma_f32_16x16x32_bf16 v[132:135], a[24:27], a[80:83], v[132:135]
s_add_u32 m0, s58, 0
s_add_u32 s55, s81, 512
v_mfma_f32_16x16x32_bf16 v[140:143], a[28:31], a[80:83], v[140:143]
buffer_load_dwordx4 v1, s[36:39], s55 offen offset:0  lds
v_mfma_f32_16x16x32_bf16 v[140:143], a[12:15], a[64:67], v[140:143]
v_mfma_f32_16x16x32_bf16 v[144:147], a[12:15], a[68:71], v[144:147]
ds_read_b128 a[52:55], v6 offset:43008
v_mfma_f32_16x16x32_bf16 v[144:147], a[28:31], a[84:87], v[144:147]
v_mfma_f32_16x16x32_bf16 v[16:19], a[24:27], a[84:87], v[16:19]
ds_read_b128 a[40:43], v5 offset:45056
v_mfma_f32_16x16x32_bf16 v[16:19], a[8:11], a[68:71], v[16:19]
s_add_u32 s55, s81, 7680
v_mfma_f32_16x16x32_bf16 v[148:151], a[4:7], a[68:71], v[148:151]
buffer_load_dwordx4 v2, s[36:39], s55 offen offset:1024  lds
v_mfma_f32_16x16x32_bf16 v[148:151], a[20:23], a[84:87], v[148:151]
v_mfma_f32_16x16x32_bf16 v[20:23], a[16:19], a[84:87], v[20:23]
ds_read_b128 a[56:59], v6 offset:45056
v_mfma_f32_16x16x32_bf16 v[20:23], a[0:3], a[68:71], v[20:23]
v_mfma_f32_16x16x32_bf16 a[128:131], a[0:3], a[72:75], a[128:131]
ds_read_b128 a[44:47], v5 offset:47104
v_mfma_f32_16x16x32_bf16 a[128:131], a[16:19], a[88:91], a[128:131]
s_add_u32 s55, s81, 14848
v_mfma_f32_16x16x32_bf16 a[132:135], a[20:23], a[88:91], a[132:135]
buffer_load_dwordx4 v1, s[36:39], s55 offen offset:2048  lds
v_mfma_f32_16x16x32_bf16 a[132:135], a[4:7], a[72:75], a[132:135]
v_mfma_f32_16x16x32_bf16 a[136:139], a[8:11], a[72:75], a[136:139]
ds_read_b128 a[60:63], v6 offset:47104
v_mfma_f32_16x16x32_bf16 a[136:139], a[24:27], a[88:91], a[136:139]
v_mfma_f32_16x16x32_bf16 a[140:143], a[28:31], a[88:91], a[140:143]
v_mfma_f32_16x16x32_bf16 a[140:143], a[12:15], a[72:75], a[140:143]
s_add_u32 s55, s81, 22016
v_mfma_f32_16x16x32_bf16 v[152:155], a[12:15], a[76:79], v[152:155]
buffer_load_dwordx4 v2, s[36:39], s55 offen offset:3072  lds
v_mfma_f32_16x16x32_bf16 v[152:155], a[28:31], a[92:95], v[152:155]
v_mfma_f32_16x16x32_bf16 v[24:27], a[24:27], a[92:95], v[24:27]
v_mfma_f32_16x16x32_bf16 v[24:27], a[8:11], a[76:79], v[24:27]
v_mfma_f32_16x16x32_bf16 v[156:159], a[4:7], a[76:79], v[156:159]
ds_read_b64_tr_b16 a[96:97], v13 offset:49152
ds_read_b64_tr_b16 a[98:99], v13 offset:49664
v_mfma_f32_16x16x32_bf16 v[156:159], a[20:23], a[92:95], v[156:159]
v_mfma_f32_16x16x32_bf16 v[28:31], a[16:19], a[92:95], v[28:31]
s_waitcnt lgkmcnt(2)
ds_read_b64_tr_b16 a[112:113], v13 offset:57344
ds_read_b64_tr_b16 a[114:115], v13 offset:57856
v_mfma_f32_16x16x32_bf16 v[28:31], a[0:3], a[76:79], v[28:31]
s_add_u32 m0, s58, 4096
s_add_u32 s55, s81, 33280
v_mfma_f32_16x16x32_bf16 v[32:35], a[0:3], a[32:35], v[32:35]
buffer_load_dwordx4 v1, s[36:39], s55 offen offset:0  lds
v_mfma_f32_16x16x32_bf16 v[32:35], a[16:19], a[48:51], v[32:35]
v_mfma_f32_16x16x32_bf16 v[160:163], a[20:23], a[48:51], v[160:163]
ds_read_b64_tr_b16 a[100:101], v14 offset:49152
ds_read_b64_tr_b16 a[102:103], v14 offset:49664
v_mfma_f32_16x16x32_bf16 v[160:163], a[4:7], a[32:35], v[160:163]
v_mfma_f32_16x16x32_bf16 v[36:39], a[8:11], a[32:35], v[36:39]
ds_read_b64_tr_b16 a[116:117], v14 offset:57344
ds_read_b64_tr_b16 a[118:119], v14 offset:57856
v_mfma_f32_16x16x32_bf16 v[36:39], a[24:27], a[48:51], v[36:39]
s_add_u32 s55, s81, 40448
v_mfma_f32_16x16x32_bf16 v[164:167], a[28:31], a[48:51], v[164:167]
buffer_load_dwordx4 v2, s[36:39], s55 offen offset:1024  lds
v_mfma_f32_16x16x32_bf16 v[164:167], a[12:15], a[32:35], v[164:167]
v_mfma_f32_16x16x32_bf16 v[168:171], a[12:15], a[36:39], v[168:171]
ds_read_b64_tr_b16 a[104:105], v13 offset:53248
ds_read_b64_tr_b16 a[106:107], v13 offset:53760
v_mfma_f32_16x16x32_bf16 v[168:171], a[28:31], a[52:55], v[168:171]
v_mfma_f32_16x16x32_bf16 v[40:43], a[24:27], a[52:55], v[40:43]
ds_read_b64_tr_b16 a[120:121], v13 offset:61440
ds_read_b64_tr_b16 a[122:123], v13 offset:61952
v_mfma_f32_16x16x32_bf16 v[40:43], a[8:11], a[36:39], v[40:43]
s_add_u32 s55, s81, 47616
v_mfma_f32_16x16x32_bf16 v[172:175], a[4:7], a[36:39], v[172:175]
buffer_load_dwordx4 v1, s[36:39], s55 offen offset:2048  lds
v_mfma_f32_16x16x32_bf16 v[172:175], a[20:23], a[52:55], v[172:175]
v_mfma_f32_16x16x32_bf16 v[44:47], a[16:19], a[52:55], v[44:47]
ds_read_b64_tr_b16 a[108:109], v14 offset:53248
ds_read_b64_tr_b16 a[110:111], v14 offset:53760
v_mfma_f32_16x16x32_bf16 v[44:47], a[0:3], a[36:39], v[44:47]
v_mfma_f32_16x16x32_bf16 v[48:51], a[0:3], a[40:43], v[48:51]
ds_read_b64_tr_b16 a[124:125], v14 offset:61440
ds_read_b64_tr_b16 a[126:127], v14 offset:61952
v_mfma_f32_16x16x32_bf16 v[48:51], a[16:19], a[56:59], v[48:51]
s_add_u32 s55, s81, 54784
v_mfma_f32_16x16x32_bf16 v[176:179], a[20:23], a[56:59], v[176:179]
buffer_load_dwordx4 v2, s[36:39], s55 offen offset:3072  lds
v_mfma_f32_16x16x32_bf16 v[176:179], a[4:7], a[40:43], v[176:179]
v_mfma_f32_16x16x32_bf16 v[52:55], a[8:11], a[40:43], v[52:55]
v_mfma_f32_16x16x32_bf16 v[52:55], a[24:27], a[56:59], v[52:55]
v_mfma_f32_16x16x32_bf16 v[180:183], a[28:31], a[56:59], v[180:183]
v_mfma_f32_16x16x32_bf16 v[180:183], a[12:15], a[40:43], v[180:183]
v_mfma_f32_16x16x32_bf16 v[184:187], a[12:15], a[44:47], v[184:187]
v_mfma_f32_16x16x32_bf16 v[184:187], a[28:31], a[60:63], v[184:187]
buffer_store_dwordx4 a[240:243], v8, s[48:51], 0 offen sc1
v_mfma_f32_16x16x32_bf16 v[56:59], a[24:27], a[60:63], v[56:59]
v_mfma_f32_16x16x32_bf16 v[56:59], a[8:11], a[44:47], v[56:59]
s_movk_i32 s35, 4096
v_mfma_f32_16x16x32_bf16 v[188:191], a[4:7], a[44:47], v[188:191]
v_mfma_f32_16x16x32_bf16 v[188:191], a[20:23], a[60:63], v[188:191]
buffer_store_dwordx4 a[244:247], v8, s[48:51], s35 offen sc1
v_mfma_f32_16x16x32_bf16 v[60:63], a[16:19], a[60:63], v[60:63]
s_waitcnt vmcnt(14) lgkmcnt(0)
v_mfma_f32_16x16x32_bf16 v[60:63], a[0:3], a[44:47], v[60:63]
s_barrier
v_mfma_f32_16x16x32_bf16 v[64:67], a[32:35], a[96:99], v[64:67]
v_mfma_f32_16x16x32_bf16 v[64:67], a[48:51], a[112:115], v[64:67]
v_mfma_f32_16x16x32_bf16 v[192:195], a[52:55], a[112:115], v[192:195]
ds_read_b64_tr_b16 a[0:1], v9 offset:0
ds_read_b64_tr_b16 a[2:3], v9 offset:512
v_mfma_f32_16x16x32_bf16 v[192:195], a[36:39], a[96:99], v[192:195]
v_mfma_f32_16x16x32_bf16 v[68:71], a[40:43], a[96:99], v[68:71]
ds_read_b64_tr_b16 a[16:17], v9 offset:8192
ds_read_b64_tr_b16 a[18:19], v9 offset:8704
v_mfma_f32_16x16x32_bf16 v[68:71], a[56:59], a[112:115], v[68:71]
s_add_u32 m0, s57, 32768
s_add_u32 s52, s83, 2097152
v_mfma_f32_16x16x32_bf16 v[196:199], a[60:63], a[112:115], v[196:199]
buffer_load_dwordx4 v3, s[40:43], s52 offen offset:0  lds
v_mfma_f32_16x16x32_bf16 v[196:199], a[44:47], a[96:99], v[196:199]
v_mfma_f32_16x16x32_bf16 v[200:203], a[44:47], a[100:103], v[200:203]
ds_read_b64_tr_b16 a[4:5], v10 offset:0
ds_read_b64_tr_b16 a[6:7], v10 offset:512
v_mfma_f32_16x16x32_bf16 v[200:203], a[60:63], a[116:119], v[200:203]
v_mfma_f32_16x16x32_bf16 v[72:75], a[56:59], a[116:119], v[72:75]
ds_read_b64_tr_b16 a[20:21], v10 offset:8192
ds_read_b64_tr_b16 a[22:23], v10 offset:8704
v_mfma_f32_16x16x32_bf16 v[72:75], a[40:43], a[100:103], v[72:75]
s_add_u32 s52, s83, 2161664
v_mfma_f32_16x16x32_bf16 v[204:207], a[36:39], a[100:103], v[204:207]
buffer_load_dwordx4 v4, s[40:43], s52 offen offset:1024  lds
v_mfma_f32_16x16x32_bf16 v[204:207], a[52:55], a[116:119], v[204:207]
v_mfma_f32_16x16x32_bf16 v[76:79], a[48:51], a[116:119], v[76:79]
ds_read_b64_tr_b16 a[8:9], v11 offset:0
ds_read_b64_tr_b16 a[10:11], v11 offset:512
v_mfma_f32_16x16x32_bf16 v[76:79], a[32:35], a[100:103], v[76:79]
v_mfma_f32_16x16x32_bf16 v[80:83], a[32:35], a[104:107], v[80:83]
ds_read_b64_tr_b16 a[24:25], v11 offset:8192
ds_read_b64_tr_b16 a[26:27], v11 offset:8704
v_mfma_f32_16x16x32_bf16 v[80:83], a[48:51], a[120:123], v[80:83]
s_add_u32 s52, s83, 2226176
v_mfma_f32_16x16x32_bf16 v[208:211], a[52:55], a[120:123], v[208:211]
buffer_load_dwordx4 v3, s[40:43], s52 offen offset:2048  lds
v_mfma_f32_16x16x32_bf16 v[208:211], a[36:39], a[104:107], v[208:211]
v_mfma_f32_16x16x32_bf16 v[84:87], a[40:43], a[104:107], v[84:87]
ds_read_b64_tr_b16 a[12:13], v12 offset:0
ds_read_b64_tr_b16 a[14:15], v12 offset:512
v_mfma_f32_16x16x32_bf16 v[84:87], a[56:59], a[120:123], v[84:87]
v_mfma_f32_16x16x32_bf16 v[212:215], a[60:63], a[120:123], v[212:215]
ds_read_b64_tr_b16 a[28:29], v12 offset:8192
ds_read_b64_tr_b16 a[30:31], v12 offset:8704
v_mfma_f32_16x16x32_bf16 v[212:215], a[44:47], a[104:107], v[212:215]
s_add_u32 s52, s83, 2290688
v_mfma_f32_16x16x32_bf16 v[216:219], a[44:47], a[108:111], v[216:219]
buffer_load_dwordx4 v4, s[40:43], s52 offen offset:3072  lds
v_mfma_f32_16x16x32_bf16 v[216:219], a[60:63], a[124:127], v[216:219]
v_mfma_f32_16x16x32_bf16 v[88:91], a[56:59], a[124:127], v[88:91]
v_mfma_f32_16x16x32_bf16 v[88:91], a[40:43], a[108:111], v[88:91]
v_mfma_f32_16x16x32_bf16 v[220:223], a[36:39], a[108:111], v[220:223]
v_mfma_f32_16x16x32_bf16 v[220:223], a[52:55], a[124:127], v[220:223]
v_mfma_f32_16x16x32_bf16 v[92:95], a[48:51], a[124:127], v[92:95]
v_add_u32 v5, 0x10000, v5
v_add_u32 v6, 0x10000, v6
v_mfma_f32_16x16x32_bf16 v[92:95], a[32:35], a[108:111], v[92:95]
s_add_u32 m0, s57, 49152
s_add_u32 s52, s83, 2097152
v_mfma_f32_16x16x32_bf16 v[96:99], a[64:67], a[108:111], v[96:99]
buffer_load_dwordx4 v3, s[64:67], s52 offen offset:0  lds
v_mfma_f32_16x16x32_bf16 v[96:99], a[80:83], a[124:127], v[96:99]
v_mfma_f32_16x16x32_bf16 v[224:227], a[84:87], a[124:127], v[224:227]
ds_read_b128 a[32:35], v5 offset:0
ds_read_b128 a[48:51], v6 offset:0
v_mfma_f32_16x16x32_bf16 v[224:227], a[68:71], a[108:111], v[224:227]
v_mfma_f32_16x16x32_bf16 v[100:103], a[72:75], a[108:111], v[100:103]
ds_read_b128 a[36:39], v5 offset:2048
v_mfma_f32_16x16x32_bf16 v[100:103], a[88:91], a[124:127], v[100:103]
s_add_u32 s52, s83, 2161664
v_mfma_f32_16x16x32_bf16 v[228:231], a[92:95], a[124:127], v[228:231]
buffer_load_dwordx4 v4, s[64:67], s52 offen offset:1024  lds
v_mfma_f32_16x16x32_bf16 v[228:231], a[76:79], a[108:111], v[228:231]
v_mfma_f32_16x16x32_bf16 v[232:235], a[76:79], a[104:107], v[232:235]
ds_read_b128 a[52:55], v6 offset:2048
ds_read_b128 a[40:43], v5 offset:4096
v_mfma_f32_16x16x32_bf16 v[232:235], a[92:95], a[120:123], v[232:235]
v_mfma_f32_16x16x32_bf16 v[104:107], a[88:91], a[120:123], v[104:107]
ds_read_b128 a[56:59], v6 offset:4096
v_mfma_f32_16x16x32_bf16 v[104:107], a[72:75], a[104:107], v[104:107]
s_add_u32 s52, s83, 2226176
v_mfma_f32_16x16x32_bf16 v[236:239], a[68:71], a[104:107], v[236:239]
buffer_load_dwordx4 v3, s[64:67], s52 offen offset:2048  lds
v_mfma_f32_16x16x32_bf16 v[236:239], a[84:87], a[120:123], v[236:239]
v_mfma_f32_16x16x32_bf16 v[108:111], a[80:83], a[120:123], v[108:111]
ds_read_b128 a[44:47], v5 offset:6144
v_mfma_f32_16x16x32_bf16 v[108:111], a[64:67], a[104:107], v[108:111]
v_mfma_f32_16x16x32_bf16 v[112:115], a[64:67], a[100:103], v[112:115]
ds_read_b128 a[60:63], v6 offset:6144
v_mfma_f32_16x16x32_bf16 v[112:115], a[80:83], a[116:119], v[112:115]
s_add_u32 s52, s83, 2290688
v_mfma_f32_16x16x32_bf16 v[240:243], a[84:87], a[116:119], v[240:243]
buffer_load_dwordx4 v4, s[64:67], s52 offen offset:3072  lds
v_mfma_f32_16x16x32_bf16 v[240:243], a[68:71], a[100:103], v[240:243]
v_mfma_f32_16x16x32_bf16 v[116:119], a[72:75], a[100:103], v[116:119]
v_mfma_f32_16x16x32_bf16 v[116:119], a[88:91], a[116:119], v[116:119]
v_mfma_f32_16x16x32_bf16 v[244:247], a[92:95], a[116:119], v[244:247]
v_mfma_f32_16x16x32_bf16 v[244:247], a[76:79], a[100:103], v[244:247]
v_mfma_f32_16x16x32_bf16 v[248:251], a[76:79], a[96:99], v[248:251]
v_mfma_f32_16x16x32_bf16 v[248:251], a[92:95], a[112:115], v[248:251]
v_mfma_f32_16x16x32_bf16 v[120:123], a[88:91], a[112:115], v[120:123]
v_mfma_f32_16x16x32_bf16 v[120:123], a[72:75], a[96:99], v[120:123]
v_mfma_f32_16x16x32_bf16 v[252:255], a[68:71], a[96:99], v[252:255]
v_mfma_f32_16x16x32_bf16 v[252:255], a[84:87], a[112:115], v[252:255]
v_mfma_f32_16x16x32_bf16 v[124:127], a[80:83], a[112:115], v[124:127]
s_waitcnt vmcnt(18) lgkmcnt(0)
v_mfma_f32_16x16x32_bf16 v[124:127], a[64:67], a[96:99], v[124:127]
s_barrier
v_mfma_f32_16x16x32_bf16 v[128:131], a[0:3], a[32:35], v[128:131]
s_add_u32 m0, s58, 32768
s_add_u32 s55, s80, 256
v_mfma_f32_16x16x32_bf16 v[128:131], a[16:19], a[48:51], v[128:131]
buffer_load_dwordx4 v1, s[36:39], s55 offen offset:0  lds
v_mfma_f32_16x16x32_bf16 v[136:139], a[20:23], a[48:51], v[136:139]
s_lshl_b32 s35, s32, 5
ds_read_b128 a[64:67], v5 offset:8192
ds_read_b128 a[80:83], v6 offset:8192
v_mfma_f32_16x16x32_bf16 v[136:139], a[4:7], a[32:35], v[136:139]
v_mfma_f32_16x16x32_bf16 v[132:135], a[8:11], a[32:35], v[132:135]
ds_read_b128 a[68:71], v5 offset:10240
v_mfma_f32_16x16x32_bf16 v[132:135], a[24:27], a[48:51], v[132:135]
s_add_u32 s55, s80, 7424
s_add_u32 s35, s35, s31
v_mfma_f32_16x16x32_bf16 v[140:143], a[28:31], a[48:51], v[140:143]
buffer_load_dwordx4 v2, s[36:39], s55 offen offset:1024  lds
v_mfma_f32_16x16x32_bf16 v[140:143], a[12:15], a[32:35], v[140:143]
v_mfma_f32_16x16x32_bf16 v[144:147], a[12:15], a[36:39], v[144:147]
ds_read_b128 a[84:87], v6 offset:10240
v_mfma_f32_16x16x32_bf16 v[144:147], a[28:31], a[52:55], v[144:147]
s_lshl_b32 s27, s35, 2
v_mfma_f32_16x16x32_bf16 v[16:19], a[24:27], a[52:55], v[16:19]
ds_read_b128 a[72:75], v5 offset:12288
v_mfma_f32_16x16x32_bf16 v[16:19], a[8:11], a[36:39], v[16:19]
s_add_u32 s55, s80, 14592
s_add_u32 s35, s27, 4096
v_mfma_f32_16x16x32_bf16 v[148:151], a[4:7], a[36:39], v[148:151]
buffer_load_dwordx4 v1, s[36:39], s55 offen offset:2048  lds
v_mfma_f32_16x16x32_bf16 v[148:151], a[20:23], a[52:55], v[148:151]
v_mfma_f32_16x16x32_bf16 v[20:23], a[16:19], a[52:55], v[20:23]
ds_read_b128 a[88:91], v6 offset:12288
v_mfma_f32_16x16x32_bf16 v[20:23], a[0:3], a[36:39], v[20:23]
v_accvgpr_write_b32 a253, s3
v_mov_b32 v8, s35
v_mfma_f32_16x16x32_bf16 a[128:131], a[0:3], a[40:43], a[128:131]
ds_read_b128 a[76:79], v5 offset:14336
v_mfma_f32_16x16x32_bf16 a[128:131], a[16:19], a[56:59], a[128:131]
s_add_u32 s55, s80, 21760
v_mfma_f32_16x16x32_bf16 a[132:135], a[20:23], a[56:59], a[132:135]
buffer_load_dwordx4 v2, s[36:39], s55 offen offset:3072  lds
v_mfma_f32_16x16x32_bf16 a[132:135], a[4:7], a[40:43], a[132:135]
v_mfma_f32_16x16x32_bf16 a[136:139], a[8:11], a[40:43], a[136:139]
ds_read_b128 a[92:95], v6 offset:14336
v_mfma_f32_16x16x32_bf16 a[136:139], a[24:27], a[56:59], a[136:139]
v_mfma_f32_16x16x32_bf16 a[140:143], a[28:31], a[56:59], a[140:143]
v_mfma_f32_16x16x32_bf16 a[140:143], a[12:15], a[40:43], a[140:143]
s_add_u32 m0, s58, 36864
s_add_u32 s55, s80, 33024
v_mfma_f32_16x16x32_bf16 v[152:155], a[12:15], a[44:47], v[152:155]
buffer_load_dwordx4 v1, s[36:39], s55 offen offset:0  lds
v_mfma_f32_16x16x32_bf16 v[152:155], a[28:31], a[60:63], v[152:155]
s_add_u32 s55, s80, 40192
v_mfma_f32_16x16x32_bf16 v[24:27], a[24:27], a[60:63], v[24:27]
buffer_load_dwordx4 v2, s[36:39], s55 offen offset:1024  lds
v_mfma_f32_16x16x32_bf16 v[24:27], a[8:11], a[44:47], v[24:27]
v_mfma_f32_16x16x32_bf16 v[156:159], a[4:7], a[44:47], v[156:159]
ds_read_b64_tr_b16 a[96:97], v13 offset:16384
ds_read_b64_tr_b16 a[98:99], v13 offset:16896
v_mfma_f32_16x16x32_bf16 v[156:159], a[20:23], a[60:63], v[156:159]
v_mfma_f32_16x16x32_bf16 v[28:31], a[16:19], a[60:63], v[28:31]
s_waitcnt lgkmcnt(2)
ds_read_b64_tr_b16 a[112:113], v13 offset:24576
ds_read_b64_tr_b16 a[114:115], v13 offset:25088
v_mfma_f32_16x16x32_bf16 v[28:31], a[0:3], a[44:47], v[28:31]
s_add_u32 s55, s80, 47360
v_mfma_f32_16x16x32_bf16 v[32:35], a[0:3], a[64:67], v[32:35]
buffer_load_dwordx4 v1, s[36:39], s55 offen offset:2048  lds
v_mfma_f32_16x16x32_bf16 v[32:35], a[16:19], a[80:83], v[32:35]
v_mfma_f32_16x16x32_bf16 v[160:163], a[20:23], a[80:83], v[160:163]
ds_read_b64_tr_b16 a[100:101], v14 offset:16384
ds_read_b64_tr_b16 a[102:103], v14 offset:16896
v_mfma_f32_16x16x32_bf16 v[160:163], a[4:7], a[64:67], v[160:163]
v_mfma_f32_16x16x32_bf16 v[36:39], a[8:11], a[64:67], v[36:39]
ds_read_b64_tr_b16 a[116:117], v14 offset:24576
ds_read_b64_tr_b16 a[118:119], v14 offset:25088
v_mfma_f32_16x16x32_bf16 v[36:39], a[24:27], a[80:83], v[36:39]
s_add_u32 s55, s80, 54528
v_mfma_f32_16x16x32_bf16 v[164:167], a[28:31], a[80:83], v[164:167]
buffer_load_dwordx4 v2, s[36:39], s55 offen offset:3072  lds
v_mfma_f32_16x16x32_bf16 v[164:167], a[12:15], a[64:67], v[164:167]
v_mfma_f32_16x16x32_bf16 v[168:171], a[12:15], a[68:71], v[168:171]
ds_read_b64_tr_b16 a[104:105], v13 offset:20480
ds_read_b64_tr_b16 a[106:107], v13 offset:20992
v_mfma_f32_16x16x32_bf16 v[168:171], a[28:31], a[84:87], v[168:171]
v_mfma_f32_16x16x32_bf16 v[40:43], a[24:27], a[84:87], v[40:43]
ds_read_b64_tr_b16 a[120:121], v13 offset:28672
ds_read_b64_tr_b16 a[122:123], v13 offset:29184
v_mfma_f32_16x16x32_bf16 v[40:43], a[8:11], a[68:71], v[40:43]
s_add_u32 m0, s57, 0
s_add_u32 s52, s82, 1048576
v_mfma_f32_16x16x32_bf16 v[172:175], a[4:7], a[68:71], v[172:175]
buffer_load_dwordx4 v3, s[40:43], s52 offen offset:0  lds
v_mfma_f32_16x16x32_bf16 v[172:175], a[20:23], a[84:87], v[172:175]
v_mfma_f32_16x16x32_bf16 v[44:47], a[16:19], a[84:87], v[44:47]
ds_read_b64_tr_b16 a[108:109], v14 offset:20480
ds_read_b64_tr_b16 a[110:111], v14 offset:20992
v_mfma_f32_16x16x32_bf16 v[44:47], a[0:3], a[68:71], v[44:47]
v_mfma_f32_16x16x32_bf16 v[48:51], a[0:3], a[72:75], v[48:51]
ds_read_b64_tr_b16 a[124:125], v14 offset:28672
ds_read_b64_tr_b16 a[126:127], v14 offset:29184
v_mfma_f32_16x16x32_bf16 v[48:51], a[16:19], a[88:91], v[48:51]
s_add_u32 s52, s82, 1113088
v_mfma_f32_16x16x32_bf16 v[176:179], a[20:23], a[88:91], v[176:179]
buffer_load_dwordx4 v4, s[40:43], s52 offen offset:1024  lds
v_mfma_f32_16x16x32_bf16 v[176:179], a[4:7], a[72:75], v[176:179]
s_add_u32 s52, s82, 1177600
v_mfma_f32_16x16x32_bf16 v[52:55], a[8:11], a[72:75], v[52:55]
buffer_load_dwordx4 v3, s[40:43], s52 offen offset:2048  lds
v_mfma_f32_16x16x32_bf16 v[52:55], a[24:27], a[88:91], v[52:55]
s_add_u32 s52, s82, 1242112
v_mfma_f32_16x16x32_bf16 v[180:183], a[28:31], a[88:91], v[180:183]
buffer_load_dwordx4 v4, s[40:43], s52 offen offset:3072  lds
v_mfma_f32_16x16x32_bf16 v[180:183], a[12:15], a[72:75], v[180:183]
v_mfma_f32_16x16x32_bf16 v[184:187], a[12:15], a[76:79], v[184:187]
v_mfma_f32_16x16x32_bf16 v[184:187], a[28:31], a[92:95], v[184:187]
v_mfma_f32_16x16x32_bf16 v[56:59], a[24:27], a[92:95], v[56:59]
v_mfma_f32_16x16x32_bf16 v[56:59], a[8:11], a[76:79], v[56:59]
v_mfma_f32_16x16x32_bf16 v[188:191], a[4:7], a[76:79], v[188:191]
v_mfma_f32_16x16x32_bf16 v[188:191], a[20:23], a[92:95], v[188:191]
v_mfma_f32_16x16x32_bf16 v[60:63], a[16:19], a[92:95], v[60:63]
s_waitcnt vmcnt(16) lgkmcnt(0)
v_mfma_f32_16x16x32_bf16 v[60:63], a[0:3], a[76:79], v[60:63]
s_barrier
v_mfma_f32_16x16x32_bf16 v[64:67], a[64:67], a[96:99], v[64:67]
L_t1:
s_cbranch_execz L_r0
v_mfma_f32_16x16x32_bf16 v[64:67], a[80:83], a[112:115], v[64:67]
v_mfma_f32_16x16x32_bf16 v[192:195], a[84:87], a[112:115], v[192:195]
ds_read_b64_tr_b16 a[0:1], v9 offset:32768
ds_read_b64_tr_b16 a[2:3], v9 offset:33280
v_mfma_f32_16x16x32_bf16 v[192:195], a[68:71], a[96:99], v[192:195]
s_cmp_lg_u32 s30, 0
s_cbranch_scc1 L_sig_xn
s_mov_b64 exec, 1
global_store_dword v8, a253, s[16:17] sc1
s_mov_b64 exec, -1
L_sig_xn:
v_mfma_f32_16x16x32_bf16 v[68:71], a[72:75], a[96:99], v[68:71]
ds_read_b64_tr_b16 a[16:17], v9 offset:40960
ds_read_b64_tr_b16 a[18:19], v9 offset:41472
v_mfma_f32_16x16x32_bf16 v[68:71], a[88:91], a[112:115], v[68:71]
s_add_u32 m0, s57, 16384
s_add_u32 s52, s82, 1048576
v_mfma_f32_16x16x32_bf16 v[196:199], a[92:95], a[112:115], v[196:199]
buffer_load_dwordx4 v3, s[64:67], s52 offen offset:0  lds
v_mfma_f32_16x16x32_bf16 v[196:199], a[76:79], a[96:99], v[196:199]
v_mfma_f32_16x16x32_bf16 v[200:203], a[76:79], a[100:103], v[200:203]
ds_read_b64_tr_b16 a[4:5], v10 offset:32768
ds_read_b64_tr_b16 a[6:7], v10 offset:33280
v_mfma_f32_16x16x32_bf16 v[200:203], a[92:95], a[116:119], v[200:203]
v_mfma_f32_16x16x32_bf16 v[72:75], a[88:91], a[116:119], v[72:75]
ds_read_b64_tr_b16 a[20:21], v10 offset:40960
ds_read_b64_tr_b16 a[22:23], v10 offset:41472
v_mfma_f32_16x16x32_bf16 v[72:75], a[72:75], a[100:103], v[72:75]
s_add_u32 s52, s82, 1113088
v_mfma_f32_16x16x32_bf16 v[204:207], a[68:71], a[100:103], v[204:207]
buffer_load_dwordx4 v4, s[64:67], s52 offen offset:1024  lds
v_mfma_f32_16x16x32_bf16 v[204:207], a[84:87], a[116:119], v[204:207]
v_mfma_f32_16x16x32_bf16 v[76:79], a[80:83], a[116:119], v[76:79]
ds_read_b64_tr_b16 a[8:9], v11 offset:32768
ds_read_b64_tr_b16 a[10:11], v11 offset:33280
v_mfma_f32_16x16x32_bf16 v[76:79], a[64:67], a[100:103], v[76:79]
v_mfma_f32_16x16x32_bf16 v[80:83], a[64:67], a[104:107], v[80:83]
ds_read_b64_tr_b16 a[24:25], v11 offset:40960
ds_read_b64_tr_b16 a[26:27], v11 offset:41472
v_mfma_f32_16x16x32_bf16 v[80:83], a[80:83], a[120:123], v[80:83]
s_add_u32 s52, s82, 1177600
v_mfma_f32_16x16x32_bf16 v[208:211], a[84:87], a[120:123], v[208:211]
buffer_load_dwordx4 v3, s[64:67], s52 offen offset:2048  lds
v_mfma_f32_16x16x32_bf16 v[208:211], a[68:71], a[104:107], v[208:211]
v_mfma_f32_16x16x32_bf16 v[84:87], a[72:75], a[104:107], v[84:87]
ds_read_b64_tr_b16 a[12:13], v12 offset:32768
ds_read_b64_tr_b16 a[14:15], v12 offset:33280
v_mfma_f32_16x16x32_bf16 v[84:87], a[88:91], a[120:123], v[84:87]
v_mfma_f32_16x16x32_bf16 v[212:215], a[92:95], a[120:123], v[212:215]
ds_read_b64_tr_b16 a[28:29], v12 offset:40960
ds_read_b64_tr_b16 a[30:31], v12 offset:41472
v_mfma_f32_16x16x32_bf16 v[212:215], a[76:79], a[104:107], v[212:215]
s_add_u32 s52, s82, 1242112
v_mfma_f32_16x16x32_bf16 v[216:219], a[76:79], a[108:111], v[216:219]
buffer_load_dwordx4 v4, s[64:67], s52 offen offset:3072  lds
v_mfma_f32_16x16x32_bf16 v[216:219], a[92:95], a[124:127], v[216:219]
v_mfma_f32_16x16x32_bf16 v[88:91], a[88:91], a[124:127], v[88:91]
v_mfma_f32_16x16x32_bf16 v[88:91], a[72:75], a[108:111], v[88:91]
v_mfma_f32_16x16x32_bf16 v[220:223], a[68:71], a[108:111], v[220:223]
v_mfma_f32_16x16x32_bf16 v[220:223], a[84:87], a[124:127], v[220:223]
v_mfma_f32_16x16x32_bf16 v[92:95], a[80:83], a[124:127], v[92:95]
v_add_u32 v5, 0xffff0000, v5
v_add_u32 v6, 0xffff0000, v6
v_mfma_f32_16x16x32_bf16 v[92:95], a[64:67], a[108:111], v[92:95]
s_add_u32 m0, s58, 65536
s_add_u32 s55, s81, 256
v_mfma_f32_16x16x32_bf16 v[96:99], a[32:35], a[108:111], v[96:99]
buffer_load_dwordx4 v1, s[36:39], s55 offen offset:0  lds
v_mfma_f32_16x16x32_bf16 v[96:99], a[48:51], a[124:127], v[96:99]
v_mfma_f32_16x16x32_bf16 v[224:227], a[52:55], a[124:127], v[224:227]
ds_read_b128 a[64:67], v5 offset:0
ds_read_b128 a[80:83], v6 offset:0
v_mfma_f32_16x16x32_bf16 v[224:227], a[36:39], a[108:111], v[224:227]
v_mfma_f32_16x16x32_bf16 v[100:103], a[40:43], a[108:111], v[100:103]
ds_read_b128 a[68:71], v5 offset:2048
v_mfma_f32_16x16x32_bf16 v[100:103], a[56:59], a[124:127], v[100:103]
s_add_u32 s55, s81, 7424
v_mfma_f32_16x16x32_bf16 v[228:231], a[60:63], a[124:127], v[228:231]
buffer_load_dwordx4 v2, s[36:39], s55 offen offset:1024  lds
v_mfma_f32_16x16x32_bf16 v[228:231], a[44:47], a[108:111], v[228:231]
v_mfma_f32_16x16x32_bf16 v[232:235], a[44:47], a[104:107], v[232:235]
ds_read_b128 a[84:87], v6 offset:2048
ds_read_b128 a[72:75], v5 offset:4096
v_mfma_f32_16x16x32_bf16 v[232:235], a[60:63], a[120:123], v[232:235]
v_mfma_f32_16x16x32_bf16 v[104:107], a[56:59], a[120:123], v[104:107]
ds_read_b128 a[88:91], v6 offset:4096
v_mfma_f32_16x16x32_bf16 v[104:107], a[40:43], a[104:107], v[104:107]
s_add_u32 s55, s81, 14592
v_mfma_f32_16x16x32_bf16 v[236:239], a[36:39], a[104:107], v[236:239]
buffer_load_dwordx4 v1, s[36:39], s55 offen offset:2048  lds
v_mfma_f32_16x16x32_bf16 v[236:239], a[52:55], a[120:123], v[236:239]
v_mfma_f32_16x16x32_bf16 v[108:111], a[48:51], a[120:123], v[108:111]
ds_read_b128 a[76:79], v5 offset:6144
v_mfma_f32_16x16x32_bf16 v[108:111], a[32:35], a[104:107], v[108:111]
v_mfma_f32_16x16x32_bf16 v[112:115], a[32:35], a[100:103], v[112:115]
ds_read_b128 a[92:95], v6 offset:6144
v_mfma_f32_16x16x32_bf16 v[112:115], a[48:51], a[116:119], v[112:115]
s_add_u32 s55, s81, 21760
v_mfma_f32_16x16x32_bf16 v[240:243], a[52:55], a[116:119], v[240:243]
buffer_load_dwordx4 v2, s[36:39], s55 offen offset:3072  lds
v_mfma_f32_16x16x32_bf16 v[240:243], a[36:39], a[100:103], v[240:243]
v_mfma_f32_16x16x32_bf16 v[116:119], a[40:43], a[100:103], v[116:119]
v_mfma_f32_16x16x32_bf16 v[116:119], a[56:59], a[116:119], v[116:119]
v_mfma_f32_16x16x32_bf16 v[244:247], a[60:63], a[116:119], v[244:247]
v_mfma_f32_16x16x32_bf16 v[244:247], a[44:47], a[100:103], v[244:247]
v_mfma_f32_16x16x32_bf16 v[248:251], a[44:47], a[96:99], v[248:251]
v_mfma_f32_16x16x32_bf16 v[248:251], a[60:63], a[112:115], v[248:251]
v_mfma_f32_16x16x32_bf16 v[120:123], a[56:59], a[112:115], v[120:123]
v_mfma_f32_16x16x32_bf16 v[120:123], a[40:43], a[96:99], v[120:123]
v_mfma_f32_16x16x32_bf16 v[252:255], a[36:39], a[96:99], v[252:255]
v_mfma_f32_16x16x32_bf16 v[252:255], a[52:55], a[112:115], v[252:255]
v_mfma_f32_16x16x32_bf16 v[124:127], a[48:51], a[112:115], v[124:127]
s_waitcnt vmcnt(20) lgkmcnt(0)
v_mfma_f32_16x16x32_bf16 v[124:127], a[32:35], a[96:99], v[124:127]
s_barrier
v_mfma_f32_16x16x32_bf16 v[128:131], a[0:3], a[64:67], v[128:131]
v_mfma_f32_16x16x32_bf16 v[128:131], a[16:19], a[80:83], v[128:131]
v_mfma_f32_16x16x32_bf16 v[136:139], a[20:23], a[80:83], v[136:139]
ds_read_b128 a[32:35], v5 offset:8192
ds_read_b128 a[48:51], v6 offset:8192
v_mfma_f32_16x16x32_bf16 v[136:139], a[4:7], a[64:67], v[136:139]
v_mfma_f32_16x16x32_bf16 v[132:135], a[8:11], a[64:67], v[132:135]
ds_read_b128 a[36:39], v5 offset:10240
v_mfma_f32_16x16x32_bf16 v[132:135], a[24:27], a[80:83], v[132:135]
s_add_u32 m0, s57, 32768
s_add_u32 s52, s83, 1048576
v_mfma_f32_16x16x32_bf16 v[140:143], a[28:31], a[80:83], v[140:143]
buffer_load_dwordx4 v3, s[40:43], s52 offen offset:0  lds
v_mfma_f32_16x16x32_bf16 v[140:143], a[12:15], a[64:67], v[140:143]
v_mfma_f32_16x16x32_bf16 v[144:147], a[12:15], a[68:71], v[144:147]
ds_read_b128 a[52:55], v6 offset:10240
v_mfma_f32_16x16x32_bf16 v[144:147], a[28:31], a[84:87], v[144:147]
v_mfma_f32_16x16x32_bf16 v[16:19], a[24:27], a[84:87], v[16:19]
ds_read_b128 a[40:43], v5 offset:12288
v_mfma_f32_16x16x32_bf16 v[16:19], a[8:11], a[68:71], v[16:19]
s_add_u32 s52, s83, 1113088
v_mfma_f32_16x16x32_bf16 v[148:151], a[4:7], a[68:71], v[148:151]
buffer_load_dwordx4 v4, s[40:43], s52 offen offset:1024  lds
v_mfma_f32_16x16x32_bf16 v[148:151], a[20:23], a[84:87], v[148:151]
v_mfma_f32_16x16x32_bf16 v[20:23], a[16:19], a[84:87], v[20:23]
ds_read_b128 a[56:59], v6 offset:12288
v_mfma_f32_16x16x32_bf16 v[20:23], a[0:3], a[68:71], v[20:23]
v_mfma_f32_16x16x32_bf16 a[128:131], a[0:3], a[72:75], a[128:131]
ds_read_b128 a[44:47], v5 offset:14336
v_mfma_f32_16x16x32_bf16 a[128:131], a[16:19], a[88:91], a[128:131]
s_add_u32 s52, s83, 1177600
v_mfma_f32_16x16x32_bf16 a[132:135], a[20:23], a[88:91], a[132:135]
buffer_load_dwordx4 v3, s[40:43], s52 offen offset:2048  lds
v_mfma_f32_16x16x32_bf16 a[132:135], a[4:7], a[72:75], a[132:135]
v_mfma_f32_16x16x32_bf16 a[136:139], a[8:11], a[72:75], a[136:139]
ds_read_b128 a[60:63], v6 offset:14336
v_mfma_f32_16x16x32_bf16 a[136:139], a[24:27], a[88:91], a[136:139]
v_mfma_f32_16x16x32_bf16 a[140:143], a[28:31], a[88:91], a[140:143]
v_mfma_f32_16x16x32_bf16 a[140:143], a[12:15], a[72:75], a[140:143]
s_add_u32 s52, s83, 1242112
v_mfma_f32_16x16x32_bf16 v[152:155], a[12:15], a[76:79], v[152:155]
buffer_load_dwordx4 v4, s[40:43], s52 offen offset:3072  lds
v_mfma_f32_16x16x32_bf16 v[152:155], a[28:31], a[92:95], v[152:155]
v_mfma_f32_16x16x32_bf16 v[24:27], a[24:27], a[92:95], v[24:27]
v_mfma_f32_16x16x32_bf16 v[24:27], a[8:11], a[76:79], v[24:27]
v_mfma_f32_16x16x32_bf16 v[156:159], a[4:7], a[76:79], v[156:159]
ds_read_b64_tr_b16 a[96:97], v13 offset:49152
ds_read_b64_tr_b16 a[98:99], v13 offset:49664
v_mfma_f32_16x16x32_bf16 v[156:159], a[20:23], a[92:95], v[156:159]
v_mfma_f32_16x16x32_bf16 v[28:31], a[16:19], a[92:95], v[28:31]
s_waitcnt lgkmcnt(2)
ds_read_b64_tr_b16 a[112:113], v13 offset:57344
ds_read_b64_tr_b16 a[114:115], v13 offset:57856
v_mfma_f32_16x16x32_bf16 v[28:31], a[0:3], a[76:79], v[28:31]
s_add_u32 m0, s58, 69632
s_add_u32 s55, s81, 33024
v_mfma_f32_16x16x32_bf16 v[32:35], a[0:3], a[32:35], v[32:35]
buffer_load_dwordx4 v1, s[36:39], s55 offen offset:0  lds
v_mfma_f32_16x16x32_bf16 v[32:35], a[16:19], a[48:51], v[32:35]
v_mfma_f32_16x16x32_bf16 v[160:163], a[20:23], a[48:51], v[160:163]
ds_read_b64_tr_b16 a[100:101], v14 offset:49152
ds_read_b64_tr_b16 a[102:103], v14 offset:49664
v_mfma_f32_16x16x32_bf16 v[160:163], a[4:7], a[32:35], v[160:163]
v_mfma_f32_16x16x32_bf16 v[36:39], a[8:11], a[32:35], v[36:39]
ds_read_b64_tr_b16 a[116:117], v14 offset:57344
ds_read_b64_tr_b16 a[118:119], v14 offset:57856
v_mfma_f32_16x16x32_bf16 v[36:39], a[24:27], a[48:51], v[36:39]
s_add_u32 s55, s81, 40192
v_mfma_f32_16x16x32_bf16 v[164:167], a[28:31], a[48:51], v[164:167]
buffer_load_dwordx4 v2, s[36:39], s55 offen offset:1024  lds
v_mfma_f32_16x16x32_bf16 v[164:167], a[12:15], a[32:35], v[164:167]
v_mfma_f32_16x16x32_bf16 v[168:171], a[12:15], a[36:39], v[168:171]
ds_read_b64_tr_b16 a[104:105], v13 offset:53248
ds_read_b64_tr_b16 a[106:107], v13 offset:53760
v_mfma_f32_16x16x32_bf16 v[168:171], a[28:31], a[52:55], v[168:171]
v_mfma_f32_16x16x32_bf16 v[40:43], a[24:27], a[52:55], v[40:43]
ds_read_b64_tr_b16 a[120:121], v13 offset:61440
ds_read_b64_tr_b16 a[122:123], v13 offset:61952
v_mfma_f32_16x16x32_bf16 v[40:43], a[8:11], a[36:39], v[40:43]
s_add_u32 s55, s81, 47360
v_mfma_f32_16x16x32_bf16 v[172:175], a[4:7], a[36:39], v[172:175]
buffer_load_dwordx4 v1, s[36:39], s55 offen offset:2048  lds
v_mfma_f32_16x16x32_bf16 v[172:175], a[20:23], a[52:55], v[172:175]
v_mfma_f32_16x16x32_bf16 v[44:47], a[16:19], a[52:55], v[44:47]
ds_read_b64_tr_b16 a[108:109], v14 offset:53248
ds_read_b64_tr_b16 a[110:111], v14 offset:53760
v_mfma_f32_16x16x32_bf16 v[44:47], a[0:3], a[36:39], v[44:47]
v_mfma_f32_16x16x32_bf16 v[48:51], a[0:3], a[40:43], v[48:51]
ds_read_b64_tr_b16 a[124:125], v14 offset:61440
ds_read_b64_tr_b16 a[126:127], v14 offset:61952
v_mfma_f32_16x16x32_bf16 v[48:51], a[16:19], a[56:59], v[48:51]
s_add_u32 s55, s81, 54528
v_mfma_f32_16x16x32_bf16 v[176:179], a[20:23], a[56:59], v[176:179]
buffer_load_dwordx4 v2, s[36:39], s55 offen offset:3072  lds
v_mfma_f32_16x16x32_bf16 v[176:179], a[4:7], a[40:43], v[176:179]
v_mfma_f32_16x16x32_bf16 v[52:55], a[8:11], a[40:43], v[52:55]
v_mfma_f32_16x16x32_bf16 v[52:55], a[24:27], a[56:59], v[52:55]
v_mfma_f32_16x16x32_bf16 v[180:183], a[28:31], a[56:59], v[180:183]
v_mfma_f32_16x16x32_bf16 v[180:183], a[12:15], a[40:43], v[180:183]
v_mfma_f32_16x16x32_bf16 v[184:187], a[12:15], a[44:47], v[184:187]
v_mfma_f32_16x16x32_bf16 v[184:187], a[28:31], a[60:63], v[184:187]
v_mfma_f32_16x16x32_bf16 v[56:59], a[24:27], a[60:63], v[56:59]
v_mfma_f32_16x16x32_bf16 v[56:59], a[8:11], a[44:47], v[56:59]
v_mfma_f32_16x16x32_bf16 v[188:191], a[4:7], a[44:47], v[188:191]
v_mfma_f32_16x16x32_bf16 v[188:191], a[20:23], a[60:63], v[188:191]
v_mfma_f32_16x16x32_bf16 v[60:63], a[16:19], a[60:63], v[60:63]
s_waitcnt vmcnt(16) lgkmcnt(0)
v_mfma_f32_16x16x32_bf16 v[60:63], a[0:3], a[44:47], v[60:63]
s_barrier
v_mfma_f32_16x16x32_bf16 v[64:67], a[32:35], a[96:99], v[64:67]
v_lshl_add_u32 v7, v15, 1, s26
v_mfma_f32_16x16x32_bf16 v[64:67], a[48:51], a[112:115], v[64:67]
v_mfma_f32_16x16x32_bf16 v[192:195], a[52:55], a[112:115], v[192:195]
ds_read_b64_tr_b16 a[0:1], v9 offset:0
ds_read_b64_tr_b16 a[2:3], v9 offset:512
v_mfma_f32_16x16x32_bf16 v[192:195], a[36:39], a[96:99], v[192:195]
v_mfma_f32_16x16x32_bf16 v[68:71], a[40:43], a[96:99], v[68:71]
ds_read_b64_tr_b16 a[16:17], v9 offset:8192
ds_read_b64_tr_b16 a[18:19], v9 offset:8704
v_mfma_f32_16x16x32_bf16 v[68:71], a[56:59], a[112:115], v[68:71]
s_add_u32 m0, s57, 49152
s_add_u32 s52, s83, 1048576
s_lshl_b32 s35, s32, 7
v_mfma_f32_16x16x32_bf16 v[196:199], a[60:63], a[112:115], v[196:199]
buffer_load_dwordx4 v3, s[64:67], s52 offen offset:0  lds
v_mfma_f32_16x16x32_bf16 v[196:199], a[44:47], a[96:99], v[196:199]
v_mfma_f32_16x16x32_bf16 v[200:203], a[44:47], a[100:103], v[200:203]
ds_read_b64_tr_b16 a[4:5], v10 offset:0
ds_read_b64_tr_b16 a[6:7], v10 offset:512
v_mfma_f32_16x16x32_bf16 v[200:203], a[60:63], a[116:119], v[200:203]
s_add_u32 s35, s35, 4096
v_mfma_f32_16x16x32_bf16 v[72:75], a[56:59], a[116:119], v[72:75]
ds_read_b64_tr_b16 a[20:21], v10 offset:8192
ds_read_b64_tr_b16 a[22:23], v10 offset:8704
v_mfma_f32_16x16x32_bf16 v[72:75], a[40:43], a[100:103], v[72:75]
s_add_u32 s52, s83, 1113088
v_mfma_f32_16x16x32_bf16 v[204:207], a[36:39], a[100:103], v[204:207]
buffer_load_dwordx4 v4, s[64:67], s52 offen offset:1024  lds
v_mfma_f32_16x16x32_bf16 v[204:207], a[52:55], a[116:119], v[204:207]
v_mfma_f32_16x16x32_bf16 v[76:79], a[48:51], a[116:119], v[76:79]
ds_read_b64_tr_b16 a[8:9], v11 offset:0
ds_read_b64_tr_b16 a[10:11], v11 offset:512
v_mfma_f32_16x16x32_bf16 v[76:79], a[32:35], a[100:103], v[76:79]
v_bfe_u32 v8, v15, 4, 5
v_lshl_add_u32 v8, v8, 2, s35
v_mfma_f32_16x16x32_bf16 v[80:83], a[32:35], a[104:107], v[80:83]
ds_read_b64_tr_b16 a[24:25], v11 offset:8192
ds_read_b64_tr_b16 a[26:27], v11 offset:8704
v_mfma_f32_16x16x32_bf16 v[80:83], a[48:51], a[120:123], v[80:83]
s_add_u32 s52, s83, 1177600
v_mfma_f32_16x16x32_bf16 v[208:211], a[52:55], a[120:123], v[208:211]
buffer_load_dwordx4 v3, s[64:67], s52 offen offset:2048  lds
v_mfma_f32_16x16x32_bf16 v[208:211], a[36:39], a[104:107], v[208:211]
v_mfma_f32_16x16x32_bf16 v[84:87], a[40:43], a[104:107], v[84:87]
ds_read_b64_tr_b16 a[12:13], v12 offset:0
ds_read_b64_tr_b16 a[14:15], v12 offset:512
v_mfma_f32_16x16x32_bf16 v[84:87], a[56:59], a[120:123], v[84:87]
v_mfma_f32_16x16x32_bf16 v[212:215], a[60:63], a[120:123], v[212:215]
ds_read_b64_tr_b16 a[28:29], v12 offset:8192
ds_read_b64_tr_b16 a[30:31], v12 offset:8704
v_mfma_f32_16x16x32_bf16 v[212:215], a[44:47], a[104:107], v[212:215]
s_add_u32 s52, s83, 1242112
v_mfma_f32_16x16x32_bf16 v[216:219], a[44:47], a[108:111], v[216:219]
buffer_load_dwordx4 v4, s[64:67], s52 offen offset:3072  lds
v_mfma_f32_16x16x32_bf16 v[216:219], a[60:63], a[124:127], v[216:219]
v_mfma_f32_16x16x32_bf16 v[88:91], a[56:59], a[124:127], v[88:91]
v_mfma_f32_16x16x32_bf16 v[88:91], a[40:43], a[108:111], v[88:91]
v_mfma_f32_16x16x32_bf16 v[220:223], a[36:39], a[108:111], v[220:223]
v_mfma_f32_16x16x32_bf16 v[220:223], a[52:55], a[124:127], v[220:223]
v_mfma_f32_16x16x32_bf16 v[92:95], a[48:51], a[124:127], v[92:95]
v_mfma_f32_16x16x32_bf16 v[92:95], a[32:35], a[108:111], v[92:95]
s_add_u32 m0, s58, 0
s_add_u32 s55, s80, 768
v_mfma_f32_16x16x32_bf16 v[96:99], a[64:67], a[108:111], v[96:99]
buffer_load_dwordx4 v1, s[36:39], s55 offen offset:0  lds
v_mfma_f32_16x16x32_bf16 v[96:99], a[80:83], a[124:127], v[96:99]
v_mfma_f32_16x16x32_bf16 v[224:227], a[84:87], a[124:127], v[224:227]
ds_read_b128 a[32:35], v5 offset:32768
ds_read_b128 a[48:51], v6 offset:32768
v_mfma_f32_16x16x32_bf16 v[224:227], a[68:71], a[108:111], v[224:227]
v_mfma_f32_16x16x32_bf16 v[100:103], a[72:75], a[108:111], v[100:103]
ds_read_b128 a[36:39], v5 offset:34816
v_mfma_f32_16x16x32_bf16 v[100:103], a[88:91], a[124:127], v[100:103]
s_add_u32 s55, s80, 7936
v_mfma_f32_16x16x32_bf16 v[228:231], a[92:95], a[124:127], v[228:231]
buffer_load_dwordx4 v2, s[36:39], s55 offen offset:1024  lds
v_mfma_f32_16x16x32_bf16 v[228:231], a[76:79], a[108:111], v[228:231]
v_mfma_f32_16x16x32_bf16 v[232:235], a[76:79], a[104:107], v[232:235]
ds_read_b128 a[52:55], v6 offset:34816
ds_read_b128 a[40:43], v5 offset:36864
v_mfma_f32_16x16x32_bf16 v[232:235], a[92:95], a[120:123], v[232:235]
v_mfma_f32_16x16x32_bf16 v[104:107], a[88:91], a[120:123], v[104:107]
ds_read_b128 a[56:59], v6 offset:36864
v_mfma_f32_16x16x32_bf16 v[104:107], a[72:75], a[104:107], v[104:107]
s_add_u32 s55, s80, 15104
v_mfma_f32_16x16x32_bf16 v[236:239], a[68:71], a[104:107], v[236:239]
buffer_load_dwordx4 v1, s[36:39], s55 offen offset:2048  lds
v_mfma_f32_16x16x32_bf16 v[236:239], a[84:87], a[120:123], v[236:239]
v_mfma_f32_16x16x32_bf16 v[108:111], a[80:83], a[120:123], v[108:111]
ds_read_b128 a[44:47], v5 offset:38912
v_mfma_f32_16x16x32_bf16 v[108:111], a[64:67], a[104:107], v[108:111]
v_mfma_f32_16x16x32_bf16 v[112:115], a[64:67], a[100:103], v[112:115]
ds_read_b128 a[60:63], v6 offset:38912
v_mfma_f32_16x16x32_bf16 v[112:115], a[80:83], a[116:119], v[112:115]
s_add_u32 s55, s80, 22272
v_mfma_f32_16x16x32_bf16 v[240:243], a[84:87], a[116:119], v[240:243]
buffer_load_dwordx4 v2, s[36:39], s55 offen offset:3072  lds
v_mfma_f32_16x16x32_bf16 v[240:243], a[68:71], a[100:103], v[240:243]
v_mfma_f32_16x16x32_bf16 v[116:119], a[72:75], a[100:103], v[116:119]
v_mfma_f32_16x16x32_bf16 v[116:119], a[88:91], a[116:119], v[116:119]
v_mfma_f32_16x16x32_bf16 v[244:247], a[92:95], a[116:119], v[244:247]
v_mfma_f32_16x16x32_bf16 v[244:247], a[76:79], a[100:103], v[244:247]
v_mfma_f32_16x16x32_bf16 v[248:251], a[76:79], a[96:99], v[248:251]
s_mov_b32 s76, s8
v_mfma_f32_16x16x32_bf16 v[248:251], a[92:95], a[112:115], v[248:251]
s_mov_b32 s77, s9
s_mov_b32 s78, 4194304
v_mfma_f32_16x16x32_bf16 v[120:123], a[88:91], a[112:115], v[120:123]
s_mov_b32 s59, 0
v_mfma_f32_16x16x32_bf16 v[120:123], a[72:75], a[96:99], v[120:123]
buffer_load_dword a255, v7, s[76:79], s59 offen
v_mfma_f32_16x16x32_bf16 v[252:255], a[68:71], a[96:99], v[252:255]
v_mfma_f32_16x16x32_bf16 v[252:255], a[84:87], a[112:115], v[252:255]
v_mfma_f32_16x16x32_bf16 v[124:127], a[80:83], a[112:115], v[124:127]
s_waitcnt vmcnt(21) lgkmcnt(0)
v_mfma_f32_16x16x32_bf16 v[124:127], a[64:67], a[96:99], v[124:127]
s_barrier
v_mfma_f32_16x16x32_bf16 v[128:131], a[0:3], a[32:35], v[128:131]
v_mfma_f32_16x16x32_bf16 v[128:131], a[16:19], a[48:51], v[128:131]
global_load_dword a252, v8, s[16:17] sc1
v_mfma_f32_16x16x32_bf16 v[136:139], a[20:23], a[48:51], v[136:139]
ds_read_b128 a[64:67], v5 offset:40960
ds_read_b128 a[80:83], v6 offset:40960
v_mfma_f32_16x16x32_bf16 v[136:139], a[4:7], a[32:35], v[136:139]
v_mfma_f32_16x16x32_bf16 v[132:135], a[8:11], a[32:35], v[132:135]
ds_read_b128 a[68:71], v5 offset:43008
v_mfma_f32_16x16x32_bf16 v[132:135], a[24:27], a[48:51], v[132:135]
s_add_u32 m0, s57, 0
s_add_u32 s52, s82, 3145728
v_mfma_f32_16x16x32_bf16 v[140:143], a[28:31], a[48:51], v[140:143]
buffer_load_dwordx4 v3, s[40:43], s52 offen offset:0  lds
v_mfma_f32_16x16x32_bf16 v[140:143], a[12:15], a[32:35], v[140:143]
v_mfma_f32_16x16x32_bf16 v[144:147], a[12:15], a[36:39], v[144:147]
ds_read_b128 a[84:87], v6 offset:43008
v_mfma_f32_16x16x32_bf16 v[144:147], a[28:31], a[52:55], v[144:147]
v_mfma_f32_16x16x32_bf16 v[16:19], a[24:27], a[52:55], v[16:19]
ds_read_b128 a[72:75], v5 offset:45056
v_mfma_f32_16x16x32_bf16 v[16:19], a[8:11], a[36:39], v[16:19]
s_add_u32 s52, s82, 3210240
v_mfma_f32_16x16x32_bf16 v[148:151], a[4:7], a[36:39], v[148:151]
buffer_load_dwordx4 v4, s[40:43], s52 offen offset:1024  lds
v_mfma_f32_16x16x32_bf16 v[148:151], a[20:23], a[52:55], v[148:151]
v_mfma_f32_16x16x32_bf16 v[20:23], a[16:19], a[52:55], v[20:23]
ds_read_b128 a[88:91], v6 offset:45056
v_mfma_f32_16x16x32_bf16 v[20:23], a[0:3], a[36:39], v[20:23]
v_mfma_f32_16x16x32_bf16 a[128:131], a[0:3], a[40:43], a[128:131]
ds_read_b128 a[76:79], v5 offset:47104
v_mfma_f32_16x16x32_bf16 a[128:131], a[16:19], a[56:59], a[128:131]
s_add_u32 s52, s82, 3274752
v_mfma_f32_16x16x32_bf16 a[132:135], a[20:23], a[56:59], a[132:135]
buffer_load_dwordx4 v3, s[40:43], s52 offen offset:2048  lds
v_mfma_f32_16x16x32_bf16 a[132:135], a[4:7], a[40:43], a[132:135]
v_mfma_f32_16x16x32_bf16 a[136:139], a[8:11], a[40:43], a[136:139]
ds_read_b128 a[92:95], v6 offset:47104
v_mfma_f32_16x16x32_bf16 a[136:139], a[24:27], a[56:59], a[136:139]
v_mfma_f32_16x16x32_bf16 a[140:143], a[28:31], a[56:59], a[140:143]
v_mfma_f32_16x16x32_bf16 a[140:143], a[12:15], a[40:43], a[140:143]
s_add_u32 s52, s82, 3339264
v_mfma_f32_16x16x32_bf16 v[152:155], a[12:15], a[44:47], v[152:155]
buffer_load_dwordx4 v4, s[40:43], s52 offen offset:3072  lds
v_mfma_f32_16x16x32_bf16 v[152:155], a[28:31], a[60:63], v[152:155]
v_mfma_f32_16x16x32_bf16 v[24:27], a[24:27], a[60:63], v[24:27]
v_mfma_f32_16x16x32_bf16 v[24:27], a[8:11], a[44:47], v[24:27]
v_mfma_f32_16x16x32_bf16 v[156:159], a[4:7], a[44:47], v[156:159]
ds_read_b64_tr_b16 a[96:97], v13 offset:16384
ds_read_b64_tr_b16 a[98:99], v13 offset:16896
v_mfma_f32_16x16x32_bf16 v[156:159], a[20:23], a[60:63], v[156:159]
v_mfma_f32_16x16x32_bf16 v[28:31], a[16:19], a[60:63], v[28:31]
s_waitcnt lgkmcnt(2)
ds_read_b64_tr_b16 a[112:113], v13 offset:24576
ds_read_b64_tr_b16 a[114:115], v13 offset:25088
v_mfma_f32_16x16x32_bf16 v[28:31], a[0:3], a[44:47], v[28:31]
s_add_u32 m0, s58, 4096
s_add_u32 s55, s80, 33536
v_mfma_f32_16x16x32_bf16 v[32:35], a[0:3], a[64:67], v[32:35]
buffer_load_dwordx4 v1, s[36:39], s55 offen offset:0  lds
v_mfma_f32_16x16x32_bf16 v[32:35], a[16:19], a[80:83], v[32:35]
v_mfma_f32_16x16x32_bf16 v[160:163], a[20:23], a[80:83], v[160:163]
ds_read_b64_tr_b16 a[100:101], v14 offset:16384
ds_read_b64_tr_b16 a[102:103], v14 offset:16896
v_mfma_f32_16x16x32_bf16 v[160:163], a[4:7], a[64:67], v[160:163]
v_mfma_f32_16x16x32_bf16 v[36:39], a[8:11], a[64:67], v[36:39]
ds_read_b64_tr_b16 a[116:117], v14 offset:24576
ds_read_b64_tr_b16 a[118:119], v14 offset:25088
v_mfma_f32_16x16x32_bf16 v[36:39], a[24:27], a[80:83], v[36:39]
s_add_u32 s55, s80, 40704
v_mfma_f32_16x16x32_bf16 v[164:167], a[28:31], a[80:83], v[164:167]
buffer_load_dwordx4 v2, s[36:39], s55 offen offset:1024  lds
v_mfma_f32_16x16x32_bf16 v[164:167], a[12:15], a[64:67], v[164:167]
v_mfma_f32_16x16x32_bf16 v[168:171], a[12:15], a[68:71], v[168:171]
ds_read_b64_tr_b16 a[104:105], v13 offset:20480
ds_read_b64_tr_b16 a[106:107], v13 offset:20992
v_mfma_f32_16x16x32_bf16 v[168:171], a[28:31], a[84:87], v[168:171]
v_mfma_f32_16x16x32_bf16 v[40:43], a[24:27], a[84:87], v[40:43]
ds_read_b64_tr_b16 a[120:121], v13 offset:28672
ds_read_b64_tr_b16 a[122:123], v13 offset:29184
v_mfma_f32_16x16x32_bf16 v[40:43], a[8:11], a[68:71], v[40:43]
s_add_u32 s55, s80, 47872
v_mfma_f32_16x16x32_bf16 v[172:175], a[4:7], a[68:71], v[172:175]
buffer_load_dwordx4 v1, s[36:39], s55 offen offset:2048  lds
v_mfma_f32_16x16x32_bf16 v[172:175], a[20:23], a[84:87], v[172:175]
v_mfma_f32_16x16x32_bf16 v[44:47], a[16:19], a[84:87], v[44:47]
ds_read_b64_tr_b16 a[108:109], v14 offset:20480
ds_read_b64_tr_b16 a[110:111], v14 offset:20992
v_mfma_f32_16x16x32_bf16 v[44:47], a[0:3], a[68:71], v[44:47]
v_mfma_f32_16x16x32_bf16 v[48:51], a[0:3], a[72:75], v[48:51]
ds_read_b64_tr_b16 a[124:125], v14 offset:28672
ds_read_b64_tr_b16 a[126:127], v14 offset:29184
v_mfma_f32_16x16x32_bf16 v[48:51], a[16:19], a[88:91], v[48:51]
s_add_u32 s55, s80, 55040
v_mfma_f32_16x16x32_bf16 v[176:179], a[20:23], a[88:91], v[176:179]
buffer_load_dwordx4 v2, s[36:39], s55 offen offset:3072  lds
v_mfma_f32_16x16x32_bf16 v[176:179], a[4:7], a[72:75], v[176:179]
v_mfma_f32_16x16x32_bf16 v[52:55], a[8:11], a[72:75], v[52:55]
v_mfma_f32_16x16x32_bf16 v[52:55], a[24:27], a[88:91], v[52:55]
v_mfma_f32_16x16x32_bf16 v[180:183], a[28:31], a[88:91], v[180:183]
v_mfma_f32_16x16x32_bf16 v[180:183], a[12:15], a[72:75], v[180:183]
v_mfma_f32_16x16x32_bf16 v[184:187], a[12:15], a[76:79], v[184:187]
s_mov_b32 s76, s18
v_mfma_f32_16x16x32_bf16 v[184:187], a[28:31], a[92:95], v[184:187]
s_mov_b32 s77, s19
s_mov_b32 s78, 1835008
v_mfma_f32_16x16x32_bf16 v[56:59], a[24:27], a[92:95], v[56:59]
s_mov_b32 s59, 0
v_mfma_f32_16x16x32_bf16 v[56:59], a[8:11], a[76:79], v[56:59]
buffer_load_dword a255, v7, s[76:79], s59 offen
v_mfma_f32_16x16x32_bf16 v[188:191], a[4:7], a[76:79], v[188:191]
v_mfma_f32_16x16x32_bf16 v[188:191], a[20:23], a[92:95], v[188:191]
v_mfma_f32_16x16x32_bf16 v[60:63], a[16:19], a[92:95], v[60:63]
s_waitcnt vmcnt(19) lgkmcnt(0)
v_mfma_f32_16x16x32_bf16 v[60:63], a[0:3], a[76:79], v[60:63]
s_barrier
v_mfma_f32_16x16x32_bf16 v[64:67], a[64:67], a[96:99], v[64:67]
v_mfma_f32_16x16x32_bf16 v[64:67], a[80:83], a[112:115], v[64:67]
s_mov_b32 s60, s32
s_xor_b32 s61, s60, 0
s_and_b32 s61, s61, 1
v_mfma_f32_16x16x32_bf16 v[192:195], a[84:87], a[112:115], v[192:195]
s_lshl_b32 s84, s61, 19
ds_read_b64_tr_b16 a[0:1], v9 offset:32768
ds_read_b64_tr_b16 a[2:3], v9 offset:33280
v_mfma_f32_16x16x32_bf16 v[192:195], a[68:71], a[96:99], v[192:195]
s_mul_i32 s88, s61, 229376
s_lshl_b32 s92, s61, 10
s_xor_b32 s61, s60, 1
v_mfma_f32_16x16x32_bf16 v[68:71], a[72:75], a[96:99], v[68:71]
s_and_b32 s61, s61, 1
ds_read_b64_tr_b16 a[16:17], v9 offset:40960
ds_read_b64_tr_b16 a[18:19], v9 offset:41472
v_mfma_f32_16x16x32_bf16 v[68:71], a[88:91], a[112:115], v[68:71]
s_add_u32 m0, s57, 16384
s_add_u32 s52, s82, 3145728
s_lshl_b32 s85, s61, 19
v_mfma_f32_16x16x32_bf16 v[196:199], a[92:95], a[112:115], v[196:199]
buffer_load_dwordx4 v3, s[64:67], s52 offen offset:0  lds
v_mfma_f32_16x16x32_bf16 v[196:199], a[76:79], a[96:99], v[196:199]
s_mul_i32 s89, s61, 229376
s_lshl_b32 s93, s61, 10
v_mfma_f32_16x16x32_bf16 v[200:203], a[76:79], a[100:103], v[200:203]
ds_read_b64_tr_b16 a[4:5], v10 offset:32768
ds_read_b64_tr_b16 a[6:7], v10 offset:33280
v_mfma_f32_16x16x32_bf16 v[200:203], a[92:95], a[116:119], v[200:203]
v_mfma_f32_16x16x32_bf16 v[72:75], a[88:91], a[116:119], v[72:75]
ds_read_b64_tr_b16 a[20:21], v10 offset:40960
ds_read_b64_tr_b16 a[22:23], v10 offset:41472
v_mfma_f32_16x16x32_bf16 v[72:75], a[72:75], a[100:103], v[72:75]
s_add_u32 s52, s82, 3210240
v_mfma_f32_16x16x32_bf16 v[204:207], a[68:71], a[100:103], v[204:207]
buffer_load_dwordx4 v4, s[64:67], s52 offen offset:1024  lds
v_mfma_f32_16x16x32_bf16 v[204:207], a[84:87], a[116:119], v[204:207]
v_mfma_f32_16x16x32_bf16 v[76:79], a[80:83], a[116:119], v[76:79]
ds_read_b64_tr_b16 a[8:9], v11 offset:32768
ds_read_b64_tr_b16 a[10:11], v11 offset:33280
v_mfma_f32_16x16x32_bf16 v[76:79], a[64:67], a[100:103], v[76:79]
v_mfma_f32_16x16x32_bf16 v[80:83], a[64:67], a[104:107], v[80:83]
ds_read_b64_tr_b16 a[24:25], v11 offset:40960
ds_read_b64_tr_b16 a[26:27], v11 offset:41472
v_mfma_f32_16x16x32_bf16 v[80:83], a[80:83], a[120:123], v[80:83]
s_add_u32 s52, s82, 3274752
v_mfma_f32_16x16x32_bf16 v[208:211], a[84:87], a[120:123], v[208:211]
buffer_load_dwordx4 v3, s[64:67], s52 offen offset:2048  lds
v_mfma_f32_16x16x32_bf16 v[208:211], a[68:71], a[104:107], v[208:211]
v_mfma_f32_16x16x32_bf16 v[84:87], a[72:75], a[104:107], v[84:87]
ds_read_b64_tr_b16 a[12:13], v12 offset:32768
ds_read_b64_tr_b16 a[14:15], v12 offset:33280
v_mfma_f32_16x16x32_bf16 v[84:87], a[88:91], a[120:123], v[84:87]
v_mfma_f32_16x16x32_bf16 v[212:215], a[92:95], a[120:123], v[212:215]
ds_read_b64_tr_b16 a[28:29], v12 offset:40960
ds_read_b64_tr_b16 a[30:31], v12 offset:41472
v_mfma_f32_16x16x32_bf16 v[212:215], a[76:79], a[104:107], v[212:215]
s_add_u32 s52, s82, 3339264
v_mfma_f32_16x16x32_bf16 v[216:219], a[76:79], a[108:111], v[216:219]
buffer_load_dwordx4 v4, s[64:67], s52 offen offset:3072  lds
v_mfma_f32_16x16x32_bf16 v[216:219], a[92:95], a[124:127], v[216:219]
v_mfma_f32_16x16x32_bf16 v[88:91], a[88:91], a[124:127], v[88:91]
v_mfma_f32_16x16x32_bf16 v[88:91], a[72:75], a[108:111], v[88:91]
v_mfma_f32_16x16x32_bf16 v[220:223], a[68:71], a[108:111], v[220:223]
v_mfma_f32_16x16x32_bf16 v[220:223], a[84:87], a[124:127], v[220:223]
v_mfma_f32_16x16x32_bf16 v[92:95], a[80:83], a[124:127], v[92:95]
v_add_u32 v5, 0x10000, v5
v_add_u32 v6, 0x10000, v6
v_mfma_f32_16x16x32_bf16 v[92:95], a[64:67], a[108:111], v[92:95]
s_add_u32 m0, s58, 32768
s_add_u32 s55, s81, 768
v_mfma_f32_16x16x32_bf16 v[96:99], a[32:35], a[108:111], v[96:99]
L_t2:
s_cbranch_execz L_r0
buffer_load_dwordx4 v1, s[36:39], s55 offen offset:0  lds
v_mfma_f32_16x16x32_bf16 v[96:99], a[48:51], a[124:127], v[96:99]
v_mfma_f32_16x16x32_bf16 v[224:227], a[52:55], a[124:127], v[224:227]
ds_read_b128 a[64:67], v5 offset:0
ds_read_b128 a[80:83], v6 offset:0
v_mfma_f32_16x16x32_bf16 v[224:227], a[36:39], a[108:111], v[224:227]
v_mfma_f32_16x16x32_bf16 v[100:103], a[40:43], a[108:111], v[100:103]
ds_read_b128 a[68:71], v5 offset:2048
v_mfma_f32_16x16x32_bf16 v[100:103], a[56:59], a[124:127], v[100:103]
s_add_u32 s55, s81, 7936
v_mfma_f32_16x16x32_bf16 v[228:231], a[60:63], a[124:127], v[228:231]
buffer_load_dwordx4 v2, s[36:39], s55 offen offset:1024  lds
v_mfma_f32_16x16x32_bf16 v[228:231], a[44:47], a[108:111], v[228:231]
v_mfma_f32_16x16x32_bf16 v[232:235], a[44:47], a[104:107], v[232:235]
ds_read_b128 a[84:87], v6 offset:2048
ds_read_b128 a[72:75], v5 offset:4096
v_mfma_f32_16x16x32_bf16 v[232:235], a[60:63], a[120:123], v[232:235]
v_mfma_f32_16x16x32_bf16 v[104:107], a[56:59], a[120:123], v[104:107]
ds_read_b128 a[88:91], v6 offset:4096
v_mfma_f32_16x16x32_bf16 v[104:107], a[40:43], a[104:107], v[104:107]
s_add_u32 s55, s81, 15104
v_mfma_f32_16x16x32_bf16 v[236:239], a[36:39], a[104:107], v[236:239]
buffer_load_dwordx4 v1, s[36:39], s55 offen offset:2048  lds
v_mfma_f32_16x16x32_bf16 v[236:239], a[52:55], a[120:123], v[236:239]
v_mfma_f32_16x16x32_bf16 v[108:111], a[48:51], a[120:123], v[108:111]
ds_read_b128 a[76:79], v5 offset:6144
v_mfma_f32_16x16x32_bf16 v[108:111], a[32:35], a[104:107], v[108:111]
v_mfma_f32_16x16x32_bf16 v[112:115], a[32:35], a[100:103], v[112:115]
ds_read_b128 a[92:95], v6 offset:6144
v_mfma_f32_16x16x32_bf16 v[112:115], a[48:51], a[116:119], v[112:115]
s_add_u32 s55, s81, 22272
v_mfma_f32_16x16x32_bf16 v[240:243], a[52:55], a[116:119], v[240:243]
buffer_load_dwordx4 v2, s[36:39], s55 offen offset:3072  lds
v_mfma_f32_16x16x32_bf16 v[240:243], a[36:39], a[100:103], v[240:243]
v_mfma_f32_16x16x32_bf16 v[116:119], a[40:43], a[100:103], v[116:119]
v_mfma_f32_16x16x32_bf16 v[116:119], a[56:59], a[116:119], v[116:119]
v_mfma_f32_16x16x32_bf16 v[244:247], a[60:63], a[116:119], v[244:247]
v_mfma_f32_16x16x32_bf16 v[244:247], a[44:47], a[100:103], v[244:247]
v_mfma_f32_16x16x32_bf16 v[248:251], a[44:47], a[96:99], v[248:251]
s_mov_b32 s76, s20
v_mfma_f32_16x16x32_bf16 v[248:251], a[60:63], a[112:115], v[248:251]
s_mov_b32 s77, s21
s_mov_b32 s78, 1835008
v_mfma_f32_16x16x32_bf16 v[120:123], a[56:59], a[112:115], v[120:123]
s_mov_b32 s59, 0
v_mfma_f32_16x16x32_bf16 v[120:123], a[40:43], a[96:99], v[120:123]
buffer_load_dword a255, v7, s[76:79], s59 offen
v_mfma_f32_16x16x32_bf16 v[252:255], a[36:39], a[96:99], v[252:255]
v_mfma_f32_16x16x32_bf16 v[252:255], a[52:55], a[112:115], v[252:255]
v_mfma_f32_16x16x32_bf16 v[124:127], a[48:51], a[112:115], v[124:127]
s_waitcnt vmcnt(24) lgkmcnt(0)
v_mfma_f32_16x16x32_bf16 v[124:127], a[32:35], a[96:99], v[124:127]
s_barrier
v_mfma_f32_16x16x32_bf16 v[128:131], a[0:3], a[64:67], v[128:131]
v_mfma_f32_16x16x32_bf16 v[128:131], a[16:19], a[80:83], v[128:131]
v_mfma_f32_16x16x32_bf16 v[136:139], a[20:23], a[80:83], v[136:139]
ds_read_b128 a[32:35], v5 offset:8192
ds_read_b128 a[48:51], v6 offset:8192
v_mfma_f32_16x16x32_bf16 v[136:139], a[4:7], a[64:67], v[136:139]
v_mfma_f32_16x16x32_bf16 v[132:135], a[8:11], a[64:67], v[132:135]
ds_read_b128 a[36:39], v5 offset:10240
v_mfma_f32_16x16x32_bf16 v[132:135], a[24:27], a[80:83], v[132:135]
s_add_u32 m0, s57, 32768
s_add_u32 s52, s83, 3145728
v_mfma_f32_16x16x32_bf16 v[140:143], a[28:31], a[80:83], v[140:143]
buffer_load_dwordx4 v3, s[40:43], s52 offen offset:0  lds
v_mfma_f32_16x16x32_bf16 v[140:143], a[12:15], a[64:67], v[140:143]
v_mfma_f32_16x16x32_bf16 v[144:147], a[12:15], a[68:71], v[144:147]
ds_read_b128 a[52:55], v6 offset:10240
v_mfma_f32_16x16x32_bf16 v[144:147], a[28:31], a[84:87], v[144:147]
v_mfma_f32_16x16x32_bf16 v[16:19], a[24:27], a[84:87], v[16:19]
ds_read_b128 a[40:43], v5 offset:12288
v_mfma_f32_16x16x32_bf16 v[16:19], a[8:11], a[68:71], v[16:19]
s_add_u32 s52, s83, 3210240
v_mfma_f32_16x16x32_bf16 v[148:151], a[4:7], a[68:71], v[148:151]
buffer_load_dwordx4 v4, s[40:43], s52 offen offset:1024  lds
v_mfma_f32_16x16x32_bf16 v[148:151], a[20:23], a[84:87], v[148:151]
v_mfma_f32_16x16x32_bf16 v[20:23], a[16:19], a[84:87], v[20:23]
ds_read_b128 a[56:59], v6 offset:12288
v_mfma_f32_16x16x32_bf16 v[20:23], a[0:3], a[68:71], v[20:23]
v_mfma_f32_16x16x32_bf16 a[128:131], a[0:3], a[72:75], a[128:131]
ds_read_b128 a[44:47], v5 offset:14336
v_mfma_f32_16x16x32_bf16 a[128:131], a[16:19], a[88:91], a[128:131]
s_add_u32 s52, s83, 3274752
v_mfma_f32_16x16x32_bf16 a[132:135], a[20:23], a[88:91], a[132:135]
buffer_load_dwordx4 v3, s[40:43], s52 offen offset:2048  lds
v_mfma_f32_16x16x32_bf16 a[132:135], a[4:7], a[72:75], a[132:135]
v_mfma_f32_16x16x32_bf16 a[136:139], a[8:11], a[72:75], a[136:139]
ds_read_b128 a[60:63], v6 offset:14336
v_mfma_f32_16x16x32_bf16 a[136:139], a[24:27], a[88:91], a[136:139]
v_mfma_f32_16x16x32_bf16 a[140:143], a[28:31], a[88:91], a[140:143]
v_mfma_f32_16x16x32_bf16 a[140:143], a[12:15], a[72:75], a[140:143]
s_add_u32 s52, s83, 3339264
v_mfma_f32_16x16x32_bf16 v[152:155], a[12:15], a[76:79], v[152:155]
buffer_load_dwordx4 v4, s[40:43], s52 offen offset:3072  lds
v_mfma_f32_16x16x32_bf16 v[152:155], a[28:31], a[92:95], v[152:155]
v_mfma_f32_16x16x32_bf16 v[24:27], a[24:27], a[92:95], v[24:27]
v_mfma_f32_16x16x32_bf16 v[24:27], a[8:11], a[76:79], v[24:27]
v_mfma_f32_16x16x32_bf16 v[156:159], a[4:7], a[76:79], v[156:159]
ds_read_b64_tr_b16 a[96:97], v13 offset:49152
ds_read_b64_tr_b16 a[98:99], v13 offset:49664
v_mfma_f32_16x16x32_bf16 v[156:159], a[20:23], a[92:95], v[156:159]
v_mfma_f32_16x16x32_bf16 v[28:31], a[16:19], a[92:95], v[28:31]
s_waitcnt lgkmcnt(2)
ds_read_b64_tr_b16 a[112:113], v13 offset:57344
ds_read_b64_tr_b16 a[114:115], v13 offset:57856
v_mfma_f32_16x16x32_bf16 v[28:31], a[0:3], a[76:79], v[28:31]
s_add_u32 m0, s58, 36864
s_add_u32 s55, s81, 33536
v_mfma_f32_16x16x32_bf16 v[32:35], a[0:3], a[32:35], v[32:35]
buffer_load_dwordx4 v1, s[36:39], s55 offen offset:0  lds
v_mfma_f32_16x16x32_bf16 v[32:35], a[16:19], a[48:51], v[32:35]
v_mfma_f32_16x16x32_bf16 v[160:163], a[20:23], a[48:51], v[160:163]
ds_read_b64_tr_b16 a[100:101], v14 offset:49152
ds_read_b64_tr_b16 a[102:103], v14 offset:49664
v_mfma_f32_16x16x32_bf16 v[160:163], a[4:7], a[32:35], v[160:163]
v_mfma_f32_16x16x32_bf16 v[36:39], a[8:11], a[32:35], v[36:39]
ds_read_b64_tr_b16 a[116:117], v14 offset:57344
ds_read_b64_tr_b16 a[118:119], v14 offset:57856
v_mfma_f32_16x16x32_bf16 v[36:39], a[24:27], a[48:51], v[36:39]
s_add_u32 s55, s81, 40704
v_mfma_f32_16x16x32_bf16 v[164:167], a[28:31], a[48:51], v[164:167]
buffer_load_dwordx4 v2, s[36:39], s55 offen offset:1024  lds
v_mfma_f32_16x16x32_bf16 v[164:167], a[12:15], a[32:35], v[164:167]
v_mfma_f32_16x16x32_bf16 v[168:171], a[12:15], a[36:39], v[168:171]
ds_read_b64_tr_b16 a[104:105], v13 offset:53248
ds_read_b64_tr_b16 a[106:107], v13 offset:53760
v_mfma_f32_16x16x32_bf16 v[168:171], a[28:31], a[52:55], v[168:171]
v_mfma_f32_16x16x32_bf16 v[40:43], a[24:27], a[52:55], v[40:43]
ds_read_b64_tr_b16 a[120:121], v13 offset:61440
ds_read_b64_tr_b16 a[122:123], v13 offset:61952
v_mfma_f32_16x16x32_bf16 v[40:43], a[8:11], a[36:39], v[40:43]
s_add_u32 s55, s81, 47872
v_mfma_f32_16x16x32_bf16 v[172:175], a[4:7], a[36:39], v[172:175]
buffer_load_dwordx4 v1, s[36:39], s55 offen offset:2048  lds
v_mfma_f32_16x16x32_bf16 v[172:175], a[20:23], a[52:55], v[172:175]
v_mfma_f32_16x16x32_bf16 v[44:47], a[16:19], a[52:55], v[44:47]
ds_read_b64_tr_b16 a[108:109], v14 offset:53248
ds_read_b64_tr_b16 a[110:111], v14 offset:53760
v_mfma_f32_16x16x32_bf16 v[44:47], a[0:3], a[36:39], v[44:47]
v_mfma_f32_16x16x32_bf16 v[48:51], a[0:3], a[40:43], v[48:51]
ds_read_b64_tr_b16 a[124:125], v14 offset:61440
ds_read_b64_tr_b16 a[126:127], v14 offset:61952
v_mfma_f32_16x16x32_bf16 v[48:51], a[16:19], a[56:59], v[48:51]
s_add_u32 s55, s81, 55040
v_mfma_f32_16x16x32_bf16 v[176:179], a[20:23], a[56:59], v[176:179]
buffer_load_dwordx4 v2, s[36:39], s55 offen offset:3072  lds
v_mfma_f32_16x16x32_bf16 v[176:179], a[4:7], a[40:43], v[176:179]
v_mfma_f32_16x16x32_bf16 v[52:55], a[8:11], a[40:43], v[52:55]
v_mfma_f32_16x16x32_bf16 v[52:55], a[24:27], a[56:59], v[52:55]
v_mfma_f32_16x16x32_bf16 v[180:183], a[28:31], a[56:59], v[180:183]
v_mfma_f32_16x16x32_bf16 v[180:183], a[12:15], a[40:43], v[180:183]
v_mfma_f32_16x16x32_bf16 v[184:187], a[12:15], a[44:47], v[184:187]
s_mov_b32 s76, s8
v_mfma_f32_16x16x32_bf16 v[184:187], a[28:31], a[60:63], v[184:187]
s_mov_b32 s77, s9
s_mov_b32 s78, 4194304
v_mfma_f32_16x16x32_bf16 v[56:59], a[24:27], a[60:63], v[56:59]
s_mov_b32 s59, 2097152
v_mfma_f32_16x16x32_bf16 v[56:59], a[8:11], a[44:47], v[56:59]
buffer_load_dword a255, v7, s[76:79], s59 offen
v_mfma_f32_16x16x32_bf16 v[188:191], a[4:7], a[44:47], v[188:191]
v_mfma_f32_16x16x32_bf16 v[188:191], a[20:23], a[60:63], v[188:191]
v_mfma_f32_16x16x32_bf16 v[60:63], a[16:19], a[60:63], v[60:63]
s_waitcnt vmcnt(19) lgkmcnt(0)
v_mfma_f32_16x16x32_bf16 v[60:63], a[0:3], a[44:47], v[60:63]
s_barrier
v_accvgpr_read_b32 v7, a252
v_mfma_f32_16x16x32_bf16 v[64:67], a[32:35], a[96:99], v[64:67]
v_mfma_f32_16x16x32_bf16 v[64:67], a[48:51], a[112:115], v[64:67]
v_cmp_ne_u32 vcc, s3, v7
s_cbranch_vccnz L_xn_spin
L_xn:
v_mfma_f32_16x16x32_bf16 v[192:195], a[52:55], a[112:115], v[192:195]
ds_read_b64_tr_b16 a[0:1], v9 offset:0
ds_read_b64_tr_b16 a[2:3], v9 offset:512
v_mfma_f32_16x16x32_bf16 v[192:195], a[36:39], a[96:99], v[192:195]
v_mfma_f32_16x16x32_bf16 v[68:71], a[40:43], a[96:99], v[68:71]
ds_read_b64_tr_b16 a[16:17], v9 offset:8192
ds_read_b64_tr_b16 a[18:19], v9 offset:8704
v_mfma_f32_16x16x32_bf16 v[68:71], a[56:59], a[112:115], v[68:71]
s_add_u32 m0, s57, 49152
s_add_u32 s52, s83, 3145728
v_mfma_f32_16x16x32_bf16 v[196:199], a[60:63], a[112:115], v[196:199]
buffer_load_dwordx4 v3, s[64:67], s52 offen offset:0  lds
v_mfma_f32_16x16x32_bf16 v[196:199], a[44:47], a[96:99], v[196:199]
s_mov_b32 s36, s28
v_add_u32 v1, s68, v15
v_add_u32 v2, s68, v15
v_mfma_f32_16x16x32_bf16 v[200:203], a[44:47], a[100:103], v[200:203]
ds_read_b64_tr_b16 a[4:5], v10 offset:0
ds_read_b64_tr_b16 a[6:7], v10 offset:512
v_mfma_f32_16x16x32_bf16 v[200:203], a[60:63], a[116:119], v[200:203]
s_mov_b32 s37, s29
v_mfma_f32_16x16x32_bf16 v[72:75], a[56:59], a[116:119], v[72:75]
ds_read_b64_tr_b16 a[20:21], v10 offset:8192
ds_read_b64_tr_b16 a[22:23], v10 offset:8704
v_mfma_f32_16x16x32_bf16 v[72:75], a[40:43], a[100:103], v[72:75]
s_add_u32 s52, s83, 3210240
v_mfma_f32_16x16x32_bf16 v[204:207], a[36:39], a[100:103], v[204:207]
buffer_load_dwordx4 v4, s[64:67], s52 offen offset:1024  lds
v_mfma_f32_16x16x32_bf16 v[204:207], a[52:55], a[116:119], v[204:207]
v_mfma_f32_16x16x32_bf16 v[76:79], a[48:51], a[116:119], v[76:79]
ds_read_b64_tr_b16 a[8:9], v11 offset:0
ds_read_b64_tr_b16 a[10:11], v11 offset:512
v_mfma_f32_16x16x32_bf16 v[76:79], a[32:35], a[100:103], v[76:79]
v_mfma_f32_16x16x32_bf16 v[80:83], a[32:35], a[104:107], v[80:83]
ds_read_b64_tr_b16 a[24:25], v11 offset:8192
ds_read_b64_tr_b16 a[26:27], v11 offset:8704
v_mfma_f32_16x16x32_bf16 v[80:83], a[48:51], a[120:123], v[80:83]
s_add_u32 s52, s83, 3274752
v_mfma_f32_16x16x32_bf16 v[208:211], a[52:55], a[120:123], v[208:211]
buffer_load_dwordx4 v3, s[64:67], s52 offen offset:2048  lds
v_mfma_f32_16x16x32_bf16 v[208:211], a[36:39], a[104:107], v[208:211]
v_mfma_f32_16x16x32_bf16 v[84:87], a[40:43], a[104:107], v[84:87]
ds_read_b64_tr_b16 a[12:13], v12 offset:0
ds_read_b64_tr_b16 a[14:15], v12 offset:512
v_mfma_f32_16x16x32_bf16 v[84:87], a[56:59], a[120:123], v[84:87]
v_mfma_f32_16x16x32_bf16 v[212:215], a[60:63], a[120:123], v[212:215]
ds_read_b64_tr_b16 a[28:29], v12 offset:8192
ds_read_b64_tr_b16 a[30:31], v12 offset:8704
v_mfma_f32_16x16x32_bf16 v[212:215], a[44:47], a[104:107], v[212:215]
s_add_u32 s52, s83, 3339264
v_mfma_f32_16x16x32_bf16 v[216:219], a[44:47], a[108:111], v[216:219]
buffer_load_dwordx4 v4, s[64:67], s52 offen offset:3072  lds
v_mfma_f32_16x16x32_bf16 v[216:219], a[60:63], a[124:127], v[216:219]
v_mfma_f32_16x16x32_bf16 v[88:91], a[56:59], a[124:127], v[88:91]
v_mfma_f32_16x16x32_bf16 v[88:91], a[40:43], a[108:111], v[88:91]
v_mfma_f32_16x16x32_bf16 v[220:223], a[36:39], a[108:111], v[220:223]
v_mfma_f32_16x16x32_bf16 v[220:223], a[52:55], a[124:127], v[220:223]
v_mfma_f32_16x16x32_bf16 v[92:95], a[48:51], a[124:127], v[92:95]
v_add_u32 v5, 0xffff0000, v5
v_add_u32 v6, 0xffff0000, v6
v_mfma_f32_16x16x32_bf16 v[92:95], a[32:35], a[108:111], v[92:95]
s_add_u32 m0, s58, 65536
s_add_u32 s55, s92, 0
v_mfma_f32_16x16x32_bf16 v[96:99], a[64:67], a[108:111], v[96:99]
buffer_load_dwordx4 v1, s[36:39], s55 offen offset:0 sc1 lds
v_mfma_f32_16x16x32_bf16 v[96:99], a[80:83], a[124:127], v[96:99]
v_mfma_f32_16x16x32_bf16 v[224:227], a[84:87], a[124:127], v[224:227]
ds_read_b128 a[32:35], v5 offset:0
ds_read_b128 a[48:51], v6 offset:0
v_mfma_f32_16x16x32_bf16 v[224:227], a[68:71], a[108:111], v[224:227]
v_mfma_f32_16x16x32_bf16 v[100:103], a[72:75], a[108:111], v[100:103]
ds_read_b128 a[36:39], v5 offset:2048
v_mfma_f32_16x16x32_bf16 v[100:103], a[88:91], a[124:127], v[100:103]
s_add_u32 s55, s92, 7168
v_mfma_f32_16x16x32_bf16 v[228:231], a[92:95], a[124:127], v[228:231]
buffer_load_dwordx4 v2, s[36:39], s55 offen offset:1024 sc1 lds
v_mfma_f32_16x16x32_bf16 v[228:231], a[76:79], a[108:111], v[228:231]
v_mfma_f32_16x16x32_bf16 v[232:235], a[76:79], a[104:107], v[232:235]
ds_read_b128 a[52:55], v6 offset:2048
ds_read_b128 a[40:43], v5 offset:4096
v_mfma_f32_16x16x32_bf16 v[232:235], a[92:95], a[120:123], v[232:235]
v_mfma_f32_16x16x32_bf16 v[104:107], a[88:91], a[120:123], v[104:107]
ds_read_b128 a[56:59], v6 offset:4096
v_mfma_f32_16x16x32_bf16 v[104:107], a[72:75], a[104:107], v[104:107]
s_add_u32 s55, s92, 14336
v_mfma_f32_16x16x32_bf16 v[236:239], a[68:71], a[104:107], v[236:239]
buffer_load_dwordx4 v1, s[36:39], s55 offen offset:2048 sc1 lds
v_mfma_f32_16x16x32_bf16 v[236:239], a[84:87], a[120:123], v[236:239]
v_mfma_f32_16x16x32_bf16 v[108:111], a[80:83], a[120:123], v[108:111]
ds_read_b128 a[44:47], v5 offset:6144
v_mfma_f32_16x16x32_bf16 v[108:111], a[64:67], a[104:107], v[108:111]
v_mfma_f32_16x16x32_bf16 v[112:115], a[64:67], a[100:103], v[112:115]
ds_read_b128 a[60:63], v6 offset:6144
v_mfma_f32_16x16x32_bf16 v[112:115], a[80:83], a[116:119], v[112:115]
s_add_u32 s55, s92, 21504
v_mfma_f32_16x16x32_bf16 v[240:243], a[84:87], a[116:119], v[240:243]
buffer_load_dwordx4 v2, s[36:39], s55 offen offset:3072 sc1 lds
v_mfma_f32_16x16x32_bf16 v[240:243], a[68:71], a[100:103], v[240:243]
v_mfma_f32_16x16x32_bf16 v[116:119], a[72:75], a[100:103], v[116:119]
v_mfma_f32_16x16x32_bf16 v[116:119], a[88:91], a[116:119], v[116:119]
v_mfma_f32_16x16x32_bf16 v[244:247], a[92:95], a[116:119], v[244:247]
v_mfma_f32_16x16x32_bf16 v[244:247], a[76:79], a[100:103], v[244:247]
v_mfma_f32_16x16x32_bf16 v[248:251], a[76:79], a[96:99], v[248:251]
v_mfma_f32_16x16x32_bf16 v[248:251], a[92:95], a[112:115], v[248:251]
s_mov_b32 s40, s8
v_accvgpr_read_b32 v7, a250
v_accvgpr_read_b32 v8, a251
v_mfma_f32_16x16x32_bf16 v[120:123], a[88:91], a[112:115], v[120:123]
s_mov_b32 s41, s9
v_mfma_f32_16x16x32_bf16 v[120:123], a[72:75], a[96:99], v[120:123]
s_cmp_eq_u32 s34, 0
s_cselect_b32 s64, s18, s20
s_cselect_b32 s65, s19, s21
v_mfma_f32_16x16x32_bf16 v[252:255], a[68:71], a[96:99], v[252:255]
s_mov_b32 s66, 1835008
v_mfma_f32_16x16x32_bf16 v[252:255], a[84:87], a[112:115], v[252:255]
v_mfma_f32_16x16x32_bf16 v[124:127], a[80:83], a[112:115], v[124:127]
s_waitcnt vmcnt(22) lgkmcnt(0)
v_mfma_f32_16x16x32_bf16 v[124:127], a[64:67], a[96:99], v[124:127]
s_barrier
v_mfma_f32_16x16x32_bf16 v[128:131], a[0:3], a[32:35], v[128:131]
v_mfma_f32_16x16x32_bf16 v[128:131], a[16:19], a[48:51], v[128:131]
v_mfma_f32_16x16x32_bf16 v[136:139], a[20:23], a[48:51], v[136:139]
ds_read_b128 a[64:67], v5 offset:8192
ds_read_b128 a[80:83], v6 offset:8192
v_mfma_f32_16x16x32_bf16 v[136:139], a[4:7], a[32:35], v[136:139]
v_mfma_f32_16x16x32_bf16 v[132:135], a[8:11], a[32:35], v[132:135]
ds_read_b128 a[68:71], v5 offset:10240
v_mfma_f32_16x16x32_bf16 v[132:135], a[24:27], a[48:51], v[132:135]
s_add_u32 m0, s57, 0
s_add_u32 s52, s84, 0
v_mfma_f32_16x16x32_bf16 v[140:143], a[28:31], a[48:51], v[140:143]
buffer_load_dwordx4 v3, s[40:43], s52 offen offset:0  lds
v_mfma_f32_16x16x32_bf16 v[140:143], a[12:15], a[32:35], v[140:143]
v_mfma_f32_16x16x32_bf16 v[144:147], a[12:15], a[36:39], v[144:147]
ds_read_b128 a[84:87], v6 offset:10240
v_mfma_f32_16x16x32_bf16 v[144:147], a[28:31], a[52:55], v[144:147]
v_mfma_f32_16x16x32_bf16 v[16:19], a[24:27], a[52:55], v[16:19]
ds_read_b128 a[72:75], v5 offset:12288
v_mfma_f32_16x16x32_bf16 v[16:19], a[8:11], a[36:39], v[16:19]
s_add_u32 s52, s84, 64512
v_mfma_f32_16x16x32_bf16 v[148:151], a[4:7], a[36:39], v[148:151]
buffer_load_dwordx4 v4, s[40:43], s52 offen offset:1024  lds
v_mfma_f32_16x16x32_bf16 v[148:151], a[20:23], a[52:55], v[148:151]
v_mfma_f32_16x16x32_bf16 v[20:23], a[16:19], a[52:55], v[20:23]
ds_read_b128 a[88:91], v6 offset:12288
v_mfma_f32_16x16x32_bf16 v[20:23], a[0:3], a[36:39], v[20:23]
v_mfma_f32_16x16x32_bf16 a[128:131], a[0:3], a[40:43], a[128:131]
ds_read_b128 a[76:79], v5 offset:14336
v_mfma_f32_16x16x32_bf16 a[128:131], a[16:19], a[56:59], a[128:131]
s_add_u32 s52, s84, 129024
v_mfma_f32_16x16x32_bf16 a[132:135], a[20:23], a[56:59], a[132:135]
buffer_load_dwordx4 v3, s[40:43], s52 offen offset:2048  lds
v_mfma_f32_16x16x32_bf16 a[132:135], a[4:7], a[40:43], a[132:135]
v_mfma_f32_16x16x32_bf16 a[136:139], a[8:11], a[40:43], a[136:139]
ds_read_b128 a[92:95], v6 offset:14336
v_mfma_f32_16x16x32_bf16 a[136:139], a[24:27], a[56:59], a[136:139]
v_mfma_f32_16x16x32_bf16 a[140:143], a[28:31], a[56:59], a[140:143]
v_mfma_f32_16x16x32_bf16 a[140:143], a[12:15], a[40:43], a[140:143]
s_add_u32 s52, s84, 193536
v_mfma_f32_16x16x32_bf16 v[152:155], a[12:15], a[44:47], v[152:155]
buffer_load_dwordx4 v4, s[40:43], s52 offen offset:3072  lds
v_mfma_f32_16x16x32_bf16 v[152:155], a[28:31], a[60:63], v[152:155]
v_mfma_f32_16x16x32_bf16 v[24:27], a[24:27], a[60:63], v[24:27]
v_mfma_f32_16x16x32_bf16 v[24:27], a[8:11], a[44:47], v[24:27]
v_mfma_f32_16x16x32_bf16 v[156:159], a[4:7], a[44:47], v[156:159]
ds_read_b64_tr_b16 a[96:97], v13 offset:16384
ds_read_b64_tr_b16 a[98:99], v13 offset:16896
v_mfma_f32_16x16x32_bf16 v[156:159], a[20:23], a[60:63], v[156:159]
v_mfma_f32_16x16x32_bf16 v[28:31], a[16:19], a[60:63], v[28:31]
s_waitcnt lgkmcnt(2)
ds_read_b64_tr_b16 a[112:113], v13 offset:24576
ds_read_b64_tr_b16 a[114:115], v13 offset:25088
v_mfma_f32_16x16x32_bf16 v[28:31], a[0:3], a[44:47], v[28:31]
s_add_u32 m0, s58, 69632
s_add_u32 s55, s92, 32768
v_mfma_f32_16x16x32_bf16 v[32:35], a[0:3], a[64:67], v[32:35]
buffer_load_dwordx4 v1, s[36:39], s55 offen offset:0 sc1 lds
v_mfma_f32_16x16x32_bf16 v[32:35], a[16:19], a[80:83], v[32:35]
v_mfma_f32_16x16x32_bf16 v[160:163], a[20:23], a[80:83], v[160:163]
ds_read_b64_tr_b16 a[100:101], v14 offset:16384
ds_read_b64_tr_b16 a[102:103], v14 offset:16896
v_mfma_f32_16x16x32_bf16 v[160:163], a[4:7], a[64:67], v[160:163]
v_mfma_f32_16x16x32_bf16 v[36:39], a[8:11], a[64:67], v[36:39]
ds_read_b64_tr_b16 a[116:117], v14 offset:24576
ds_read_b64_tr_b16 a[118:119], v14 offset:25088
v_mfma_f32_16x16x32_bf16 v[36:39], a[24:27], a[80:83], v[36:39]
s_add_u32 s55, s92, 39936
v_mfma_f32_16x16x32_bf16 v[164:167], a[28:31], a[80:83], v[164:167]
buffer_load_dwordx4 v2, s[36:39], s55 offen offset:1024 sc1 lds
v_mfma_f32_16x16x32_bf16 v[164:167], a[12:15], a[64:67], v[164:167]
v_mfma_f32_16x16x32_bf16 v[168:171], a[12:15], a[68:71], v[168:171]
ds_read_b64_tr_b16 a[104:105], v13 offset:20480
ds_read_b64_tr_b16 a[106:107], v13 offset:20992
v_mfma_f32_16x16x32_bf16 v[168:171], a[28:31], a[84:87], v[168:171]
v_mfma_f32_16x16x32_bf16 v[40:43], a[24:27], a[84:87], v[40:43]
ds_read_b64_tr_b16 a[120:121], v13 offset:28672
ds_read_b64_tr_b16 a[122:123], v13 offset:29184
v_mfma_f32_16x16x32_bf16 v[40:43], a[8:11], a[68:71], v[40:43]
s_add_u32 s55, s92, 47104
v_mfma_f32_16x16x32_bf16 v[172:175], a[4:7], a[68:71], v[172:175]
buffer_load_dwordx4 v1, s[36:39], s55 offen offset:2048 sc1 lds
v_mfma_f32_16x16x32_bf16 v[172:175], a[20:23], a[84:87], v[172:175]
v_mfma_f32_16x16x32_bf16 v[44:47], a[16:19], a[84:87], v[44:47]
ds_read_b64_tr_b16 a[108:109], v14 offset:20480
ds_read_b64_tr_b16 a[110:111], v14 offset:20992
v_mfma_f32_16x16x32_bf16 v[44:47], a[0:3], a[68:71], v[44:47]
v_mfma_f32_16x16x32_bf16 v[48:51], a[0:3], a[72:75], v[48:51]
ds_read_b64_tr_b16 a[124:125], v14 offset:28672
ds_read_b64_tr_b16 a[126:127], v14 offset:29184
v_mfma_f32_16x16x32_bf16 v[48:51], a[16:19], a[88:91], v[48:51]
s_add_u32 s55, s92, 54272
v_mfma_f32_16x16x32_bf16 v[176:179], a[20:23], a[88:91], v[176:179]
buffer_load_dwordx4 v2, s[36:39], s55 offen offset:3072 sc1 lds
v_mfma_f32_16x16x32_bf16 v[176:179], a[4:7], a[72:75], v[176:179]
v_mfma_f32_16x16x32_bf16 v[52:55], a[8:11], a[72:75], v[52:55]
v_mfma_f32_16x16x32_bf16 v[52:55], a[24:27], a[88:91], v[52:55]
v_mfma_f32_16x16x32_bf16 v[180:183], a[28:31], a[88:91], v[180:183]
v_mfma_f32_16x16x32_bf16 v[180:183], a[12:15], a[72:75], v[180:183]
v_mfma_f32_16x16x32_bf16 v[184:187], a[12:15], a[76:79], v[184:187]
v_mfma_f32_16x16x32_bf16 v[184:187], a[28:31], a[92:95], v[184:187]
v_mfma_f32_16x16x32_bf16 v[56:59], a[24:27], a[92:95], v[56:59]
v_mfma_f32_16x16x32_bf16 v[56:59], a[8:11], a[76:79], v[56:59]
v_mfma_f32_16x16x32_bf16 v[188:191], a[4:7], a[76:79], v[188:191]
v_mfma_f32_16x16x32_bf16 v[188:191], a[20:23], a[92:95], v[188:191]
v_mfma_f32_16x16x32_bf16 v[60:63], a[16:19], a[92:95], v[60:63]
s_waitcnt vmcnt(17) lgkmcnt(0)
v_mfma_f32_16x16x32_bf16 v[60:63], a[0:3], a[76:79], v[60:63]
s_barrier
v_mfma_f32_16x16x32_bf16 v[64:67], a[64:67], a[96:99], v[64:67]
v_xor_b32 v3, v3, v7
v_xor_b32 v4, v4, v8
v_mfma_f32_16x16x32_bf16 v[64:67], a[80:83], a[112:115], v[64:67]
v_mfma_f32_16x16x32_bf16 v[192:195], a[84:87], a[112:115], v[192:195]
ds_read_b64_tr_b16 a[0:1], v9 offset:32768
ds_read_b64_tr_b16 a[2:3], v9 offset:33280
v_mfma_f32_16x16x32_bf16 v[192:195], a[68:71], a[96:99], v[192:195]
v_mfma_f32_16x16x32_bf16 v[68:71], a[72:75], a[96:99], v[68:71]
ds_read_b64_tr_b16 a[16:17], v9 offset:40960
ds_read_b64_tr_b16 a[18:19], v9 offset:41472
v_mfma_f32_16x16x32_bf16 v[68:71], a[88:91], a[112:115], v[68:71]
s_add_u32 m0, s57, 16384
s_add_u32 s52, s88, 0
v_mfma_f32_16x16x32_bf16 v[196:199], a[92:95], a[112:115], v[196:199]
buffer_load_dwordx4 v3, s[64:67], s52 offen offset:0  lds
v_mfma_f32_16x16x32_bf16 v[196:199], a[76:79], a[96:99], v[196:199]
v_mfma_f32_16x16x32_bf16 v[200:203], a[76:79], a[100:103], v[200:203]
ds_read_b64_tr_b16 a[4:5], v10 offset:32768
ds_read_b64_tr_b16 a[6:7], v10 offset:33280
v_mfma_f32_16x16x32_bf16 v[200:203], a[92:95], a[116:119], v[200:203]
v_mfma_f32_16x16x32_bf16 v[72:75], a[88:91], a[116:119], v[72:75]
ds_read_b64_tr_b16 a[20:21], v10 offset:40960
ds_read_b64_tr_b16 a[22:23], v10 offset:41472
v_mfma_f32_16x16x32_bf16 v[72:75], a[72:75], a[100:103], v[72:75]
s_add_u32 m0, s58, 0
s_add_u32 s55, s93, 0
v_mfma_f32_16x16x32_bf16 v[204:207], a[68:71], a[100:103], v[204:207]
buffer_load_dwordx4 v1, s[36:39], s55 offen offset:0 sc1 lds
v_mfma_f32_16x16x32_bf16 v[204:207], a[84:87], a[116:119], v[204:207]
v_mfma_f32_16x16x32_bf16 v[76:79], a[80:83], a[116:119], v[76:79]
ds_read_b64_tr_b16 a[8:9], v11 offset:32768
ds_read_b64_tr_b16 a[10:11], v11 offset:33280
v_mfma_f32_16x16x32_bf16 v[76:79], a[64:67], a[100:103], v[76:79]
v_mfma_f32_16x16x32_bf16 v[80:83], a[64:67], a[104:107], v[80:83]
ds_read_b64_tr_b16 a[24:25], v11 offset:40960
ds_read_b64_tr_b16 a[26:27], v11 offset:41472
v_mfma_f32_16x16x32_bf16 v[80:83], a[80:83], a[120:123], v[80:83]
s_add_u32 m0, s57, 16384
s_add_u32 s52, s88, 27648
v_mfma_f32_16x16x32_bf16 v[208:211], a[84:87], a[120:123], v[208:211]
buffer_load_dwordx4 v4, s[64:67], s52 offen offset:1024  lds
v_mfma_f32_16x16x32_bf16 v[208:211], a[68:71], a[104:107], v[208:211]
v_mfma_f32_16x16x32_bf16 v[84:87], a[72:75], a[104:107], v[84:87]
ds_read_b64_tr_b16 a[12:13], v12 offset:32768
ds_read_b64_tr_b16 a[14:15], v12 offset:33280
v_mfma_f32_16x16x32_bf16 v[84:87], a[88:91], a[120:123], v[84:87]
v_mfma_f32_16x16x32_bf16 v[212:215], a[92:95], a[120:123], v[212:215]
ds_read_b64_tr_b16 a[28:29], v12 offset:40960
ds_read_b64_tr_b16 a[30:31], v12 offset:41472
v_mfma_f32_16x16x32_bf16 v[212:215], a[76:79], a[104:107], v[212:215]
s_add_u32 m0, s58, 0
s_add_u32 s55, s93, 7168
v_mfma_f32_16x16x32_bf16 v[216:219], a[76:79], a[108:111], v[216:219]
buffer_load_dwordx4 v2, s[36:39], s55 offen offset:1024 sc1 lds
v_mfma_f32_16x16x32_bf16 v[216:219], a[92:95], a[124:127], v[216:219]
v_mfma_f32_16x16x32_bf16 v[88:91], a[88:91], a[124:127], v[88:91]
v_mfma_f32_16x16x32_bf16 v[88:91], a[72:75], a[108:111], v[88:91]
v_mfma_f32_16x16x32_bf16 v[220:223], a[68:71], a[108:111], v[220:223]
v_mfma_f32_16x16x32_bf16 v[220:223], a[84:87], a[124:127], v[220:223]
v_mfma_f32_16x16x32_bf16 v[92:95], a[80:83], a[124:127], v[92:95]
v_mfma_f32_16x16x32_bf16 v[92:95], a[64:67], a[108:111], v[92:95]
s_add_u32 m0, s57, 16384
s_add_u32 s52, s88, 55296
v_mfma_f32_16x16x32_bf16 v[96:99], a[32:35], a[108:111], v[96:99]
buffer_load_dwordx4 v3, s[64:67], s52 offen offset:2048  lds
v_mfma_f32_16x16x32_bf16 v[96:99], a[48:51], a[124:127], v[96:99]
v_mfma_f32_16x16x32_bf16 v[224:227], a[52:55], a[124:127], v[224:227]
ds_read_b128 a[64:67], v5 offset:32768
ds_read_b128 a[80:83], v6 offset:32768
v_mfma_f32_16x16x32_bf16 v[224:227], a[36:39], a[108:111], v[224:227]
v_mfma_f32_16x16x32_bf16 v[100:103], a[40:43], a[108:111], v[100:103]
ds_read_b128 a[68:71], v5 offset:34816
v_mfma_f32_16x16x32_bf16 v[100:103], a[56:59], a[124:127], v[100:103]
s_add_u32 m0, s58, 0
s_add_u32 s55, s93, 14336
v_mfma_f32_16x16x32_bf16 v[228:231], a[60:63], a[124:127], v[228:231]
buffer_load_dwordx4 v1, s[36:39], s55 offen offset:2048 sc1 lds
v_mfma_f32_16x16x32_bf16 v[228:231], a[44:47], a[108:111], v[228:231]
v_mfma_f32_16x16x32_bf16 v[232:235], a[44:47], a[104:107], v[232:235]
ds_read_b128 a[84:87], v6 offset:34816
ds_read_b128 a[72:75], v5 offset:36864
v_mfma_f32_16x16x32_bf16 v[232:235], a[60:63], a[120:123], v[232:235]
v_mfma_f32_16x16x32_bf16 v[104:107], a[56:59], a[120:123], v[104:107]
ds_read_b128 a[88:91], v6 offset:36864
v_mfma_f32_16x16x32_bf16 v[104:107], a[40:43], a[104:107], v[104:107]
s_add_u32 m0, s57, 16384
s_add_u32 s52, s88, 82944
v_mfma_f32_16x16x32_bf16 v[236:239], a[36:39], a[104:107], v[236:239]
buffer_load_dwordx4 v4, s[64:67], s52 offen offset:3072  lds
v_mfma_f32_16x16x32_bf16 v[236:239], a[52:55], a[120:123], v[236:239]
v_mfma_f32_16x16x32_bf16 v[108:111], a[48:51], a[120:123], v[108:111]
ds_read_b128 a[76:79], v5 offset:38912
v_mfma_f32_16x16x32_bf16 v[108:111], a[32:35], a[104:107], v[108:111]
v_mfma_f32_16x16x32_bf16 v[112:115], a[32:35], a[100:103], v[112:115]
ds_read_b128 a[92:95], v6 offset:38912
v_mfma_f32_16x16x32_bf16 v[112:115], a[48:51], a[116:119], v[112:115]
s_add_u32 m0, s58, 0
s_add_u32 s55, s93, 21504
v_mfma_f32_16x16x32_bf16 v[240:243], a[52:55], a[116:119], v[240:243]
buffer_load_dwordx4 v2, s[36:39], s55 offen offset:3072 sc1 lds
v_mfma_f32_16x16x32_bf16 v[240:243], a[36:39], a[100:103], v[240:243]
v_mfma_f32_16x16x32_bf16 v[116:119], a[40:43], a[100:103], v[116:119]
v_mfma_f32_16x16x32_bf16 v[116:119], a[56:59], a[116:119], v[116:119]
v_mfma_f32_16x16x32_bf16 v[244:247], a[60:63], a[116:119], v[244:247]
v_mfma_f32_16x16x32_bf16 v[244:247], a[44:47], a[100:103], v[244:247]
v_mfma_f32_16x16x32_bf16 v[248:251], a[44:47], a[96:99], v[248:251]
v_mfma_f32_16x16x32_bf16 v[248:251], a[60:63], a[112:115], v[248:251]
v_mfma_f32_16x16x32_bf16 v[120:123], a[56:59], a[112:115], v[120:123]
v_mfma_f32_16x16x32_bf16 v[120:123], a[40:43], a[96:99], v[120:123]
v_mfma_f32_16x16x32_bf16 v[252:255], a[36:39], a[96:99], v[252:255]
v_mfma_f32_16x16x32_bf16 v[252:255], a[52:55], a[112:115], v[252:255]
v_mfma_f32_16x16x32_bf16 v[124:127], a[48:51], a[112:115], v[124:127]
s_waitcnt vmcnt(20) lgkmcnt(0)
v_mfma_f32_16x16x32_bf16 v[124:127], a[32:35], a[96:99], v[124:127]
s_barrier
v_mfma_f32_16x16x32_bf16 v[128:131], a[0:3], a[64:67], v[128:131]
v_xor_b32 v3, v3, v7
v_xor_b32 v4, v4, v8
v_mfma_f32_16x16x32_bf16 v[128:131], a[16:19], a[80:83], v[128:131]
v_mfma_f32_16x16x32_bf16 v[136:139], a[20:23], a[80:83], v[136:139]
ds_read_b128 a[32:35], v5 offset:40960
ds_read_b128 a[48:51], v6 offset:40960
v_mfma_f32_16x16x32_bf16 v[136:139], a[4:7], a[64:67], v[136:139]
v_mfma_f32_16x16x32_bf16 v[132:135], a[8:11], a[64:67], v[132:135]
ds_read_b128 a[36:39], v5 offset:43008
v_mfma_f32_16x16x32_bf16 v[132:135], a[24:27], a[80:83], v[132:135]
s_add_u32 m0, s57, 32768
s_add_u32 s52, s85, 0
v_mfma_f32_16x16x32_bf16 v[140:143], a[28:31], a[80:83], v[140:143]
L_t3:
s_cbranch_execz L_r0
buffer_load_dwordx4 v3, s[40:43], s52 offen offset:0  lds
v_mfma_f32_16x16x32_bf16 v[140:143], a[12:15], a[64:67], v[140:143]
v_mfma_f32_16x16x32_bf16 v[144:147], a[12:15], a[68:71], v[144:147]
ds_read_b128 a[52:55], v6 offset:43008
v_mfma_f32_16x16x32_bf16 v[144:147], a[28:31], a[84:87], v[144:147]
v_mfma_f32_16x16x32_bf16 v[16:19], a[24:27], a[84:87], v[16:19]
ds_read_b128 a[40:43], v5 offset:45056
v_cvt_pk_bf16_f32 v128, v128, v129
v_mfma_f32_16x16x32_bf16 v[16:19], a[8:11], a[68:71], v[16:19]
s_add_u32 s52, s85, 64512
v_cvt_pk_bf16_f32 v129, v130, v131
v_cvt_pk_bf16_f32 v130, v136, v137
v_mfma_f32_16x16x32_bf16 v[148:151], a[4:7], a[68:71], v[148:151]
buffer_load_dwordx4 v4, s[40:43], s52 offen offset:1024  lds
v_mfma_f32_16x16x32_bf16 v[148:151], a[20:23], a[84:87], v[148:151]
v_cvt_pk_bf16_f32 v131, v138, v139
v_mfma_f32_16x16x32_bf16 v[20:23], a[16:19], a[84:87], v[20:23]
ds_read_b128 a[56:59], v6 offset:45056
v_cvt_pk_bf16_f32 v132, v132, v133
v_mfma_f32_16x16x32_bf16 v[20:23], a[0:3], a[68:71], v[20:23]
v_cvt_pk_bf16_f32 v133, v134, v135
v_cvt_pk_bf16_f32 v134, v140, v141
v_mfma_f32_16x16x32_bf16 a[128:131], a[0:3], a[72:75], a[128:131]
ds_read_b128 a[44:47], v5 offset:47104
v_cvt_pk_bf16_f32 v135, v142, v143
v_mfma_f32_16x16x32_bf16 a[128:131], a[16:19], a[88:91], a[128:131]
s_add_u32 s52, s85, 129024
v_mfma_f32_16x16x32_bf16 a[132:135], a[20:23], a[88:91], a[132:135]
buffer_load_dwordx4 v3, s[40:43], s52 offen offset:2048  lds
v_mfma_f32_16x16x32_bf16 a[132:135], a[4:7], a[72:75], a[132:135]
v_cvt_pk_bf16_f32 v16, v16, v17
v_cvt_pk_bf16_f32 v17, v18, v19
v_mfma_f32_16x16x32_bf16 a[136:139], a[8:11], a[72:75], a[136:139]
ds_read_b128 a[60:63], v6 offset:47104
v_cvt_pk_bf16_f32 v18, v144, v145
v_mfma_f32_16x16x32_bf16 a[136:139], a[24:27], a[88:91], a[136:139]
v_cvt_pk_bf16_f32 v19, v146, v147
v_mfma_f32_16x16x32_bf16 a[140:143], a[28:31], a[88:91], a[140:143]
v_cvt_pk_bf16_f32 v20, v20, v21
v_cvt_pk_bf16_f32 v21, v22, v23
v_mfma_f32_16x16x32_bf16 a[140:143], a[12:15], a[72:75], a[140:143]
s_add_u32 s52, s85, 193536
v_cvt_pk_bf16_f32 v22, v148, v149
v_cvt_pk_bf16_f32 v23, v150, v151
v_mfma_f32_16x16x32_bf16 v[152:155], a[12:15], a[76:79], v[152:155]
buffer_load_dwordx4 v4, s[40:43], s52 offen offset:3072  lds
v_mfma_f32_16x16x32_bf16 v[152:155], a[28:31], a[92:95], v[152:155]
v_mfma_f32_16x16x32_bf16 v[24:27], a[24:27], a[92:95], v[24:27]
v_accvgpr_read_b32 v136, a128
v_accvgpr_read_b32 v137, a129
v_mfma_f32_16x16x32_bf16 v[24:27], a[8:11], a[76:79], v[24:27]
v_accvgpr_read_b32 v138, a130
v_accvgpr_read_b32 v139, a131
v_mfma_f32_16x16x32_bf16 v[156:159], a[4:7], a[76:79], v[156:159]
ds_read_b64_tr_b16 a[96:97], v13 offset:49152
ds_read_b64_tr_b16 a[98:99], v13 offset:49664
v_mfma_f32_16x16x32_bf16 v[156:159], a[20:23], a[92:95], v[156:159]
v_accvgpr_read_b32 v140, a132
v_accvgpr_read_b32 v141, a133
v_mfma_f32_16x16x32_bf16 v[28:31], a[16:19], a[92:95], v[28:31]
s_waitcnt lgkmcnt(2)
ds_read_b64_tr_b16 a[112:113], v13 offset:57344
ds_read_b64_tr_b16 a[114:115], v13 offset:57856
v_mfma_f32_16x16x32_bf16 v[28:31], a[0:3], a[76:79], v[28:31]
s_add_u32 m0, s58, 4096
s_add_u32 s55, s93, 32768
v_accvgpr_read_b32 v142, a134
v_mfma_f32_16x16x32_bf16 v[32:35], a[0:3], a[32:35], v[32:35]
buffer_load_dwordx4 v1, s[36:39], s55 offen offset:0 sc1 lds
v_mfma_f32_16x16x32_bf16 v[32:35], a[16:19], a[48:51], v[32:35]
v_accvgpr_read_b32 v143, a135
v_cvt_pk_bf16_f32 v136, v136, v137
v_mfma_f32_16x16x32_bf16 v[160:163], a[20:23], a[48:51], v[160:163]
ds_read_b64_tr_b16 a[100:101], v14 offset:49152
ds_read_b64_tr_b16 a[102:103], v14 offset:49664
v_mfma_f32_16x16x32_bf16 v[160:163], a[4:7], a[32:35], v[160:163]
v_cvt_pk_bf16_f32 v137, v138, v139
v_cvt_pk_bf16_f32 v138, v140, v141
v_mfma_f32_16x16x32_bf16 v[36:39], a[8:11], a[32:35], v[36:39]
ds_read_b64_tr_b16 a[116:117], v14 offset:57344
ds_read_b64_tr_b16 a[118:119], v14 offset:57856
v_mfma_f32_16x16x32_bf16 v[36:39], a[24:27], a[48:51], v[36:39]
s_add_u32 s55, s93, 39936
v_cvt_pk_bf16_f32 v139, v142, v143
v_accvgpr_read_b32 v144, a136
v_mfma_f32_16x16x32_bf16 v[164:167], a[28:31], a[48:51], v[164:167]
buffer_load_dwordx4 v2, s[36:39], s55 offen offset:1024 sc1 lds
v_mfma_f32_16x16x32_bf16 v[164:167], a[12:15], a[32:35], v[164:167]
v_accvgpr_read_b32 v145, a137
v_accvgpr_read_b32 v146, a138
v_mfma_f32_16x16x32_bf16 v[168:171], a[12:15], a[36:39], v[168:171]
ds_read_b64_tr_b16 a[104:105], v13 offset:53248
ds_read_b64_tr_b16 a[106:107], v13 offset:53760
v_mfma_f32_16x16x32_bf16 v[168:171], a[28:31], a[52:55], v[168:171]
v_accvgpr_read_b32 v147, a139
v_accvgpr_read_b32 v148, a140
v_mfma_f32_16x16x32_bf16 v[40:43], a[24:27], a[52:55], v[40:43]
ds_read_b64_tr_b16 a[120:121], v13 offset:61440
ds_read_b64_tr_b16 a[122:123], v13 offset:61952
v_mfma_f32_16x16x32_bf16 v[40:43], a[8:11], a[36:39], v[40:43]
s_add_u32 s55, s93, 47104
v_accvgpr_read_b32 v149, a141
v_accvgpr_read_b32 v150, a142
v_mfma_f32_16x16x32_bf16 v[172:175], a[4:7], a[36:39], v[172:175]
buffer_load_dwordx4 v1, s[36:39], s55 offen offset:2048 sc1 lds
v_mfma_f32_16x16x32_bf16 v[172:175], a[20:23], a[52:55], v[172:175]
v_accvgpr_read_b32 v151, a143
v_cvt_pk_bf16_f32 v144, v144, v145
v_mfma_f32_16x16x32_bf16 v[44:47], a[16:19], a[52:55], v[44:47]
ds_read_b64_tr_b16 a[108:109], v14 offset:53248
ds_read_b64_tr_b16 a[110:111], v14 offset:53760
v_mfma_f32_16x16x32_bf16 v[44:47], a[0:3], a[36:39], v[44:47]
v_cvt_pk_bf16_f32 v145, v146, v147
v_cvt_pk_bf16_f32 v146, v148, v149
v_mfma_f32_16x16x32_bf16 v[48:51], a[0:3], a[40:43], v[48:51]
ds_read_b64_tr_b16 a[124:125], v14 offset:61440
ds_read_b64_tr_b16 a[126:127], v14 offset:61952
v_mfma_f32_16x16x32_bf16 v[48:51], a[16:19], a[56:59], v[48:51]
s_add_u32 s55, s93, 54272
v_cvt_pk_bf16_f32 v147, v150, v151
v_cvt_pk_bf16_f32 v24, v24, v25
v_mfma_f32_16x16x32_bf16 v[176:179], a[20:23], a[56:59], v[176:179]
buffer_load_dwordx4 v2, s[36:39], s55 offen offset:3072 sc1 lds
v_mfma_f32_16x16x32_bf16 v[176:179], a[4:7], a[40:43], v[176:179]
v_cvt_pk_bf16_f32 v25, v26, v27
v_cvt_pk_bf16_f32 v26, v152, v153
v_mfma_f32_16x16x32_bf16 v[52:55], a[8:11], a[40:43], v[52:55]
s_add_u32 s59, s72, 0
v_cvt_pk_bf16_f32 v27, v154, v155
v_cvt_pk_bf16_f32 v28, v28, v29
v_mfma_f32_16x16x32_bf16 v[52:55], a[24:27], a[56:59], v[52:55]
buffer_store_dwordx4 v[128:131], v15, s[44:47], s59 offen offset:0 sc1
v_mfma_f32_16x16x32_bf16 v[180:183], a[28:31], a[56:59], v[180:183]
v_cvt_pk_bf16_f32 v29, v30, v31
v_cvt_pk_bf16_f32 v30, v156, v157
v_mfma_f32_16x16x32_bf16 v[180:183], a[12:15], a[40:43], v[180:183]
v_cvt_pk_bf16_f32 v31, v158, v159
v_cvt_pk_bf16_f32 v32, v32, v33
v_mfma_f32_16x16x32_bf16 v[184:187], a[12:15], a[44:47], v[184:187]
v_cvt_pk_bf16_f32 v33, v34, v35
v_cvt_pk_bf16_f32 v34, v160, v161
v_mfma_f32_16x16x32_bf16 v[184:187], a[28:31], a[60:63], v[184:187]
v_cvt_pk_bf16_f32 v35, v162, v163
v_cvt_pk_bf16_f32 v36, v36, v37
v_mfma_f32_16x16x32_bf16 v[56:59], a[24:27], a[60:63], v[56:59]
s_add_u32 s59, s72, 0
v_cvt_pk_bf16_f32 v37, v38, v39
v_cvt_pk_bf16_f32 v38, v164, v165
v_mfma_f32_16x16x32_bf16 v[56:59], a[8:11], a[44:47], v[56:59]
buffer_store_dwordx4 v[132:135], v15, s[44:47], s59 offen offset:1024 sc1
v_mfma_f32_16x16x32_bf16 v[188:191], a[4:7], a[44:47], v[188:191]
v_cvt_pk_bf16_f32 v39, v166, v167
v_cvt_pk_bf16_f32 v40, v40, v41
v_mfma_f32_16x16x32_bf16 v[188:191], a[20:23], a[60:63], v[188:191]
v_cvt_pk_bf16_f32 v41, v42, v43
v_cvt_pk_bf16_f32 v42, v168, v169
v_mfma_f32_16x16x32_bf16 v[60:63], a[16:19], a[60:63], v[60:63]
s_waitcnt vmcnt(18) lgkmcnt(0)
v_mfma_f32_16x16x32_bf16 v[60:63], a[0:3], a[44:47], v[60:63]
s_barrier
v_mfma_f32_16x16x32_bf16 v[64:67], a[32:35], a[96:99], v[64:67]
v_xor_b32 v3, v3, v7
v_xor_b32 v4, v4, v8
v_mfma_f32_16x16x32_bf16 v[64:67], a[48:51], a[112:115], v[64:67]
v_cvt_pk_bf16_f32 v43, v170, v171
v_cvt_pk_bf16_f32 v44, v44, v45
v_mfma_f32_16x16x32_bf16 v[192:195], a[52:55], a[112:115], v[192:195]
ds_read_b64_tr_b16 a[0:1], v9 offset:0
ds_read_b64_tr_b16 a[2:3], v9 offset:512
v_mfma_f32_16x16x32_bf16 v[192:195], a[36:39], a[96:99], v[192:195]
v_cvt_pk_bf16_f32 v45, v46, v47
v_cvt_pk_bf16_f32 v46, v172, v173
v_mfma_f32_16x16x32_bf16 v[68:71], a[40:43], a[96:99], v[68:71]
ds_read_b64_tr_b16 a[16:17], v9 offset:8192
ds_read_b64_tr_b16 a[18:19], v9 offset:8704
v_mfma_f32_16x16x32_bf16 v[68:71], a[56:59], a[112:115], v[68:71]
s_add_u32 m0, s57, 49152
s_add_u32 s52, s89, 0
v_cvt_pk_bf16_f32 v47, v174, v175
v_mfma_f32_16x16x32_bf16 v[196:199], a[60:63], a[112:115], v[196:199]
buffer_load_dwordx4 v3, s[64:67], s52 offen offset:0  lds
v_mfma_f32_16x16x32_bf16 v[196:199], a[44:47], a[96:99], v[196:199]
s_movk_i32 s71, 0x2000
v_xor_b32 v13, s74, v13
v_xor_b32 v14, s75, v14
v_mfma_f32_16x16x32_bf16 v[200:203], a[44:47], a[100:103], v[200:203]
ds_read_b64_tr_b16 a[4:5], v10 offset:0
ds_read_b64_tr_b16 a[6:7], v10 offset:512
v_mfma_f32_16x16x32_bf16 v[200:203], a[60:63], a[116:119], v[200:203]
v_cvt_pk_bf16_f32 v48, v48, v49
v_cvt_pk_bf16_f32 v49, v50, v51
v_mfma_f32_16x16x32_bf16 v[72:75], a[56:59], a[116:119], v[72:75]
ds_read_b64_tr_b16 a[20:21], v10 offset:8192
ds_read_b64_tr_b16 a[22:23], v10 offset:8704
v_mfma_f32_16x16x32_bf16 v[72:75], a[40:43], a[100:103], v[72:75]
s_add_u32 m0, s58, 32768
s_add_u32 s55, s92, 2048
v_cvt_pk_bf16_f32 v50, v176, v177
v_mfma_f32_16x16x32_bf16 v[204:207], a[36:39], a[100:103], v[204:207]
buffer_load_dwordx4 v1, s[36:39], s55 offen offset:0 sc1 lds
v_mfma_f32_16x16x32_bf16 v[204:207], a[52:55], a[116:119], v[204:207]
v_cvt_pk_bf16_f32 v51, v178, v179
v_cvt_pk_bf16_f32 v52, v52, v53
v_mfma_f32_16x16x32_bf16 v[76:79], a[48:51], a[116:119], v[76:79]
ds_read_b64_tr_b16 a[8:9], v11 offset:0
ds_read_b64_tr_b16 a[10:11], v11 offset:512
v_mfma_f32_16x16x32_bf16 v[76:79], a[32:35], a[100:103], v[76:79]
v_cvt_pk_bf16_f32 v53, v54, v55
v_cvt_pk_bf16_f32 v54, v180, v181
v_mfma_f32_16x16x32_bf16 v[80:83], a[32:35], a[104:107], v[80:83]
ds_read_b64_tr_b16 a[24:25], v11 offset:8192
ds_read_b64_tr_b16 a[26:27], v11 offset:8704
v_mfma_f32_16x16x32_bf16 v[80:83], a[48:51], a[120:123], v[80:83]
s_add_u32 m0, s57, 49152
s_add_u32 s52, s89, 27648
v_cvt_pk_bf16_f32 v55, v182, v183
v_mfma_f32_16x16x32_bf16 v[208:211], a[52:55], a[120:123], v[208:211]
buffer_load_dwordx4 v4, s[64:67], s52 offen offset:1024  lds
v_mfma_f32_16x16x32_bf16 v[208:211], a[36:39], a[104:107], v[208:211]
v_cvt_pk_bf16_f32 v56, v56, v57
v_cvt_pk_bf16_f32 v57, v58, v59
v_mfma_f32_16x16x32_bf16 v[84:87], a[40:43], a[104:107], v[84:87]
ds_read_b64_tr_b16 a[12:13], v12 offset:0
ds_read_b64_tr_b16 a[14:15], v12 offset:512
v_mfma_f32_16x16x32_bf16 v[84:87], a[56:59], a[120:123], v[84:87]
v_cvt_pk_bf16_f32 v58, v184, v185
v_cvt_pk_bf16_f32 v59, v186, v187
v_mfma_f32_16x16x32_bf16 v[212:215], a[60:63], a[120:123], v[212:215]
ds_read_b64_tr_b16 a[28:29], v12 offset:8192
ds_read_b64_tr_b16 a[30:31], v12 offset:8704
v_mfma_f32_16x16x32_bf16 v[212:215], a[44:47], a[104:107], v[212:215]
s_add_u32 m0, s58, 32768
s_add_u32 s55, s92, 9216
v_cvt_pk_bf16_f32 v60, v60, v61
v_mfma_f32_16x16x32_bf16 v[216:219], a[44:47], a[108:111], v[216:219]
buffer_load_dwordx4 v2, s[36:39], s55 offen offset:1024 sc1 lds
v_mfma_f32_16x16x32_bf16 v[216:219], a[60:63], a[124:127], v[216:219]
v_cvt_pk_bf16_f32 v61, v62, v63
v_cvt_pk_bf16_f32 v62, v188, v189
v_mfma_f32_16x16x32_bf16 v[88:91], a[56:59], a[124:127], v[88:91]
s_add_u32 s59, s72, 16384
v_cvt_pk_bf16_f32 v63, v190, v191
v_cvt_pk_bf16_f32 v64, v64, v65
v_mfma_f32_16x16x32_bf16 v[88:91], a[40:43], a[108:111], v[88:91]
buffer_store_dwordx4 v[136:139], v15, s[44:47], s59 offen offset:0 sc1
v_mfma_f32_16x16x32_bf16 v[220:223], a[36:39], a[108:111], v[220:223]
v_cvt_pk_bf16_f32 v65, v66, v67
v_cvt_pk_bf16_f32 v66, v192, v193
v_mfma_f32_16x16x32_bf16 v[220:223], a[52:55], a[124:127], v[220:223]
v_xor_b32 v5, s73, v5
v_xor_b32 v6, s73, v6
v_mfma_f32_16x16x32_bf16 v[92:95], a[48:51], a[124:127], v[92:95]
v_add_u32 v5, 0x10000, v5
v_add_u32 v6, 0x10000, v6
v_mfma_f32_16x16x32_bf16 v[92:95], a[32:35], a[108:111], v[92:95]
s_add_u32 m0, s57, 49152
s_add_u32 s52, s89, 55296
v_cvt_pk_bf16_f32 v67, v194, v195
v_mfma_f32_16x16x32_bf16 v[96:99], a[64:67], a[108:111], v[96:99]
buffer_load_dwordx4 v3, s[64:67], s52 offen offset:2048  lds
v_mfma_f32_16x16x32_bf16 v[96:99], a[80:83], a[124:127], v[96:99]
v_cvt_pk_bf16_f32 v68, v68, v69
v_cvt_pk_bf16_f32 v69, v70, v71
v_mfma_f32_16x16x32_bf16 v[224:227], a[84:87], a[124:127], v[224:227]
ds_read_b128 a[32:35], v5 offset:0
ds_read_b128 a[48:51], v6 offset:0
v_mfma_f32_16x16x32_bf16 v[224:227], a[68:71], a[108:111], v[224:227]
v_cvt_pk_bf16_f32 v70, v196, v197
v_cvt_pk_bf16_f32 v71, v198, v199
v_mfma_f32_16x16x32_bf16 v[100:103], a[72:75], a[108:111], v[100:103]
ds_read_b128 a[36:39], v5 offset:2048
v_cvt_pk_bf16_f32 v72, v72, v73
v_mfma_f32_16x16x32_bf16 v[100:103], a[88:91], a[124:127], v[100:103]
s_add_u32 m0, s58, 32768
s_add_u32 s55, s92, 16384
v_cvt_pk_bf16_f32 v73, v74, v75
v_mfma_f32_16x16x32_bf16 v[228:231], a[92:95], a[124:127], v[228:231]
buffer_load_dwordx4 v1, s[36:39], s55 offen offset:2048 sc1 lds
v_mfma_f32_16x16x32_bf16 v[228:231], a[76:79], a[108:111], v[228:231]
v_cvt_pk_bf16_f32 v74, v200, v201
v_cvt_pk_bf16_f32 v75, v202, v203
v_mfma_f32_16x16x32_bf16 v[232:235], a[76:79], a[104:107], v[232:235]
ds_read_b128 a[52:55], v6 offset:2048
ds_read_b128 a[40:43], v5 offset:4096
v_mfma_f32_16x16x32_bf16 v[232:235], a[92:95], a[120:123], v[232:235]
v_cvt_pk_bf16_f32 v76, v76, v77
v_cvt_pk_bf16_f32 v77, v78, v79
v_mfma_f32_16x16x32_bf16 v[104:107], a[88:91], a[120:123], v[104:107]
ds_read_b128 a[56:59], v6 offset:4096
v_cvt_pk_bf16_f32 v78, v204, v205
v_mfma_f32_16x16x32_bf16 v[104:107], a[72:75], a[104:107], v[104:107]
s_add_u32 m0, s57, 49152
s_add_u32 s52, s89, 82944
v_cvt_pk_bf16_f32 v79, v206, v207
v_mfma_f32_16x16x32_bf16 v[236:239], a[68:71], a[104:107], v[236:239]
buffer_load_dwordx4 v4, s[64:67], s52 offen offset:3072  lds
v_mfma_f32_16x16x32_bf16 v[236:239], a[84:87], a[120:123], v[236:239]
v_cvt_pk_bf16_f32 v80, v80, v81
v_cvt_pk_bf16_f32 v81, v82, v83
v_mfma_f32_16x16x32_bf16 v[108:111], a[80:83], a[120:123], v[108:111]
ds_read_b128 a[44:47], v5 offset:6144
v_cvt_pk_bf16_f32 v82, v208, v209
v_mfma_f32_16x16x32_bf16 v[108:111], a[64:67], a[104:107], v[108:111]
v_cvt_pk_bf16_f32 v83, v210, v211
v_cvt_pk_bf16_f32 v84, v84, v85
v_mfma_f32_16x16x32_bf16 v[112:115], a[64:67], a[100:103], v[112:115]
ds_read_b128 a[60:63], v6 offset:6144
v_cvt_pk_bf16_f32 v85, v86, v87
v_mfma_f32_16x16x32_bf16 v[112:115], a[80:83], a[116:119], v[112:115]
s_add_u32 m0, s58, 32768
s_add_u32 s55, s92, 23552
v_cvt_pk_bf16_f32 v86, v212, v213
v_mfma_f32_16x16x32_bf16 v[240:243], a[84:87], a[116:119], v[240:243]
buffer_load_dwordx4 v2, s[36:39], s55 offen offset:3072 sc1 lds
v_mfma_f32_16x16x32_bf16 v[240:243], a[68:71], a[100:103], v[240:243]
v_cvt_pk_bf16_f32 v87, v214, v215
v_cvt_pk_bf16_f32 v88, v88, v89
v_mfma_f32_16x16x32_bf16 v[116:119], a[72:75], a[100:103], v[116:119]
s_add_u32 s59, s72, 16384
v_cvt_pk_bf16_f32 v89, v90, v91
v_cvt_pk_bf16_f32 v90, v216, v217
v_mfma_f32_16x16x32_bf16 v[116:119], a[88:91], a[116:119], v[116:119]
buffer_store_dwordx4 v[144:147], v15, s[44:47], s59 offen offset:1024 sc1
v_mfma_f32_16x16x32_bf16 v[244:247], a[92:95], a[116:119], v[244:247]
v_cvt_pk_bf16_f32 v91, v218, v219
v_cvt_pk_bf16_f32 v92, v92, v93
v_mfma_f32_16x16x32_bf16 v[244:247], a[76:79], a[100:103], v[244:247]
v_cvt_pk_bf16_f32 v93, v94, v95
v_cvt_pk_bf16_f32 v94, v220, v221
v_mfma_f32_16x16x32_bf16 v[248:251], a[76:79], a[96:99], v[248:251]
v_cvt_pk_bf16_f32 v95, v222, v223
v_cvt_pk_bf16_f32 v96, v96, v97
v_mfma_f32_16x16x32_bf16 v[248:251], a[92:95], a[112:115], v[248:251]
v_cvt_pk_bf16_f32 v97, v98, v99
v_cvt_pk_bf16_f32 v98, v224, v225
v_mfma_f32_16x16x32_bf16 v[120:123], a[88:91], a[112:115], v[120:123]
s_add_u32 s59, s72, 4096
v_cvt_pk_bf16_f32 v99, v226, v227
v_cvt_pk_bf16_f32 v100, v100, v101
v_mfma_f32_16x16x32_bf16 v[120:123], a[72:75], a[96:99], v[120:123]
buffer_store_dwordx4 v[16:19], v15, s[44:47], s59 offen offset:1024 sc1
v_mfma_f32_16x16x32_bf16 v[252:255], a[68:71], a[96:99], v[252:255]
v_cvt_pk_bf16_f32 v101, v102, v103
v_cvt_pk_bf16_f32 v102, v228, v229
v_mfma_f32_16x16x32_bf16 v[252:255], a[84:87], a[112:115], v[252:255]
v_cvt_pk_bf16_f32 v103, v230, v231
v_cvt_pk_bf16_f32 v104, v104, v105
v_mfma_f32_16x16x32_bf16 v[124:127], a[80:83], a[112:115], v[124:127]
s_waitcnt vmcnt(22) lgkmcnt(0)
v_mfma_f32_16x16x32_bf16 v[124:127], a[64:67], a[96:99], v[124:127]
s_barrier
v_mfma_f32_16x16x32_bf16 a[128:131], a[0:3], a[32:35], 0
v_xor_b32 v3, v3, v7
v_xor_b32 v4, v4, v8
v_mfma_f32_16x16x32_bf16 a[128:131], a[16:19], a[48:51], a[128:131]
v_xor_b32 v5, s71, v5
v_xor_b32 v6, s71, v6
v_mfma_f32_16x16x32_bf16 a[132:135], a[20:23], a[48:51], 0
ds_read_b128 a[64:67], v5 offset:0
ds_read_b128 a[80:83], v6 offset:0
v_mfma_f32_16x16x32_bf16 a[132:135], a[4:7], a[32:35], a[132:135]
v_cvt_pk_bf16_f32 v105, v106, v107
v_cvt_pk_bf16_f32 v106, v232, v233
v_mfma_f32_16x16x32_bf16 a[136:139], a[8:11], a[32:35], 0
ds_read_b128 a[68:71], v5 offset:2048
v_cvt_pk_bf16_f32 v107, v234, v235
v_mfma_f32_16x16x32_bf16 a[136:139], a[24:27], a[48:51], a[136:139]
s_add_u32 m0, s57, 0
s_add_u32 s52, s84, 1048576
v_cvt_pk_bf16_f32 v108, v108, v109
v_mfma_f32_16x16x32_bf16 a[140:143], a[28:31], a[48:51], 0
buffer_load_dwordx4 v3, s[40:43], s52 offen offset:0  lds
v_mfma_f32_16x16x32_bf16 a[140:143], a[12:15], a[32:35], a[140:143]
v_cvt_pk_bf16_f32 v109, v110, v111
v_cvt_pk_bf16_f32 v110, v236, v237
v_mfma_f32_16x16x32_bf16 a[144:147], a[12:15], a[36:39], 0
ds_read_b128 a[84:87], v6 offset:2048
v_cvt_pk_bf16_f32 v111, v238, v239
v_mfma_f32_16x16x32_bf16 a[144:147], a[28:31], a[52:55], a[144:147]
v_cvt_pk_bf16_f32 v112, v112, v113
v_cvt_pk_bf16_f32 v113, v114, v115
v_mfma_f32_16x16x32_bf16 a[148:151], a[24:27], a[52:55], 0
ds_read_b128 a[72:75], v5 offset:4096
v_cvt_pk_bf16_f32 v114, v240, v241
v_mfma_f32_16x16x32_bf16 a[148:151], a[8:11], a[36:39], a[148:151]
s_add_u32 s52, s84, 1113088
v_cvt_pk_bf16_f32 v115, v242, v243
v_cvt_pk_bf16_f32 v116, v116, v117
v_mfma_f32_16x16x32_bf16 a[152:155], a[4:7], a[36:39], 0
buffer_load_dwordx4 v4, s[40:43], s52 offen offset:1024  lds
v_mfma_f32_16x16x32_bf16 a[152:155], a[20:23], a[52:55], a[152:155]
v_cvt_pk_bf16_f32 v117, v118, v119
v_cvt_pk_bf16_f32 v118, v244, v245
v_mfma_f32_16x16x32_bf16 a[156:159], a[16:19], a[52:55], 0
ds_read_b128 a[88:91], v6 offset:4096
v_cvt_pk_bf16_f32 v119, v246, v247
v_mfma_f32_16x16x32_bf16 a[156:159], a[0:3], a[36:39], a[156:159]
v_cvt_pk_bf16_f32 v120, v120, v121
v_cvt_pk_bf16_f32 v121, v122, v123
v_mfma_f32_16x16x32_bf16 a[160:163], a[0:3], a[40:43], 0
ds_read_b128 a[76:79], v5 offset:6144
v_cvt_pk_bf16_f32 v122, v248, v249
v_mfma_f32_16x16x32_bf16 a[160:163], a[16:19], a[56:59], a[160:163]
s_add_u32 s52, s84, 1177600
v_cvt_pk_bf16_f32 v123, v250, v251
v_cvt_pk_bf16_f32 v124, v124, v125
v_mfma_f32_16x16x32_bf16 a[164:167], a[20:23], a[56:59], 0
buffer_load_dwordx4 v3, s[40:43], s52 offen offset:2048  lds
v_mfma_f32_16x16x32_bf16 a[164:167], a[4:7], a[40:43], a[164:167]
v_cvt_pk_bf16_f32 v125, v126, v127
v_cvt_pk_bf16_f32 v126, v252, v253
v_mfma_f32_16x16x32_bf16 a[168:171], a[8:11], a[40:43], 0
ds_read_b128 a[92:95], v6 offset:6144
v_cvt_pk_bf16_f32 v127, v254, v255
v_mfma_f32_16x16x32_bf16 a[168:171], a[24:27], a[56:59], a[168:171]
v_accvgpr_read_b32 v16, a128
v_accvgpr_read_b32 v17, a129
v_mfma_f32_16x16x32_bf16 a[172:175], a[28:31], a[56:59], 0
v_accvgpr_read_b32 v18, a130
v_accvgpr_read_b32 v19, a131
v_mfma_f32_16x16x32_bf16 a[172:175], a[12:15], a[40:43], a[172:175]
s_add_u32 s52, s84, 1242112
v_mfma_f32_16x16x32_bf16 a[176:179], a[12:15], a[44:47], 0
buffer_load_dwordx4 v4, s[40:43], s52 offen offset:3072  lds
v_mfma_f32_16x16x32_bf16 a[176:179], a[28:31], a[60:63], a[176:179]
v_mfma_f32_16x16x32_bf16 a[180:183], a[24:27], a[60:63], 0
s_add_u32 s59, s72, 4096
v_mfma_f32_16x16x32_bf16 a[180:183], a[8:11], a[44:47], a[180:183]
buffer_store_dwordx4 v[20:23], v15, s[44:47], s59 offen offset:0 sc1
v_mfma_f32_16x16x32_bf16 a[184:187], a[4:7], a[44:47], 0
ds_read_b64_tr_b16 a[96:97], v13 offset:16384
ds_read_b64_tr_b16 a[98:99], v13 offset:16896
v_mfma_f32_16x16x32_bf16 a[184:187], a[20:23], a[60:63], a[184:187]
v_accvgpr_read_b32 v20, a132
v_accvgpr_read_b32 v21, a133
v_mfma_f32_16x16x32_bf16 a[188:191], a[16:19], a[60:63], 0
s_waitcnt lgkmcnt(2)
ds_read_b64_tr_b16 a[112:113], v13 offset:24576
ds_read_b64_tr_b16 a[114:115], v13 offset:25088
v_mfma_f32_16x16x32_bf16 a[188:191], a[0:3], a[44:47], a[188:191]
s_add_u32 m0, s58, 36864
s_add_u32 s55, s92, 34816
v_accvgpr_read_b32 v22, a134
v_mfma_f32_16x16x32_bf16 a[192:195], a[0:3], a[64:67], 0
buffer_load_dwordx4 v1, s[36:39], s55 offen offset:0 sc1 lds
v_mfma_f32_16x16x32_bf16 a[192:195], a[16:19], a[80:83], a[192:195]
v_accvgpr_read_b32 v23, a135
v_mfma_f32_16x16x32_bf16 a[196:199], a[20:23], a[80:83], 0
ds_read_b64_tr_b16 a[100:101], v14 offset:16384
ds_read_b64_tr_b16 a[102:103], v14 offset:16896
v_mfma_f32_16x16x32_bf16 a[196:199], a[4:7], a[64:67], a[196:199]
v_mfma_f32_16x16x32_bf16 a[200:203], a[8:11], a[64:67], 0
ds_read_b64_tr_b16 a[116:117], v14 offset:24576
ds_read_b64_tr_b16 a[118:119], v14 offset:25088
v_mfma_f32_16x16x32_bf16 a[200:203], a[24:27], a[80:83], a[200:203]
s_add_u32 s55, s92, 41984
v_mfma_f32_16x16x32_bf16 a[204:207], a[28:31], a[80:83], 0
buffer_load_dwordx4 v2, s[36:39], s55 offen offset:1024 sc1 lds
v_mfma_f32_16x16x32_bf16 a[204:207], a[12:15], a[64:67], a[204:207]
v_mfma_f32_16x16x32_bf16 a[208:211], a[12:15], a[68:71], 0
ds_read_b64_tr_b16 a[104:105], v13 offset:20480
ds_read_b64_tr_b16 a[106:107], v13 offset:20992
v_mfma_f32_16x16x32_bf16 a[208:211], a[28:31], a[84:87], a[208:211]
v_mfma_f32_16x16x32_bf16 a[212:215], a[24:27], a[84:87], 0
ds_read_b64_tr_b16 a[120:121], v13 offset:28672
ds_read_b64_tr_b16 a[122:123], v13 offset:29184
v_mfma_f32_16x16x32_bf16 a[212:215], a[8:11], a[68:71], a[212:215]
s_add_u32 s55, s92, 49152
v_mfma_f32_16x16x32_bf16 a[216:219], a[4:7], a[68:71], 0
buffer_load_dwordx4 v1, s[36:39], s55 offen offset:2048 sc1 lds
v_mfma_f32_16x16x32_bf16 a[216:219], a[20:23], a[84:87], a[216:219]
v_mfma_f32_16x16x32_bf16 a[220:223], a[16:19], a[84:87], 0
ds_read_b64_tr_b16 a[108:109], v14 offset:20480
ds_read_b64_tr_b16 a[110:111], v14 offset:20992
v_mfma_f32_16x16x32_bf16 a[220:223], a[0:3], a[68:71], a[220:223]
v_mfma_f32_16x16x32_bf16 a[224:227], a[0:3], a[72:75], 0
ds_read_b64_tr_b16 a[124:125], v14 offset:28672
ds_read_b64_tr_b16 a[126:127], v14 offset:29184
v_mfma_f32_16x16x32_bf16 a[224:227], a[16:19], a[88:91], a[224:227]
s_add_u32 s55, s92, 56320
v_mfma_f32_16x16x32_bf16 a[228:231], a[20:23], a[88:91], 0
buffer_load_dwordx4 v2, s[36:39], s55 offen offset:3072 sc1 lds
v_mfma_f32_16x16x32_bf16 a[228:231], a[4:7], a[72:75], a[228:231]
v_mfma_f32_16x16x32_bf16 a[232:235], a[8:11], a[72:75], 0
s_add_u32 s59, s72, 20480
v_mfma_f32_16x16x32_bf16 a[232:235], a[24:27], a[88:91], a[232:235]
buffer_store_dwordx4 v[24:27], v15, s[44:47], s59 offen offset:1024 sc1
v_mfma_f32_16x16x32_bf16 a[236:239], a[28:31], a[88:91], 0
v_mfma_f32_16x16x32_bf16 a[236:239], a[12:15], a[72:75], a[236:239]
v_accvgpr_read_b32 v24, a136
v_accvgpr_read_b32 v25, a137
v_mfma_f32_16x16x32_bf16 a[240:243], a[12:15], a[76:79], 0
v_accvgpr_read_b32 v26, a138
v_accvgpr_read_b32 v27, a139
v_mfma_f32_16x16x32_bf16 a[240:243], a[28:31], a[92:95], a[240:243]
v_mfma_f32_16x16x32_bf16 a[244:247], a[24:27], a[92:95], 0
s_add_u32 s59, s72, 20480
v_mfma_f32_16x16x32_bf16 a[244:247], a[8:11], a[76:79], a[244:247]
buffer_store_dwordx4 v[28:31], v15, s[44:47], s59 offen offset:0 sc1
v_mfma_f32_16x16x32_bf16 a[248:251], a[4:7], a[76:79], 0
v_mfma_f32_16x16x32_bf16 a[248:251], a[20:23], a[92:95], a[248:251]
v_accvgpr_read_b32 v28, a140
v_accvgpr_read_b32 v29, a141
v_mfma_f32_16x16x32_bf16 a[252:255], a[16:19], a[92:95], 0
s_waitcnt vmcnt(24) lgkmcnt(0)
v_mfma_f32_16x16x32_bf16 a[252:255], a[0:3], a[76:79], a[252:255]
s_barrier
v_mfma_f32_16x16x32_bf16 v[140:143], a[96:99], a[64:67], 0
v_xor_b32 v3, v3, v7
v_xor_b32 v4, v4, v8
v_mfma_f32_16x16x32_bf16 v[140:143], a[112:115], a[80:83], v[140:143]
s_add_u32 m0, s57, 16384
s_add_u32 s52, s88, 458752
v_accvgpr_read_b32 v30, a142
v_mfma_f32_16x16x32_bf16 v[148:151], a[116:119], a[80:83], 0
buffer_load_dwordx4 v3, s[64:67], s52 offen offset:0  lds
v_mfma_f32_16x16x32_bf16 v[148:151], a[100:103], a[64:67], v[148:151]
v_accvgpr_read_b32 v31, a143
v_mfma_f32_16x16x32_bf16 v[136:139], a[104:107], a[64:67], 0
ds_read_b64_tr_b16 a[0:1], v9 offset:32768
ds_read_b64_tr_b16 a[2:3], v9 offset:33280
v_mfma_f32_16x16x32_bf16 v[136:139], a[120:123], a[80:83], v[136:139]
v_mfma_f32_16x16x32_bf16 v[144:147], a[124:127], a[80:83], 0
ds_read_b64_tr_b16 a[16:17], v9 offset:40960
ds_read_b64_tr_b16 a[18:19], v9 offset:41472
v_mfma_f32_16x16x32_bf16 v[144:147], a[108:111], a[64:67], v[144:147]
L_t4:
s_cbranch_execz L_r1
s_add_u32 m0, s58, 65536
s_add_u32 s55, s93, 2048
v_mfma_f32_16x16x32_bf16 v[128:131], a[108:111], a[68:71], 0
buffer_load_dwordx4 v1, s[36:39], s55 offen offset:0 sc1 lds
v_mfma_f32_16x16x32_bf16 v[128:131], a[124:127], a[84:87], v[128:131]
v_mfma_f32_16x16x32_bf16 v[132:135], a[120:123], a[84:87], 0
ds_read_b64_tr_b16 a[4:5], v10 offset:32768
ds_read_b64_tr_b16 a[6:7], v10 offset:33280
v_mfma_f32_16x16x32_bf16 v[132:135], a[104:107], a[68:71], v[132:135]
v_mfma_f32_16x16x32_bf16 v[152:155], a[100:103], a[68:71], 0
ds_read_b64_tr_b16 a[20:21], v10 offset:40960
ds_read_b64_tr_b16 a[22:23], v10 offset:41472
v_mfma_f32_16x16x32_bf16 v[152:155], a[116:119], a[84:87], v[152:155]
s_add_u32 m0, s57, 16384
s_add_u32 s52, s88, 486400
v_mfma_f32_16x16x32_bf16 v[156:159], a[112:115], a[84:87], 0
buffer_load_dwordx4 v4, s[64:67], s52 offen offset:1024  lds
v_mfma_f32_16x16x32_bf16 v[156:159], a[96:99], a[68:71], v[156:159]
v_mfma_f32_16x16x32_bf16 v[160:163], a[96:99], a[72:75], 0
ds_read_b64_tr_b16 a[8:9], v11 offset:32768
ds_read_b64_tr_b16 a[10:11], v11 offset:33280
v_mfma_f32_16x16x32_bf16 v[160:163], a[112:115], a[88:91], v[160:163]
v_mfma_f32_16x16x32_bf16 v[164:167], a[116:119], a[88:91], 0
ds_read_b64_tr_b16 a[24:25], v11 offset:40960
ds_read_b64_tr_b16 a[26:27], v11 offset:41472
v_mfma_f32_16x16x32_bf16 v[164:167], a[100:103], a[72:75], v[164:167]
s_add_u32 m0, s58, 65536
s_add_u32 s55, s93, 9216
v_mfma_f32_16x16x32_bf16 v[168:171], a[104:107], a[72:75], 0
buffer_load_dwordx4 v2, s[36:39], s55 offen offset:1024 sc1 lds
v_mfma_f32_16x16x32_bf16 v[168:171], a[120:123], a[88:91], v[168:171]
v_mfma_f32_16x16x32_bf16 v[172:175], a[124:127], a[88:91], 0
ds_read_b64_tr_b16 a[12:13], v12 offset:32768
ds_read_b64_tr_b16 a[14:15], v12 offset:33280
v_mfma_f32_16x16x32_bf16 v[172:175], a[108:111], a[72:75], v[172:175]
v_mfma_f32_16x16x32_bf16 v[176:179], a[108:111], a[76:79], 0
ds_read_b64_tr_b16 a[28:29], v12 offset:40960
ds_read_b64_tr_b16 a[30:31], v12 offset:41472
v_mfma_f32_16x16x32_bf16 v[176:179], a[124:127], a[92:95], v[176:179]
s_add_u32 m0, s57, 16384
s_add_u32 s52, s88, 514048
v_mfma_f32_16x16x32_bf16 v[180:183], a[120:123], a[92:95], 0
buffer_load_dwordx4 v3, s[64:67], s52 offen offset:2048  lds
v_mfma_f32_16x16x32_bf16 v[180:183], a[104:107], a[76:79], v[180:183]
v_xor_b32 v5, s71, v5
v_xor_b32 v6, s71, v6
v_mfma_f32_16x16x32_bf16 v[184:187], a[100:103], a[76:79], 0
v_add_u32 v5, 0xffff0000, v5
v_add_u32 v6, 0xffff0000, v6
v_mfma_f32_16x16x32_bf16 v[184:187], a[116:119], a[92:95], v[184:187]
s_add_u32 m0, s58, 65536
s_add_u32 s55, s93, 16384
v_mfma_f32_16x16x32_bf16 v[188:191], a[112:115], a[92:95], 0
buffer_load_dwordx4 v1, s[36:39], s55 offen offset:2048 sc1 lds
v_mfma_f32_16x16x32_bf16 v[188:191], a[96:99], a[76:79], v[188:191]
v_mfma_f32_16x16x32_bf16 v[192:195], a[96:99], a[32:35], 0
ds_read_b128 a[64:67], v5 offset:0
ds_read_b128 a[80:83], v6 offset:0
v_mfma_f32_16x16x32_bf16 v[192:195], a[112:115], a[48:51], v[192:195]
v_mfma_f32_16x16x32_bf16 v[196:199], a[120:123], a[48:51], 0
ds_read_b128 a[68:71], v5 offset:2048
ds_read_b128 a[84:87], v6 offset:2048
v_mfma_f32_16x16x32_bf16 v[196:199], a[104:107], a[32:35], v[196:199]
v_mfma_f32_16x16x32_bf16 v[200:203], a[104:107], a[36:39], 0
ds_read_b128 a[72:75], v5 offset:4096
ds_read_b128 a[88:91], v6 offset:4096
v_mfma_f32_16x16x32_bf16 v[200:203], a[120:123], a[52:55], v[200:203]
s_add_u32 m0, s57, 16384
s_add_u32 s52, s88, 541696
v_mfma_f32_16x16x32_bf16 v[204:207], a[112:115], a[52:55], 0
buffer_load_dwordx4 v4, s[64:67], s52 offen offset:3072  lds
v_mfma_f32_16x16x32_bf16 v[204:207], a[96:99], a[36:39], v[204:207]
v_mfma_f32_16x16x32_bf16 v[208:211], a[96:99], a[40:43], 0
ds_read_b128 a[76:79], v5 offset:6144
ds_read_b128 a[92:95], v6 offset:6144
v_mfma_f32_16x16x32_bf16 v[208:211], a[112:115], a[56:59], v[208:211]
v_mfma_f32_16x16x32_bf16 v[212:215], a[120:123], a[56:59], 0
v_mfma_f32_16x16x32_bf16 v[212:215], a[104:107], a[40:43], v[212:215]
s_add_u32 m0, s58, 65536
s_add_u32 s55, s93, 23552
v_mfma_f32_16x16x32_bf16 v[216:219], a[104:107], a[44:47], 0
buffer_load_dwordx4 v2, s[36:39], s55 offen offset:3072 sc1 lds
v_mfma_f32_16x16x32_bf16 v[216:219], a[120:123], a[60:63], v[216:219]
v_mfma_f32_16x16x32_bf16 v[220:223], a[112:115], a[60:63], 0
s_bitcmp1_b32 s2, 0
v_mfma_f32_16x16x32_bf16 v[220:223], a[96:99], a[44:47], v[220:223]
s_cbranch_scc1 L_short17
v_mfma_f32_16x16x32_bf16 v[224:227], a[100:103], a[44:47], 0
v_mfma_f32_16x16x32_bf16 v[224:227], a[116:119], a[60:63], v[224:227]
v_mfma_f32_16x16x32_bf16 v[228:231], a[124:127], a[60:63], 0
v_mfma_f32_16x16x32_bf16 v[228:231], a[108:111], a[44:47], v[228:231]
v_mfma_f32_16x16x32_bf16 v[232:235], a[108:111], a[40:43], 0
v_mfma_f32_16x16x32_bf16 v[232:235], a[124:127], a[56:59], v[232:235]
v_mfma_f32_16x16x32_bf16 v[236:239], a[116:119], a[56:59], 0
v_mfma_f32_16x16x32_bf16 v[236:239], a[100:103], a[40:43], v[236:239]
v_mfma_f32_16x16x32_bf16 v[240:243], a[100:103], a[36:39], 0
v_mfma_f32_16x16x32_bf16 v[240:243], a[116:119], a[52:55], v[240:243]
v_mfma_f32_16x16x32_bf16 v[244:247], a[124:127], a[52:55], 0
v_mfma_f32_16x16x32_bf16 v[244:247], a[108:111], a[36:39], v[244:247]
v_mfma_f32_16x16x32_bf16 v[248:251], a[108:111], a[32:35], 0
v_mfma_f32_16x16x32_bf16 v[248:251], a[124:127], a[48:51], v[248:251]
v_mfma_f32_16x16x32_bf16 v[252:255], a[116:119], a[48:51], 0
v_mfma_f32_16x16x32_bf16 v[252:255], a[100:103], a[32:35], v[252:255]
L_short17:
s_waitcnt vmcnt(22) lgkmcnt(0)
s_barrier
v_mfma_f32_16x16x32_bf16 v[16:19], a[0:3], a[64:67], v[16:19]
v_xor_b32 v3, v3, v7
v_xor_b32 v4, v4, v8
v_mfma_f32_16x16x32_bf16 v[16:19], a[16:19], a[80:83], v[16:19]
v_xor_b32 v5, s71, v5
v_xor_b32 v6, s71, v6
v_mfma_f32_16x16x32_bf16 v[20:23], a[20:23], a[80:83], v[20:23]
ds_read_b128 a[32:35], v5 offset:0
ds_read_b128 a[48:51], v6 offset:0
v_mfma_f32_16x16x32_bf16 v[20:23], a[4:7], a[64:67], v[20:23]
v_mfma_f32_16x16x32_bf16 v[24:27], a[8:11], a[64:67], v[24:27]
ds_read_b128 a[36:39], v5 offset:2048
v_mfma_f32_16x16x32_bf16 v[24:27], a[24:27], a[80:83], v[24:27]
s_add_u32 m0, s57, 32768
s_add_u32 s52, s85, 1048576
v_mfma_f32_16x16x32_bf16 v[28:31], a[28:31], a[80:83], v[28:31]
buffer_load_dwordx4 v3, s[40:43], s52 offen offset:0  lds
v_mfma_f32_16x16x32_bf16 v[28:31], a[12:15], a[64:67], v[28:31]
v_mfma_f32_16x16x32_bf16 a[144:147], a[12:15], a[68:71], a[144:147]
ds_read_b128 a[52:55], v6 offset:2048
v_mfma_f32_16x16x32_bf16 a[144:147], a[28:31], a[84:87], a[144:147]
v_mfma_f32_16x16x32_bf16 a[148:151], a[24:27], a[84:87], a[148:151]
ds_read_b128 a[40:43], v5 offset:4096
v_mfma_f32_16x16x32_bf16 a[148:151], a[8:11], a[68:71], a[148:151]
s_add_u32 s52, s85, 1113088
v_mfma_f32_16x16x32_bf16 a[152:155], a[4:7], a[68:71], a[152:155]
buffer_load_dwordx4 v4, s[40:43], s52 offen offset:1024  lds
v_mfma_f32_16x16x32_bf16 a[152:155], a[20:23], a[84:87], a[152:155]
v_mfma_f32_16x16x32_bf16 a[156:159], a[16:19], a[84:87], a[156:159]
ds_read_b128 a[56:59], v6 offset:4096
v_mfma_f32_16x16x32_bf16 a[156:159], a[0:3], a[68:71], a[156:159]
v_mfma_f32_16x16x32_bf16 a[160:163], a[0:3], a[72:75], a[160:163]
ds_read_b128 a[44:47], v5 offset:6144
v_mfma_f32_16x16x32_bf16 a[160:163], a[16:19], a[88:91], a[160:163]
s_add_u32 s52, s85, 1177600
v_mfma_f32_16x16x32_bf16 a[164:167], a[20:23], a[88:91], a[164:167]
buffer_load_dwordx4 v3, s[40:43], s52 offen offset:2048  lds
v_mfma_f32_16x16x32_bf16 a[164:167], a[4:7], a[72:75], a[164:167]
v_mfma_f32_16x16x32_bf16 a[168:171], a[8:11], a[72:75], a[168:171]
ds_read_b128 a[60:63], v6 offset:6144
v_mfma_f32_16x16x32_bf16 a[168:171], a[24:27], a[88:91], a[168:171]
v_mfma_f32_16x16x32_bf16 a[172:175], a[28:31], a[88:91], a[172:175]
v_mfma_f32_16x16x32_bf16 a[172:175], a[12:15], a[72:75], a[172:175]
s_add_u32 s52, s85, 1242112
v_mfma_f32_16x16x32_bf16 a[176:179], a[12:15], a[76:79], a[176:179]
buffer_load_dwordx4 v4, s[40:43], s52 offen offset:3072  lds
v_mfma_f32_16x16x32_bf16 a[176:179], a[28:31], a[92:95], a[176:179]
v_mfma_f32_16x16x32_bf16 a[180:183], a[24:27], a[92:95], a[180:183]
s_add_u32 s59, s72, 32768
v_mfma_f32_16x16x32_bf16 a[180:183], a[8:11], a[76:79], a[180:183]
buffer_store_dwordx4 v[32:35], v15, s[44:47], s59 offen offset:0 sc1
v_mfma_f32_16x16x32_bf16 a[184:187], a[4:7], a[76:79], a[184:187]
ds_read_b64_tr_b16 a[96:97], v13 offset:49152
ds_read_b64_tr_b16 a[98:99], v13 offset:49664
v_mfma_f32_16x16x32_bf16 a[184:187], a[20:23], a[92:95], a[184:187]
v_accvgpr_read_b32 v32, a144
v_accvgpr_read_b32 v33, a145
v_mfma_f32_16x16x32_bf16 a[188:191], a[16:19], a[92:95], a[188:191]
s_waitcnt lgkmcnt(2)
ds_read_b64_tr_b16 a[112:113], v13 offset:57344
ds_read_b64_tr_b16 a[114:115], v13 offset:57856
v_mfma_f32_16x16x32_bf16 a[188:191], a[0:3], a[76:79], a[188:191]
s_add_u32 m0, s58, 69632
s_add_u32 s55, s93, 34816
v_accvgpr_read_b32 v34, a146
v_mfma_f32_16x16x32_bf16 a[192:195], a[0:3], a[32:35], a[192:195]
buffer_load_dwordx4 v1, s[36:39], s55 offen offset:0 sc1 lds
v_mfma_f32_16x16x32_bf16 a[192:195], a[16:19], a[48:51], a[192:195]
v_accvgpr_read_b32 v35, a147
v_mfma_f32_16x16x32_bf16 a[196:199], a[20:23], a[48:51], a[196:199]
ds_read_b64_tr_b16 a[100:101], v14 offset:49152
ds_read_b64_tr_b16 a[102:103], v14 offset:49664
v_mfma_f32_16x16x32_bf16 a[196:199], a[4:7], a[32:35], a[196:199]
v_mfma_f32_16x16x32_bf16 a[200:203], a[8:11], a[32:35], a[200:203]
ds_read_b64_tr_b16 a[116:117], v14 offset:57344
ds_read_b64_tr_b16 a[118:119], v14 offset:57856
v_mfma_f32_16x16x32_bf16 a[200:203], a[24:27], a[48:51], a[200:203]
s_add_u32 s55, s93, 41984
v_mfma_f32_16x16x32_bf16 a[204:207], a[28:31], a[48:51], a[204:207]
buffer_load_dwordx4 v2, s[36:39], s55 offen offset:1024 sc1 lds
v_mfma_f32_16x16x32_bf16 a[204:207], a[12:15], a[32:35], a[204:207]
v_mfma_f32_16x16x32_bf16 a[208:211], a[12:15], a[36:39], a[208:211]
ds_read_b64_tr_b16 a[104:105], v13 offset:53248
ds_read_b64_tr_b16 a[106:107], v13 offset:53760
v_mfma_f32_16x16x32_bf16 a[208:211], a[28:31], a[52:55], a[208:211]
v_mfma_f32_16x16x32_bf16 a[212:215], a[24:27], a[52:55], a[212:215]
ds_read_b64_tr_b16 a[120:121], v13 offset:61440
ds_read_b64_tr_b16 a[122:123], v13 offset:61952
v_mfma_f32_16x16x32_bf16 a[212:215], a[8:11], a[36:39], a[212:215]
s_add_u32 s55, s93, 49152
v_mfma_f32_16x16x32_bf16 a[216:219], a[4:7], a[36:39], a[216:219]
buffer_load_dwordx4 v1, s[36:39], s55 offen offset:2048 sc1 lds
v_mfma_f32_16x16x32_bf16 a[216:219], a[20:23], a[52:55], a[216:219]
v_mfma_f32_16x16x32_bf16 a[220:223], a[16:19], a[52:55], a[220:223]
ds_read_b64_tr_b16 a[108:109], v14 offset:53248
ds_read_b64_tr_b16 a[110:111], v14 offset:53760
v_mfma_f32_16x16x32_bf16 a[220:223], a[0:3], a[36:39], a[220:223]
v_mfma_f32_16x16x32_bf16 a[224:227], a[0:3], a[40:43], a[224:227]
ds_read_b64_tr_b16 a[124:125], v14 offset:61440
ds_read_b64_tr_b16 a[126:127], v14 offset:61952
v_mfma_f32_16x16x32_bf16 a[224:227], a[16:19], a[56:59], a[224:227]
s_add_u32 s55, s93, 56320
v_mfma_f32_16x16x32_bf16 a[228:231], a[20:23], a[56:59], a[228:231]
buffer_load_dwordx4 v2, s[36:39], s55 offen offset:3072 sc1 lds
v_mfma_f32_16x16x32_bf16 a[228:231], a[4:7], a[40:43], a[228:231]
v_mfma_f32_16x16x32_bf16 a[232:235], a[8:11], a[40:43], a[232:235]
s_add_u32 s59, s72, 32768
v_mfma_f32_16x16x32_bf16 a[232:235], a[24:27], a[56:59], a[232:235]
buffer_store_dwordx4 v[36:39], v15, s[44:47], s59 offen offset:1024 sc1
v_mfma_f32_16x16x32_bf16 a[236:239], a[28:31], a[56:59], a[236:239]
v_mfma_f32_16x16x32_bf16 a[236:239], a[12:15], a[40:43], a[236:239]
v_accvgpr_read_b32 v36, a148
v_accvgpr_read_b32 v37, a149
v_mfma_f32_16x16x32_bf16 a[240:243], a[12:15], a[44:47], a[240:243]
v_accvgpr_read_b32 v38, a150
v_accvgpr_read_b32 v39, a151
v_mfma_f32_16x16x32_bf16 a[240:243], a[28:31], a[60:63], a[240:243]
v_mfma_f32_16x16x32_bf16 a[244:247], a[24:27], a[60:63], a[244:247]
s_add_u32 s59, s72, 36864
v_mfma_f32_16x16x32_bf16 a[244:247], a[8:11], a[44:47], a[244:247]
buffer_store_dwordx4 v[40:43], v15, s[44:47], s59 offen offset:1024 sc1
v_mfma_f32_16x16x32_bf16 a[248:251], a[4:7], a[44:47], a[248:251]
v_mfma_f32_16x16x32_bf16 a[248:251], a[20:23], a[60:63], a[248:251]
v_accvgpr_read_b32 v40, a152
v_accvgpr_read_b32 v41, a153
v_mfma_f32_16x16x32_bf16 a[252:255], a[16:19], a[60:63], a[252:255]
s_waitcnt vmcnt(21) lgkmcnt(0)
v_mfma_f32_16x16x32_bf16 a[252:255], a[0:3], a[44:47], a[252:255]
s_barrier
v_mfma_f32_16x16x32_bf16 v[140:143], a[96:99], a[32:35], v[140:143]
v_xor_b32 v3, v3, v7
v_xor_b32 v4, v4, v8
v_mfma_f32_16x16x32_bf16 v[140:143], a[112:115], a[48:51], v[140:143]
s_add_u32 m0, s57, 49152
s_add_u32 s52, s89, 458752
v_accvgpr_read_b32 v42, a154
v_mfma_f32_16x16x32_bf16 v[148:151], a[116:119], a[48:51], v[148:151]
buffer_load_dwordx4 v3, s[64:67], s52 offen offset:0  lds
v_mfma_f32_16x16x32_bf16 v[148:151], a[100:103], a[32:35], v[148:151]
v_accvgpr_read_b32 v43, a155
v_mfma_f32_16x16x32_bf16 v[136:139], a[104:107], a[32:35], v[136:139]
ds_read_b64_tr_b16 a[0:1], v9 offset:0
ds_read_b64_tr_b16 a[2:3], v9 offset:512
v_mfma_f32_16x16x32_bf16 v[136:139], a[120:123], a[48:51], v[136:139]
v_mfma_f32_16x16x32_bf16 v[144:147], a[124:127], a[48:51], v[144:147]
ds_read_b64_tr_b16 a[16:17], v9 offset:8192
ds_read_b64_tr_b16 a[18:19], v9 offset:8704
v_mfma_f32_16x16x32_bf16 v[144:147], a[108:111], a[32:35], v[144:147]
s_add_u32 m0, s58, 0
s_add_u32 s55, s92, 4096
v_mfma_f32_16x16x32_bf16 v[128:131], a[108:111], a[36:39], v[128:131]
buffer_load_dwordx4 v1, s[36:39], s55 offen offset:0 sc1 lds
v_mfma_f32_16x16x32_bf16 v[128:131], a[124:127], a[52:55], v[128:131]
v_mfma_f32_16x16x32_bf16 v[132:135], a[120:123], a[52:55], v[132:135]
ds_read_b64_tr_b16 a[4:5], v10 offset:0
ds_read_b64_tr_b16 a[6:7], v10 offset:512
v_mfma_f32_16x16x32_bf16 v[132:135], a[104:107], a[36:39], v[132:135]
v_mfma_f32_16x16x32_bf16 v[152:155], a[100:103], a[36:39], v[152:155]
ds_read_b64_tr_b16 a[20:21], v10 offset:8192
ds_read_b64_tr_b16 a[22:23], v10 offset:8704
v_mfma_f32_16x16x32_bf16 v[152:155], a[116:119], a[52:55], v[152:155]
s_add_u32 m0, s57, 49152
s_add_u32 s52, s89, 486400
v_mfma_f32_16x16x32_bf16 v[156:159], a[112:115], a[52:55], v[156:159]
buffer_load_dwordx4 v4, s[64:67], s52 offen offset:1024  lds
v_mfma_f32_16x16x32_bf16 v[156:159], a[96:99], a[36:39], v[156:159]
v_mfma_f32_16x16x32_bf16 v[160:163], a[96:99], a[40:43], v[160:163]
ds_read_b64_tr_b16 a[8:9], v11 offset:0
ds_read_b64_tr_b16 a[10:11], v11 offset:512
v_mfma_f32_16x16x32_bf16 v[160:163], a[112:115], a[56:59], v[160:163]
v_mfma_f32_16x16x32_bf16 v[164:167], a[116:119], a[56:59], v[164:167]
ds_read_b64_tr_b16 a[24:25], v11 offset:8192
ds_read_b64_tr_b16 a[26:27], v11 offset:8704
v_mfma_f32_16x16x32_bf16 v[164:167], a[100:103], a[40:43], v[164:167]
s_add_u32 m0, s58, 0
s_add_u32 s55, s92, 11264
v_mfma_f32_16x16x32_bf16 v[168:171], a[104:107], a[40:43], v[168:171]
buffer_load_dwordx4 v2, s[36:39], s55 offen offset:1024 sc1 lds
v_mfma_f32_16x16x32_bf16 v[168:171], a[120:123], a[56:59], v[168:171]
v_mfma_f32_16x16x32_bf16 v[172:175], a[124:127], a[56:59], v[172:175]
ds_read_b64_tr_b16 a[12:13], v12 offset:0
ds_read_b64_tr_b16 a[14:15], v12 offset:512
v_mfma_f32_16x16x32_bf16 v[172:175], a[108:111], a[40:43], v[172:175]
v_mfma_f32_16x16x32_bf16 v[176:179], a[108:111], a[44:47], v[176:179]
ds_read_b64_tr_b16 a[28:29], v12 offset:8192
ds_read_b64_tr_b16 a[30:31], v12 offset:8704
v_mfma_f32_16x16x32_bf16 v[176:179], a[124:127], a[60:63], v[176:179]
s_add_u32 m0, s57, 49152
s_add_u32 s52, s89, 514048
v_mfma_f32_16x16x32_bf16 v[180:183], a[120:123], a[60:63], v[180:183]
buffer_load_dwordx4 v3, s[64:67], s52 offen offset:2048  lds
v_mfma_f32_16x16x32_bf16 v[180:183], a[104:107], a[44:47], v[180:183]
v_xor_b32 v5, s71, v5
v_xor_b32 v6, s71, v6
v_mfma_f32_16x16x32_bf16 v[184:187], a[100:103], a[44:47], v[184:187]
v_mfma_f32_16x16x32_bf16 v[184:187], a[116:119], a[60:63], v[184:187]
s_add_u32 m0, s58, 0
s_add_u32 s55, s92, 18432
v_mfma_f32_16x16x32_bf16 v[188:191], a[112:115], a[60:63], v[188:191]
buffer_load_dwordx4 v1, s[36:39], s55 offen offset:2048 sc1 lds
v_mfma_f32_16x16x32_bf16 v[188:191], a[96:99], a[44:47], v[188:191]
v_mfma_f32_16x16x32_bf16 v[192:195], a[96:99], a[64:67], v[192:195]
ds_read_b128 a[32:35], v5 offset:32768
ds_read_b128 a[48:51], v6 offset:32768
v_mfma_f32_16x16x32_bf16 v[192:195], a[112:115], a[80:83], v[192:195]
v_mfma_f32_16x16x32_bf16 v[196:199], a[120:123], a[80:83], v[196:199]
ds_read_b128 a[36:39], v5 offset:34816
ds_read_b128 a[52:55], v6 offset:34816
v_mfma_f32_16x16x32_bf16 v[196:199], a[104:107], a[64:67], v[196:199]
v_mfma_f32_16x16x32_bf16 v[200:203], a[104:107], a[68:71], v[200:203]
ds_read_b128 a[40:43], v5 offset:36864
ds_read_b128 a[56:59], v6 offset:36864
v_mfma_f32_16x16x32_bf16 v[200:203], a[120:123], a[84:87], v[200:203]
s_add_u32 m0, s57, 49152
s_add_u32 s52, s89, 541696
v_mfma_f32_16x16x32_bf16 v[204:207], a[112:115], a[84:87], v[204:207]
buffer_load_dwordx4 v4, s[64:67], s52 offen offset:3072  lds
v_mfma_f32_16x16x32_bf16 v[204:207], a[96:99], a[68:71], v[204:207]
v_mfma_f32_16x16x32_bf16 v[208:211], a[96:99], a[72:75], v[208:211]
ds_read_b128 a[44:47], v5 offset:38912
ds_read_b128 a[60:63], v6 offset:38912
v_mfma_f32_16x16x32_bf16 v[208:211], a[112:115], a[88:91], v[208:211]
v_mfma_f32_16x16x32_bf16 v[212:215], a[120:123], a[88:91], v[212:215]
v_mfma_f32_16x16x32_bf16 v[212:215], a[104:107], a[72:75], v[212:215]
s_add_u32 m0, s58, 0
s_add_u32 s55, s92, 25600
v_mfma_f32_16x16x32_bf16 v[216:219], a[104:107], a[76:79], v[216:219]
buffer_load_dwordx4 v2, s[36:39], s55 offen offset:3072 sc1 lds
v_mfma_f32_16x16x32_bf16 v[216:219], a[120:123], a[92:95], v[216:219]
v_mfma_f32_16x16x32_bf16 v[220:223], a[112:115], a[92:95], v[220:223]
s_bitcmp1_b32 s2, 0
v_mfma_f32_16x16x32_bf16 v[220:223], a[96:99], a[76:79], v[220:223]
s_cbranch_scc1 L_short19
v_mfma_f32_16x16x32_bf16 v[224:227], a[100:103], a[76:79], v[224:227]
v_mfma_f32_16x16x32_bf16 v[224:227], a[116:119], a[92:95], v[224:227]
v_mfma_f32_16x16x32_bf16 v[228:231], a[124:127], a[92:95], v[228:231]
v_mfma_f32_16x16x32_bf16 v[228:231], a[108:111], a[76:79], v[228:231]
v_mfma_f32_16x16x32_bf16 v[232:235], a[108:111], a[72:75], v[232:235]
v_mfma_f32_16x16x32_bf16 v[232:235], a[124:127], a[88:91], v[232:235]
v_mfma_f32_16x16x32_bf16 v[236:239], a[116:119], a[88:91], v[236:239]
v_mfma_f32_16x16x32_bf16 v[236:239], a[100:103], a[72:75], v[236:239]
v_mfma_f32_16x16x32_bf16 v[240:243], a[100:103], a[68:71], v[240:243]
v_mfma_f32_16x16x32_bf16 v[240:243], a[116:119], a[84:87], v[240:243]
v_mfma_f32_16x16x32_bf16 v[244:247], a[124:127], a[84:87], v[244:247]
v_mfma_f32_16x16x32_bf16 v[244:247], a[108:111], a[68:71], v[244:247]
v_mfma_f32_16x16x32_bf16 v[248:251], a[108:111], a[64:67], v[248:251]
v_mfma_f32_16x16x32_bf16 v[248:251], a[124:127], a[80:83], v[248:251]
v_mfma_f32_16x16x32_bf16 v[252:255], a[116:119], a[80:83], v[252:255]
v_mfma_f32_16x16x32_bf16 v[252:255], a[100:103], a[64:67], v[252:255]
L_short19:
s_waitcnt vmcnt(20) lgkmcnt(0)
s_barrier
v_mfma_f32_16x16x32_bf16 v[16:19], a[0:3], a[32:35], v[16:19]
v_xor_b32 v3, v3, v7
v_xor_b32 v4, v4, v8
v_mfma_f32_16x16x32_bf16 v[16:19], a[16:19], a[48:51], v[16:19]
v_xor_b32 v5, s71, v5
v_xor_b32 v6, s71, v6
v_mfma_f32_16x16x32_bf16 v[20:23], a[20:23], a[48:51], v[20:23]
ds_read_b128 a[64:67], v5 offset:32768
ds_read_b128 a[80:83], v6 offset:32768
v_mfma_f32_16x16x32_bf16 v[20:23], a[4:7], a[32:35], v[20:23]
v_mfma_f32_16x16x32_bf16 v[24:27], a[8:11], a[32:35], v[24:27]
ds_read_b128 a[68:71], v5 offset:34816
v_mfma_f32_16x16x32_bf16 v[24:27], a[24:27], a[48:51], v[24:27]
s_add_u32 m0, s57, 0
s_add_u32 s52, s84, 2097152
v_mfma_f32_16x16x32_bf16 v[28:31], a[28:31], a[48:51], v[28:31]
buffer_load_dwordx4 v3, s[40:43], s52 offen offset:0  lds
v_mfma_f32_16x16x32_bf16 v[28:31], a[12:15], a[32:35], v[28:31]
v_mfma_f32_16x16x32_bf16 v[32:35], a[12:15], a[36:39], v[32:35]
ds_read_b128 a[84:87], v6 offset:34816
v_mfma_f32_16x16x32_bf16 v[32:35], a[28:31], a[52:55], v[32:35]
v_mfma_f32_16x16x32_bf16 v[36:39], a[24:27], a[52:55], v[36:39]
ds_read_b128 a[72:75], v5 offset:36864
v_mfma_f32_16x16x32_bf16 v[36:39], a[8:11], a[36:39], v[36:39]
s_add_u32 s52, s84, 2161664
v_mfma_f32_16x16x32_bf16 v[40:43], a[4:7], a[36:39], v[40:43]
buffer_load_dwordx4 v4, s[40:43], s52 offen offset:1024  lds
v_mfma_f32_16x16x32_bf16 v[40:43], a[20:23], a[52:55], v[40:43]
v_mfma_f32_16x16x32_bf16 a[156:159], a[16:19], a[52:55], a[156:159]
ds_read_b128 a[88:91], v6 offset:36864
v_mfma_f32_16x16x32_bf16 a[156:159], a[0:3], a[36:39], a[156:159]
v_mfma_f32_16x16x32_bf16 a[160:163], a[0:3], a[40:43], a[160:163]
ds_read_b128 a[76:79], v5 offset:38912
v_mfma_f32_16x16x32_bf16 a[160:163], a[16:19], a[56:59], a[160:163]
s_add_u32 s52, s84, 2226176
v_mfma_f32_16x16x32_bf16 a[164:167], a[20:23], a[56:59], a[164:167]
buffer_load_dwordx4 v3, s[40:43], s52 offen offset:2048  lds
v_mfma_f32_16x16x32_bf16 a[164:167], a[4:7], a[40:43], a[164:167]
v_mfma_f32_16x16x32_bf16 a[168:171], a[8:11], a[40:43], a[168:171]
ds_read_b128 a[92:95], v6 offset:38912
v_mfma_f32_16x16x32_bf16 a[168:171], a[24:27], a[56:59], a[168:171]
v_mfma_f32_16x16x32_bf16 a[172:175], a[28:31], a[56:59], a[172:175]
v_mfma_f32_16x16x32_bf16 a[172:175], a[12:15], a[40:43], a[172:175]
s_add_u32 s52, s84, 2290688
v_mfma_f32_16x16x32_bf16 a[176:179], a[12:15], a[44:47], a[176:179]
buffer_load_dwordx4 v4, s[40:43], s52 offen offset:3072  lds
v_mfma_f32_16x16x32_bf16 a[176:179], a[28:31], a[60:63], a[176:179]
v_mfma_f32_16x16x32_bf16 a[180:183], a[24:27], a[60:63], a[180:183]
s_add_u32 s59, s72, 36864
v_mfma_f32_16x16x32_bf16 a[180:183], a[8:11], a[44:47], a[180:183]
buffer_store_dwordx4 v[44:47], v15, s[44:47], s59 offen offset:0 sc1
v_mfma_f32_16x16x32_bf16 a[184:187], a[4:7], a[44:47], a[184:187]
ds_read_b64_tr_b16 a[96:97], v13 offset:16384
ds_read_b64_tr_b16 a[98:99], v13 offset:16896
v_mfma_f32_16x16x32_bf16 a[184:187], a[20:23], a[60:63], a[184:187]
v_accvgpr_read_b32 v44, a156
v_accvgpr_read_b32 v45, a157
v_mfma_f32_16x16x32_bf16 a[188:191], a[16:19], a[60:63], a[188:191]
s_waitcnt lgkmcnt(2)
ds_read_b64_tr_b16 a[112:113], v13 offset:24576
ds_read_b64_tr_b16 a[114:115], v13 offset:25088
v_mfma_f32_16x16x32_bf16 a[188:191], a[0:3], a[44:47], a[188:191]
s_add_u32 m0, s58, 4096
s_add_u32 s55, s92, 36864
v_accvgpr_read_b32 v46, a158
v_mfma_f32_16x16x32_bf16 a[192:195], a[0:3], a[64:67], a[192:195]
buffer_load_dwordx4 v1, s[36:39], s55 offen offset:0 sc1 lds
v_mfma_f32_16x16x32_bf16 a[192:195], a[16:19], a[80:83], a[192:195]
v_accvgpr_read_b32 v47, a159
v_mfma_f32_16x16x32_bf16 a[196:199], a[20:23], a[80:83], a[196:199]
ds_read_b64_tr_b16 a[100:101], v14 offset:16384
ds_read_b64_tr_b16 a[102:103], v14 offset:16896
v_mfma_f32_16x16x32_bf16 a[196:199], a[4:7], a[64:67], a[196:199]
v_mfma_f32_16x16x32_bf16 a[200:203], a[8:11], a[64:67], a[200:203]
ds_read_b64_tr_b16 a[116:117], v14 offset:24576
ds_read_b64_tr_b16 a[118:119], v14 offset:25088
v_mfma_f32_16x16x32_bf16 a[200:203], a[24:27], a[80:83], a[200:203]
s_add_u32 s55, s92, 44032
v_mfma_f32_16x16x32_bf16 a[204:207], a[28:31], a[80:83], a[204:207]
buffer_load_dwordx4 v2, s[36:39], s55 offen offset:1024 sc1 lds
v_mfma_f32_16x16x32_bf16 a[204:207], a[12:15], a[64:67], a[204:207]
v_mfma_f32_16x16x32_bf16 a[208:211], a[12:15], a[68:71], a[208:211]
ds_read_b64_tr_b16 a[104:105], v13 offset:20480
ds_read_b64_tr_b16 a[106:107], v13 offset:20992
v_mfma_f32_16x16x32_bf16 a[208:211], a[28:31], a[84:87], a[208:211]
v_mfma_f32_16x16x32_bf16 a[212:215], a[24:27], a[84:87], a[212:215]
ds_read_b64_tr_b16 a[120:121], v13 offset:28672
ds_read_b64_tr_b16 a[122:123], v13 offset:29184
v_mfma_f32_16x16x32_bf16 a[212:215], a[8:11], a[68:71], a[212:215]
s_add_u32 s55, s92, 51200
v_mfma_f32_16x16x32_bf16 a[216:219], a[4:7], a[68:71], a[216:219]
buffer_load_dwordx4 v1, s[36:39], s55 offen offset:2048 sc1 lds
v_mfma_f32_16x16x32_bf16 a[216:219], a[20:23], a[84:87], a[216:219]
v_mfma_f32_16x16x32_bf16 a[220:223], a[16:19], a[84:87], a[220:223]
ds_read_b64_tr_b16 a[108:109], v14 offset:20480
ds_read_b64_tr_b16 a[110:111], v14 offset:20992
v_mfma_f32_16x16x32_bf16 a[220:223], a[0:3], a[68:71], a[220:223]
v_mfma_f32_16x16x32_bf16 a[224:227], a[0:3], a[72:75], a[224:227]
ds_read_b64_tr_b16 a[124:125], v14 offset:28672
ds_read_b64_tr_b16 a[126:127], v14 offset:29184
v_mfma_f32_16x16x32_bf16 a[224:227], a[16:19], a[88:91], a[224:227]
s_add_u32 s55, s92, 58368
v_mfma_f32_16x16x32_bf16 a[228:231], a[20:23], a[88:91], a[228:231]
buffer_load_dwordx4 v2, s[36:39], s55 offen offset:3072 sc1 lds
v_mfma_f32_16x16x32_bf16 a[228:231], a[4:7], a[72:75], a[228:231]
v_mfma_f32_16x16x32_bf16 a[232:235], a[8:11], a[72:75], a[232:235]
s_add_u32 s59, s72, 49152
v_mfma_f32_16x16x32_bf16 a[232:235], a[24:27], a[88:91], a[232:235]
buffer_store_dwordx4 v[48:51], v15, s[44:47], s59 offen offset:0 sc1
v_mfma_f32_16x16x32_bf16 a[236:239], a[28:31], a[88:91], a[236:239]
v_mfma_f32_16x16x32_bf16 a[236:239], a[12:15], a[72:75], a[236:239]
v_accvgpr_read_b32 v48, a160
v_accvgpr_read_b32 v49, a161
v_mfma_f32_16x16x32_bf16 a[240:243], a[12:15], a[76:79], a[240:243]
v_accvgpr_read_b32 v50, a162
v_accvgpr_read_b32 v51, a163
v_mfma_f32_16x16x32_bf16 a[240:243], a[28:31], a[92:95], a[240:243]
v_mfma_f32_16x16x32_bf16 a[244:247], a[24:27], a[92:95], a[244:247]
s_add_u32 s59, s72, 49152
v_mfma_f32_16x16x32_bf16 a[244:247], a[8:11], a[76:79], a[244:247]
buffer_store_dwordx4 v[52:55], v15, s[44:47], s59 offen offset:1024 sc1
v_mfma_f32_16x16x32_bf16 a[248:251], a[4:7], a[76:79], a[248:251]
v_mfma_f32_16x16x32_bf16 a[248:251], a[20:23], a[92:95], a[248:251]
v_accvgpr_read_b32 v52, a164
v_accvgpr_read_b32 v53, a165
v_mfma_f32_16x16x32_bf16 a[252:255], a[16:19], a[92:95], a[252:255]
s_waitcnt vmcnt(21) lgkmcnt(0)
v_mfma_f32_16x16x32_bf16 a[252:255], a[0:3], a[76:79], a[252:255]
s_barrier
v_mfma_f32_16x16x32_bf16 v[140:143], a[96:99], a[64:67], v[140:143]
v_xor_b32 v3, v3, v7
v_xor_b32 v4, v4, v8
v_mfma_f32_16x16x32_bf16 v[140:143], a[112:115], a[80:83], v[140:143]
s_add_u32 m0, s57, 16384
s_add_u32 s52, s88, 917504
v_accvgpr_read_b32 v54, a166
v_mfma_f32_16x16x32_bf16 v[148:151], a[116:119], a[80:83], v[148:151]
buffer_load_dwordx4 v3, s[64:67], s52 offen offset:0  lds
v_mfma_f32_16x16x32_bf16 v[148:151], a[100:103], a[64:67], v[148:151]
v_accvgpr_read_b32 v55, a167
v_mfma_f32_16x16x32_bf16 v[136:139], a[104:107], a[64:67], v[136:139]
ds_read_b64_tr_b16 a[0:1], v9 offset:32768
ds_read_b64_tr_b16 a[2:3], v9 offset:33280
v_mfma_f32_16x16x32_bf16 v[136:139], a[120:123], a[80:83], v[136:139]
v_mfma_f32_16x16x32_bf16 v[144:147], a[124:127], a[80:83], v[144:147]
ds_read_b64_tr_b16 a[16:17], v9 offset:40960
ds_read_b64_tr_b16 a[18:19], v9 offset:41472
v_mfma_f32_16x16x32_bf16 v[144:147], a[108:111], a[64:67], v[144:147]
s_add_u32 m0, s58, 32768
s_add_u32 s55, s93, 4096
v_mfma_f32_16x16x32_bf16 v[128:131], a[108:111], a[68:71], v[128:131]
buffer_load_dwordx4 v1, s[36:39], s55 offen offset:0 sc1 lds
v_mfma_f32_16x16x32_bf16 v[128:131], a[124:127], a[84:87], v[128:131]
v_mfma_f32_16x16x32_bf16 v[132:135], a[120:123], a[84:87], v[132:135]
ds_read_b64_tr_b16 a[4:5], v10 offset:32768
ds_read_b64_tr_b16 a[6:7], v10 offset:33280
v_mfma_f32_16x16x32_bf16 v[132:135], a[104:107], a[68:71], v[132:135]
v_mfma_f32_16x16x32_bf16 v[152:155], a[100:103], a[68:71], v[152:155]
ds_read_b64_tr_b16 a[20:21], v10 offset:40960
ds_read_b64_tr_b16 a[22:23], v10 offset:41472
v_mfma_f32_16x16x32_bf16 v[152:155], a[116:119], a[84:87], v[152:155]
s_add_u32 m0, s57, 16384
s_add_u32 s52, s88, 945152
v_mfma_f32_16x16x32_bf16 v[156:159], a[112:115], a[84:87], v[156:159]
buffer_load_dwordx4 v4, s[64:67], s52 offen offset:1024  lds
v_mfma_f32_16x16x32_bf16 v[156:159], a[96:99], a[68:71], v[156:159]
v_mfma_f32_16x16x32_bf16 v[160:163], a[96:99], a[72:75], v[160:163]
ds_read_b64_tr_b16 a[8:9], v11 offset:32768
ds_read_b64_tr_b16 a[10:11], v11 offset:33280
v_mfma_f32_16x16x32_bf16 v[160:163], a[112:115], a[88:91], v[160:163]
v_mfma_f32_16x16x32_bf16 v[164:167], a[116:119], a[88:91], v[164:167]
L_t5:
s_cbranch_execz L_r1
ds_read_b64_tr_b16 a[24:25], v11 offset:40960
ds_read_b64_tr_b16 a[26:27], v11 offset:41472
v_mfma_f32_16x16x32_bf16 v[164:167], a[100:103], a[72:75], v[164:167]
s_add_u32 m0, s58, 32768
s_add_u32 s55, s93, 11264
v_mfma_f32_16x16x32_bf16 v[168:171], a[104:107], a[72:75], v[168:171]
buffer_load_dwordx4 v2, s[36:39], s55 offen offset:1024 sc1 lds
v_mfma_f32_16x16x32_bf16 v[168:171], a[120:123], a[88:91], v[168:171]
v_mfma_f32_16x16x32_bf16 v[172:175], a[124:127], a[88:91], v[172:175]
ds_read_b64_tr_b16 a[12:13], v12 offset:32768
ds_read_b64_tr_b16 a[14:15], v12 offset:33280
v_mfma_f32_16x16x32_bf16 v[172:175], a[108:111], a[72:75], v[172:175]
v_mfma_f32_16x16x32_bf16 v[176:179], a[108:111], a[76:79], v[176:179]
ds_read_b64_tr_b16 a[28:29], v12 offset:40960
ds_read_b64_tr_b16 a[30:31], v12 offset:41472
v_mfma_f32_16x16x32_bf16 v[176:179], a[124:127], a[92:95], v[176:179]
s_add_u32 m0, s57, 16384
s_add_u32 s52, s88, 972800
v_mfma_f32_16x16x32_bf16 v[180:183], a[120:123], a[92:95], v[180:183]
buffer_load_dwordx4 v3, s[64:67], s52 offen offset:2048  lds
v_mfma_f32_16x16x32_bf16 v[180:183], a[104:107], a[76:79], v[180:183]
v_xor_b32 v5, s71, v5
v_xor_b32 v6, s71, v6
v_mfma_f32_16x16x32_bf16 v[184:187], a[100:103], a[76:79], v[184:187]
v_add_u32 v5, 0x10000, v5
v_add_u32 v6, 0x10000, v6
v_mfma_f32_16x16x32_bf16 v[184:187], a[116:119], a[92:95], v[184:187]
s_add_u32 m0, s58, 32768
s_add_u32 s55, s93, 18432
v_mfma_f32_16x16x32_bf16 v[188:191], a[112:115], a[92:95], v[188:191]
buffer_load_dwordx4 v1, s[36:39], s55 offen offset:2048 sc1 lds
v_mfma_f32_16x16x32_bf16 v[188:191], a[96:99], a[76:79], v[188:191]
v_mfma_f32_16x16x32_bf16 v[192:195], a[96:99], a[32:35], v[192:195]
ds_read_b128 a[64:67], v5 offset:0
ds_read_b128 a[80:83], v6 offset:0
v_mfma_f32_16x16x32_bf16 v[192:195], a[112:115], a[48:51], v[192:195]
v_mfma_f32_16x16x32_bf16 v[196:199], a[120:123], a[48:51], v[196:199]
ds_read_b128 a[68:71], v5 offset:2048
ds_read_b128 a[84:87], v6 offset:2048
v_mfma_f32_16x16x32_bf16 v[196:199], a[104:107], a[32:35], v[196:199]
v_mfma_f32_16x16x32_bf16 v[200:203], a[104:107], a[36:39], v[200:203]
ds_read_b128 a[72:75], v5 offset:4096
ds_read_b128 a[88:91], v6 offset:4096
v_mfma_f32_16x16x32_bf16 v[200:203], a[120:123], a[52:55], v[200:203]
s_add_u32 m0, s57, 16384
s_add_u32 s52, s88, 1000448
v_mfma_f32_16x16x32_bf16 v[204:207], a[112:115], a[52:55], v[204:207]
buffer_load_dwordx4 v4, s[64:67], s52 offen offset:3072  lds
v_mfma_f32_16x16x32_bf16 v[204:207], a[96:99], a[36:39], v[204:207]
v_mfma_f32_16x16x32_bf16 v[208:211], a[96:99], a[40:43], v[208:211]
ds_read_b128 a[76:79], v5 offset:6144
ds_read_b128 a[92:95], v6 offset:6144
v_mfma_f32_16x16x32_bf16 v[208:211], a[112:115], a[56:59], v[208:211]
v_mfma_f32_16x16x32_bf16 v[212:215], a[120:123], a[56:59], v[212:215]
v_mfma_f32_16x16x32_bf16 v[212:215], a[104:107], a[40:43], v[212:215]
s_add_u32 m0, s58, 32768
s_add_u32 s55, s93, 25600
v_mfma_f32_16x16x32_bf16 v[216:219], a[104:107], a[44:47], v[216:219]
buffer_load_dwordx4 v2, s[36:39], s55 offen offset:3072 sc1 lds
v_mfma_f32_16x16x32_bf16 v[216:219], a[120:123], a[60:63], v[216:219]
v_mfma_f32_16x16x32_bf16 v[220:223], a[112:115], a[60:63], v[220:223]
s_bitcmp1_b32 s2, 0
v_mfma_f32_16x16x32_bf16 v[220:223], a[96:99], a[44:47], v[220:223]
s_cbranch_scc1 L_short21
v_mfma_f32_16x16x32_bf16 v[224:227], a[100:103], a[44:47], v[224:227]
v_mfma_f32_16x16x32_bf16 v[224:227], a[116:119], a[60:63], v[224:227]
v_mfma_f32_16x16x32_bf16 v[228:231], a[124:127], a[60:63], v[228:231]
v_mfma_f32_16x16x32_bf16 v[228:231], a[108:111], a[44:47], v[228:231]
v_mfma_f32_16x16x32_bf16 v[232:235], a[108:111], a[40:43], v[232:235]
v_mfma_f32_16x16x32_bf16 v[232:235], a[124:127], a[56:59], v[232:235]
v_mfma_f32_16x16x32_bf16 v[236:239], a[116:119], a[56:59], v[236:239]
v_mfma_f32_16x16x32_bf16 v[236:239], a[100:103], a[40:43], v[236:239]
v_mfma_f32_16x16x32_bf16 v[240:243], a[100:103], a[36:39], v[240:243]
v_mfma_f32_16x16x32_bf16 v[240:243], a[116:119], a[52:55], v[240:243]
v_mfma_f32_16x16x32_bf16 v[244:247], a[124:127], a[52:55], v[244:247]
v_mfma_f32_16x16x32_bf16 v[244:247], a[108:111], a[36:39], v[244:247]
v_mfma_f32_16x16x32_bf16 v[248:251], a[108:111], a[32:35], v[248:251]
v_mfma_f32_16x16x32_bf16 v[248:251], a[124:127], a[48:51], v[248:251]
v_mfma_f32_16x16x32_bf16 v[252:255], a[116:119], a[48:51], v[252:255]
v_mfma_f32_16x16x32_bf16 v[252:255], a[100:103], a[32:35], v[252:255]
L_short21:
s_waitcnt vmcnt(20) lgkmcnt(0)
s_barrier
v_mfma_f32_16x16x32_bf16 v[16:19], a[0:3], a[64:67], v[16:19]
v_xor_b32 v3, v3, v7
v_xor_b32 v4, v4, v8
v_mfma_f32_16x16x32_bf16 v[16:19], a[16:19], a[80:83], v[16:19]
v_xor_b32 v5, s71, v5
v_xor_b32 v6, s71, v6
v_mfma_f32_16x16x32_bf16 v[20:23], a[20:23], a[80:83], v[20:23]
ds_read_b128 a[32:35], v5 offset:0
ds_read_b128 a[48:51], v6 offset:0
v_mfma_f32_16x16x32_bf16 v[20:23], a[4:7], a[64:67], v[20:23]
v_mfma_f32_16x16x32_bf16 v[24:27], a[8:11], a[64:67], v[24:27]
ds_read_b128 a[36:39], v5 offset:2048
v_mfma_f32_16x16x32_bf16 v[24:27], a[24:27], a[80:83], v[24:27]
s_add_u32 m0, s57, 32768
s_add_u32 s52, s85, 2097152
v_mfma_f32_16x16x32_bf16 v[28:31], a[28:31], a[80:83], v[28:31]
buffer_load_dwordx4 v3, s[40:43], s52 offen offset:0  lds
v_mfma_f32_16x16x32_bf16 v[28:31], a[12:15], a[64:67], v[28:31]
v_mfma_f32_16x16x32_bf16 v[32:35], a[12:15], a[68:71], v[32:35]
ds_read_b128 a[52:55], v6 offset:2048
v_mfma_f32_16x16x32_bf16 v[32:35], a[28:31], a[84:87], v[32:35]
v_mfma_f32_16x16x32_bf16 v[36:39], a[24:27], a[84:87], v[36:39]
ds_read_b128 a[40:43], v5 offset:4096
v_mfma_f32_16x16x32_bf16 v[36:39], a[8:11], a[68:71], v[36:39]
s_add_u32 s52, s85, 2161664
v_mfma_f32_16x16x32_bf16 v[40:43], a[4:7], a[68:71], v[40:43]
buffer_load_dwordx4 v4, s[40:43], s52 offen offset:1024  lds
v_mfma_f32_16x16x32_bf16 v[40:43], a[20:23], a[84:87], v[40:43]
v_mfma_f32_16x16x32_bf16 v[44:47], a[16:19], a[84:87], v[44:47]
ds_read_b128 a[56:59], v6 offset:4096
v_mfma_f32_16x16x32_bf16 v[44:47], a[0:3], a[68:71], v[44:47]
v_mfma_f32_16x16x32_bf16 v[48:51], a[0:3], a[72:75], v[48:51]
ds_read_b128 a[44:47], v5 offset:6144
v_mfma_f32_16x16x32_bf16 v[48:51], a[16:19], a[88:91], v[48:51]
s_add_u32 s52, s85, 2226176
v_mfma_f32_16x16x32_bf16 v[52:55], a[20:23], a[88:91], v[52:55]
buffer_load_dwordx4 v3, s[40:43], s52 offen offset:2048  lds
v_mfma_f32_16x16x32_bf16 v[52:55], a[4:7], a[72:75], v[52:55]
v_mfma_f32_16x16x32_bf16 a[168:171], a[8:11], a[72:75], a[168:171]
ds_read_b128 a[60:63], v6 offset:6144
v_mfma_f32_16x16x32_bf16 a[168:171], a[24:27], a[88:91], a[168:171]
v_mfma_f32_16x16x32_bf16 a[172:175], a[28:31], a[88:91], a[172:175]
v_mfma_f32_16x16x32_bf16 a[172:175], a[12:15], a[72:75], a[172:175]
s_add_u32 s52, s85, 2290688
v_mfma_f32_16x16x32_bf16 a[176:179], a[12:15], a[76:79], a[176:179]
buffer_load_dwordx4 v4, s[40:43], s52 offen offset:3072  lds
v_mfma_f32_16x16x32_bf16 a[176:179], a[28:31], a[92:95], a[176:179]
v_mfma_f32_16x16x32_bf16 a[180:183], a[24:27], a[92:95], a[180:183]
s_add_u32 s59, s72, 53248
v_mfma_f32_16x16x32_bf16 a[180:183], a[8:11], a[76:79], a[180:183]
buffer_store_dwordx4 v[56:59], v15, s[44:47], s59 offen offset:1024 sc1
v_mfma_f32_16x16x32_bf16 a[184:187], a[4:7], a[76:79], a[184:187]
ds_read_b64_tr_b16 a[96:97], v13 offset:49152
ds_read_b64_tr_b16 a[98:99], v13 offset:49664
v_mfma_f32_16x16x32_bf16 a[184:187], a[20:23], a[92:95], a[184:187]
v_accvgpr_read_b32 v56, a168
v_accvgpr_read_b32 v57, a169
v_mfma_f32_16x16x32_bf16 a[188:191], a[16:19], a[92:95], a[188:191]
s_waitcnt lgkmcnt(2)
ds_read_b64_tr_b16 a[112:113], v13 offset:57344
ds_read_b64_tr_b16 a[114:115], v13 offset:57856
v_mfma_f32_16x16x32_bf16 a[188:191], a[0:3], a[76:79], a[188:191]
s_add_u32 m0, s58, 36864
s_add_u32 s55, s93, 36864
v_accvgpr_read_b32 v58, a170
v_mfma_f32_16x16x32_bf16 a[192:195], a[0:3], a[32:35], a[192:195]
buffer_load_dwordx4 v1, s[36:39], s55 offen offset:0 sc1 lds
v_mfma_f32_16x16x32_bf16 a[192:195], a[16:19], a[48:51], a[192:195]
v_accvgpr_read_b32 v59, a171
v_mfma_f32_16x16x32_bf16 a[196:199], a[20:23], a[48:51], a[196:199]
ds_read_b64_tr_b16 a[100:101], v14 offset:49152
ds_read_b64_tr_b16 a[102:103], v14 offset:49664
v_mfma_f32_16x16x32_bf16 a[196:199], a[4:7], a[32:35], a[196:199]
v_mfma_f32_16x16x32_bf16 a[200:203], a[8:11], a[32:35], a[200:203]
ds_read_b64_tr_b16 a[116:117], v14 offset:57344
ds_read_b64_tr_b16 a[118:119], v14 offset:57856
v_mfma_f32_16x16x32_bf16 a[200:203], a[24:27], a[48:51], a[200:203]
s_add_u32 s55, s93, 44032
v_mfma_f32_16x16x32_bf16 a[204:207], a[28:31], a[48:51], a[204:207]
buffer_load_dwordx4 v2, s[36:39], s55 offen offset:1024 sc1 lds
v_mfma_f32_16x16x32_bf16 a[204:207], a[12:15], a[32:35], a[204:207]
v_mfma_f32_16x16x32_bf16 a[208:211], a[12:15], a[36:39], a[208:211]
ds_read_b64_tr_b16 a[104:105], v13 offset:53248
ds_read_b64_tr_b16 a[106:107], v13 offset:53760
v_mfma_f32_16x16x32_bf16 a[208:211], a[28:31], a[52:55], a[208:211]
v_mfma_f32_16x16x32_bf16 a[212:215], a[24:27], a[52:55], a[212:215]
ds_read_b64_tr_b16 a[120:121], v13 offset:61440
ds_read_b64_tr_b16 a[122:123], v13 offset:61952
v_mfma_f32_16x16x32_bf16 a[212:215], a[8:11], a[36:39], a[212:215]
s_add_u32 s55, s93, 51200
v_mfma_f32_16x16x32_bf16 a[216:219], a[4:7], a[36:39], a[216:219]
buffer_load_dwordx4 v1, s[36:39], s55 offen offset:2048 sc1 lds
v_mfma_f32_16x16x32_bf16 a[216:219], a[20:23], a[52:55], a[216:219]
v_mfma_f32_16x16x32_bf16 a[220:223], a[16:19], a[52:55], a[220:223]
ds_read_b64_tr_b16 a[108:109], v14 offset:53248
ds_read_b64_tr_b16 a[110:111], v14 offset:53760
v_mfma_f32_16x16x32_bf16 a[220:223], a[0:3], a[36:39], a[220:223]
v_mfma_f32_16x16x32_bf16 a[224:227], a[0:3], a[40:43], a[224:227]
ds_read_b64_tr_b16 a[124:125], v14 offset:61440
ds_read_b64_tr_b16 a[126:127], v14 offset:61952
v_mfma_f32_16x16x32_bf16 a[224:227], a[16:19], a[56:59], a[224:227]
s_add_u32 s55, s93, 58368
v_mfma_f32_16x16x32_bf16 a[228:231], a[20:23], a[56:59], a[228:231]
buffer_load_dwordx4 v2, s[36:39], s55 offen offset:3072 sc1 lds
v_mfma_f32_16x16x32_bf16 a[228:231], a[4:7], a[40:43], a[228:231]
v_mfma_f32_16x16x32_bf16 a[232:235], a[8:11], a[40:43], a[232:235]
s_add_u32 s59, s72, 53248
v_mfma_f32_16x16x32_bf16 a[232:235], a[24:27], a[56:59], a[232:235]
buffer_store_dwordx4 v[60:63], v15, s[44:47], s59 offen offset:0 sc1
v_mfma_f32_16x16x32_bf16 a[236:239], a[28:31], a[56:59], a[236:239]
v_mfma_f32_16x16x32_bf16 a[236:239], a[12:15], a[40:43], a[236:239]
v_accvgpr_read_b32 v60, a172
v_accvgpr_read_b32 v61, a173
v_mfma_f32_16x16x32_bf16 a[240:243], a[12:15], a[44:47], a[240:243]
v_accvgpr_read_b32 v62, a174
v_accvgpr_read_b32 v63, a175
v_mfma_f32_16x16x32_bf16 a[240:243], a[28:31], a[60:63], a[240:243]
v_mfma_f32_16x16x32_bf16 a[244:247], a[24:27], a[60:63], a[244:247]
s_add_u32 s59, s72, 40960
v_mfma_f32_16x16x32_bf16 a[244:247], a[8:11], a[44:47], a[244:247]
buffer_store_dwordx4 v[64:67], v15, s[44:47], s59 offen offset:0 sc1
v_mfma_f32_16x16x32_bf16 a[248:251], a[4:7], a[44:47], a[248:251]
v_mfma_f32_16x16x32_bf16 a[248:251], a[20:23], a[60:63], a[248:251]
v_accvgpr_read_b32 v64, a176
v_accvgpr_read_b32 v65, a177
v_mfma_f32_16x16x32_bf16 a[252:255], a[16:19], a[60:63], a[252:255]
s_waitcnt vmcnt(21) lgkmcnt(0)
v_mfma_f32_16x16x32_bf16 a[252:255], a[0:3], a[44:47], a[252:255]
s_barrier
v_mfma_f32_16x16x32_bf16 v[140:143], a[96:99], a[32:35], v[140:143]
v_xor_b32 v3, v3, v7
v_xor_b32 v4, v4, v8
v_mfma_f32_16x16x32_bf16 v[140:143], a[112:115], a[48:51], v[140:143]
s_add_u32 m0, s57, 49152
s_add_u32 s52, s89, 917504
v_accvgpr_read_b32 v66, a178
v_mfma_f32_16x16x32_bf16 v[148:151], a[116:119], a[48:51], v[148:151]
buffer_load_dwordx4 v3, s[64:67], s52 offen offset:0  lds
v_mfma_f32_16x16x32_bf16 v[148:151], a[100:103], a[32:35], v[148:151]
v_accvgpr_read_b32 v67, a179
v_mfma_f32_16x16x32_bf16 v[136:139], a[104:107], a[32:35], v[136:139]
ds_read_b64_tr_b16 a[0:1], v9 offset:0
ds_read_b64_tr_b16 a[2:3], v9 offset:512
v_mfma_f32_16x16x32_bf16 v[136:139], a[120:123], a[48:51], v[136:139]
v_mfma_f32_16x16x32_bf16 v[144:147], a[124:127], a[48:51], v[144:147]
ds_read_b64_tr_b16 a[16:17], v9 offset:8192
ds_read_b64_tr_b16 a[18:19], v9 offset:8704
v_mfma_f32_16x16x32_bf16 v[144:147], a[108:111], a[32:35], v[144:147]
s_add_u32 m0, s58, 65536
s_add_u32 s55, s92, 6144
v_mfma_f32_16x16x32_bf16 v[128:131], a[108:111], a[36:39], v[128:131]
buffer_load_dwordx4 v1, s[36:39], s55 offen offset:0 sc1 lds
v_mfma_f32_16x16x32_bf16 v[128:131], a[124:127], a[52:55], v[128:131]
v_mfma_f32_16x16x32_bf16 v[132:135], a[120:123], a[52:55], v[132:135]
ds_read_b64_tr_b16 a[4:5], v10 offset:0
ds_read_b64_tr_b16 a[6:7], v10 offset:512
v_mfma_f32_16x16x32_bf16 v[132:135], a[104:107], a[36:39], v[132:135]
v_mfma_f32_16x16x32_bf16 v[152:155], a[100:103], a[36:39], v[152:155]
ds_read_b64_tr_b16 a[20:21], v10 offset:8192
ds_read_b64_tr_b16 a[22:23], v10 offset:8704
v_mfma_f32_16x16x32_bf16 v[152:155], a[116:119], a[52:55], v[152:155]
s_add_u32 m0, s57, 49152
s_add_u32 s52, s89, 945152
v_mfma_f32_16x16x32_bf16 v[156:159], a[112:115], a[52:55], v[156:159]
buffer_load_dwordx4 v4, s[64:67], s52 offen offset:1024  lds
v_mfma_f32_16x16x32_bf16 v[156:159], a[96:99], a[36:39], v[156:159]
v_mfma_f32_16x16x32_bf16 v[160:163], a[96:99], a[40:43], v[160:163]
ds_read_b64_tr_b16 a[8:9], v11 offset:0
ds_read_b64_tr_b16 a[10:11], v11 offset:512
v_mfma_f32_16x16x32_bf16 v[160:163], a[112:115], a[56:59], v[160:163]
v_mfma_f32_16x16x32_bf16 v[164:167], a[116:119], a[56:59], v[164:167]
ds_read_b64_tr_b16 a[24:25], v11 offset:8192
ds_read_b64_tr_b16 a[26:27], v11 offset:8704
v_mfma_f32_16x16x32_bf16 v[164:167], a[100:103], a[40:43], v[164:167]
s_add_u32 m0, s58, 65536
s_add_u32 s55, s92, 13312
v_mfma_f32_16x16x32_bf16 v[168:171], a[104:107], a[40:43], v[168:171]
buffer_load_dwordx4 v2, s[36:39], s55 offen offset:1024 sc1 lds
v_mfma_f32_16x16x32_bf16 v[168:171], a[120:123], a[56:59], v[168:171]
v_mfma_f32_16x16x32_bf16 v[172:175], a[124:127], a[56:59], v[172:175]
ds_read_b64_tr_b16 a[12:13], v12 offset:0
ds_read_b64_tr_b16 a[14:15], v12 offset:512
v_mfma_f32_16x16x32_bf16 v[172:175], a[108:111], a[40:43], v[172:175]
v_mfma_f32_16x16x32_bf16 v[176:179], a[108:111], a[44:47], v[176:179]
ds_read_b64_tr_b16 a[28:29], v12 offset:8192
ds_read_b64_tr_b16 a[30:31], v12 offset:8704
v_mfma_f32_16x16x32_bf16 v[176:179], a[124:127], a[60:63], v[176:179]
s_add_u32 m0, s57, 49152
s_add_u32 s52, s89, 972800
v_mfma_f32_16x16x32_bf16 v[180:183], a[120:123], a[60:63], v[180:183]
buffer_load_dwordx4 v3, s[64:67], s52 offen offset:2048  lds
v_mfma_f32_16x16x32_bf16 v[180:183], a[104:107], a[44:47], v[180:183]
v_xor_b32 v5, s71, v5
v_xor_b32 v6, s71, v6
v_mfma_f32_16x16x32_bf16 v[184:187], a[100:103], a[44:47], v[184:187]
v_add_u32 v5, 0xffff0000, v5
v_add_u32 v6, 0xffff0000, v6
v_mfma_f32_16x16x32_bf16 v[184:187], a[116:119], a[60:63], v[184:187]
s_add_u32 m0, s58, 65536
s_add_u32 s55, s92, 20480
v_mfma_f32_16x16x32_bf16 v[188:191], a[112:115], a[60:63], v[188:191]
buffer_load_dwordx4 v1, s[36:39], s55 offen offset:2048 sc1 lds
v_mfma_f32_16x16x32_bf16 v[188:191], a[96:99], a[44:47], v[188:191]
v_mfma_f32_16x16x32_bf16 v[192:195], a[96:99], a[64:67], v[192:195]
ds_read_b128 a[32:35], v5 offset:0
ds_read_b128 a[48:51], v6 offset:0
v_mfma_f32_16x16x32_bf16 v[192:195], a[112:115], a[80:83], v[192:195]
v_mfma_f32_16x16x32_bf16 v[196:199], a[120:123], a[80:83], v[196:199]
ds_read_b128 a[36:39], v5 offset:2048
ds_read_b128 a[52:55], v6 offset:2048
v_mfma_f32_16x16x32_bf16 v[196:199], a[104:107], a[64:67], v[196:199]
v_mfma_f32_16x16x32_bf16 v[200:203], a[104:107], a[68:71], v[200:203]
ds_read_b128 a[40:43], v5 offset:4096
ds_read_b128 a[56:59], v6 offset:4096
v_mfma_f32_16x16x32_bf16 v[200:203], a[120:123], a[84:87], v[200:203]
s_add_u32 m0, s57, 49152
s_add_u32 s52, s89, 1000448
v_mfma_f32_16x16x32_bf16 v[204:207], a[112:115], a[84:87], v[204:207]
buffer_load_dwordx4 v4, s[64:67], s52 offen offset:3072  lds
v_mfma_f32_16x16x32_bf16 v[204:207], a[96:99], a[68:71], v[204:207]
v_mfma_f32_16x16x32_bf16 v[208:211], a[96:99], a[72:75], v[208:211]
ds_read_b128 a[44:47], v5 offset:6144
ds_read_b128 a[60:63], v6 offset:6144
v_mfma_f32_16x16x32_bf16 v[208:211], a[112:115], a[88:91], v[208:211]
v_mfma_f32_16x16x32_bf16 v[212:215], a[120:123], a[88:91], v[212:215]
v_mfma_f32_16x16x32_bf16 v[212:215], a[104:107], a[72:75], v[212:215]
s_add_u32 m0, s58, 65536
s_add_u32 s55, s92, 27648
v_mfma_f32_16x16x32_bf16 v[216:219], a[104:107], a[76:79], v[216:219]
buffer_load_dwordx4 v2, s[36:39], s55 offen offset:3072 sc1 lds
v_mfma_f32_16x16x32_bf16 v[216:219], a[120:123], a[92:95], v[216:219]
v_mfma_f32_16x16x32_bf16 v[220:223], a[112:115], a[92:95], v[220:223]
s_bitcmp1_b32 s2, 0
v_mfma_f32_16x16x32_bf16 v[220:223], a[96:99], a[76:79], v[220:223]
s_cbranch_scc1 L_short23
v_mfma_f32_16x16x32_bf16 v[224:227], a[100:103], a[76:79], v[224:227]
v_mfma_f32_16x16x32_bf16 v[224:227], a[116:119], a[92:95], v[224:227]
v_mfma_f32_16x16x32_bf16 v[228:231], a[124:127], a[92:95], v[228:231]
v_mfma_f32_16x16x32_bf16 v[228:231], a[108:111], a[76:79], v[228:231]
v_mfma_f32_16x16x32_bf16 v[232:235], a[108:111], a[72:75], v[232:235]
v_mfma_f32_16x16x32_bf16 v[232:235], a[124:127], a[88:91], v[232:235]
v_mfma_f32_16x16x32_bf16 v[236:239], a[116:119], a[88:91], v[236:239]
v_mfma_f32_16x16x32_bf16 v[236:239], a[100:103], a[72:75], v[236:239]
v_mfma_f32_16x16x32_bf16 v[240:243], a[100:103], a[68:71], v[240:243]
v_mfma_f32_16x16x32_bf16 v[240:243], a[116:119], a[84:87], v[240:243]
v_mfma_f32_16x16x32_bf16 v[244:247], a[124:127], a[84:87], v[244:247]
v_mfma_f32_16x16x32_bf16 v[244:247], a[108:111], a[68:71], v[244:247]
v_mfma_f32_16x16x32_bf16 v[248:251], a[108:111], a[64:67], v[248:251]
v_mfma_f32_16x16x32_bf16 v[248:251], a[124:127], a[80:83], v[248:251]
v_mfma_f32_16x16x32_bf16 v[252:255], a[116:119], a[80:83], v[252:255]
v_mfma_f32_16x16x32_bf16 v[252:255], a[100:103], a[64:67], v[252:255]
L_short23:
s_waitcnt vmcnt(20) lgkmcnt(0)
s_barrier
v_mfma_f32_16x16x32_bf16 v[16:19], a[0:3], a[32:35], v[16:19]
v_xor_b32 v3, v3, v7
v_xor_b32 v4, v4, v8
v_mfma_f32_16x16x32_bf16 v[16:19], a[16:19], a[48:51], v[16:19]
v_xor_b32 v5, s71, v5
v_xor_b32 v6, s71, v6
v_mfma_f32_16x16x32_bf16 v[20:23], a[20:23], a[48:51], v[20:23]
ds_read_b128 a[64:67], v5 offset:0
ds_read_b128 a[80:83], v6 offset:0
v_mfma_f32_16x16x32_bf16 v[20:23], a[4:7], a[32:35], v[20:23]
v_mfma_f32_16x16x32_bf16 v[24:27], a[8:11], a[32:35], v[24:27]
ds_read_b128 a[68:71], v5 offset:2048
v_mfma_f32_16x16x32_bf16 v[24:27], a[24:27], a[48:51], v[24:27]
s_add_u32 m0, s57, 0
s_add_u32 s52, s84, 3145728
v_mfma_f32_16x16x32_bf16 v[28:31], a[28:31], a[48:51], v[28:31]
buffer_load_dwordx4 v3, s[40:43], s52 offen offset:0  lds
v_mfma_f32_16x16x32_bf16 v[28:31], a[12:15], a[32:35], v[28:31]
v_mfma_f32_16x16x32_bf16 v[32:35], a[12:15], a[36:39], v[32:35]
ds_read_b128 a[84:87], v6 offset:2048
v_mfma_f32_16x16x32_bf16 v[32:35], a[28:31], a[52:55], v[32:35]
v_mfma_f32_16x16x32_bf16 v[36:39], a[24:27], a[52:55], v[36:39]
ds_read_b128 a[72:75], v5 offset:4096
v_mfma_f32_16x16x32_bf16 v[36:39], a[8:11], a[36:39], v[36:39]
s_add_u32 s52, s84, 3210240
v_mfma_f32_16x16x32_bf16 v[40:43], a[4:7], a[36:39], v[40:43]
buffer_load_dwordx4 v4, s[40:43], s52 offen offset:1024  lds
v_mfma_f32_16x16x32_bf16 v[40:43], a[20:23], a[52:55], v[40:43]
v_mfma_f32_16x16x32_bf16 v[44:47], a[16:19], a[52:55], v[44:47]
ds_read_b128 a[88:91], v6 offset:4096
v_mfma_f32_16x16x32_bf16 v[44:47], a[0:3], a[36:39], v[44:47]
v_mfma_f32_16x16x32_bf16 v[48:51], a[0:3], a[40:43], v[48:51]
ds_read_b128 a[76:79], v5 offset:6144
v_mfma_f32_16x16x32_bf16 v[48:51], a[16:19], a[56:59], v[48:51]
s_add_u32 s52, s84, 3274752
v_mfma_f32_16x16x32_bf16 v[52:55], a[20:23], a[56:59], v[52:55]
buffer_load_dwordx4 v3, s[40:43], s52 offen offset:2048  lds
v_mfma_f32_16x16x32_bf16 v[52:55], a[4:7], a[40:43], v[52:55]
v_mfma_f32_16x16x32_bf16 v[56:59], a[8:11], a[40:43], v[56:59]
ds_read_b128 a[92:95], v6 offset:6144
v_mfma_f32_16x16x32_bf16 v[56:59], a[24:27], a[56:59], v[56:59]
v_mfma_f32_16x16x32_bf16 v[60:63], a[28:31], a[56:59], v[60:63]
v_mfma_f32_16x16x32_bf16 v[60:63], a[12:15], a[40:43], v[60:63]
s_add_u32 s52, s84, 3339264
v_mfma_f32_16x16x32_bf16 v[64:67], a[12:15], a[44:47], v[64:67]
buffer_load_dwordx4 v4, s[40:43], s52 offen offset:3072  lds
v_mfma_f32_16x16x32_bf16 v[64:67], a[28:31], a[60:63], v[64:67]
v_mfma_f32_16x16x32_bf16 a[180:183], a[24:27], a[60:63], a[180:183]
s_add_u32 s59, s72, 57344
v_mfma_f32_16x16x32_bf16 a[180:183], a[8:11], a[44:47], a[180:183]
buffer_store_dwordx4 v[68:71], v15, s[44:47], s59 offen offset:0 sc1
v_mfma_f32_16x16x32_bf16 a[184:187], a[4:7], a[44:47], a[184:187]
ds_read_b64_tr_b16 a[96:97], v13 offset:16384
ds_read_b64_tr_b16 a[98:99], v13 offset:16896
v_mfma_f32_16x16x32_bf16 a[184:187], a[20:23], a[60:63], a[184:187]
v_mfma_f32_16x16x32_bf16 a[188:191], a[16:19], a[60:63], a[188:191]
s_waitcnt lgkmcnt(2)
ds_read_b64_tr_b16 a[112:113], v13 offset:24576
ds_read_b64_tr_b16 a[114:115], v13 offset:25088
v_mfma_f32_16x16x32_bf16 a[188:191], a[0:3], a[44:47], a[188:191]
s_add_u32 m0, s58, 69632
s_add_u32 s55, s92, 38912
v_mfma_f32_16x16x32_bf16 a[192:195], a[0:3], a[64:67], a[192:195]
buffer_load_dwordx4 v1, s[36:39], s55 offen offset:0 sc1 lds
v_mfma_f32_16x16x32_bf16 a[192:195], a[16:19], a[80:83], a[192:195]
v_mfma_f32_16x16x32_bf16 a[196:199], a[20:23], a[80:83], a[196:199]
ds_read_b64_tr_b16 a[100:101], v14 offset:16384
ds_read_b64_tr_b16 a[102:103], v14 offset:16896
v_mfma_f32_16x16x32_bf16 a[196:199], a[4:7], a[64:67], a[196:199]
v_accvgpr_read_b32 v68, a180
v_accvgpr_read_b32 v69, a181
v_mfma_f32_16x16x32_bf16 a[200:203], a[8:11], a[64:67], a[200:203]
ds_read_b64_tr_b16 a[116:117], v14 offset:24576
ds_read_b64_tr_b16 a[118:119], v14 offset:25088
v_mfma_f32_16x16x32_bf16 a[200:203], a[24:27], a[80:83], a[200:203]
s_add_u32 s55, s92, 46080
v_accvgpr_read_b32 v70, a182
v_accvgpr_read_b32 v71, a183
v_mfma_f32_16x16x32_bf16 a[204:207], a[28:31], a[80:83], a[204:207]
buffer_load_dwordx4 v2, s[36:39], s55 offen offset:1024 sc1 lds
v_mfma_f32_16x16x32_bf16 a[204:207], a[12:15], a[64:67], a[204:207]
v_mfma_f32_16x16x32_bf16 a[208:211], a[12:15], a[68:71], a[208:211]
ds_read_b64_tr_b16 a[104:105], v13 offset:20480
ds_read_b64_tr_b16 a[106:107], v13 offset:20992
v_mfma_f32_16x16x32_bf16 a[208:211], a[28:31], a[84:87], a[208:211]
v_mfma_f32_16x16x32_bf16 a[212:215], a[24:27], a[84:87], a[212:215]
ds_read_b64_tr_b16 a[120:121], v13 offset:28672
ds_read_b64_tr_b16 a[122:123], v13 offset:29184
v_mfma_f32_16x16x32_bf16 a[212:215], a[8:11], a[68:71], a[212:215]
s_add_u32 s55, s92, 53248
v_mfma_f32_16x16x32_bf16 a[216:219], a[4:7], a[68:71], a[216:219]
buffer_load_dwordx4 v1, s[36:39], s55 offen offset:2048 sc1 lds
v_mfma_f32_16x16x32_bf16 a[216:219], a[20:23], a[84:87], a[216:219]
v_mfma_f32_16x16x32_bf16 a[220:223], a[16:19], a[84:87], a[220:223]
ds_read_b64_tr_b16 a[108:109], v14 offset:20480
ds_read_b64_tr_b16 a[110:111], v14 offset:20992
v_mfma_f32_16x16x32_bf16 a[220:223], a[0:3], a[68:71], a[220:223]
v_mfma_f32_16x16x32_bf16 a[224:227], a[0:3], a[72:75], a[224:227]
ds_read_b64_tr_b16 a[124:125], v14 offset:28672
ds_read_b64_tr_b16 a[126:127], v14 offset:29184
v_mfma_f32_16x16x32_bf16 a[224:227], a[16:19], a[88:91], a[224:227]
s_add_u32 s55, s92, 60416
v_mfma_f32_16x16x32_bf16 a[228:231], a[20:23], a[88:91], a[228:231]
buffer_load_dwordx4 v2, s[36:39], s55 offen offset:3072 sc1 lds
v_mfma_f32_16x16x32_bf16 a[228:231], a[4:7], a[72:75], a[228:231]
v_mfma_f32_16x16x32_bf16 a[232:235], a[8:11], a[72:75], a[232:235]
s_add_u32 s59, s72, 57344
v_mfma_f32_16x16x32_bf16 a[232:235], a[24:27], a[88:91], a[232:235]
buffer_store_dwordx4 v[72:75], v15, s[44:47], s59 offen offset:1024 sc1
v_mfma_f32_16x16x32_bf16 a[236:239], a[28:31], a[88:91], a[236:239]
v_mfma_f32_16x16x32_bf16 a[236:239], a[12:15], a[72:75], a[236:239]
v_accvgpr_read_b32 v72, a184
v_accvgpr_read_b32 v73, a185
v_mfma_f32_16x16x32_bf16 a[240:243], a[12:15], a[76:79], a[240:243]
v_accvgpr_read_b32 v74, a186
v_accvgpr_read_b32 v75, a187
v_mfma_f32_16x16x32_bf16 a[240:243], a[28:31], a[92:95], a[240:243]
v_mfma_f32_16x16x32_bf16 a[244:247], a[24:27], a[92:95], a[244:247]
s_add_u32 s59, s72, 40960
v_mfma_f32_16x16x32_bf16 a[244:247], a[8:11], a[76:79], a[244:247]
buffer_store_dwordx4 v[76:79], v15, s[44:47], s59 offen offset:1024 sc1
v_mfma_f32_16x16x32_bf16 a[248:251], a[4:7], a[76:79], a[248:251]
v_mfma_f32_16x16x32_bf16 a[248:251], a[20:23], a[92:95], a[248:251]
v_accvgpr_read_b32 v76, a188
v_accvgpr_read_b32 v77, a189
v_mfma_f32_16x16x32_bf16 a[252:255], a[16:19], a[92:95], a[252:255]
s_waitcnt vmcnt(21) lgkmcnt(0)
v_mfma_f32_16x16x32_bf16 a[252:255], a[0:3], a[76:79], a[252:255]
s_barrier
v_mfma_f32_16x16x32_bf16 v[140:143], a[96:99], a[64:67], v[140:143]
v_xor_b32 v3, v3, v7
v_xor_b32 v4, v4, v8
v_mfma_f32_16x16x32_bf16 v[140:143], a[112:115], a[80:83], v[140:143]
s_add_u32 m0, s57, 16384
s_add_u32 s52, s88, 1376256
v_accvgpr_read_b32 v78, a190
v_mfma_f32_16x16x32_bf16 v[148:151], a[116:119], a[80:83], v[148:151]
buffer_load_dwordx4 v3, s[64:67], s52 offen offset:0  lds
v_mfma_f32_16x16x32_bf16 v[148:151], a[100:103], a[64:67], v[148:151]
v_accvgpr_read_b32 v79, a191
v_mfma_f32_16x16x32_bf16 v[136:139], a[104:107], a[64:67], v[136:139]
ds_read_b64_tr_b16 a[0:1], v9 offset:32768
ds_read_b64_tr_b16 a[2:3], v9 offset:33280
v_mfma_f32_16x16x32_bf16 v[136:139], a[120:123], a[80:83], v[136:139]
v_mfma_f32_16x16x32_bf16 v[144:147], a[124:127], a[80:83], v[144:147]
ds_read_b64_tr_b16 a[16:17], v9 offset:40960
ds_read_b64_tr_b16 a[18:19], v9 offset:41472
v_mfma_f32_16x16x32_bf16 v[144:147], a[108:111], a[64:67], v[144:147]
s_add_u32 m0, s58, 0
s_add_u32 s55, s93, 6144
v_mfma_f32_16x16x32_bf16 v[128:131], a[108:111], a[68:71], v[128:131]
buffer_load_dwordx4 v1, s[36:39], s55 offen offset:0 sc1 lds
v_mfma_f32_16x16x32_bf16 v[128:131], a[124:127], a[84:87], v[128:131]
v_mfma_f32_16x16x32_bf16 v[132:135], a[120:123], a[84:87], v[132:135]
ds_read_b64_tr_b16 a[4:5], v10 offset:32768
ds_read_b64_tr_b16 a[6:7], v10 offset:33280
v_mfma_f32_16x16x32_bf16 v[132:135], a[104:107], a[68:71], v[132:135]
v_mfma_f32_16x16x32_bf16 v[152:155], a[100:103], a[68:71], v[152:155]
ds_read_b64_tr_b16 a[20:21], v10 offset:40960
ds_read_b64_tr_b16 a[22:23], v10 offset:41472
v_mfma_f32_16x16x32_bf16 v[152:155], a[116:119], a[84:87], v[152:155]
s_add_u32 m0, s57, 16384
s_add_u32 s52, s88, 1403904
v_mfma_f32_16x16x32_bf16 v[156:159], a[112:115], a[84:87], v[156:159]
buffer_load_dwordx4 v4, s[64:67], s52 offen offset:1024  lds
v_mfma_f32_16x16x32_bf16 v[156:159], a[96:99], a[68:71], v[156:159]
v_mfma_f32_16x16x32_bf16 v[160:163], a[96:99], a[72:75], v[160:163]
ds_read_b64_tr_b16 a[8:9], v11 offset:32768
ds_read_b64_tr_b16 a[10:11], v11 offset:33280
v_mfma_f32_16x16x32_bf16 v[160:163], a[112:115], a[88:91], v[160:163]
v_mfma_f32_16x16x32_bf16 v[164:167], a[116:119], a[88:91], v[164:167]
ds_read_b64_tr_b16 a[24:25], v11 offset:40960
ds_read_b64_tr_b16 a[26:27], v11 offset:41472
v_mfma_f32_16x16x32_bf16 v[164:167], a[100:103], a[72:75], v[164:167]
s_add_u32 m0, s58, 0
s_add_u32 s55, s93, 13312
v_mfma_f32_16x16x32_bf16 v[168:171], a[104:107], a[72:75], v[168:171]
buffer_load_dwordx4 v2, s[36:39], s55 offen offset:1024 sc1 lds
v_mfma_f32_16x16x32_bf16 v[168:171], a[120:123], a[88:91], v[168:171]
v_mfma_f32_16x16x32_bf16 v[172:175], a[124:127], a[88:91], v[172:175]
ds_read_b64_tr_b16 a[12:13], v12 offset:32768
ds_read_b64_tr_b16 a[14:15], v12 offset:33280
v_mfma_f32_16x16x32_bf16 v[172:175], a[108:111], a[72:75], v[172:175]
v_mfma_f32_16x16x32_bf16 v[176:179], a[108:111], a[76:79], v[176:179]
ds_read_b64_tr_b16 a[28:29], v12 offset:40960
ds_read_b64_tr_b16 a[30:31], v12 offset:41472
v_mfma_f32_16x16x32_bf16 v[176:179], a[124:127], a[92:95], v[176:179]
s_add_u32 m0, s57, 16384
s_add_u32 s52, s88, 1431552
v_mfma_f32_16x16x32_bf16 v[180:183], a[120:123], a[92:95], v[180:183]
buffer_load_dwordx4 v3, s[64:67], s52 offen offset:2048  lds
v_mfma_f32_16x16x32_bf16 v[180:183], a[104:107], a[76:79], v[180:183]
v_xor_b32 v5, s71, v5
v_xor_b32 v6, s71, v6
v_mfma_f32_16x16x32_bf16 v[184:187], a[100:103], a[76:79], v[184:187]
L_t6:
s_cbranch_execz L_r1
v_mfma_f32_16x16x32_bf16 v[184:187], a[116:119], a[92:95], v[184:187]
s_add_u32 m0, s58, 0
s_add_u32 s55, s93, 20480
v_mfma_f32_16x16x32_bf16 v[188:191], a[112:115], a[92:95], v[188:191]
buffer_load_dwordx4 v1, s[36:39], s55 offen offset:2048 sc1 lds
v_mfma_f32_16x16x32_bf16 v[188:191], a[96:99], a[76:79], v[188:191]
v_mfma_f32_16x16x32_bf16 v[192:195], a[96:99], a[32:35], v[192:195]
ds_read_b128 a[64:67], v5 offset:32768
ds_read_b128 a[80:83], v6 offset:32768
v_mfma_f32_16x16x32_bf16 v[192:195], a[112:115], a[48:51], v[192:195]
v_mfma_f32_16x16x32_bf16 v[196:199], a[120:123], a[48:51], v[196:199]
ds_read_b128 a[68:71], v5 offset:34816
ds_read_b128 a[84:87], v6 offset:34816
v_mfma_f32_16x16x32_bf16 v[196:199], a[104:107], a[32:35], v[196:199]
v_mfma_f32_16x16x32_bf16 v[200:203], a[104:107], a[36:39], v[200:203]
ds_read_b128 a[72:75], v5 offset:36864
ds_read_b128 a[88:91], v6 offset:36864
v_mfma_f32_16x16x32_bf16 v[200:203], a[120:123], a[52:55], v[200:203]
s_add_u32 m0, s57, 16384
s_add_u32 s52, s88, 1459200
v_mfma_f32_16x16x32_bf16 v[204:207], a[112:115], a[52:55], v[204:207]
buffer_load_dwordx4 v4, s[64:67], s52 offen offset:3072  lds
v_mfma_f32_16x16x32_bf16 v[204:207], a[96:99], a[36:39], v[204:207]
v_mfma_f32_16x16x32_bf16 v[208:211], a[96:99], a[40:43], v[208:211]
s_add_u32 s59, s72, 45056
ds_read_b128 a[76:79], v5 offset:38912
ds_read_b128 a[92:95], v6 offset:38912
v_mfma_f32_16x16x32_bf16 v[208:211], a[112:115], a[56:59], v[208:211]
buffer_store_dwordx4 v[80:83], v15, s[44:47], s59 offen offset:0 sc1
v_mfma_f32_16x16x32_bf16 v[212:215], a[120:123], a[56:59], v[212:215]
v_mfma_f32_16x16x32_bf16 v[212:215], a[104:107], a[40:43], v[212:215]
s_add_u32 m0, s58, 0
s_add_u32 s55, s93, 27648
v_accvgpr_read_b32 v80, a192
v_mfma_f32_16x16x32_bf16 v[216:219], a[104:107], a[44:47], v[216:219]
buffer_load_dwordx4 v2, s[36:39], s55 offen offset:3072 sc1 lds
v_mfma_f32_16x16x32_bf16 v[216:219], a[120:123], a[60:63], v[216:219]
v_accvgpr_read_b32 v81, a193
v_accvgpr_read_b32 v82, a194
v_mfma_f32_16x16x32_bf16 v[220:223], a[112:115], a[60:63], v[220:223]
s_bitcmp1_b32 s2, 0
v_accvgpr_read_b32 v83, a195
v_mfma_f32_16x16x32_bf16 v[220:223], a[96:99], a[44:47], v[220:223]
s_cbranch_scc1 L_short25
v_mfma_f32_16x16x32_bf16 v[224:227], a[100:103], a[44:47], v[224:227]
v_mfma_f32_16x16x32_bf16 v[224:227], a[116:119], a[60:63], v[224:227]
v_mfma_f32_16x16x32_bf16 v[228:231], a[124:127], a[60:63], v[228:231]
v_mfma_f32_16x16x32_bf16 v[228:231], a[108:111], a[44:47], v[228:231]
v_mfma_f32_16x16x32_bf16 v[232:235], a[108:111], a[40:43], v[232:235]
v_mfma_f32_16x16x32_bf16 v[232:235], a[124:127], a[56:59], v[232:235]
v_mfma_f32_16x16x32_bf16 v[236:239], a[116:119], a[56:59], v[236:239]
v_mfma_f32_16x16x32_bf16 v[236:239], a[100:103], a[40:43], v[236:239]
v_mfma_f32_16x16x32_bf16 v[240:243], a[100:103], a[36:39], v[240:243]
v_mfma_f32_16x16x32_bf16 v[240:243], a[116:119], a[52:55], v[240:243]
v_mfma_f32_16x16x32_bf16 v[244:247], a[124:127], a[52:55], v[244:247]
v_mfma_f32_16x16x32_bf16 v[244:247], a[108:111], a[36:39], v[244:247]
v_mfma_f32_16x16x32_bf16 v[248:251], a[108:111], a[32:35], v[248:251]
v_mfma_f32_16x16x32_bf16 v[248:251], a[124:127], a[48:51], v[248:251]
v_mfma_f32_16x16x32_bf16 v[252:255], a[116:119], a[48:51], v[252:255]
v_mfma_f32_16x16x32_bf16 v[252:255], a[100:103], a[32:35], v[252:255]
L_short25:
s_waitcnt vmcnt(21) lgkmcnt(0)
s_barrier
v_mfma_f32_16x16x32_bf16 v[16:19], a[0:3], a[64:67], v[16:19]
v_xor_b32 v3, v3, v7
v_xor_b32 v4, v4, v8
v_mfma_f32_16x16x32_bf16 v[16:19], a[16:19], a[80:83], v[16:19]
v_xor_b32 v5, s71, v5
v_xor_b32 v6, s71, v6
v_mfma_f32_16x16x32_bf16 v[20:23], a[20:23], a[80:83], v[20:23]
ds_read_b128 a[32:35], v5 offset:32768
ds_read_b128 a[48:51], v6 offset:32768
v_mfma_f32_16x16x32_bf16 v[20:23], a[4:7], a[64:67], v[20:23]
v_mfma_f32_16x16x32_bf16 v[24:27], a[8:11], a[64:67], v[24:27]
ds_read_b128 a[36:39], v5 offset:34816
v_mfma_f32_16x16x32_bf16 v[24:27], a[24:27], a[80:83], v[24:27]
s_add_u32 m0, s57, 32768
s_add_u32 s52, s85, 3145728
v_mfma_f32_16x16x32_bf16 v[28:31], a[28:31], a[80:83], v[28:31]
buffer_load_dwordx4 v3, s[40:43], s52 offen offset:0  lds
v_mfma_f32_16x16x32_bf16 v[28:31], a[12:15], a[64:67], v[28:31]
v_mfma_f32_16x16x32_bf16 v[32:35], a[12:15], a[68:71], v[32:35]
ds_read_b128 a[52:55], v6 offset:34816
v_mfma_f32_16x16x32_bf16 v[32:35], a[28:31], a[84:87], v[32:35]
v_mfma_f32_16x16x32_bf16 v[36:39], a[24:27], a[84:87], v[36:39]
ds_read_b128 a[40:43], v5 offset:36864
v_mfma_f32_16x16x32_bf16 v[36:39], a[8:11], a[68:71], v[36:39]
s_add_u32 s52, s85, 3210240
v_mfma_f32_16x16x32_bf16 v[40:43], a[4:7], a[68:71], v[40:43]
buffer_load_dwordx4 v4, s[40:43], s52 offen offset:1024  lds
v_mfma_f32_16x16x32_bf16 v[40:43], a[20:23], a[84:87], v[40:43]
v_mfma_f32_16x16x32_bf16 v[44:47], a[16:19], a[84:87], v[44:47]
ds_read_b128 a[56:59], v6 offset:36864
v_mfma_f32_16x16x32_bf16 v[44:47], a[0:3], a[68:71], v[44:47]
v_mfma_f32_16x16x32_bf16 v[48:51], a[0:3], a[72:75], v[48:51]
ds_read_b128 a[44:47], v5 offset:38912
v_mfma_f32_16x16x32_bf16 v[48:51], a[16:19], a[88:91], v[48:51]
s_add_u32 s52, s85, 3274752
v_mfma_f32_16x16x32_bf16 v[52:55], a[20:23], a[88:91], v[52:55]
buffer_load_dwordx4 v3, s[40:43], s52 offen offset:2048  lds
v_mfma_f32_16x16x32_bf16 v[52:55], a[4:7], a[72:75], v[52:55]
v_mfma_f32_16x16x32_bf16 v[56:59], a[8:11], a[72:75], v[56:59]
ds_read_b128 a[60:63], v6 offset:38912
v_mfma_f32_16x16x32_bf16 v[56:59], a[24:27], a[88:91], v[56:59]
v_mfma_f32_16x16x32_bf16 v[60:63], a[28:31], a[88:91], v[60:63]
v_mfma_f32_16x16x32_bf16 v[60:63], a[12:15], a[72:75], v[60:63]
s_add_u32 s52, s85, 3339264
v_mfma_f32_16x16x32_bf16 v[64:67], a[12:15], a[76:79], v[64:67]
buffer_load_dwordx4 v4, s[40:43], s52 offen offset:3072  lds
v_mfma_f32_16x16x32_bf16 v[64:67], a[28:31], a[92:95], v[64:67]
v_mfma_f32_16x16x32_bf16 v[68:71], a[24:27], a[92:95], v[68:71]
s_add_u32 s59, s72, 61440
v_mfma_f32_16x16x32_bf16 v[68:71], a[8:11], a[76:79], v[68:71]
buffer_store_dwordx4 v[84:87], v15, s[44:47], s59 offen offset:0 sc1
v_mfma_f32_16x16x32_bf16 v[72:75], a[4:7], a[76:79], v[72:75]
ds_read_b64_tr_b16 a[96:97], v13 offset:49152
ds_read_b64_tr_b16 a[98:99], v13 offset:49664
v_mfma_f32_16x16x32_bf16 v[72:75], a[20:23], a[92:95], v[72:75]
v_mfma_f32_16x16x32_bf16 v[76:79], a[16:19], a[92:95], v[76:79]
s_waitcnt lgkmcnt(2)
ds_read_b64_tr_b16 a[112:113], v13 offset:57344
ds_read_b64_tr_b16 a[114:115], v13 offset:57856
v_mfma_f32_16x16x32_bf16 v[76:79], a[0:3], a[76:79], v[76:79]
s_add_u32 m0, s58, 4096
s_add_u32 s55, s93, 38912
v_mfma_f32_16x16x32_bf16 v[80:83], a[0:3], a[32:35], v[80:83]
buffer_load_dwordx4 v1, s[36:39], s55 offen offset:0 sc1 lds
v_mfma_f32_16x16x32_bf16 v[80:83], a[16:19], a[48:51], v[80:83]
v_mfma_f32_16x16x32_bf16 a[196:199], a[20:23], a[48:51], a[196:199]
ds_read_b64_tr_b16 a[100:101], v14 offset:49152
ds_read_b64_tr_b16 a[102:103], v14 offset:49664
v_mfma_f32_16x16x32_bf16 a[196:199], a[4:7], a[32:35], a[196:199]
v_mfma_f32_16x16x32_bf16 a[200:203], a[8:11], a[32:35], a[200:203]
ds_read_b64_tr_b16 a[116:117], v14 offset:57344
ds_read_b64_tr_b16 a[118:119], v14 offset:57856
v_mfma_f32_16x16x32_bf16 a[200:203], a[24:27], a[48:51], a[200:203]
s_add_u32 s55, s93, 46080
v_mfma_f32_16x16x32_bf16 a[204:207], a[28:31], a[48:51], a[204:207]
buffer_load_dwordx4 v2, s[36:39], s55 offen offset:1024 sc1 lds
v_mfma_f32_16x16x32_bf16 a[204:207], a[12:15], a[32:35], a[204:207]
v_mfma_f32_16x16x32_bf16 a[208:211], a[12:15], a[36:39], a[208:211]
ds_read_b64_tr_b16 a[104:105], v13 offset:53248
ds_read_b64_tr_b16 a[106:107], v13 offset:53760
v_mfma_f32_16x16x32_bf16 a[208:211], a[28:31], a[52:55], a[208:211]
v_mfma_f32_16x16x32_bf16 a[212:215], a[24:27], a[52:55], a[212:215]
ds_read_b64_tr_b16 a[120:121], v13 offset:61440
ds_read_b64_tr_b16 a[122:123], v13 offset:61952
v_mfma_f32_16x16x32_bf16 a[212:215], a[8:11], a[36:39], a[212:215]
s_add_u32 s55, s93, 53248
v_accvgpr_read_b32 v84, a196
v_accvgpr_read_b32 v85, a197
v_mfma_f32_16x16x32_bf16 a[216:219], a[4:7], a[36:39], a[216:219]
buffer_load_dwordx4 v1, s[36:39], s55 offen offset:2048 sc1 lds
v_mfma_f32_16x16x32_bf16 a[216:219], a[20:23], a[52:55], a[216:219]
v_accvgpr_read_b32 v86, a198
v_accvgpr_read_b32 v87, a199
v_mfma_f32_16x16x32_bf16 a[220:223], a[16:19], a[52:55], a[220:223]
ds_read_b64_tr_b16 a[108:109], v14 offset:53248
ds_read_b64_tr_b16 a[110:111], v14 offset:53760
v_mfma_f32_16x16x32_bf16 a[220:223], a[0:3], a[36:39], a[220:223]
v_mfma_f32_16x16x32_bf16 a[224:227], a[0:3], a[40:43], a[224:227]
ds_read_b64_tr_b16 a[124:125], v14 offset:61440
ds_read_b64_tr_b16 a[126:127], v14 offset:61952
v_mfma_f32_16x16x32_bf16 a[224:227], a[16:19], a[56:59], a[224:227]
s_add_u32 s55, s93, 60416
v_mfma_f32_16x16x32_bf16 a[228:231], a[20:23], a[56:59], a[228:231]
buffer_load_dwordx4 v2, s[36:39], s55 offen offset:3072 sc1 lds
v_mfma_f32_16x16x32_bf16 a[228:231], a[4:7], a[40:43], a[228:231]
v_mfma_f32_16x16x32_bf16 a[232:235], a[8:11], a[40:43], a[232:235]
s_add_u32 s59, s72, 61440
v_mfma_f32_16x16x32_bf16 a[232:235], a[24:27], a[56:59], a[232:235]
buffer_store_dwordx4 v[88:91], v15, s[44:47], s59 offen offset:1024 sc1
v_mfma_f32_16x16x32_bf16 a[236:239], a[28:31], a[56:59], a[236:239]
v_mfma_f32_16x16x32_bf16 a[236:239], a[12:15], a[40:43], a[236:239]
v_accvgpr_read_b32 v88, a200
v_accvgpr_read_b32 v89, a201
v_mfma_f32_16x16x32_bf16 a[240:243], a[12:15], a[44:47], a[240:243]
v_accvgpr_read_b32 v90, a202
v_accvgpr_read_b32 v91, a203
v_mfma_f32_16x16x32_bf16 a[240:243], a[28:31], a[60:63], a[240:243]
v_mfma_f32_16x16x32_bf16 a[244:247], a[24:27], a[60:63], a[244:247]
s_add_u32 s59, s72, 45056
v_mfma_f32_16x16x32_bf16 a[244:247], a[8:11], a[44:47], a[244:247]
buffer_store_dwordx4 v[92:95], v15, s[44:47], s59 offen offset:1024 sc1
v_mfma_f32_16x16x32_bf16 a[248:251], a[4:7], a[44:47], a[248:251]
v_mfma_f32_16x16x32_bf16 a[248:251], a[20:23], a[60:63], a[248:251]
v_accvgpr_read_b32 v92, a204
v_accvgpr_read_b32 v93, a205
v_mfma_f32_16x16x32_bf16 a[252:255], a[16:19], a[60:63], a[252:255]
s_waitcnt vmcnt(22) lgkmcnt(0)
v_mfma_f32_16x16x32_bf16 a[252:255], a[0:3], a[44:47], a[252:255]
s_barrier
v_mfma_f32_16x16x32_bf16 v[140:143], a[96:99], a[32:35], v[140:143]
v_xor_b32 v3, v3, v7
v_xor_b32 v4, v4, v8
v_mfma_f32_16x16x32_bf16 v[140:143], a[112:115], a[48:51], v[140:143]
s_add_u32 m0, s57, 49152
s_add_u32 s52, s89, 1376256
v_accvgpr_read_b32 v94, a206
v_mfma_f32_16x16x32_bf16 v[148:151], a[116:119], a[48:51], v[148:151]
buffer_load_dwordx4 v3, s[64:67], s52 offen offset:0  lds
v_mfma_f32_16x16x32_bf16 v[148:151], a[100:103], a[32:35], v[148:151]
s_lshl_b32 s35, s31, 5
s_add_u32 s35, s35, s32
v_accvgpr_read_b32 v95, a207
v_mfma_f32_16x16x32_bf16 v[136:139], a[104:107], a[32:35], v[136:139]
s_lshl_b32 s35, s35, 2
ds_read_b64_tr_b16 a[0:1], v9 offset:0
ds_read_b64_tr_b16 a[2:3], v9 offset:512
v_mfma_f32_16x16x32_bf16 v[136:139], a[120:123], a[48:51], v[136:139]
s_add_u32 s35, s35, 20480
v_mov_b32 v7, s3
v_mov_b32 v8, s35
v_mfma_f32_16x16x32_bf16 v[144:147], a[124:127], a[48:51], v[144:147]
s_lshl_b32 s35, s31, 7
ds_read_b64_tr_b16 a[16:17], v9 offset:8192
ds_read_b64_tr_b16 a[18:19], v9 offset:8704
v_mfma_f32_16x16x32_bf16 v[144:147], a[108:111], a[32:35], v[144:147]
s_add_u32 s52, s89, 1403904
s_add_u32 s35, s35, 20480
v_mfma_f32_16x16x32_bf16 v[128:131], a[108:111], a[36:39], v[128:131]
buffer_load_dwordx4 v4, s[64:67], s52 offen offset:1024  lds
v_mfma_f32_16x16x32_bf16 v[128:131], a[124:127], a[52:55], v[128:131]
v_mfma_f32_16x16x32_bf16 v[132:135], a[120:123], a[52:55], v[132:135]
s_add_u32 s59, s72, 12288
ds_read_b64_tr_b16 a[4:5], v10 offset:0
ds_read_b64_tr_b16 a[6:7], v10 offset:512
v_mfma_f32_16x16x32_bf16 v[132:135], a[104:107], a[36:39], v[132:135]
buffer_store_dwordx4 v[96:99], v15, s[44:47], s59 offen offset:1024 sc1
v_mfma_f32_16x16x32_bf16 v[152:155], a[100:103], a[36:39], v[152:155]
ds_read_b64_tr_b16 a[20:21], v10 offset:8192
ds_read_b64_tr_b16 a[22:23], v10 offset:8704
v_mfma_f32_16x16x32_bf16 v[152:155], a[116:119], a[52:55], v[152:155]
s_add_u32 s52, s89, 1431552
v_accvgpr_read_b32 v96, a208
v_accvgpr_read_b32 v97, a209
v_mfma_f32_16x16x32_bf16 v[156:159], a[112:115], a[52:55], v[156:159]
buffer_load_dwordx4 v3, s[64:67], s52 offen offset:2048  lds
v_mfma_f32_16x16x32_bf16 v[156:159], a[96:99], a[36:39], v[156:159]
v_accvgpr_read_b32 v98, a210
v_accvgpr_read_b32 v99, a211
v_mfma_f32_16x16x32_bf16 v[160:163], a[96:99], a[40:43], v[160:163]
ds_read_b64_tr_b16 a[8:9], v11 offset:0
ds_read_b64_tr_b16 a[10:11], v11 offset:512
v_mfma_f32_16x16x32_bf16 v[160:163], a[112:115], a[56:59], v[160:163]
v_mfma_f32_16x16x32_bf16 v[164:167], a[116:119], a[56:59], v[164:167]
ds_read_b64_tr_b16 a[24:25], v11 offset:8192
ds_read_b64_tr_b16 a[26:27], v11 offset:8704
v_mfma_f32_16x16x32_bf16 v[164:167], a[100:103], a[40:43], v[164:167]
s_add_u32 s52, s89, 1459200
v_mfma_f32_16x16x32_bf16 v[168:171], a[104:107], a[40:43], v[168:171]
buffer_load_dwordx4 v4, s[64:67], s52 offen offset:3072  lds
v_mfma_f32_16x16x32_bf16 v[168:171], a[120:123], a[56:59], v[168:171]
v_mfma_f32_16x16x32_bf16 v[172:175], a[124:127], a[56:59], v[172:175]
s_add_u32 s59, s72, 28672
ds_read_b64_tr_b16 a[12:13], v12 offset:0
ds_read_b64_tr_b16 a[14:15], v12 offset:512
v_mfma_f32_16x16x32_bf16 v[172:175], a[108:111], a[40:43], v[172:175]
buffer_store_dwordx4 v[100:103], v15, s[44:47], s59 offen offset:1024 sc1
v_mfma_f32_16x16x32_bf16 v[176:179], a[108:111], a[44:47], v[176:179]
s_lshl_b32 s63, s32, 2
ds_read_b64_tr_b16 a[28:29], v12 offset:8192
ds_read_b64_tr_b16 a[30:31], v12 offset:8704
v_mfma_f32_16x16x32_bf16 v[176:179], a[124:127], a[60:63], v[176:179]
s_lshr_b32 s52, 0x14203142, s63
v_accvgpr_read_b32 v100, a212
v_accvgpr_read_b32 v101, a213
v_mfma_f32_16x16x32_bf16 v[180:183], a[120:123], a[60:63], v[180:183]
s_and_b32 s52, s52, 7
v_accvgpr_read_b32 v102, a214
v_accvgpr_read_b32 v103, a215
v_mfma_f32_16x16x32_bf16 v[180:183], a[104:107], a[44:47], v[180:183]
s_lshl_b32 s52, s52, 15
v_xor_b32 v5, s71, v5
v_xor_b32 v6, s71, v6
v_mfma_f32_16x16x32_bf16 v[184:187], a[100:103], a[44:47], v[184:187]
s_lshr_b32 s18, 0x20314203, s63
v_add_u32 v5, 0x10000, v5
v_add_u32 v6, 0x10000, v6
v_mfma_f32_16x16x32_bf16 v[184:187], a[116:119], a[60:63], v[184:187]
s_and_b32 s18, s18, 7
s_lshl_b32 s18, s18, 15
s_lshr_b32 s19, 0x31420314, s63
v_mfma_f32_16x16x32_bf16 v[188:191], a[112:115], a[60:63], v[188:191]
s_and_b32 s19, s19, 7
s_lshl_b32 s19, s19, 15
s_lshr_b32 s53, 0x42031420, s63
v_mfma_f32_16x16x32_bf16 v[188:191], a[96:99], a[44:47], v[188:191]
s_and_b32 s53, s53, 7
s_lshl_b32 s53, s53, 15
s_lshr_b32 s20, 0x3142031, s63
v_mfma_f32_16x16x32_bf16 v[192:195], a[96:99], a[64:67], v[192:195]
s_and_b32 s20, s20, 7
ds_read_b128 a[32:35], v5 offset:0
ds_read_b128 a[48:51], v6 offset:0
v_mfma_f32_16x16x32_bf16 v[192:195], a[112:115], a[80:83], v[192:195]
s_lshl_b32 s20, s20, 15
s_mov_b32 s60, 0x3e0293ee
s_mov_b32 s61, 0x3e0293ee
v_mfma_f32_16x16x32_bf16 v[196:199], a[120:123], a[80:83], v[196:199]
s_lshl_b32 s56, s30, 13
ds_read_b128 a[36:39], v5 offset:2048
ds_read_b128 a[52:55], v6 offset:2048
v_mfma_f32_16x16x32_bf16 v[196:199], a[104:107], a[64:67], v[196:199]
s_mul_i32 s26, s33, 24576
s_lshl_b32 s63, s34, 14
s_add_u32 s26, s26, s63
v_mfma_f32_16x16x32_bf16 v[200:203], a[104:107], a[68:71], v[200:203]
ds_read_b128 a[40:43], v5 offset:4096
ds_read_b128 a[56:59], v6 offset:4096
v_mfma_f32_16x16x32_bf16 v[200:203], a[120:123], a[84:87], v[200:203]
v_add_u32 v1, s26, v15
v_add_u32 v2, s52, v15
v_mfma_f32_16x16x32_bf16 v[204:207], a[112:115], a[84:87], v[204:207]
s_add_u32 s18, s18, s56
s_add_u32 s19, s19, s56
v_mov_b32 v3, 0xf149f2ca
v_mfma_f32_16x16x32_bf16 v[204:207], a[96:99], a[68:71], v[204:207]
s_cmp_eq_u32 s33, 0
s_cselect_b32 s63, s53, s20
s_lshl_b32 s26, s34, 11
v_mfma_f32_16x16x32_bf16 v[208:211], a[96:99], a[72:75], v[208:211]
s_add_u32 s59, s72, 28672
ds_read_b128 a[44:47], v5 offset:6144
ds_read_b128 a[60:63], v6 offset:6144
v_mfma_f32_16x16x32_bf16 v[208:211], a[112:115], a[88:91], v[208:211]
buffer_store_dwordx4 v[104:107], v15, s[44:47], s59 offen offset:0 sc1
v_mfma_f32_16x16x32_bf16 v[212:215], a[120:123], a[88:91], v[212:215]
s_add_u32 s63, s63, s26
s_lshl1_add_u32 s63, s73, s63
v_add_u32 v4, s63, v15
v_mfma_f32_16x16x32_bf16 v[212:215], a[104:107], a[72:75], v[212:215]
s_sub_u32 s21, 15, s32
v_accvgpr_read_b32 v104, a216
v_accvgpr_read_b32 v105, a217
v_mfma_f32_16x16x32_bf16 v[216:219], a[104:107], a[76:79], v[216:219]
v_accvgpr_read_b32 v106, a218
v_accvgpr_read_b32 v107, a219
v_mfma_f32_16x16x32_bf16 v[216:219], a[120:123], a[92:95], v[216:219]
s_cmp_eq_u32 s33, 0
s_cselect_b32 s21, s21, s32
s_mul_i32 s21, s21, 1507328
v_mfma_f32_16x16x32_bf16 v[220:223], a[112:115], a[92:95], v[220:223]
s_bitcmp1_b32 s2, 0
v_mfma_f32_16x16x32_bf16 v[220:223], a[96:99], a[76:79], v[220:223]
s_cbranch_scc1 L_short27
v_mfma_f32_16x16x32_bf16 v[224:227], a[100:103], a[76:79], v[224:227]
v_mfma_f32_16x16x32_bf16 v[224:227], a[116:119], a[92:95], v[224:227]
v_mfma_f32_16x16x32_bf16 v[228:231], a[124:127], a[92:95], v[228:231]
v_mfma_f32_16x16x32_bf16 v[228:231], a[108:111], a[76:79], v[228:231]
v_mfma_f32_16x16x32_bf16 v[232:235], a[108:111], a[72:75], v[232:235]
v_mfma_f32_16x16x32_bf16 v[232:235], a[124:127], a[88:91], v[232:235]
v_mfma_f32_16x16x32_bf16 v[236:239], a[116:119], a[88:91], v[236:239]
v_mfma_f32_16x16x32_bf16 v[236:239], a[100:103], a[72:75], v[236:239]
v_mfma_f32_16x16x32_bf16 v[240:243], a[100:103], a[68:71], v[240:243]
v_mfma_f32_16x16x32_bf16 v[240:243], a[116:119], a[84:87], v[240:243]
v_mfma_f32_16x16x32_bf16 v[244:247], a[124:127], a[84:87], v[244:247]
v_mfma_f32_16x16x32_bf16 v[244:247], a[108:111], a[68:71], v[244:247]
v_mfma_f32_16x16x32_bf16 v[248:251], a[108:111], a[64:67], v[248:251]
v_mfma_f32_16x16x32_bf16 v[248:251], a[124:127], a[80:83], v[248:251]
v_mfma_f32_16x16x32_bf16 v[252:255], a[116:119], a[80:83], v[252:255]
v_mfma_f32_16x16x32_bf16 v[252:255], a[100:103], a[64:67], v[252:255]
L_short27:
s_waitcnt vmcnt(20) lgkmcnt(0)
s_barrier
v_mfma_f32_16x16x32_bf16 v[16:19], a[0:3], a[32:35], v[16:19]
s_lshr_b32 s26, s31, 3
s_mul_i32 s26, s26, 14336
s_add_u32 s21, s21, s26
v_mfma_f32_16x16x32_bf16 v[16:19], a[16:19], a[48:51], v[16:19]
v_xor_b32 v5, s71, v5
v_xor_b32 v6, s71, v6
v_mfma_f32_16x16x32_bf16 v[20:23], a[20:23], a[48:51], v[20:23]
ds_read_b128 a[64:67], v5 offset:0
ds_read_b128 a[80:83], v6 offset:0
v_mfma_f32_16x16x32_bf16 v[20:23], a[4:7], a[32:35], v[20:23]
s_cmp_eq_u32 s30, 0
s_cselect_b32 s57, 204800, -1
v_mfma_f32_16x16x32_bf16 v[24:27], a[8:11], a[32:35], v[24:27]
s_add_u32 s48, s28, 37748736
s_addc_u32 s49, s29, 0
ds_read_b128 a[68:71], v5 offset:2048
v_mfma_f32_16x16x32_bf16 v[24:27], a[24:27], a[48:51], v[24:27]
s_mov_b32 s50, 24117248
s_mov_b32 s51, 0x20000
v_mfma_f32_16x16x32_bf16 v[28:31], a[28:31], a[48:51], v[28:31]
s_add_u32 s59, s72, 12288
s_mov_b32 s40, s22
s_mov_b32 s41, s23
v_mfma_f32_16x16x32_bf16 v[28:31], a[12:15], a[32:35], v[28:31]
buffer_store_dwordx4 v[108:111], v15, s[44:47], s59 offen offset:0 sc1
v_mfma_f32_16x16x32_bf16 v[32:35], a[12:15], a[36:39], v[32:35]
s_mov_b32 s42, 1835008
s_mov_b32 s43, 0x20000
ds_read_b128 a[84:87], v6 offset:2048
v_mfma_f32_16x16x32_bf16 v[32:35], a[28:31], a[52:55], v[32:35]
v_accvgpr_read_b32 v108, a220
v_accvgpr_read_b32 v109, a221
v_mfma_f32_16x16x32_bf16 v[36:39], a[24:27], a[52:55], v[36:39]
ds_read_b128 a[72:75], v5 offset:4096
v_accvgpr_read_b32 v110, a222
v_mfma_f32_16x16x32_bf16 v[36:39], a[8:11], a[36:39], v[36:39]
s_mov_b32 s36, s14
s_mov_b32 s37, s15
v_accvgpr_read_b32 v111, a223
v_mfma_f32_16x16x32_bf16 v[40:43], a[4:7], a[36:39], v[40:43]
s_mov_b32 s38, 4194304
s_mov_b32 s39, 0x20000
v_mfma_f32_16x16x32_bf16 v[40:43], a[20:23], a[52:55], v[40:43]
s_add_u32 s8, s28, 68157440
s_addc_u32 s9, s29, 0
s_mov_b32 s10, 6291456
v_mfma_f32_16x16x32_bf16 v[44:47], a[16:19], a[52:55], v[44:47]
s_mov_b32 s11, 0x20000
s_and_b32 s26, s31, 2
ds_read_b128 a[88:91], v6 offset:4096
v_mfma_f32_16x16x32_bf16 v[44:47], a[0:3], a[36:39], v[44:47]
s_mul_i32 s26, s26, 1536
s_and_b32 s63, s31, 1
s_xor_b32 s63, s63, 1
v_mfma_f32_16x16x32_bf16 v[48:51], a[0:3], a[40:43], v[48:51]
s_lshl2_add_u32 s62, s63, s34
s_lshl_b32 s62, s62, 9
ds_read_b128 a[76:79], v5 offset:6144
v_mfma_f32_16x16x32_bf16 v[48:51], a[16:19], a[56:59], v[48:51]
s_add_u32 s62, s62, s26
s_add_u32 s62, s62, 8192
s_lshl_b32 s63, s63, 9
v_mfma_f32_16x16x32_bf16 v[52:55], a[20:23], a[56:59], v[52:55]
s_add_u32 s59, s72, 8192
s_add_u32 s26, s26, s63
s_mul_i32 s63, s34, 753664
v_mfma_f32_16x16x32_bf16 v[52:55], a[4:7], a[40:43], v[52:55]
buffer_store_dwordx4 v[112:115], v15, s[44:47], s59 offen offset:1024 sc1
v_mfma_f32_16x16x32_bf16 v[56:59], a[8:11], a[40:43], v[56:59]
s_sub_u32 s23, 753664, s63
s_add_u32 s22, s62, s23
ds_read_b128 a[92:95], v6 offset:6144
v_mfma_f32_16x16x32_bf16 v[56:59], a[24:27], a[56:59], v[56:59]
s_add_u32 s62, s62, s63
v_accvgpr_read_b32 v112, a224
v_accvgpr_read_b32 v113, a225
v_mfma_f32_16x16x32_bf16 v[60:63], a[28:31], a[56:59], v[60:63]
s_add_u32 s26, s26, s23
v_accvgpr_read_b32 v114, a226
v_accvgpr_read_b32 v115, a227
v_mfma_f32_16x16x32_bf16 v[60:63], a[12:15], a[40:43], v[60:63]
s_and_b32 s63, s31, 3
s_lshl1_add_u32 s63, s63, s34
s_lshl_b32 s63, s63, 10
v_mfma_f32_16x16x32_bf16 v[64:67], a[12:15], a[44:47], v[64:67]
s_add_u32 s101, s63, 753664
s_add_u32 s23, s63, 1130496
v_mfma_f32_16x16x32_bf16 v[64:67], a[28:31], a[60:63], v[64:67]
s_bitcmp1_b32 s2, 0
s_cselect_b32 s62, s62, s101
s_cselect_b32 s22, s22, s23
v_mfma_f32_16x16x32_bf16 v[68:71], a[24:27], a[60:63], v[68:71]
s_bitcmp1_b32 s2, 0
s_cselect_b32 s26, s26, s63
s_cselect_b32 s63, 2, 1
v_mfma_f32_16x16x32_bf16 v[68:71], a[8:11], a[44:47], v[68:71]
s_mul_i32 s63, s63, 188416
s_add_u32 s62, s62, s21
s_add_u32 s22, s22, s21
v_mfma_f32_16x16x32_bf16 v[72:75], a[4:7], a[44:47], v[72:75]
s_add_u32 s101, s62, s63
ds_read_b64_tr_b16 a[96:97], v13 offset:16384
ds_read_b64_tr_b16 a[98:99], v13 offset:16896
v_mfma_f32_16x16x32_bf16 v[72:75], a[20:23], a[60:63], v[72:75]
s_add_u32 s23, s22, s63
s_add_u32 s21, s21, s26
s_bfe_u32 s0, s2, 0x20001
v_mfma_f32_16x16x32_bf16 v[76:79], a[16:19], a[60:63], v[76:79]
s_waitcnt lgkmcnt(2)
ds_read_b64_tr_b16 a[112:113], v13 offset:24576
ds_read_b64_tr_b16 a[114:115], v13 offset:25088
v_mfma_f32_16x16x32_bf16 v[76:79], a[0:3], a[44:47], v[76:79]
s_bfe_u32 s1, s2, 0x30003
s_sub_u32 s15, 7, s1
v_mfma_f32_16x16x32_bf16 v[80:83], a[0:3], a[64:67], v[80:83]
s_add_u32 s59, s72, 24576
s_bitcmp1_b32 s2, 0
s_cselect_b32 s15, s1, s15
v_mfma_f32_16x16x32_bf16 v[80:83], a[16:19], a[80:83], v[80:83]
buffer_store_dwordx4 v[116:119], v15, s[44:47], s59 offen offset:1024 sc1
v_mfma_f32_16x16x32_bf16 v[84:87], a[20:23], a[80:83], v[84:87]
s_lshl_b32 s15, s15, 2
ds_read_b64_tr_b16 a[100:101], v14 offset:16384
ds_read_b64_tr_b16 a[102:103], v14 offset:16896
v_mfma_f32_16x16x32_bf16 v[84:87], a[4:7], a[64:67], v[84:87]
s_add_u32 s15, s15, s0
v_accvgpr_read_b32 v116, a228
v_accvgpr_read_b32 v117, a229
v_mfma_f32_16x16x32_bf16 v[88:91], a[8:11], a[64:67], v[88:91]
s_lshl_b32 s15, s15, 5
ds_read_b64_tr_b16 a[116:117], v14 offset:24576
ds_read_b64_tr_b16 a[118:119], v14 offset:25088
v_mfma_f32_16x16x32_bf16 v[88:91], a[24:27], a[80:83], v[88:91]
v_accvgpr_read_b32 v118, a230
v_accvgpr_read_b32 v119, a231
v_mfma_f32_16x16x32_bf16 v[92:95], a[28:31], a[80:83], v[92:95]
s_bitcmp1_b32 s2, 0
s_cselect_b32 s63, 0, 8
s_add_u32 s1, s1, s63
v_mfma_f32_16x16x32_bf16 v[92:95], a[12:15], a[64:67], v[92:95]
s_lshl_b32 s1, s1, 1
s_add_u32 s1, s1, s33
s_lshl_b32 s1, s1, 2
v_mfma_f32_16x16x32_bf16 v[96:99], a[12:15], a[68:71], v[96:99]
s_lshr_b32 s6, s2, 6
ds_read_b64_tr_b16 a[104:105], v13 offset:20480
ds_read_b64_tr_b16 a[106:107], v13 offset:20992
v_mfma_f32_16x16x32_bf16 v[96:99], a[28:31], a[84:87], v[96:99]
s_lshl_b32 s6, s6, 1
s_add_u32 s6, s6, s34
s_lshl_b32 s6, s6, 7
v_mfma_f32_16x16x32_bf16 v[100:103], a[24:27], a[84:87], v[100:103]
s_lshl_b32 s12, s34, 1
ds_read_b64_tr_b16 a[120:121], v13 offset:28672
ds_read_b64_tr_b16 a[122:123], v13 offset:29184
v_mfma_f32_16x16x32_bf16 v[100:103], a[8:11], a[68:71], v[100:103]
s_add_u32 s12, s12, s0
s_add_u32 s13, s12, 1
s_and_b32 s12, s12, 3
v_mfma_f32_16x16x32_bf16 v[104:107], a[4:7], a[68:71], v[104:107]
s_add_u32 s59, s72, 24576
s_and_b32 s13, s13, 3
s_add_u32 s12, s12, s1
v_mfma_f32_16x16x32_bf16 v[104:107], a[20:23], a[84:87], v[104:107]
buffer_store_dwordx4 v[120:123], v15, s[44:47], s59 offen offset:0 sc1
v_mfma_f32_16x16x32_bf16 v[108:111], a[16:19], a[84:87], v[108:111]
s_add_u32 s13, s13, s1
ds_read_b64_tr_b16 a[108:109], v14 offset:20480
ds_read_b64_tr_b16 a[110:111], v14 offset:20992
v_mfma_f32_16x16x32_bf16 v[108:111], a[0:3], a[68:71], v[108:111]
s_mul_i32 s12, s12, 188416
s_mul_i32 s13, s13, 188416
s_mul_i32 s63, s0, 14336
v_mfma_f32_16x16x32_bf16 v[112:115], a[0:3], a[72:75], v[112:115]
s_add_u32 s12, s12, s63
ds_read_b64_tr_b16 a[124:125], v14 offset:28672
ds_read_b64_tr_b16 a[126:127], v14 offset:29184
v_mfma_f32_16x16x32_bf16 v[112:115], a[16:19], a[88:91], v[112:115]
s_add_u32 s13, s13, s63
s_sub_u32 s13, s13, 2048
s_lshl_b32 s7, s63, 5
v_mfma_f32_16x16x32_bf16 v[116:119], a[20:23], a[88:91], v[116:119]
s_lshl_b32 s58, s30, 12
s_lshr_b32 s14, s2, 3
v_mfma_f32_16x16x32_bf16 v[116:119], a[4:7], a[72:75], v[116:119]
s_bitcmp1_b32 s2, 0
s_cselect_b32 s63, 0, 32
s_add_u32 s14, s14, s63
v_mfma_f32_16x16x32_bf16 a[232:235], a[8:11], a[72:75], a[232:235]
s_mul_i32 s14, s14, 98304
s_lshl_b32 s63, s30, 11
s_add_u32 s14, s14, s63
v_mfma_f32_16x16x32_bf16 a[232:235], a[24:27], a[88:91], a[232:235]
s_add_u32 s1, s1, s0
s_lshl_b32 s1, s1, 14
s_add_u32 s1, s1, s6
v_mfma_f32_16x16x32_bf16 a[236:239], a[28:31], a[88:91], a[236:239]
s_lshl_b32 s63, s33, 15
s_add_u32 s6, s6, s63
v_mfma_f32_16x16x32_bf16 a[236:239], a[12:15], a[72:75], a[236:239]
v_mfma_f32_16x16x32_bf16 a[240:243], a[12:15], a[76:79], a[240:243]
v_mfma_f32_16x16x32_bf16 a[240:243], a[28:31], a[92:95], a[240:243]
v_mfma_f32_16x16x32_bf16 a[244:247], a[24:27], a[92:95], a[244:247]
s_add_u32 s59, s72, 8192
v_mfma_f32_16x16x32_bf16 a[244:247], a[8:11], a[76:79], a[244:247]
buffer_store_dwordx4 v[124:127], v15, s[44:47], s59 offen offset:0 sc1
v_mfma_f32_16x16x32_bf16 a[248:251], a[4:7], a[76:79], a[248:251]
v_mfma_f32_16x16x32_bf16 a[248:251], a[20:23], a[92:95], a[248:251]
v_accvgpr_read_b32 v120, a232
v_accvgpr_read_b32 v121, a233
v_mfma_f32_16x16x32_bf16 a[252:255], a[16:19], a[92:95], a[252:255]
L_t7:
s_cbranch_execz L_r1
s_waitcnt vmcnt(14) lgkmcnt(0)
v_mfma_f32_16x16x32_bf16 a[252:255], a[0:3], a[76:79], a[252:255]
s_barrier
v_mfma_f32_16x16x32_bf16 v[140:143], a[96:99], a[64:67], v[140:143]
v_accvgpr_read_b32 v122, a234
v_accvgpr_read_b32 v123, a235
v_mfma_f32_16x16x32_bf16 v[140:143], a[112:115], a[80:83], v[140:143]
v_accvgpr_read_b32 v124, a236
v_accvgpr_read_b32 v125, a237
v_mfma_f32_16x16x32_bf16 v[148:151], a[116:119], a[80:83], v[148:151]
v_accvgpr_read_b32 v126, a238
v_accvgpr_read_b32 v127, a239
v_mfma_f32_16x16x32_bf16 v[148:151], a[100:103], a[64:67], v[148:151]
v_mfma_f32_16x16x32_bf16 v[136:139], a[104:107], a[64:67], v[136:139]
ds_read_b64_tr_b16 a[0:1], v9 offset:32768
ds_read_b64_tr_b16 a[2:3], v9 offset:33280
v_mfma_f32_16x16x32_bf16 v[136:139], a[120:123], a[80:83], v[136:139]
v_mfma_f32_16x16x32_bf16 v[144:147], a[124:127], a[80:83], v[144:147]
ds_read_b64_tr_b16 a[16:17], v9 offset:40960
ds_read_b64_tr_b16 a[18:19], v9 offset:41472
v_mfma_f32_16x16x32_bf16 v[144:147], a[108:111], a[64:67], v[144:147]
v_mfma_f32_16x16x32_bf16 v[128:131], a[108:111], a[68:71], v[128:131]
v_mfma_f32_16x16x32_bf16 v[128:131], a[124:127], a[84:87], v[128:131]
v_mfma_f32_16x16x32_bf16 v[132:135], a[120:123], a[84:87], v[132:135]
ds_read_b64_tr_b16 a[4:5], v10 offset:32768
ds_read_b64_tr_b16 a[6:7], v10 offset:33280
v_mfma_f32_16x16x32_bf16 v[132:135], a[104:107], a[68:71], v[132:135]
v_mfma_f32_16x16x32_bf16 v[152:155], a[100:103], a[68:71], v[152:155]
ds_read_b64_tr_b16 a[20:21], v10 offset:40960
ds_read_b64_tr_b16 a[22:23], v10 offset:41472
v_mfma_f32_16x16x32_bf16 v[152:155], a[116:119], a[84:87], v[152:155]
v_mfma_f32_16x16x32_bf16 v[156:159], a[112:115], a[84:87], v[156:159]
v_mfma_f32_16x16x32_bf16 v[156:159], a[96:99], a[68:71], v[156:159]
v_mfma_f32_16x16x32_bf16 v[160:163], a[96:99], a[72:75], v[160:163]
ds_read_b64_tr_b16 a[8:9], v11 offset:32768
ds_read_b64_tr_b16 a[10:11], v11 offset:33280
v_mfma_f32_16x16x32_bf16 v[160:163], a[112:115], a[88:91], v[160:163]
v_mfma_f32_16x16x32_bf16 v[164:167], a[116:119], a[88:91], v[164:167]
ds_read_b64_tr_b16 a[24:25], v11 offset:40960
ds_read_b64_tr_b16 a[26:27], v11 offset:41472
v_mfma_f32_16x16x32_bf16 v[164:167], a[100:103], a[72:75], v[164:167]
v_mfma_f32_16x16x32_bf16 v[168:171], a[104:107], a[72:75], v[168:171]
s_lshl_b32 s63, s30, 4
v_lshrrev_b32 v11, 8, v15
v_mul_u32_u24 v11, 320, v11
v_mfma_f32_16x16x32_bf16 v[168:171], a[120:123], a[88:91], v[168:171]
v_sub_u32 v11, v15, v11
v_ashrrev_i32 v11, 4, v11
v_mfma_f32_16x16x32_bf16 v[172:175], a[124:127], a[88:91], v[172:175]
ds_read_b64_tr_b16 a[12:13], v12 offset:32768
ds_read_b64_tr_b16 a[14:15], v12 offset:33280
v_mfma_f32_16x16x32_bf16 v[172:175], a[108:111], a[72:75], v[172:175]
v_add_u32 v11, s63, v11
v_cmp_ge_i32 s[64:65], v11, 0
v_mfma_f32_16x16x32_bf16 v[176:179], a[108:111], a[76:79], v[176:179]
ds_read_b64_tr_b16 a[28:29], v12 offset:40960
ds_read_b64_tr_b16 a[30:31], v12 offset:41472
v_mfma_f32_16x16x32_bf16 v[176:179], a[124:127], a[92:95], v[176:179]
v_cmp_ge_i32 s[66:67], v11, 1
v_cmp_ge_i32 s[68:69], v11, 2
v_mfma_f32_16x16x32_bf16 v[180:183], a[120:123], a[92:95], v[180:183]
v_cmp_ge_i32 s[70:71], v11, 3
v_cmp_ge_i32 s[72:73], v11, 16
v_mfma_f32_16x16x32_bf16 v[180:183], a[104:107], a[76:79], v[180:183]
v_xor_b32 v5, 0x2000, v5
v_xor_b32 v6, 0x2000, v6
v_mfma_f32_16x16x32_bf16 v[184:187], a[100:103], a[76:79], v[184:187]
v_add_u32 v5, 0xffff0000, v5
v_add_u32 v6, 0xffff0000, v6
v_mfma_f32_16x16x32_bf16 v[184:187], a[116:119], a[92:95], v[184:187]
v_cmp_ge_i32 s[74:75], v11, 17
v_cmp_ge_i32 s[76:77], v11, 18
v_mfma_f32_16x16x32_bf16 v[188:191], a[112:115], a[92:95], v[188:191]
v_cmp_ge_i32 s[78:79], v11, 19
v_cmp_ge_i32 s[80:81], v11, 32
v_mfma_f32_16x16x32_bf16 v[188:191], a[96:99], a[76:79], v[188:191]
v_cmp_ge_i32 s[82:83], v11, 33
v_cmp_ge_i32 s[84:85], v11, 34
v_mfma_f32_16x16x32_bf16 v[192:195], a[96:99], a[32:35], v[192:195]
ds_read_b128 a[64:67], v5 offset:0
ds_read_b128 a[80:83], v6 offset:0
v_mfma_f32_16x16x32_bf16 v[192:195], a[112:115], a[48:51], v[192:195]
v_cmp_ge_i32 s[86:87], v11, 35
v_cmp_ge_i32 s[88:89], v11, 48
v_mfma_f32_16x16x32_bf16 v[196:199], a[120:123], a[48:51], v[196:199]
ds_read_b128 a[68:71], v5 offset:2048
ds_read_b128 a[84:87], v6 offset:2048
v_mfma_f32_16x16x32_bf16 v[196:199], a[104:107], a[32:35], v[196:199]
v_cmp_ge_i32 s[90:91], v11, 49
v_cmp_ge_i32 s[92:93], v11, 50
v_mfma_f32_16x16x32_bf16 v[200:203], a[104:107], a[36:39], v[200:203]
ds_read_b128 a[72:75], v5 offset:4096
ds_read_b128 a[88:91], v6 offset:4096
v_mfma_f32_16x16x32_bf16 v[200:203], a[120:123], a[52:55], v[200:203]
v_cmp_ge_i32 s[94:95], v11, 51
v_lshrrev_b32 v11, 7, v15
v_mfma_f32_16x16x32_bf16 v[204:207], a[112:115], a[52:55], v[204:207]
v_and_b32 v9, 6, v11
v_bfe_u32 v12, v15, 4, 3
v_mfma_f32_16x16x32_bf16 v[204:207], a[96:99], a[36:39], v[204:207]
v_xor_b32 v12, v12, v9
v_lshlrev_b32 v12, 4, v12
v_mfma_f32_16x16x32_bf16 v[208:211], a[96:99], a[40:43], v[208:211]
ds_read_b128 a[76:79], v5 offset:6144
ds_read_b128 a[92:95], v6 offset:6144
v_mfma_f32_16x16x32_bf16 v[208:211], a[112:115], a[56:59], v[208:211]
v_lshl_add_u32 v12, v11, 10, v12
v_add_u32 v9, s6, v12
v_mfma_f32_16x16x32_bf16 v[212:215], a[120:123], a[56:59], v[212:215]
v_xor_b32 v5, 0x2000, v5
v_xor_b32 v6, 0x2000, v6
v_mfma_f32_16x16x32_bf16 v[212:215], a[104:107], a[40:43], v[212:215]
v_lshrrev_b32 v11, 6, v15
v_bfe_u32 v12, v11, 1, 2
v_mfma_f32_16x16x32_bf16 v[216:219], a[104:107], a[44:47], v[216:219]
v_lshlrev_b32 v12, 5, v12
v_lshl_add_u32 v12, v11, 7, v12
v_mfma_f32_16x16x32_bf16 v[216:219], a[120:123], a[60:63], v[216:219]
v_bfe_u32 v11, v15, 4, 2
v_lshl_add_u32 v10, v11, 3, v12
v_mfma_f32_16x16x32_bf16 v[220:223], a[112:115], a[60:63], v[220:223]
s_bitcmp1_b32 s2, 0
v_bfe_u32 v11, v15, 4, 4
v_lshrrev_b32 v12, 8, v15
v_mfma_f32_16x16x32_bf16 v[220:223], a[96:99], a[44:47], v[220:223]
s_cbranch_scc1 L_short29
v_mfma_f32_16x16x32_bf16 v[224:227], a[100:103], a[44:47], v[224:227]
v_mfma_f32_16x16x32_bf16 v[224:227], a[116:119], a[60:63], v[224:227]
v_mfma_f32_16x16x32_bf16 v[228:231], a[124:127], a[60:63], v[228:231]
v_mfma_f32_16x16x32_bf16 v[228:231], a[108:111], a[44:47], v[228:231]
v_mfma_f32_16x16x32_bf16 v[232:235], a[108:111], a[40:43], v[232:235]
v_mfma_f32_16x16x32_bf16 v[232:235], a[124:127], a[56:59], v[232:235]
v_mfma_f32_16x16x32_bf16 v[236:239], a[116:119], a[56:59], v[236:239]
v_mfma_f32_16x16x32_bf16 v[236:239], a[100:103], a[40:43], v[236:239]
v_mfma_f32_16x16x32_bf16 v[240:243], a[100:103], a[36:39], v[240:243]
v_mfma_f32_16x16x32_bf16 v[240:243], a[116:119], a[52:55], v[240:243]
v_mfma_f32_16x16x32_bf16 v[244:247], a[124:127], a[52:55], v[244:247]
v_mfma_f32_16x16x32_bf16 v[244:247], a[108:111], a[36:39], v[244:247]
v_mfma_f32_16x16x32_bf16 v[248:251], a[108:111], a[32:35], v[248:251]
v_mfma_f32_16x16x32_bf16 v[248:251], a[124:127], a[48:51], v[248:251]
v_mfma_f32_16x16x32_bf16 v[252:255], a[116:119], a[48:51], v[252:255]
v_mfma_f32_16x16x32_bf16 v[252:255], a[100:103], a[32:35], v[252:255]
L_short29:
s_waitcnt vmcnt(7) lgkmcnt(0)
s_barrier
v_mfma_f32_16x16x32_bf16 v[16:19], a[0:3], a[64:67], v[16:19]
ds_read_b128 a[32:35], v5 offset:0
ds_read_b128 a[48:51], v6 offset:0
v_mfma_f32_16x16x32_bf16 v[16:19], a[16:19], a[80:83], v[16:19]
v_lshlrev_b32 v12, 3, v12
v_lshl_add_u32 v12, v11, 10, v12
v_mfma_f32_16x16x32_bf16 v[20:23], a[20:23], a[80:83], v[20:23]
ds_read_b128 a[36:39], v5 offset:2048
ds_read_b128 a[52:55], v6 offset:2048
v_mfma_f32_16x16x32_bf16 v[20:23], a[4:7], a[64:67], v[20:23]
v_add_u32 v12, s1, v12
v_mfma_f32_16x16x32_bf16 v[24:27], a[8:11], a[64:67], v[24:27]
s_sub_u32 s63, 16, s32
ds_read_b128 a[40:43], v5 offset:4096
ds_read_b128 a[56:59], v6 offset:4096
v_mfma_f32_16x16x32_bf16 v[24:27], a[24:27], a[80:83], v[24:27]
s_lshl_b32 s46, s63, 16
s_add_u32 s63, s58, s53
s_add_u32 s26, s58, s20
v_mfma_f32_16x16x32_bf16 v[28:31], a[28:31], a[80:83], v[28:31]
ds_read_b128 a[44:47], v5 offset:6144
ds_read_b128 a[60:63], v6 offset:6144
v_mfma_f32_16x16x32_bf16 v[28:31], a[12:15], a[64:67], v[28:31]
v_add_u32 v5, s63, v15
v_add_u32 v6, s26, v15
v_mfma_f32_16x16x32_bf16 v[32:35], a[12:15], a[68:71], v[32:35]
ds_read_b64_tr_b16 a[96:97], v13 offset:49152
ds_read_b64_tr_b16 a[98:99], v13 offset:49664
v_mfma_f32_16x16x32_bf16 v[32:35], a[28:31], a[84:87], v[32:35]
v_mfma_f32_16x16x32_bf16 v[36:39], a[24:27], a[84:87], v[36:39]
ds_read_b64_tr_b16 a[112:113], v13 offset:57344
ds_read_b64_tr_b16 a[114:115], v13 offset:57856
v_mfma_f32_16x16x32_bf16 v[36:39], a[8:11], a[68:71], v[36:39]
v_mul_f32 v16, s60, v16
v_mul_f32 v17, s60, v17
v_mfma_f32_16x16x32_bf16 v[40:43], a[4:7], a[68:71], v[40:43]
ds_read_b64_tr_b16 a[100:101], v14 offset:49152
ds_read_b64_tr_b16 a[102:103], v14 offset:49664
v_mfma_f32_16x16x32_bf16 v[40:43], a[20:23], a[84:87], v[40:43]
v_mul_f32 v18, s60, v18
v_mul_f32 v19, s60, v19
v_mfma_f32_16x16x32_bf16 v[44:47], a[16:19], a[84:87], v[44:47]
ds_read_b64_tr_b16 a[116:117], v14 offset:57344
ds_read_b64_tr_b16 a[118:119], v14 offset:57856
v_mfma_f32_16x16x32_bf16 v[44:47], a[0:3], a[68:71], v[44:47]
v_mul_f32 v20, s60, v20
v_mul_f32 v21, s60, v21
v_mfma_f32_16x16x32_bf16 v[48:51], a[0:3], a[72:75], v[48:51]
ds_read_b64_tr_b16 a[104:105], v13 offset:53248
ds_read_b64_tr_b16 a[106:107], v13 offset:53760
v_mfma_f32_16x16x32_bf16 v[48:51], a[16:19], a[88:91], v[48:51]
v_mul_f32 v22, s60, v22
v_mul_f32 v23, s60, v23
v_mfma_f32_16x16x32_bf16 v[52:55], a[20:23], a[88:91], v[52:55]
ds_read_b64_tr_b16 a[120:121], v13 offset:61440
ds_read_b64_tr_b16 a[122:123], v13 offset:61952
v_mfma_f32_16x16x32_bf16 v[52:55], a[4:7], a[72:75], v[52:55]
v_cvt_pk_bf16_f32 v16, v16, v17
v_cvt_pk_bf16_f32 v17, v18, v19
v_mfma_f32_16x16x32_bf16 v[56:59], a[8:11], a[72:75], v[56:59]
ds_read_b64_tr_b16 a[108:109], v14 offset:53248
ds_read_b64_tr_b16 a[110:111], v14 offset:53760
v_mfma_f32_16x16x32_bf16 v[56:59], a[24:27], a[88:91], v[56:59]
v_cvt_pk_bf16_f32 v18, v20, v21
v_cvt_pk_bf16_f32 v19, v22, v23
v_mfma_f32_16x16x32_bf16 v[60:63], a[28:31], a[88:91], v[60:63]
ds_read_b64_tr_b16 a[124:125], v14 offset:61440
ds_read_b64_tr_b16 a[126:127], v14 offset:61952
v_mfma_f32_16x16x32_bf16 v[60:63], a[12:15], a[72:75], v[60:63]
v_mul_f32 v24, s60, v24
v_mul_f32 v25, s60, v25
v_mfma_f32_16x16x32_bf16 v[64:67], a[12:15], a[76:79], v[64:67]
v_mul_f32 v26, s60, v26
v_mul_f32 v27, s60, v27
v_mfma_f32_16x16x32_bf16 v[64:67], a[28:31], a[92:95], v[64:67]
s_getpc_b64 s[98:99]
L_pc2:
v_mul_f32 v28, s60, v28
v_mul_f32 v29, s60, v29
v_mfma_f32_16x16x32_bf16 v[68:71], a[24:27], a[92:95], v[68:71]
s_lshr_b32 s59, s2, 3
s_lshl2_add_u32 s59, s59, s30
s_lshl_b32 s59, s59, 9
v_mfma_f32_16x16x32_bf16 v[68:71], a[8:11], a[76:79], v[68:71]
v_lshrrev_b32 v13, 1, v15
v_add_u32 v13, s59, v13
v_mfma_f32_16x16x32_bf16 v[72:75], a[4:7], a[76:79], v[72:75]
v_min_u32 v13, L_end-L_pc2, v13
v_mul_f32 v30, s60, v30
v_mfma_f32_16x16x32_bf16 v[72:75], a[20:23], a[92:95], v[72:75]
v_mul_f32 v31, s60, v31
v_cvt_pk_bf16_f32 v24, v24, v25
v_mfma_f32_16x16x32_bf16 v[76:79], a[16:19], a[92:95], v[76:79]
s_waitcnt vmcnt(0) lgkmcnt(0)
v_cvt_pk_bf16_f32 v25, v26, v27
v_cvt_pk_bf16_f32 v26, v28, v29
v_mfma_f32_16x16x32_bf16 v[76:79], a[0:3], a[76:79], v[76:79]
s_barrier
v_cvt_pk_bf16_f32 v27, v30, v31
v_mul_f32 v36, s60, v36
v_mfma_f32_16x16x32_bf16 v[80:83], a[0:3], a[32:35], v[80:83]
v_mul_f32 v37, s60, v37
v_mul_f32 v38, s60, v38
v_mfma_f32_16x16x32_bf16 v[80:83], a[16:19], a[48:51], v[80:83]
s_cmp_lg_u32 s30, 0
s_cbranch_scc1 L_sig_kv
s_mov_b64 exec, 1
global_store_dword v8, v7, s[16:17] sc1
s_mov_b64 exec, -1
L_sig_kv:
v_mul_f32 v39, s60, v39
v_mul_f32 v32, s60, v32
v_mfma_f32_16x16x32_bf16 v[84:87], a[20:23], a[48:51], v[84:87]
ds_write_b128 v4, v[16:19] offset:0
v_mfma_f32_16x16x32_bf16 v[84:87], a[4:7], a[32:35], v[84:87]
global_load_dword v13, v13, s[98:99]
v_mfma_f32_16x16x32_bf16 v[88:91], a[8:11], a[32:35], v[88:91]
ds_write_b128 v4, v[24:27] offset:1024
v_mfma_f32_16x16x32_bf16 v[88:91], a[24:27], a[48:51], v[88:91]
v_mul_f32 v33, s60, v33
v_mul_f32 v34, s60, v34
v_mfma_f32_16x16x32_bf16 v[92:95], a[28:31], a[48:51], v[92:95]
v_mul_f32 v35, s60, v35
v_cvt_pk_bf16_f32 v36, v36, v37
v_mfma_f32_16x16x32_bf16 v[92:95], a[12:15], a[32:35], v[92:95]
v_cvt_pk_bf16_f32 v37, v38, v39
v_cvt_pk_bf16_f32 v38, v32, v33
v_mfma_f32_16x16x32_bf16 v[96:99], a[12:15], a[36:39], v[96:99]
v_cvt_pk_bf16_f32 v39, v34, v35
v_mul_f32 v44, s60, v44
v_mfma_f32_16x16x32_bf16 v[96:99], a[28:31], a[52:55], v[96:99]
ds_write_b128 v4, v[36:39] offset:5120
v_mfma_f32_16x16x32_bf16 v[100:103], a[24:27], a[52:55], v[100:103]
v_mul_f32 v45, s60, v45
v_mul_f32 v46, s60, v46
v_mfma_f32_16x16x32_bf16 v[100:103], a[8:11], a[36:39], v[100:103]
v_mul_f32 v47, s60, v47
v_mul_f32 v40, s60, v40
v_mfma_f32_16x16x32_bf16 v[104:107], a[4:7], a[36:39], v[104:107]
v_mul_f32 v41, s60, v41
v_mul_f32 v42, s60, v42
v_mfma_f32_16x16x32_bf16 v[104:107], a[20:23], a[52:55], v[104:107]
v_mul_f32 v43, s60, v43
v_cvt_pk_bf16_f32 v44, v44, v45
v_mfma_f32_16x16x32_bf16 v[108:111], a[16:19], a[52:55], v[108:111]
v_cvt_pk_bf16_f32 v45, v46, v47
v_cvt_pk_bf16_f32 v46, v40, v41
v_mfma_f32_16x16x32_bf16 v[108:111], a[0:3], a[36:39], v[108:111]
v_cvt_pk_bf16_f32 v47, v42, v43
v_mul_f32 v48, s60, v48
v_mfma_f32_16x16x32_bf16 v[112:115], a[0:3], a[40:43], v[112:115]
ds_write_b128 v4, v[44:47] offset:4096
v_mfma_f32_16x16x32_bf16 v[112:115], a[16:19], a[56:59], v[112:115]
v_mul_f32 v49, s60, v49
v_mul_f32 v50, s60, v50
v_mfma_f32_16x16x32_bf16 v[116:119], a[20:23], a[56:59], v[116:119]
v_mul_f32 v51, s60, v51
v_mul_f32 v52, s60, v52
v_mfma_f32_16x16x32_bf16 v[116:119], a[4:7], a[40:43], v[116:119]
v_mul_f32 v53, s60, v53
v_mul_f32 v54, s60, v54
v_mfma_f32_16x16x32_bf16 v[120:123], a[8:11], a[40:43], v[120:123]
v_mul_f32 v55, s60, v55
v_cvt_pk_bf16_f32 v48, v48, v49
v_mfma_f32_16x16x32_bf16 v[120:123], a[24:27], a[56:59], v[120:123]
v_cvt_pk_bf16_f32 v49, v50, v51
v_cvt_pk_bf16_f32 v50, v52, v53
v_mfma_f32_16x16x32_bf16 v[124:127], a[28:31], a[56:59], v[124:127]
v_cvt_pk_bf16_f32 v51, v54, v55
v_mul_f32 v56, s60, v56
v_mfma_f32_16x16x32_bf16 v[124:127], a[12:15], a[40:43], v[124:127]
ds_write_b128 v4, v[48:51] offset:8192
v_mfma_f32_16x16x32_bf16 a[240:243], a[12:15], a[44:47], a[240:243]
v_mul_f32 v57, s60, v57
v_mul_f32 v58, s60, v58
v_mfma_f32_16x16x32_bf16 a[240:243], a[28:31], a[60:63], a[240:243]
v_mul_f32 v59, s60, v59
v_mul_f32 v60, s60, v60
v_mfma_f32_16x16x32_bf16 a[244:247], a[24:27], a[60:63], a[244:247]
v_mul_f32 v61, s60, v61
v_mul_f32 v62, s60, v62
v_mfma_f32_16x16x32_bf16 a[244:247], a[8:11], a[44:47], a[244:247]
v_mul_f32 v63, s60, v63
v_cvt_pk_bf16_f32 v56, v56, v57
v_mfma_f32_16x16x32_bf16 a[248:251], a[4:7], a[44:47], a[248:251]
v_cvt_pk_bf16_f32 v57, v58, v59
v_cvt_pk_bf16_f32 v58, v60, v61
v_mfma_f32_16x16x32_bf16 a[248:251], a[20:23], a[60:63], a[248:251]
v_cvt_pk_bf16_f32 v59, v62, v63
v_mul_f32 v68, s60, v68
v_mfma_f32_16x16x32_bf16 a[252:255], a[16:19], a[60:63], a[252:255]
ds_write_b128 v4, v[56:59] offset:9216
v_mfma_f32_16x16x32_bf16 a[252:255], a[0:3], a[44:47], a[252:255]
v_mul_f32 v69, s60, v69
v_mul_f32 v70, s60, v70
v_mfma_f32_16x16x32_bf16 v[140:143], a[96:99], a[32:35], v[140:143]
v_mul_f32 v71, s60, v71
v_mul_f32 v64, s60, v64
v_mfma_f32_16x16x32_bf16 v[140:143], a[112:115], a[48:51], v[140:143]
v_mul_f32 v65, s60, v65
v_mul_f32 v66, s60, v66
v_mfma_f32_16x16x32_bf16 v[148:151], a[116:119], a[48:51], v[148:151]
v_mul_f32 v67, s60, v67
v_cvt_pk_bf16_f32 v68, v68, v69
v_mfma_f32_16x16x32_bf16 v[148:151], a[100:103], a[32:35], v[148:151]
v_cvt_pk_bf16_f32 v69, v70, v71
v_cvt_pk_bf16_f32 v70, v64, v65
v_mfma_f32_16x16x32_bf16 v[136:139], a[104:107], a[32:35], v[136:139]
v_cvt_pk_bf16_f32 v71, v66, v67
v_mul_f32 v76, s60, v76
v_mfma_f32_16x16x32_bf16 v[136:139], a[120:123], a[48:51], v[136:139]
ds_write_b128 v4, v[68:71] offset:13312
v_mfma_f32_16x16x32_bf16 v[144:147], a[124:127], a[48:51], v[144:147]
v_mul_f32 v77, s60, v77
v_mul_f32 v78, s60, v78
v_mfma_f32_16x16x32_bf16 v[144:147], a[108:111], a[32:35], v[144:147]
v_mul_f32 v79, s60, v79
v_mul_f32 v72, s60, v72
v_mfma_f32_16x16x32_bf16 v[128:131], a[108:111], a[36:39], v[128:131]
v_mul_f32 v73, s60, v73
v_mul_f32 v74, s60, v74
v_mfma_f32_16x16x32_bf16 v[128:131], a[124:127], a[52:55], v[128:131]
v_mul_f32 v75, s60, v75
v_cvt_pk_bf16_f32 v76, v76, v77
v_mfma_f32_16x16x32_bf16 v[132:135], a[120:123], a[52:55], v[132:135]
v_cvt_pk_bf16_f32 v77, v78, v79
v_cvt_pk_bf16_f32 v78, v72, v73
v_mfma_f32_16x16x32_bf16 v[132:135], a[104:107], a[36:39], v[132:135]
v_cvt_pk_bf16_f32 v79, v74, v75
v_mul_f32 v80, s60, v80
v_mfma_f32_16x16x32_bf16 v[152:155], a[100:103], a[36:39], v[152:155]
ds_write_b128 v4, v[76:79] offset:12288
v_xor_b32 v4, 0x4000, v4
v_mfma_f32_16x16x32_bf16 v[152:155], a[116:119], a[52:55], v[152:155]
v_mul_f32 v81, s60, v81
v_mul_f32 v82, s60, v82
v_mfma_f32_16x16x32_bf16 v[156:159], a[112:115], a[52:55], v[156:159]
v_mul_f32 v83, s60, v83
v_mul_f32 v84, s60, v84
v_mfma_f32_16x16x32_bf16 v[156:159], a[96:99], a[36:39], v[156:159]
v_mul_f32 v85, s60, v85
v_mul_f32 v86, s60, v86
v_mfma_f32_16x16x32_bf16 v[160:163], a[96:99], a[40:43], v[160:163]
v_mul_f32 v87, s60, v87
v_cvt_pk_bf16_f32 v80, v80, v81
v_mfma_f32_16x16x32_bf16 v[160:163], a[112:115], a[56:59], v[160:163]
v_cvt_pk_bf16_f32 v81, v82, v83
v_cvt_pk_bf16_f32 v82, v84, v85
v_mfma_f32_16x16x32_bf16 v[164:167], a[116:119], a[56:59], v[164:167]
v_cvt_pk_bf16_f32 v83, v86, v87
v_mul_f32 v88, s60, v88
v_mfma_f32_16x16x32_bf16 v[164:167], a[100:103], a[40:43], v[164:167]
ds_write_b128 v4, v[80:83] offset:0
v_mfma_f32_16x16x32_bf16 v[168:171], a[104:107], a[40:43], v[168:171]
v_mul_f32 v89, s60, v89
v_mul_f32 v90, s60, v90
v_mfma_f32_16x16x32_bf16 v[168:171], a[120:123], a[56:59], v[168:171]
v_mul_f32 v91, s60, v91
v_mul_f32 v92, s60, v92
v_mfma_f32_16x16x32_bf16 v[172:175], a[124:127], a[56:59], v[172:175]
v_mul_f32 v93, s60, v93
v_mul_f32 v94, s60, v94
v_mfma_f32_16x16x32_bf16 v[172:175], a[108:111], a[40:43], v[172:175]
v_mul_f32 v95, s60, v95
v_cvt_pk_bf16_f32 v88, v88, v89
v_mfma_f32_16x16x32_bf16 v[176:179], a[108:111], a[44:47], v[176:179]
v_cvt_pk_bf16_f32 v89, v90, v91
v_cvt_pk_bf16_f32 v90, v92, v93
v_mfma_f32_16x16x32_bf16 v[176:179], a[124:127], a[60:63], v[176:179]
v_cvt_pk_bf16_f32 v91, v94, v95
v_mul_f32 v100, s60, v100
v_mfma_f32_16x16x32_bf16 v[180:183], a[120:123], a[60:63], v[180:183]
ds_write_b128 v4, v[88:91] offset:1024
v_mfma_f32_16x16x32_bf16 v[180:183], a[104:107], a[44:47], v[180:183]
v_mul_f32 v101, s60, v101
v_mul_f32 v102, s60, v102
v_mfma_f32_16x16x32_bf16 v[184:187], a[100:103], a[44:47], v[184:187]
v_mul_f32 v103, s60, v103
v_mul_f32 v96, s60, v96
v_mfma_f32_16x16x32_bf16 v[184:187], a[116:119], a[60:63], v[184:187]
v_mul_f32 v97, s60, v97
v_mul_f32 v98, s60, v98
v_mfma_f32_16x16x32_bf16 v[188:191], a[112:115], a[60:63], v[188:191]
v_bfe_u32 v8, v15, 4, 3
v_lshl_add_u32 v8, v8, 2, s35
v_mfma_f32_16x16x32_bf16 v[188:191], a[96:99], a[44:47], v[188:191]
global_load_dword v7, v8, s[16:17] sc1
v_mfma_f32_16x16x32_bf16 v[192:195], a[96:99], a[64:67], v[192:195]
v_mul_f32 v99, s60, v99
v_cvt_pk_bf16_f32 v100, v100, v101
v_mfma_f32_16x16x32_bf16 v[192:195], a[112:115], a[80:83], v[192:195]
v_cvt_pk_bf16_f32 v101, v102, v103
v_cvt_pk_bf16_f32 v102, v96, v97
v_mfma_f32_16x16x32_bf16 v[196:199], a[120:123], a[80:83], v[196:199]
v_cvt_pk_bf16_f32 v103, v98, v99
v_mul_f32 v108, s60, v108
v_mfma_f32_16x16x32_bf16 v[196:199], a[104:107], a[64:67], v[196:199]
ds_write_b128 v4, v[100:103] offset:5120
v_mfma_f32_16x16x32_bf16 v[200:203], a[104:107], a[68:71], v[200:203]
v_mul_f32 v109, s60, v109
v_mul_f32 v110, s60, v110
v_mfma_f32_16x16x32_bf16 v[200:203], a[120:123], a[84:87], v[200:203]
v_mul_f32 v111, s60, v111
v_mul_f32 v104, s60, v104
v_mfma_f32_16x16x32_bf16 v[204:207], a[112:115], a[84:87], v[204:207]
v_mul_f32 v105, s60, v105
v_mul_f32 v106, s60, v106
v_mfma_f32_16x16x32_bf16 v[204:207], a[96:99], a[68:71], v[204:207]
v_mul_f32 v107, s60, v107
v_cvt_pk_bf16_f32 v108, v108, v109
v_mfma_f32_16x16x32_bf16 v[208:211], a[96:99], a[72:75], v[208:211]
v_cvt_pk_bf16_f32 v109, v110, v111
v_cvt_pk_bf16_f32 v110, v104, v105
v_mfma_f32_16x16x32_bf16 v[208:211], a[112:115], a[88:91], v[208:211]
v_cvt_pk_bf16_f32 v111, v106, v107
v_mfma_f32_16x16x32_bf16 v[212:215], a[120:123], a[88:91], v[212:215]
ds_write_b128 v4, v[108:111] offset:4096
v_mfma_f32_16x16x32_bf16 v[212:215], a[104:107], a[72:75], v[212:215]
v_mfma_f32_16x16x32_bf16 v[216:219], a[104:107], a[76:79], v[216:219]
v_mfma_f32_16x16x32_bf16 v[216:219], a[120:123], a[92:95], v[216:219]
v_mfma_f32_16x16x32_bf16 v[220:223], a[112:115], a[92:95], v[220:223]
s_bitcmp1_b32 s2, 0
v_mfma_f32_16x16x32_bf16 v[220:223], a[96:99], a[76:79], v[220:223]
s_cbranch_scc1 L_short31
v_mfma_f32_16x16x32_bf16 v[224:227], a[100:103], a[76:79], v[224:227]
v_mul_f32 v112, s60, v112
v_mul_f32 v113, s60, v113
v_mfma_f32_16x16x32_bf16 v[224:227], a[116:119], a[92:95], v[224:227]
v_mul_f32 v114, s60, v114
v_mul_f32 v115, s60, v115
v_mfma_f32_16x16x32_bf16 v[228:231], a[124:127], a[92:95], v[228:231]
v_mul_f32 v116, s60, v116
v_mul_f32 v117, s60, v117
v_mfma_f32_16x16x32_bf16 v[228:231], a[108:111], a[76:79], v[228:231]
v_mul_f32 v118, s60, v118
v_mul_f32 v119, s60, v119
v_mfma_f32_16x16x32_bf16 v[232:235], a[108:111], a[72:75], v[232:235]
v_cvt_pk_bf16_f32 v112, v112, v113
v_cvt_pk_bf16_f32 v113, v114, v115
v_mfma_f32_16x16x32_bf16 v[232:235], a[124:127], a[88:91], v[232:235]
v_cvt_pk_bf16_f32 v114, v116, v117
v_cvt_pk_bf16_f32 v115, v118, v119
v_mfma_f32_16x16x32_bf16 v[236:239], a[116:119], a[88:91], v[236:239]
ds_write_b128 v4, v[112:115] offset:8192
v_mfma_f32_16x16x32_bf16 v[236:239], a[100:103], a[72:75], v[236:239]
v_mul_f32 v120, s60, v120
v_mul_f32 v121, s60, v121
v_mfma_f32_16x16x32_bf16 v[240:243], a[100:103], a[68:71], v[240:243]
v_mul_f32 v122, s60, v122
v_mul_f32 v123, s60, v123
v_mfma_f32_16x16x32_bf16 v[240:243], a[116:119], a[84:87], v[240:243]
v_mul_f32 v124, s60, v124
v_mul_f32 v125, s60, v125
v_mfma_f32_16x16x32_bf16 v[244:247], a[124:127], a[84:87], v[244:247]
v_mul_f32 v126, s60, v126
v_mul_f32 v127, s60, v127
v_mfma_f32_16x16x32_bf16 v[244:247], a[108:111], a[68:71], v[244:247]
v_cvt_pk_bf16_f32 v120, v120, v121
v_cvt_pk_bf16_f32 v121, v122, v123
v_mfma_f32_16x16x32_bf16 v[248:251], a[108:111], a[64:67], v[248:251]
v_cvt_pk_bf16_f32 v122, v124, v125
v_cvt_pk_bf16_f32 v123, v126, v127
v_mfma_f32_16x16x32_bf16 v[248:251], a[124:127], a[80:83], v[248:251]
ds_write_b128 v4, v[120:123] offset:9216
v_mfma_f32_16x16x32_bf16 v[252:255], a[116:119], a[80:83], v[252:255]
v_mfma_f32_16x16x32_bf16 v[252:255], a[100:103], a[64:67], v[252:255]
s_branch L_q_rest
L_short31:
v_pk_mul_f32 v[112:113], v[112:113], s[60:61]
v_pk_mul_f32 v[114:115], v[114:115], s[60:61]
v_pk_mul_f32 v[116:117], v[116:117], s[60:61]
v_pk_mul_f32 v[118:119], v[118:119], s[60:61]
v_cvt_pk_bf16_f32 v112, v112, v113
v_cvt_pk_bf16_f32 v113, v114, v115
v_cvt_pk_bf16_f32 v114, v116, v117
v_cvt_pk_bf16_f32 v115, v118, v119
ds_write_b128 v4, v[112:115] offset:8192
v_pk_mul_f32 v[120:121], v[120:121], s[60:61]
v_pk_mul_f32 v[122:123], v[122:123], s[60:61]
v_pk_mul_f32 v[124:125], v[124:125], s[60:61]
v_pk_mul_f32 v[126:127], v[126:127], s[60:61]
v_cvt_pk_bf16_f32 v120, v120, v121
v_cvt_pk_bf16_f32 v121, v122, v123
v_cvt_pk_bf16_f32 v122, v124, v125
v_cvt_pk_bf16_f32 v123, v126, v127
ds_write_b128 v4, v[120:123] offset:9216
L_q_rest:
v_accvgpr_read_b32 v20, a244
v_accvgpr_read_b32 v21, a245
v_accvgpr_read_b32 v22, a246
v_accvgpr_read_b32 v23, a247
v_accvgpr_read_b32 v28, a240
v_accvgpr_read_b32 v29, a241
v_accvgpr_read_b32 v30, a242
v_accvgpr_read_b32 v31, a243
v_pk_mul_f32 v[20:21], v[20:21], s[60:61]
v_pk_mul_f32 v[22:23], v[22:23], s[60:61]
v_pk_mul_f32 v[28:29], v[28:29], s[60:61]
v_pk_mul_f32 v[30:31], v[30:31], s[60:61]
v_cvt_pk_bf16_f32 v20, v20, v21
v_cvt_pk_bf16_f32 v21, v22, v23
v_cvt_pk_bf16_f32 v22, v28, v29
v_cvt_pk_bf16_f32 v23, v30, v31
ds_write_b128 v4, v[20:23] offset:13312
v_accvgpr_read_b32 v32, a252
v_accvgpr_read_b32 v33, a253
v_accvgpr_read_b32 v34, a254
v_accvgpr_read_b32 v35, a255
v_accvgpr_read_b32 v40, a248
v_accvgpr_read_b32 v41, a249
v_accvgpr_read_b32 v42, a250
v_accvgpr_read_b32 v43, a251
v_pk_mul_f32 v[32:33], v[32:33], s[60:61]
v_pk_mul_f32 v[34:35], v[34:35], s[60:61]
v_pk_mul_f32 v[40:41], v[40:41], s[60:61]
v_pk_mul_f32 v[42:43], v[42:43], s[60:61]
v_cvt_pk_bf16_f32 v32, v32, v33
v_cvt_pk_bf16_f32 v33, v34, v35
v_cvt_pk_bf16_f32 v34, v40, v41
v_cvt_pk_bf16_f32 v35, v42, v43
ds_write_b128 v4, v[32:35] offset:12288
s_waitcnt lgkmcnt(0)
s_barrier
s_cmp_eq_u32 s32, 0
ds_read_b128 a[128:131], v6 offset:0
v_mov_b32 v48, 0xc0135761
v_mov_b32 v49, 0xc0135761
v_mov_b32 v50, 0xbdd2d3e8
ds_read_b128 a[132:135], v6 offset:1024
v_mov_b32 v51, 0xbdd2d3e8
v_mov_b32 v52, 1.0
v_mov_b32 v53, 1.0
ds_read_b128 a[136:139], v6 offset:2048
s_cselect_b64 vcc, s[64:65], -1
v_cndmask_b32_e64 v56, v3, 0, vcc
s_cselect_b64 vcc, s[66:67], -1
v_cndmask_b32_e64 v57, v3, 0, vcc
s_cselect_b64 vcc, s[68:69], -1
v_cndmask_b32_e64 v58, v3, 0, vcc
ds_read_b128 a[140:143], v6 offset:3072
s_cselect_b64 vcc, s[70:71], -1
v_cndmask_b32_e64 v59, v3, 0, vcc
v_and_b32 v88, 48, v15
v_cmp_eq_u32 vcc, 0, v88
v_mov_b32 v89, 0x3f803f80
s_nop 0
v_cndmask_b32 v88, 0, v89, vcc
v_mov_b32 v89, v88
ds_read_b128 a[144:147], v6 offset:16384
v_mov_b64 v[90:91], v[88:89]
s_sub_u32 s26, s19, s56
v_add_u32 v4, s26, v15
s_bitcmp1_b32 s2, 0
s_cbranch_scc0 L_ffn64
v_bfe_u32 v40, v15, 8, 1
v_mul_u32_u24 v40, 188160, v40
v_lshrrev_b32 v14, 9, v15
v_lshlrev_b32 v14, 8, v14
v_sub_u32 v14, v15, v14
v_add_u32 v14, v14, v40
s_waitcnt vmcnt(0)
v_cmp_ne_u32 vcc, s3, v7
s_cbranch_vccnz L_kv1_spin
L_kv1:
ds_read_b128 a[148:151], v6 offset:17408
ds_read_b128 a[152:155], v6 offset:18432
ds_read_b128 a[156:159], v6 offset:19456
L_t8:
s_cbranch_execz L_r2
ds_read_b128 a[160:163], v5 offset:0
s_lshl2_add_u32 s54, s33, s34
s_mov_b32 m0, s19
s_lshl_b32 s54, s54, 12
buffer_load_dwordx4 v15, s[44:47], s54 offen offset:0 sc1 lds
buffer_load_dwordx4 v15, s[44:47], s54 offen offset:1024 sc1 lds
v_pk_mul_f32 v[40:41], v[148:149], v[148:149]
v_pk_mul_f32 v[42:43], v[150:151], v[150:151]
v_pk_mul_f32 v[44:45], v[152:153], v[152:153]
v_pk_mul_f32 v[46:47], v[154:155], v[154:155]
v_pk_fma_f32 v[40:41], v[40:41], v[50:51], v[48:49]
v_pk_fma_f32 v[42:43], v[42:43], v[50:51], v[48:49]
v_pk_fma_f32 v[44:45], v[44:45], v[50:51], v[48:49]
v_pk_fma_f32 v[46:47], v[46:47], v[50:51], v[48:49]
v_pk_mul_f32 v[40:41], v[40:41], v[148:149]
v_pk_mul_f32 v[42:43], v[42:43], v[150:151]
v_pk_mul_f32 v[44:45], v[44:45], v[152:153]
v_pk_mul_f32 v[46:47], v[46:47], v[154:155]
v_exp_f32 v40, v40
v_exp_f32 v41, v41
v_exp_f32 v42, v42
v_exp_f32 v43, v43
v_exp_f32 v44, v44
v_exp_f32 v45, v45
v_exp_f32 v46, v46
v_exp_f32 v47, v47
ds_read_b128 a[164:167], v5 offset:1024
ds_read_b128 a[168:171], v5 offset:2048
ds_read_b128 a[172:175], v5 offset:3072
ds_read_b128 a[176:179], v5 offset:16384
buffer_load_dwordx4 v15, s[44:47], s54 offen offset:2048 sc1 lds
buffer_load_dwordx4 v15, s[44:47], s54 offen offset:3072 sc1 lds
v_pk_add_f32 v[40:41], v[40:41], v[52:53]
v_pk_add_f32 v[42:43], v[42:43], v[52:53]
v_pk_add_f32 v[44:45], v[44:45], v[52:53]
v_pk_add_f32 v[46:47], v[46:47], v[52:53]
v_rcp_f32 v40, v40
v_rcp_f32 v41, v41
v_rcp_f32 v42, v42
v_rcp_f32 v43, v43
v_rcp_f32 v44, v44
v_rcp_f32 v45, v45
v_rcp_f32 v46, v46
v_rcp_f32 v47, v47
v_pk_mul_f32 v[148:149], v[148:149], v[40:41]
v_pk_mul_f32 v[150:151], v[150:151], v[42:43]
v_pk_mul_f32 v[152:153], v[152:153], v[44:45]
v_pk_mul_f32 v[154:155], v[154:155], v[46:47]
v_pk_mul_f32 v[148:149], v[148:149], v[144:145]
v_pk_mul_f32 v[150:151], v[150:151], v[146:147]
v_pk_mul_f32 v[152:153], v[152:153], v[128:129]
v_pk_mul_f32 v[154:155], v[154:155], v[130:131]
v_cvt_pk_bf16_f32 v104, v148, v149
v_cvt_pk_bf16_f32 v105, v150, v151
v_cvt_pk_bf16_f32 v106, v152, v153
v_cvt_pk_bf16_f32 v107, v154, v155
ds_read_b128 a[180:183], v5 offset:17408
ds_read_b128 a[184:187], v5 offset:18432
ds_read_b128 a[188:191], v5 offset:19456
s_add_u32 m0, s52, s56
s_mov_b32 s54, 8192
buffer_load_dwordx4 v1, s[44:47], s54 offen offset:0 sc1 lds
buffer_load_dwordx4 v1, s[44:47], s54 offen offset:1024 sc1 lds
v_pk_mul_f32 v[40:41], v[164:165], v[164:165]
v_pk_mul_f32 v[42:43], v[166:167], v[166:167]
v_pk_mul_f32 v[44:45], v[184:185], v[184:185]
v_pk_mul_f32 v[46:47], v[186:187], v[186:187]
v_permlane16_swap_b32 v104, v106
v_permlane16_swap_b32 v105, v107
v_pk_fma_f32 v[40:41], v[40:41], v[50:51], v[48:49]
v_pk_fma_f32 v[42:43], v[42:43], v[50:51], v[48:49]
v_pk_fma_f32 v[44:45], v[44:45], v[50:51], v[48:49]
v_pk_fma_f32 v[46:47], v[46:47], v[50:51], v[48:49]
v_pk_mul_f32 v[40:41], v[40:41], v[164:165]
v_pk_mul_f32 v[42:43], v[42:43], v[166:167]
v_pk_mul_f32 v[44:45], v[44:45], v[184:185]
v_pk_mul_f32 v[46:47], v[46:47], v[186:187]
v_exp_f32 v40, v40
v_exp_f32 v41, v41
v_exp_f32 v42, v42
v_exp_f32 v43, v43
v_exp_f32 v44, v44
v_exp_f32 v45, v45
v_exp_f32 v46, v46
v_exp_f32 v47, v47
buffer_load_dwordx4 v1, s[44:47], s54 offen offset:2048 sc1 lds
buffer_load_dwordx4 v1, s[44:47], s54 offen offset:3072 sc1 lds
v_pk_add_f32 v[40:41], v[40:41], v[52:53]
v_pk_add_f32 v[42:43], v[42:43], v[52:53]
v_pk_add_f32 v[44:45], v[44:45], v[52:53]
v_pk_add_f32 v[46:47], v[46:47], v[52:53]
v_rcp_f32 v40, v40
v_rcp_f32 v41, v41
v_rcp_f32 v42, v42
v_rcp_f32 v43, v43
v_rcp_f32 v44, v44
v_rcp_f32 v45, v45
v_rcp_f32 v46, v46
v_rcp_f32 v47, v47
v_pk_mul_f32 v[164:165], v[164:165], v[40:41]
v_pk_mul_f32 v[166:167], v[166:167], v[42:43]
v_pk_mul_f32 v[184:185], v[184:185], v[44:45]
v_pk_mul_f32 v[186:187], v[186:187], v[46:47]
v_pk_mul_f32 v[164:165], v[164:165], v[172:173]
v_pk_mul_f32 v[166:167], v[166:167], v[174:175]
v_pk_mul_f32 v[184:185], v[184:185], v[176:177]
v_pk_mul_f32 v[186:187], v[186:187], v[178:179]
v_cvt_pk_bf16_f32 v108, v164, v165
v_cvt_pk_bf16_f32 v109, v166, v167
v_cvt_pk_bf16_f32 v110, v184, v185
v_cvt_pk_bf16_f32 v111, v186, v187
s_add_u32 m0, m0, 4096
s_mov_b32 s54, 12288
buffer_load_dwordx4 v1, s[44:47], s54 offen offset:0 sc1 lds
buffer_load_dwordx4 v1, s[44:47], s54 offen offset:1024 sc1 lds
v_pk_mul_f32 v[40:41], v[192:193], v[192:193]
v_pk_mul_f32 v[42:43], v[194:195], v[194:195]
v_pk_mul_f32 v[44:45], v[204:205], v[204:205]
v_pk_mul_f32 v[46:47], v[206:207], v[206:207]
v_permlane16_swap_b32 v108, v110
v_permlane16_swap_b32 v109, v111
v_pk_fma_f32 v[40:41], v[40:41], v[50:51], v[48:49]
v_pk_fma_f32 v[42:43], v[42:43], v[50:51], v[48:49]
v_pk_fma_f32 v[44:45], v[44:45], v[50:51], v[48:49]
v_pk_fma_f32 v[46:47], v[46:47], v[50:51], v[48:49]
v_pk_mul_f32 v[40:41], v[40:41], v[192:193]
v_pk_mul_f32 v[42:43], v[42:43], v[194:195]
v_pk_mul_f32 v[44:45], v[44:45], v[204:205]
v_pk_mul_f32 v[46:47], v[46:47], v[206:207]
v_exp_f32 v40, v40
v_exp_f32 v41, v41
v_exp_f32 v42, v42
v_exp_f32 v43, v43
v_exp_f32 v44, v44
v_exp_f32 v45, v45
v_exp_f32 v46, v46
v_exp_f32 v47, v47
buffer_load_dwordx4 v1, s[44:47], s54 offen offset:2048 sc1 lds
buffer_load_dwordx4 v1, s[44:47], s54 offen offset:3072 sc1 lds
v_pk_add_f32 v[40:41], v[40:41], v[52:53]
v_pk_add_f32 v[42:43], v[42:43], v[52:53]
v_pk_add_f32 v[44:45], v[44:45], v[52:53]
v_pk_add_f32 v[46:47], v[46:47], v[52:53]
v_rcp_f32 v40, v40
v_rcp_f32 v41, v41
v_rcp_f32 v42, v42
v_rcp_f32 v43, v43
v_rcp_f32 v44, v44
v_rcp_f32 v45, v45
v_rcp_f32 v46, v46
v_rcp_f32 v47, v47
v_pk_mul_f32 v[192:193], v[192:193], v[40:41]
v_pk_mul_f32 v[194:195], v[194:195], v[42:43]
v_pk_mul_f32 v[204:205], v[204:205], v[44:45]
v_pk_mul_f32 v[206:207], v[206:207], v[46:47]
v_pk_mul_f32 v[192:193], v[192:193], v[196:197]
v_pk_mul_f32 v[194:195], v[194:195], v[198:199]
v_pk_mul_f32 v[204:205], v[204:205], v[200:201]
v_pk_mul_f32 v[206:207], v[206:207], v[202:203]
v_cvt_pk_bf16_f32 v112, v192, v193
v_cvt_pk_bf16_f32 v113, v194, v195
v_cvt_pk_bf16_f32 v114, v204, v205
v_cvt_pk_bf16_f32 v115, v206, v207
s_add_u32 s59, s21, 9216
buffer_store_dwordx4 v[104:107], v14, s[48:51], s59 offen sc1
s_waitcnt vmcnt(9)
s_barrier
ds_read_b128 a[0:3], v4 offset:0
ds_read_b128 a[4:7], v4 offset:1024
ds_read_b128 a[8:11], v4 offset:2048
ds_read_b128 a[12:15], v4 offset:3072
s_mov_b32 m0, s18
s_mov_b32 s54, 40960
buffer_load_dwordx4 v1, s[44:47], s54 offen offset:0 sc1 lds
buffer_load_dwordx4 v1, s[44:47], s54 offen offset:1024 sc1 lds
v_pk_mul_f32 v[40:41], v[208:209], v[208:209]
v_pk_mul_f32 v[42:43], v[210:211], v[210:211]
v_pk_mul_f32 v[44:45], v[220:221], v[220:221]
v_pk_mul_f32 v[46:47], v[222:223], v[222:223]
v_permlane16_swap_b32 v112, v114
v_permlane16_swap_b32 v113, v115
v_pk_fma_f32 v[40:41], v[40:41], v[50:51], v[48:49]
v_pk_fma_f32 v[42:43], v[42:43], v[50:51], v[48:49]
v_pk_fma_f32 v[44:45], v[44:45], v[50:51], v[48:49]
v_pk_fma_f32 v[46:47], v[46:47], v[50:51], v[48:49]
v_pk_mul_f32 v[40:41], v[40:41], v[208:209]
v_pk_mul_f32 v[42:43], v[42:43], v[210:211]
v_pk_mul_f32 v[44:45], v[44:45], v[220:221]
v_pk_mul_f32 v[46:47], v[46:47], v[222:223]
v_exp_f32 v40, v40
v_exp_f32 v41, v41
v_exp_f32 v42, v42
v_exp_f32 v43, v43
v_exp_f32 v44, v44
v_exp_f32 v45, v45
v_exp_f32 v46, v46
v_exp_f32 v47, v47
ds_read_b128 a[16:19], v4 offset:8192
ds_read_b128 a[20:23], v4 offset:9216
ds_read_b128 a[24:27], v4 offset:10240
ds_read_b128 a[28:31], v4 offset:11264
buffer_load_dwordx4 v1, s[44:47], s54 offen offset:2048 sc1 lds
buffer_load_dwordx4 v1, s[44:47], s54 offen offset:3072 sc1 lds
v_pk_add_f32 v[40:41], v[40:41], v[52:53]
v_pk_add_f32 v[42:43], v[42:43], v[52:53]
v_pk_add_f32 v[44:45], v[44:45], v[52:53]
v_pk_add_f32 v[46:47], v[46:47], v[52:53]
v_rcp_f32 v40, v40
v_rcp_f32 v41, v41
v_rcp_f32 v42, v42
v_rcp_f32 v43, v43
v_rcp_f32 v44, v44
v_rcp_f32 v45, v45
v_rcp_f32 v46, v46
v_rcp_f32 v47, v47
v_pk_mul_f32 v[208:209], v[208:209], v[40:41]
v_pk_mul_f32 v[210:211], v[210:211], v[42:43]
v_pk_mul_f32 v[220:221], v[220:221], v[44:45]
v_pk_mul_f32 v[222:223], v[222:223], v[46:47]
v_pk_mul_f32 v[208:209], v[208:209], v[212:213]
v_pk_mul_f32 v[210:211], v[210:211], v[214:215]
v_pk_mul_f32 v[220:221], v[220:221], v[216:217]
v_pk_mul_f32 v[222:223], v[222:223], v[218:219]
v_cvt_pk_bf16_f32 v116, v208, v209
v_cvt_pk_bf16_f32 v117, v210, v211
v_cvt_pk_bf16_f32 v118, v220, v221
v_cvt_pk_bf16_f32 v119, v222, v223
ds_read_b128 a[32:35], v4 offset:16384
ds_read_b128 a[36:39], v4 offset:17408
ds_read_b128 a[40:43], v4 offset:18432
ds_read_b128 a[44:47], v4 offset:19456
s_add_u32 m0, m0, 4096
s_mov_b32 s54, 45056
buffer_load_dwordx4 v1, s[44:47], s54 offen offset:0 sc1 lds
v_pk_mul_f32 v[40:41], v[140:141], v[140:141]
v_pk_mul_f32 v[42:43], v[142:143], v[142:143]
v_pk_mul_f32 v[44:45], v[156:157], v[156:157]
v_pk_mul_f32 v[46:47], v[158:159], v[158:159]
v_permlane16_swap_b32 v116, v118
v_permlane16_swap_b32 v117, v119
v_pk_fma_f32 v[40:41], v[40:41], v[50:51], v[48:49]
v_pk_fma_f32 v[42:43], v[42:43], v[50:51], v[48:49]
v_pk_fma_f32 v[44:45], v[44:45], v[50:51], v[48:49]
v_pk_fma_f32 v[46:47], v[46:47], v[50:51], v[48:49]
v_pk_mul_f32 v[40:41], v[40:41], v[140:141]
v_pk_mul_f32 v[42:43], v[42:43], v[142:143]
v_pk_mul_f32 v[44:45], v[44:45], v[156:157]
v_pk_mul_f32 v[46:47], v[46:47], v[158:159]
v_exp_f32 v40, v40
v_exp_f32 v41, v41
v_exp_f32 v42, v42
v_exp_f32 v43, v43
v_exp_f32 v44, v44
v_exp_f32 v45, v45
v_exp_f32 v46, v46
v_exp_f32 v47, v47
ds_read_b128 a[48:51], v4 offset:24576
ds_read_b128 a[52:55], v4 offset:25600
ds_read_b128 a[56:59], v4 offset:26624
ds_read_b128 a[60:63], v4 offset:27648
buffer_load_dwordx4 v1, s[44:47], s54 offen offset:1024 sc1 lds
v_pk_add_f32 v[40:41], v[40:41], v[52:53]
v_pk_add_f32 v[42:43], v[42:43], v[52:53]
v_pk_add_f32 v[44:45], v[44:45], v[52:53]
v_pk_add_f32 v[46:47], v[46:47], v[52:53]
v_rcp_f32 v40, v40
v_rcp_f32 v41, v41
v_rcp_f32 v42, v42
v_rcp_f32 v43, v43
v_rcp_f32 v44, v44
v_rcp_f32 v45, v45
v_rcp_f32 v46, v46
v_rcp_f32 v47, v47
v_pk_mul_f32 v[140:141], v[140:141], v[40:41]
v_pk_mul_f32 v[142:143], v[142:143], v[42:43]
v_pk_mul_f32 v[156:157], v[156:157], v[44:45]
v_pk_mul_f32 v[158:159], v[158:159], v[46:47]
v_pk_mul_f32 v[140:141], v[140:141], v[136:137]
v_pk_mul_f32 v[142:143], v[142:143], v[138:139]
v_pk_mul_f32 v[156:157], v[156:157], v[132:133]
v_pk_mul_f32 v[158:159], v[158:159], v[134:135]
v_cvt_pk_bf16_f32 v120, v140, v141
v_cvt_pk_bf16_f32 v121, v142, v143
v_cvt_pk_bf16_f32 v122, v156, v157
v_cvt_pk_bf16_f32 v123, v158, v159
s_add_u32 s59, s21, 386048
buffer_store_dwordx4 v[108:111], v14, s[48:51], s59 offen sc1
buffer_load_dwordx4 v1, s[44:47], s54 offen offset:2048 sc1 lds
v_pk_mul_f32 v[40:41], v[160:161], v[160:161]
v_pk_mul_f32 v[42:43], v[162:163], v[162:163]
v_pk_mul_f32 v[44:45], v[188:189], v[188:189]
v_pk_mul_f32 v[46:47], v[190:191], v[190:191]
v_permlane16_swap_b32 v120, v122
v_permlane16_swap_b32 v121, v123
v_pk_fma_f32 v[40:41], v[40:41], v[50:51], v[48:49]
v_pk_fma_f32 v[42:43], v[42:43], v[50:51], v[48:49]
v_pk_fma_f32 v[44:45], v[44:45], v[50:51], v[48:49]
v_pk_fma_f32 v[46:47], v[46:47], v[50:51], v[48:49]
v_pk_mul_f32 v[40:41], v[40:41], v[160:161]
v_pk_mul_f32 v[42:43], v[42:43], v[162:163]
v_pk_mul_f32 v[44:45], v[44:45], v[188:189]
v_pk_mul_f32 v[46:47], v[46:47], v[190:191]
s_waitcnt vmcnt(17) lgkmcnt(0)
v_mfma_f32_16x16x32_bf16 v[16:19], a[0:3], a[128:131], v[56:59]
v_exp_f32 v40, v40
v_mfma_f32_16x16x32_bf16 v[16:19], a[4:7], a[132:135], v[16:19]
v_exp_f32 v41, v41
v_mfma_f32_16x16x32_bf16 v[16:19], a[8:11], a[136:139], v[16:19]
v_exp_f32 v42, v42
v_mfma_f32_16x16x32_bf16 v[16:19], a[12:15], a[140:143], v[16:19]
v_exp_f32 v43, v43
v_mfma_f32_16x16x32_bf16 v[20:23], a[0:3], a[144:147], 0
v_exp_f32 v44, v44
v_mfma_f32_16x16x32_bf16 v[20:23], a[4:7], a[148:151], v[20:23]
v_exp_f32 v45, v45
v_mfma_f32_16x16x32_bf16 v[20:23], a[8:11], a[152:155], v[20:23]
v_exp_f32 v46, v46
v_mfma_f32_16x16x32_bf16 v[20:23], a[12:15], a[156:159], v[20:23]
v_exp_f32 v47, v47
buffer_load_dwordx4 v1, s[44:47], s54 offen offset:3072 sc1 lds
v_pk_add_f32 v[40:41], v[40:41], v[52:53]
v_pk_add_f32 v[42:43], v[42:43], v[52:53]
v_pk_add_f32 v[44:45], v[44:45], v[52:53]
v_pk_add_f32 v[46:47], v[46:47], v[52:53]
v_mfma_f32_16x16x32_bf16 v[24:27], a[0:3], a[160:163], 0
v_rcp_f32 v40, v40
v_mfma_f32_16x16x32_bf16 v[24:27], a[4:7], a[164:167], v[24:27]
v_rcp_f32 v41, v41
v_mfma_f32_16x16x32_bf16 v[24:27], a[8:11], a[168:171], v[24:27]
v_rcp_f32 v42, v42
v_mfma_f32_16x16x32_bf16 v[24:27], a[12:15], a[172:175], v[24:27]
v_rcp_f32 v43, v43
v_mfma_f32_16x16x32_bf16 v[28:31], a[0:3], a[176:179], 0
v_rcp_f32 v44, v44
v_mfma_f32_16x16x32_bf16 v[28:31], a[4:7], a[180:183], v[28:31]
v_rcp_f32 v45, v45
v_mfma_f32_16x16x32_bf16 v[28:31], a[8:11], a[184:187], v[28:31]
v_rcp_f32 v46, v46
v_mfma_f32_16x16x32_bf16 v[28:31], a[12:15], a[188:191], v[28:31]
v_rcp_f32 v47, v47
v_pk_mul_f32 v[160:161], v[160:161], v[40:41]
v_pk_mul_f32 v[162:163], v[162:163], v[42:43]
v_pk_mul_f32 v[188:189], v[188:189], v[44:45]
v_pk_mul_f32 v[190:191], v[190:191], v[46:47]
v_pk_mul_f32 v[160:161], v[160:161], v[168:169]
v_pk_mul_f32 v[162:163], v[162:163], v[170:171]
v_pk_mul_f32 v[188:189], v[188:189], v[180:181]
v_pk_mul_f32 v[190:191], v[190:191], v[182:183]
v_cvt_pk_bf16_f32 v124, v160, v161
v_cvt_pk_bf16_f32 v125, v162, v163
v_cvt_pk_bf16_f32 v126, v188, v189
v_cvt_pk_bf16_f32 v127, v190, v191
s_nop 0
v_permlane16_swap_b32 v124, v126
v_permlane16_swap_b32 v125, v127
s_branch L_ffn_done
L_ffn64:
L_t9:
s_cbranch_execz L_r2
v_mov_b32 v14, v15
s_waitcnt vmcnt(0)
v_cmp_ne_u32 vcc, s3, v7
s_cbranch_vccnz L_kv0_spin
L_kv0:
ds_read_b128 a[148:151], v6 offset:17408
ds_read_b128 a[152:155], v6 offset:18432
ds_read_b128 a[156:159], v6 offset:19456
ds_read_b128 a[160:163], v5 offset:0
s_lshl2_add_u32 s54, s33, s34
s_mov_b32 m0, s19
s_lshl_b32 s54, s54, 12
buffer_load_dwordx4 v15, s[44:47], s54 offen offset:0 sc1 lds
buffer_load_dwordx4 v15, s[44:47], s54 offen offset:1024 sc1 lds
v_pk_mul_f32 v[40:41], v[192:193], v[192:193]
v_pk_mul_f32 v[42:43], v[194:195], v[194:195]
v_pk_mul_f32 v[44:45], v[252:253], v[252:253]
v_pk_mul_f32 v[46:47], v[254:255], v[254:255]
v_pk_fma_f32 v[40:41], v[40:41], v[50:51], v[48:49]
v_pk_fma_f32 v[42:43], v[42:43], v[50:51], v[48:49]
v_pk_fma_f32 v[44:45], v[44:45], v[50:51], v[48:49]
v_pk_fma_f32 v[46:47], v[46:47], v[50:51], v[48:49]
v_pk_mul_f32 v[40:41], v[40:41], v[192:193]
v_pk_mul_f32 v[42:43], v[42:43], v[194:195]
v_pk_mul_f32 v[44:45], v[44:45], v[252:253]
v_pk_mul_f32 v[46:47], v[46:47], v[254:255]
v_exp_f32 v40, v40
v_exp_f32 v41, v41
v_exp_f32 v42, v42
v_exp_f32 v43, v43
v_exp_f32 v44, v44
v_exp_f32 v45, v45
v_exp_f32 v46, v46
v_exp_f32 v47, v47
ds_read_b128 a[164:167], v5 offset:1024
ds_read_b128 a[168:171], v5 offset:2048
ds_read_b128 a[172:175], v5 offset:3072
ds_read_b128 a[176:179], v5 offset:16384
buffer_load_dwordx4 v15, s[44:47], s54 offen offset:2048 sc1 lds
buffer_load_dwordx4 v15, s[44:47], s54 offen offset:3072 sc1 lds
v_pk_add_f32 v[40:41], v[40:41], v[52:53]
v_pk_add_f32 v[42:43], v[42:43], v[52:53]
v_pk_add_f32 v[44:45], v[44:45], v[52:53]
v_pk_add_f32 v[46:47], v[46:47], v[52:53]
v_rcp_f32 v40, v40
v_rcp_f32 v41, v41
v_rcp_f32 v42, v42
v_rcp_f32 v43, v43
v_rcp_f32 v44, v44
v_rcp_f32 v45, v45
v_rcp_f32 v46, v46
v_rcp_f32 v47, v47
v_pk_mul_f32 v[192:193], v[192:193], v[40:41]
v_pk_mul_f32 v[194:195], v[194:195], v[42:43]
v_pk_mul_f32 v[252:253], v[252:253], v[44:45]
v_pk_mul_f32 v[254:255], v[254:255], v[46:47]
v_pk_mul_f32 v[192:193], v[192:193], v[196:197]
v_pk_mul_f32 v[194:195], v[194:195], v[198:199]
v_pk_mul_f32 v[252:253], v[252:253], v[248:249]
v_pk_mul_f32 v[254:255], v[254:255], v[250:251]
v_cvt_pk_bf16_f32 v96, v192, v193
v_cvt_pk_bf16_f32 v97, v194, v195
v_cvt_pk_bf16_f32 v98, v252, v253
v_cvt_pk_bf16_f32 v99, v254, v255
ds_read_b128 a[180:183], v5 offset:17408
ds_read_b128 a[184:187], v5 offset:18432
ds_read_b128 a[188:191], v5 offset:19456
s_add_u32 m0, s52, s56
s_mov_b32 s54, 8192
buffer_load_dwordx4 v1, s[44:47], s54 offen offset:0 sc1 lds
buffer_load_dwordx4 v1, s[44:47], s54 offen offset:1024 sc1 lds
v_pk_mul_f32 v[40:41], v[204:205], v[204:205]
v_pk_mul_f32 v[42:43], v[206:207], v[206:207]
v_pk_mul_f32 v[44:45], v[240:241], v[240:241]
v_pk_mul_f32 v[46:47], v[242:243], v[242:243]
v_pk_fma_f32 v[40:41], v[40:41], v[50:51], v[48:49]
v_pk_fma_f32 v[42:43], v[42:43], v[50:51], v[48:49]
v_pk_fma_f32 v[44:45], v[44:45], v[50:51], v[48:49]
v_pk_fma_f32 v[46:47], v[46:47], v[50:51], v[48:49]
v_pk_mul_f32 v[40:41], v[40:41], v[204:205]
v_pk_mul_f32 v[42:43], v[42:43], v[206:207]
v_pk_mul_f32 v[44:45], v[44:45], v[240:241]
v_pk_mul_f32 v[46:47], v[46:47], v[242:243]
v_exp_f32 v40, v40
v_exp_f32 v41, v41
v_exp_f32 v42, v42
v_exp_f32 v43, v43
v_exp_f32 v44, v44
v_exp_f32 v45, v45
v_exp_f32 v46, v46
v_exp_f32 v47, v47
buffer_load_dwordx4 v1, s[44:47], s54 offen offset:2048 sc1 lds
buffer_load_dwordx4 v1, s[44:47], s54 offen offset:3072 sc1 lds
v_pk_add_f32 v[40:41], v[40:41], v[52:53]
v_pk_add_f32 v[42:43], v[42:43], v[52:53]
v_pk_add_f32 v[44:45], v[44:45], v[52:53]
v_pk_add_f32 v[46:47], v[46:47], v[52:53]
v_rcp_f32 v40, v40
v_rcp_f32 v41, v41
v_rcp_f32 v42, v42
v_rcp_f32 v43, v43
v_rcp_f32 v44, v44
v_rcp_f32 v45, v45
v_rcp_f32 v46, v46
v_rcp_f32 v47, v47
v_pk_mul_f32 v[204:205], v[204:205], v[40:41]
v_pk_mul_f32 v[206:207], v[206:207], v[42:43]
v_pk_mul_f32 v[240:241], v[240:241], v[44:45]
v_pk_mul_f32 v[242:243], v[242:243], v[46:47]
v_pk_mul_f32 v[204:205], v[204:205], v[200:201]
v_pk_mul_f32 v[206:207], v[206:207], v[202:203]
v_pk_mul_f32 v[240:241], v[240:241], v[244:245]
v_pk_mul_f32 v[242:243], v[242:243], v[246:247]
v_cvt_pk_bf16_f32 v100, v204, v205
v_cvt_pk_bf16_f32 v101, v206, v207
v_cvt_pk_bf16_f32 v102, v240, v241
v_cvt_pk_bf16_f32 v103, v242, v243
s_add_u32 m0, m0, 4096
s_mov_b32 s54, 12288
buffer_load_dwordx4 v1, s[44:47], s54 offen offset:0 sc1 lds
v_pk_mul_f32 v[40:41], v[208:209], v[208:209]
v_pk_mul_f32 v[42:43], v[210:211], v[210:211]
v_pk_mul_f32 v[44:45], v[236:237], v[236:237]
v_pk_mul_f32 v[46:47], v[238:239], v[238:239]
v_pk_fma_f32 v[40:41], v[40:41], v[50:51], v[48:49]
v_pk_fma_f32 v[42:43], v[42:43], v[50:51], v[48:49]
v_pk_fma_f32 v[44:45], v[44:45], v[50:51], v[48:49]
v_pk_fma_f32 v[46:47], v[46:47], v[50:51], v[48:49]
v_pk_mul_f32 v[40:41], v[40:41], v[208:209]
v_pk_mul_f32 v[42:43], v[42:43], v[210:211]
v_pk_mul_f32 v[44:45], v[44:45], v[236:237]
v_pk_mul_f32 v[46:47], v[46:47], v[238:239]
v_exp_f32 v40, v40
v_exp_f32 v41, v41
v_exp_f32 v42, v42
v_exp_f32 v43, v43
v_exp_f32 v44, v44
v_exp_f32 v45, v45
v_exp_f32 v46, v46
v_exp_f32 v47, v47
buffer_load_dwordx4 v1, s[44:47], s54 offen offset:1024 sc1 lds
v_pk_add_f32 v[40:41], v[40:41], v[52:53]
v_pk_add_f32 v[42:43], v[42:43], v[52:53]
v_pk_add_f32 v[44:45], v[44:45], v[52:53]
v_pk_add_f32 v[46:47], v[46:47], v[52:53]
v_rcp_f32 v40, v40
v_rcp_f32 v41, v41
v_rcp_f32 v42, v42
v_rcp_f32 v43, v43
v_rcp_f32 v44, v44
v_rcp_f32 v45, v45
v_rcp_f32 v46, v46
v_rcp_f32 v47, v47
v_pk_mul_f32 v[208:209], v[208:209], v[40:41]
v_pk_mul_f32 v[210:211], v[210:211], v[42:43]
v_pk_mul_f32 v[236:237], v[236:237], v[44:45]
v_pk_mul_f32 v[238:239], v[238:239], v[46:47]
v_pk_mul_f32 v[208:209], v[208:209], v[212:213]
v_pk_mul_f32 v[210:211], v[210:211], v[214:215]
v_pk_mul_f32 v[236:237], v[236:237], v[232:233]
v_pk_mul_f32 v[238:239], v[238:239], v[234:235]
v_cvt_pk_bf16_f32 v104, v208, v209
v_cvt_pk_bf16_f32 v105, v210, v211
v_cvt_pk_bf16_f32 v106, v236, v237
v_cvt_pk_bf16_f32 v107, v238, v239
s_add_u32 s59, s21, 0
buffer_store_dwordx4 v[96:99], v14, s[48:51], s59 offen sc1
buffer_load_dwordx4 v1, s[44:47], s54 offen offset:2048 sc1 lds
v_pk_mul_f32 v[40:41], v[220:221], v[220:221]
v_pk_mul_f32 v[42:43], v[222:223], v[222:223]
v_pk_mul_f32 v[44:45], v[224:225], v[224:225]
v_pk_mul_f32 v[46:47], v[226:227], v[226:227]
v_pk_fma_f32 v[40:41], v[40:41], v[50:51], v[48:49]
v_pk_fma_f32 v[42:43], v[42:43], v[50:51], v[48:49]
v_pk_fma_f32 v[44:45], v[44:45], v[50:51], v[48:49]
v_pk_fma_f32 v[46:47], v[46:47], v[50:51], v[48:49]
v_pk_mul_f32 v[40:41], v[40:41], v[220:221]
v_pk_mul_f32 v[42:43], v[42:43], v[222:223]
v_pk_mul_f32 v[44:45], v[44:45], v[224:225]
v_pk_mul_f32 v[46:47], v[46:47], v[226:227]
v_exp_f32 v40, v40
v_exp_f32 v41, v41
v_exp_f32 v42, v42
v_exp_f32 v43, v43
v_exp_f32 v44, v44
v_exp_f32 v45, v45
v_exp_f32 v46, v46
v_exp_f32 v47, v47
buffer_load_dwordx4 v1, s[44:47], s54 offen offset:3072 sc1 lds
v_pk_add_f32 v[40:41], v[40:41], v[52:53]
v_pk_add_f32 v[42:43], v[42:43], v[52:53]
v_pk_add_f32 v[44:45], v[44:45], v[52:53]
v_pk_add_f32 v[46:47], v[46:47], v[52:53]
v_rcp_f32 v40, v40
v_rcp_f32 v41, v41
v_rcp_f32 v42, v42
v_rcp_f32 v43, v43
v_rcp_f32 v44, v44
v_rcp_f32 v45, v45
v_rcp_f32 v46, v46
v_rcp_f32 v47, v47
v_pk_mul_f32 v[220:221], v[220:221], v[40:41]
v_pk_mul_f32 v[222:223], v[222:223], v[42:43]
v_pk_mul_f32 v[224:225], v[224:225], v[44:45]
v_pk_mul_f32 v[226:227], v[226:227], v[46:47]
v_pk_mul_f32 v[220:221], v[220:221], v[216:217]
v_pk_mul_f32 v[222:223], v[222:223], v[218:219]
v_pk_mul_f32 v[224:225], v[224:225], v[228:229]
v_pk_mul_f32 v[226:227], v[226:227], v[230:231]
v_cvt_pk_bf16_f32 v108, v220, v221
v_cvt_pk_bf16_f32 v109, v222, v223
v_cvt_pk_bf16_f32 v110, v224, v225
v_cvt_pk_bf16_f32 v111, v226, v227
s_mov_b32 m0, s18
s_mov_b32 s54, 40960
buffer_load_dwordx4 v1, s[44:47], s54 offen offset:0 sc1 lds
v_pk_mul_f32 v[40:41], v[140:141], v[140:141]
v_pk_mul_f32 v[42:43], v[142:143], v[142:143]
v_pk_mul_f32 v[44:45], v[148:149], v[148:149]
v_pk_mul_f32 v[46:47], v[150:151], v[150:151]
v_pk_fma_f32 v[40:41], v[40:41], v[50:51], v[48:49]
v_pk_fma_f32 v[42:43], v[42:43], v[50:51], v[48:49]
v_pk_fma_f32 v[44:45], v[44:45], v[50:51], v[48:49]
v_pk_fma_f32 v[46:47], v[46:47], v[50:51], v[48:49]
v_pk_mul_f32 v[40:41], v[40:41], v[140:141]
v_pk_mul_f32 v[42:43], v[42:43], v[142:143]
v_pk_mul_f32 v[44:45], v[44:45], v[148:149]
v_pk_mul_f32 v[46:47], v[46:47], v[150:151]
v_exp_f32 v40, v40
v_exp_f32 v41, v41
v_exp_f32 v42, v42
v_exp_f32 v43, v43
v_exp_f32 v44, v44
v_exp_f32 v45, v45
v_exp_f32 v46, v46
v_exp_f32 v47, v47
buffer_load_dwordx4 v1, s[44:47], s54 offen offset:1024 sc1 lds
v_pk_add_f32 v[40:41], v[40:41], v[52:53]
v_pk_add_f32 v[42:43], v[42:43], v[52:53]
v_pk_add_f32 v[44:45], v[44:45], v[52:53]
v_pk_add_f32 v[46:47], v[46:47], v[52:53]
v_rcp_f32 v40, v40
v_rcp_f32 v41, v41
v_rcp_f32 v42, v42
v_rcp_f32 v43, v43
v_rcp_f32 v44, v44
v_rcp_f32 v45, v45
v_rcp_f32 v46, v46
v_rcp_f32 v47, v47
v_pk_mul_f32 v[140:141], v[140:141], v[40:41]
v_pk_mul_f32 v[142:143], v[142:143], v[42:43]
v_pk_mul_f32 v[148:149], v[148:149], v[44:45]
v_pk_mul_f32 v[150:151], v[150:151], v[46:47]
v_pk_mul_f32 v[140:141], v[140:141], v[136:137]
v_pk_mul_f32 v[142:143], v[142:143], v[138:139]
v_pk_mul_f32 v[148:149], v[148:149], v[144:145]
v_pk_mul_f32 v[150:151], v[150:151], v[146:147]
v_cvt_pk_bf16_f32 v112, v140, v141
v_cvt_pk_bf16_f32 v113, v142, v143
v_cvt_pk_bf16_f32 v114, v148, v149
L_t10:
s_cbranch_execz L_r2
v_cvt_pk_bf16_f32 v115, v150, v151
s_add_u32 s59, s21, 188416
buffer_store_dwordx4 v[100:103], v14, s[48:51], s59 offen sc1
s_waitcnt vmcnt(12)
s_barrier
ds_read_b128 a[0:3], v4 offset:0
ds_read_b128 a[4:7], v4 offset:1024
ds_read_b128 a[8:11], v4 offset:2048
ds_read_b128 a[12:15], v4 offset:3072
buffer_load_dwordx4 v1, s[44:47], s54 offen offset:2048 sc1 lds
v_pk_mul_f32 v[40:41], v[156:157], v[156:157]
v_pk_mul_f32 v[42:43], v[158:159], v[158:159]
v_pk_mul_f32 v[44:45], v[152:153], v[152:153]
v_pk_mul_f32 v[46:47], v[154:155], v[154:155]
v_pk_fma_f32 v[40:41], v[40:41], v[50:51], v[48:49]
v_pk_fma_f32 v[42:43], v[42:43], v[50:51], v[48:49]
v_pk_fma_f32 v[44:45], v[44:45], v[50:51], v[48:49]
v_pk_fma_f32 v[46:47], v[46:47], v[50:51], v[48:49]
v_pk_mul_f32 v[40:41], v[40:41], v[156:157]
v_pk_mul_f32 v[42:43], v[42:43], v[158:159]
v_pk_mul_f32 v[44:45], v[44:45], v[152:153]
v_pk_mul_f32 v[46:47], v[46:47], v[154:155]
v_exp_f32 v40, v40
v_exp_f32 v41, v41
v_exp_f32 v42, v42
v_exp_f32 v43, v43
v_exp_f32 v44, v44
v_exp_f32 v45, v45
v_exp_f32 v46, v46
v_exp_f32 v47, v47
ds_read_b128 a[16:19], v4 offset:8192
ds_read_b128 a[20:23], v4 offset:9216
ds_read_b128 a[24:27], v4 offset:10240
ds_read_b128 a[28:31], v4 offset:11264
buffer_load_dwordx4 v1, s[44:47], s54 offen offset:3072 sc1 lds
v_pk_add_f32 v[40:41], v[40:41], v[52:53]
v_pk_add_f32 v[42:43], v[42:43], v[52:53]
v_pk_add_f32 v[44:45], v[44:45], v[52:53]
v_pk_add_f32 v[46:47], v[46:47], v[52:53]
v_rcp_f32 v40, v40
v_rcp_f32 v41, v41
v_rcp_f32 v42, v42
v_rcp_f32 v43, v43
v_rcp_f32 v44, v44
v_rcp_f32 v45, v45
v_rcp_f32 v46, v46
v_rcp_f32 v47, v47
v_pk_mul_f32 v[156:157], v[156:157], v[40:41]
v_pk_mul_f32 v[158:159], v[158:159], v[42:43]
v_pk_mul_f32 v[152:153], v[152:153], v[44:45]
v_pk_mul_f32 v[154:155], v[154:155], v[46:47]
v_pk_mul_f32 v[156:157], v[156:157], v[132:133]
v_pk_mul_f32 v[158:159], v[158:159], v[134:135]
v_pk_mul_f32 v[152:153], v[152:153], v[128:129]
v_pk_mul_f32 v[154:155], v[154:155], v[130:131]
v_cvt_pk_bf16_f32 v116, v156, v157
v_cvt_pk_bf16_f32 v117, v158, v159
v_cvt_pk_bf16_f32 v118, v152, v153
v_cvt_pk_bf16_f32 v119, v154, v155
ds_read_b128 a[32:35], v4 offset:16384
ds_read_b128 a[36:39], v4 offset:17408
ds_read_b128 a[40:43], v4 offset:18432
ds_read_b128 a[44:47], v4 offset:19456
s_add_u32 m0, m0, 4096
s_mov_b32 s54, 45056
buffer_load_dwordx4 v1, s[44:47], s54 offen offset:0 sc1 lds
v_pk_mul_f32 v[40:41], v[160:161], v[160:161]
v_pk_mul_f32 v[42:43], v[162:163], v[162:163]
v_pk_mul_f32 v[44:45], v[164:165], v[164:165]
v_pk_mul_f32 v[46:47], v[166:167], v[166:167]
v_pk_fma_f32 v[40:41], v[40:41], v[50:51], v[48:49]
v_pk_fma_f32 v[42:43], v[42:43], v[50:51], v[48:49]
v_pk_fma_f32 v[44:45], v[44:45], v[50:51], v[48:49]
v_pk_fma_f32 v[46:47], v[46:47], v[50:51], v[48:49]
v_pk_mul_f32 v[40:41], v[40:41], v[160:161]
v_pk_mul_f32 v[42:43], v[42:43], v[162:163]
v_pk_mul_f32 v[44:45], v[44:45], v[164:165]
v_pk_mul_f32 v[46:47], v[46:47], v[166:167]
v_exp_f32 v40, v40
v_exp_f32 v41, v41
v_exp_f32 v42, v42
v_exp_f32 v43, v43
v_exp_f32 v44, v44
v_exp_f32 v45, v45
v_exp_f32 v46, v46
v_exp_f32 v47, v47
ds_read_b128 a[48:51], v4 offset:24576
ds_read_b128 a[52:55], v4 offset:25600
ds_read_b128 a[56:59], v4 offset:26624
ds_read_b128 a[60:63], v4 offset:27648
buffer_load_dwordx4 v1, s[44:47], s54 offen offset:1024 sc1 lds
v_pk_add_f32 v[40:41], v[40:41], v[52:53]
v_pk_add_f32 v[42:43], v[42:43], v[52:53]
v_pk_add_f32 v[44:45], v[44:45], v[52:53]
v_pk_add_f32 v[46:47], v[46:47], v[52:53]
v_rcp_f32 v40, v40
v_rcp_f32 v41, v41
v_rcp_f32 v42, v42
v_rcp_f32 v43, v43
v_rcp_f32 v44, v44
v_rcp_f32 v45, v45
v_rcp_f32 v46, v46
v_rcp_f32 v47, v47
v_pk_mul_f32 v[160:161], v[160:161], v[40:41]
v_pk_mul_f32 v[162:163], v[162:163], v[42:43]
v_pk_mul_f32 v[164:165], v[164:165], v[44:45]
v_pk_mul_f32 v[166:167], v[166:167], v[46:47]
v_pk_mul_f32 v[160:161], v[160:161], v[168:169]
v_pk_mul_f32 v[162:163], v[162:163], v[170:171]
v_pk_mul_f32 v[164:165], v[164:165], v[172:173]
v_pk_mul_f32 v[166:167], v[166:167], v[174:175]
v_cvt_pk_bf16_f32 v120, v160, v161
v_cvt_pk_bf16_f32 v121, v162, v163
v_cvt_pk_bf16_f32 v122, v164, v165
v_cvt_pk_bf16_f32 v123, v166, v167
s_add_u32 s59, s21, 376832
buffer_store_dwordx4 v[104:107], v14, s[48:51], s59 offen sc1
buffer_load_dwordx4 v1, s[44:47], s54 offen offset:2048 sc1 lds
v_pk_mul_f32 v[40:41], v[188:189], v[188:189]
v_pk_mul_f32 v[42:43], v[190:191], v[190:191]
v_pk_mul_f32 v[44:45], v[184:185], v[184:185]
v_pk_mul_f32 v[46:47], v[186:187], v[186:187]
v_pk_fma_f32 v[40:41], v[40:41], v[50:51], v[48:49]
v_pk_fma_f32 v[42:43], v[42:43], v[50:51], v[48:49]
v_pk_fma_f32 v[44:45], v[44:45], v[50:51], v[48:49]
v_pk_fma_f32 v[46:47], v[46:47], v[50:51], v[48:49]
v_pk_mul_f32 v[40:41], v[40:41], v[188:189]
v_pk_mul_f32 v[42:43], v[42:43], v[190:191]
v_pk_mul_f32 v[44:45], v[44:45], v[184:185]
v_pk_mul_f32 v[46:47], v[46:47], v[186:187]
s_waitcnt vmcnt(18) lgkmcnt(0)
v_mfma_f32_16x16x32_bf16 v[16:19], a[0:3], a[128:131], v[56:59]
v_exp_f32 v40, v40
v_mfma_f32_16x16x32_bf16 v[16:19], a[4:7], a[132:135], v[16:19]
v_exp_f32 v41, v41
v_mfma_f32_16x16x32_bf16 v[16:19], a[8:11], a[136:139], v[16:19]
v_exp_f32 v42, v42
v_mfma_f32_16x16x32_bf16 v[16:19], a[12:15], a[140:143], v[16:19]
v_exp_f32 v43, v43
v_mfma_f32_16x16x32_bf16 v[20:23], a[0:3], a[144:147], 0
v_exp_f32 v44, v44
v_mfma_f32_16x16x32_bf16 v[20:23], a[4:7], a[148:151], v[20:23]
v_exp_f32 v45, v45
v_mfma_f32_16x16x32_bf16 v[20:23], a[8:11], a[152:155], v[20:23]
v_exp_f32 v46, v46
v_mfma_f32_16x16x32_bf16 v[20:23], a[12:15], a[156:159], v[20:23]
v_exp_f32 v47, v47
buffer_load_dwordx4 v1, s[44:47], s54 offen offset:3072 sc1 lds
v_pk_add_f32 v[40:41], v[40:41], v[52:53]
v_pk_add_f32 v[42:43], v[42:43], v[52:53]
v_pk_add_f32 v[44:45], v[44:45], v[52:53]
v_pk_add_f32 v[46:47], v[46:47], v[52:53]
v_mfma_f32_16x16x32_bf16 v[24:27], a[0:3], a[160:163], 0
v_rcp_f32 v40, v40
v_mfma_f32_16x16x32_bf16 v[24:27], a[4:7], a[164:167], v[24:27]
v_rcp_f32 v41, v41
v_mfma_f32_16x16x32_bf16 v[24:27], a[8:11], a[168:171], v[24:27]
v_rcp_f32 v42, v42
v_mfma_f32_16x16x32_bf16 v[24:27], a[12:15], a[172:175], v[24:27]
v_rcp_f32 v43, v43
v_mfma_f32_16x16x32_bf16 v[28:31], a[0:3], a[176:179], 0
v_rcp_f32 v44, v44
v_mfma_f32_16x16x32_bf16 v[28:31], a[4:7], a[180:183], v[28:31]
v_rcp_f32 v45, v45
v_mfma_f32_16x16x32_bf16 v[28:31], a[8:11], a[184:187], v[28:31]
v_rcp_f32 v46, v46
v_mfma_f32_16x16x32_bf16 v[28:31], a[12:15], a[188:191], v[28:31]
v_rcp_f32 v47, v47
v_pk_mul_f32 v[188:189], v[188:189], v[40:41]
v_pk_mul_f32 v[190:191], v[190:191], v[42:43]
v_pk_mul_f32 v[184:185], v[184:185], v[44:45]
v_pk_mul_f32 v[186:187], v[186:187], v[46:47]
v_pk_mul_f32 v[188:189], v[188:189], v[180:181]
v_pk_mul_f32 v[190:191], v[190:191], v[182:183]
v_pk_mul_f32 v[184:185], v[184:185], v[176:177]
v_pk_mul_f32 v[186:187], v[186:187], v[178:179]
v_cvt_pk_bf16_f32 v124, v188, v189
v_cvt_pk_bf16_f32 v125, v190, v191
v_cvt_pk_bf16_f32 v126, v184, v185
v_cvt_pk_bf16_f32 v127, v186, v187
s_add_u32 s59, s21, 565248
buffer_store_dwordx4 v[108:111], v14, s[48:51], s59 offen sc1
L_ffn_done:
L_t11:
s_cbranch_execz L_r2
v_max3_f32 v16, v16, v17, v18
v_max3_f32 v20, v20, v21, v22
v_max3_f32 v24, v24, v25, v26
v_max3_f32 v28, v28, v29, v30
v_max_f32 v16, v16, v19
v_max_f32 v20, v20, v23
v_max_f32 v24, v24, v27
v_max_f32 v28, v28, v31
v_mov_b32 v17, v16
v_mov_b32 v21, v20
v_mov_b32 v25, v24
v_mov_b32 v29, v28
v_permlane32_swap_b32 v16, v17
v_permlane32_swap_b32 v20, v21
v_permlane32_swap_b32 v24, v25
v_permlane32_swap_b32 v28, v29
v_max_f32 v16, v16, v17
v_max_f32 v20, v20, v21
v_max_f32 v24, v24, v25
v_max_f32 v28, v28, v29
v_mov_b32 v17, v16
v_mov_b32 v21, v20
v_mov_b32 v25, v24
v_mov_b32 v29, v28
v_permlane16_swap_b32 v16, v17
v_permlane16_swap_b32 v20, v21
v_permlane16_swap_b32 v24, v25
v_permlane16_swap_b32 v28, v29
v_max_f32 v16, v16, v17
v_max_f32 v20, v20, v21
v_max_f32 v24, v24, v25
v_max_f32 v28, v28, v29
v_sub_f32 v40, 0, v16
v_sub_f32 v41, 0, v16
v_sub_f32 v44, 0, v20
v_sub_f32 v45, 0, v20
v_sub_f32 v48, 0, v24
v_sub_f32 v49, 0, v24
v_sub_f32 v52, 0, v28
v_sub_f32 v53, 0, v28
v_mov_b64 v[42:43], v[40:41]
v_mov_b64 v[46:47], v[44:45]
v_mov_b64 v[50:51], v[48:49]
v_mov_b64 v[54:55], v[52:53]
s_add_u32 s35, s27, 8192
s_cmp_eq_u32 s32, 0
v_mov_b64 v[56:57], v[40:41]
v_mov_b64 v[58:59], v[40:41]
v_mov_b64 v[60:61], v[40:41]
v_mov_b64 v[62:63], v[40:41]
v_mov_b64 v[64:65], v[40:41]
v_mov_b64 v[66:67], v[40:41]
v_mov_b64 v[68:69], v[40:41]
v_mov_b64 v[70:71], v[40:41]
s_cbranch_scc0 L_first_go
v_cndmask_b32 v56, v3, v40, s[64:65]
v_cndmask_b32 v57, v3, v40, s[66:67]
v_cndmask_b32 v58, v3, v40, s[68:69]
v_cndmask_b32 v59, v3, v40, s[70:71]
v_cndmask_b32 v60, v3, v40, s[72:73]
v_cndmask_b32 v61, v3, v40, s[74:75]
v_cndmask_b32 v62, v3, v40, s[76:77]
v_cndmask_b32 v63, v3, v40, s[78:79]
v_cndmask_b32 v64, v3, v40, s[80:81]
v_cndmask_b32 v65, v3, v40, s[82:83]
v_cndmask_b32 v66, v3, v40, s[84:85]
v_cndmask_b32 v67, v3, v40, s[86:87]
v_cndmask_b32 v68, v3, v40, s[88:89]
v_cndmask_b32 v69, v3, v40, s[90:91]
v_cndmask_b32 v70, v3, v40, s[92:93]
v_cndmask_b32 v71, v3, v40, s[94:95]
L_first_go:
v_mov_b32 v7, s3
v_mov_b32 v8, s35
s_waitcnt vmcnt(8) lgkmcnt(0)
s_barrier
v_mfma_f32_16x16x32_bf16 v[16:19], a[0:3], a[128:131], v[56:59]
s_mov_b32 m0, s19
v_mov_b64 v[212:213], 0
v_mov_b64 v[214:215], 0
v_mfma_f32_16x16x32_bf16 v[16:19], a[4:7], a[132:135], v[16:19]
s_mov_b32 s54, 73728
v_mov_b64 v[216:217], 0
v_mov_b64 v[218:219], 0
v_mfma_f32_16x16x32_bf16 v[16:19], a[8:11], a[136:139], v[16:19]
buffer_load_dwordx4 v1, s[44:47], s54 offen offset:0 sc1 lds
v_mfma_f32_16x16x32_bf16 v[16:19], a[12:15], a[140:143], v[16:19]
s_add_u32 s52, s52, 32768
v_mov_b64 v[220:221], 0
v_mov_b64 v[222:223], 0
v_mfma_f32_16x16x32_bf16 v[20:23], a[28:31], a[140:143], v[60:63]
s_cmp_eq_u32 s52, 163840
v_mov_b64 v[224:225], 0
v_mov_b64 v[226:227], 0
v_mfma_f32_16x16x32_bf16 v[20:23], a[24:27], a[136:139], v[20:23]
s_cselect_b32 s52, 0, s52
v_mov_b64 v[228:229], 0
v_mov_b64 v[230:231], 0
v_mfma_f32_16x16x32_bf16 v[20:23], a[20:23], a[132:135], v[20:23]
buffer_load_dwordx4 v1, s[44:47], s54 offen offset:1024 sc1 lds
v_mfma_f32_16x16x32_bf16 v[20:23], a[16:19], a[128:131], v[20:23]
v_mov_b64 v[232:233], 0
v_mov_b64 v[234:235], 0
v_mfma_f32_16x16x32_bf16 v[24:27], a[32:35], a[128:131], v[64:67]
v_exp_f32 v16, v16
v_mfma_f32_16x16x32_bf16 v[24:27], a[36:39], a[132:135], v[24:27]
buffer_store_dwordx4 v[112:115], v14, s[48:51], s62 offen sc1
v_mfma_f32_16x16x32_bf16 v[24:27], a[40:43], a[136:139], v[24:27]
v_exp_f32 v17, v17
v_mfma_f32_16x16x32_bf16 v[24:27], a[44:47], a[140:143], v[24:27]
v_cvt_pk_bf16_f32 v32, v16, v17
v_mov_b64 v[236:237], 0
v_mfma_f32_16x16x32_bf16 v[28:31], a[60:63], a[140:143], v[68:71]
v_exp_f32 v18, v18
v_mfma_f32_16x16x32_bf16 v[28:31], a[56:59], a[136:139], v[28:31]
buffer_load_dwordx4 v1, s[44:47], s54 offen offset:2048 sc1 lds
v_mfma_f32_16x16x32_bf16 v[28:31], a[52:55], a[132:135], v[28:31]
v_exp_f32 v19, v19
v_mfma_f32_16x16x32_bf16 v[28:31], a[48:51], a[128:131], v[28:31]
v_cvt_pk_bf16_f32 v33, v18, v19
v_mov_b64 v[238:239], 0
v_exp_f32 v20, v20
v_exp_f32 v21, v21
v_mov_b64 v[208:209], 0
v_cvt_pk_bf16_f32 v34, v20, v21
v_exp_f32 v22, v22
v_exp_f32 v23, v23
v_mov_b64 v[210:211], 0
v_cvt_pk_bf16_f32 v35, v22, v23
v_mfma_f32_16x16x32_bf16 v[16:19], a[0:3], a[144:147], v[44:47]
v_exp_f32 v24, v24
v_mfma_f32_16x16x32_bf16 v[16:19], a[4:7], a[148:151], v[16:19]
ds_read_b128 a[64:67], v2 offset:0
ds_read_b128 a[96:99], v2 offset:8192
v_mfma_f32_16x16x32_bf16 v[16:19], a[8:11], a[152:155], v[16:19]
v_exp_f32 v25, v25
v_mfma_f32_16x16x32_bf16 v[16:19], a[12:15], a[156:159], v[16:19]
ds_read_b128 a[68:71], v2 offset:1024
v_cvt_pk_bf16_f32 v36, v24, v25
v_mfma_f32_16x16x32_bf16 v[20:23], a[28:31], a[156:159], v[44:47]
v_exp_f32 v26, v26
v_mfma_f32_16x16x32_bf16 v[20:23], a[24:27], a[152:155], v[20:23]
buffer_load_dwordx4 v1, s[44:47], s54 offen offset:3072 sc1 lds
v_mfma_f32_16x16x32_bf16 v[20:23], a[20:23], a[148:151], v[20:23]
v_exp_f32 v27, v27
v_mfma_f32_16x16x32_bf16 v[20:23], a[16:19], a[144:147], v[20:23]
ds_read_b128 a[100:103], v2 offset:9216
v_cvt_pk_bf16_f32 v37, v26, v27
v_exp_f32 v28, v28
ds_read_b128 a[72:75], v2 offset:2048
ds_read_b128 a[104:107], v2 offset:10240
v_exp_f32 v29, v29
s_add_u32 m0, m0, 4096
ds_read_b128 a[76:79], v2 offset:3072
v_cvt_pk_bf16_f32 v38, v28, v29
s_mov_b32 s54, 77824
v_exp_f32 v30, v30
buffer_load_dwordx4 v1, s[44:47], s54 offen offset:0 sc1 lds
v_exp_f32 v31, v31
ds_read_b128 a[108:111], v2 offset:11264
v_cvt_pk_bf16_f32 v39, v30, v31
v_mfma_f32_16x16x32_bf16 v[24:27], a[32:35], a[144:147], v[44:47]
v_exp_f32 v16, v16
v_mfma_f32_16x16x32_bf16 v[24:27], a[36:39], a[148:151], v[24:27]
ds_read_b128 a[80:83], v2 offset:4096
ds_read_b128 a[112:115], v2 offset:12288
v_mfma_f32_16x16x32_bf16 v[24:27], a[40:43], a[152:155], v[24:27]
v_exp_f32 v17, v17
v_mfma_f32_16x16x32_bf16 v[24:27], a[44:47], a[156:159], v[24:27]
ds_read_b128 a[84:87], v2 offset:5120
v_cvt_pk_bf16_f32 v92, v16, v17
v_mfma_f32_16x16x32_bf16 v[28:31], a[60:63], a[156:159], v[44:47]
v_exp_f32 v18, v18
v_mfma_f32_16x16x32_bf16 v[28:31], a[56:59], a[152:155], v[28:31]
buffer_load_dwordx4 v1, s[44:47], s54 offen offset:1024 sc1 lds
v_mfma_f32_16x16x32_bf16 v[28:31], a[52:55], a[148:151], v[28:31]
v_exp_f32 v19, v19
v_mfma_f32_16x16x32_bf16 v[28:31], a[48:51], a[144:147], v[28:31]
s_waitcnt lgkmcnt(3)
ds_read_b128 a[116:119], v2 offset:13312
v_cvt_pk_bf16_f32 v93, v18, v19
v_mfma_f32_16x16x32_bf16 v[72:75], v[88:91], v[32:35], 0
v_exp_f32 v20, v20
v_mfma_f32_16x16x32_bf16 v[128:131], a[64:67], v[32:35], 0
ds_read_b128 a[88:91], v2 offset:6144
ds_read_b128 a[120:123], v2 offset:14336
v_mfma_f32_16x16x32_bf16 v[128:131], a[96:99], v[36:39], v[128:131]
v_exp_f32 v21, v21
v_mfma_f32_16x16x32_bf16 v[132:135], a[100:103], v[36:39], 0
ds_read_b128 a[92:95], v2 offset:7168
v_cvt_pk_bf16_f32 v94, v20, v21
v_mfma_f32_16x16x32_bf16 v[132:135], a[68:71], v[32:35], v[132:135]
v_exp_f32 v22, v22
v_mfma_f32_16x16x32_bf16 v[136:139], a[72:75], v[32:35], 0
buffer_store_dwordx4 v[116:119], v14, s[48:51], s101 offen sc1
v_mfma_f32_16x16x32_bf16 v[136:139], a[104:107], v[36:39], v[136:139]
v_exp_f32 v23, v23
v_mfma_f32_16x16x32_bf16 v[140:143], a[108:111], v[36:39], 0
ds_read_b128 a[124:127], v2 offset:15360
v_cvt_pk_bf16_f32 v95, v22, v23
v_mfma_f32_16x16x32_bf16 v[140:143], a[76:79], v[32:35], v[140:143]
buffer_load_dwordx4 v1, s[44:47], s54 offen offset:2048 sc1 lds
v_mfma_f32_16x16x32_bf16 v[16:19], a[0:3], a[160:163], v[48:51]
v_exp_f32 v24, v24
v_mfma_f32_16x16x32_bf16 v[16:19], a[4:7], a[164:167], v[16:19]
buffer_load_dwordx4 v1, s[44:47], s54 offen offset:3072 sc1 lds
v_mfma_f32_16x16x32_bf16 v[16:19], a[8:11], a[168:171], v[16:19]
v_exp_f32 v25, v25
v_mfma_f32_16x16x32_bf16 v[16:19], a[12:15], a[172:175], v[16:19]
s_add_u32 m0, s53, s56
v_cvt_pk_bf16_f32 v108, v24, v25
v_mov_b64 v[240:241], 0
v_mfma_f32_16x16x32_bf16 v[20:23], a[28:31], a[172:175], v[48:51]
s_mov_b32 s54, 106496
v_exp_f32 v26, v26
v_mfma_f32_16x16x32_bf16 v[20:23], a[24:27], a[168:171], v[20:23]
buffer_load_dwordx4 v1, s[44:47], s54 offen offset:0 sc1 lds
v_mfma_f32_16x16x32_bf16 v[20:23], a[20:23], a[164:167], v[20:23]
v_exp_f32 v27, v27
v_mfma_f32_16x16x32_bf16 v[20:23], a[16:19], a[160:163], v[20:23]
s_waitcnt lgkmcnt(0)
v_cvt_pk_bf16_f32 v109, v26, v27
v_mov_b64 v[242:243], 0
v_mfma_f32_16x16x32_bf16 v[72:75], v[88:91], v[36:39], v[72:75]
v_exp_f32 v28, v28
v_mfma_f32_16x16x32_bf16 v[144:147], a[112:115], v[36:39], 0
buffer_load_dwordx4 v1, s[44:47], s54 offen offset:1024 sc1 lds
v_mfma_f32_16x16x32_bf16 v[144:147], a[80:83], v[32:35], v[144:147]
v_exp_f32 v29, v29
v_mfma_f32_16x16x32_bf16 v[148:151], a[84:87], v[32:35], 0
v_cvt_pk_bf16_f32 v110, v28, v29
v_mov_b64 v[244:245], 0
v_mfma_f32_16x16x32_bf16 v[148:151], a[116:119], v[36:39], v[148:151]
v_exp_f32 v30, v30
v_mfma_f32_16x16x32_bf16 v[152:155], a[120:123], v[36:39], 0
buffer_store_dwordx4 v[120:123], v14, s[48:51], s22 offen sc1
v_mfma_f32_16x16x32_bf16 v[152:155], a[88:91], v[32:35], v[152:155]
v_exp_f32 v31, v31
v_mfma_f32_16x16x32_bf16 v[156:159], a[92:95], v[32:35], 0
v_cvt_pk_bf16_f32 v111, v30, v31
v_mov_b64 v[246:247], 0
v_mfma_f32_16x16x32_bf16 v[156:159], a[124:127], v[36:39], v[156:159]
v_mov_b64 v[248:249], 0
v_mov_b64 v[250:251], 0
v_mfma_f32_16x16x32_bf16 v[24:27], a[32:35], a[160:163], v[48:51]
v_exp_f32 v16, v16
v_mfma_f32_16x16x32_bf16 v[24:27], a[36:39], a[164:167], v[24:27]
buffer_load_dwordx4 v1, s[44:47], s54 offen offset:2048 sc1 lds
v_mfma_f32_16x16x32_bf16 v[24:27], a[40:43], a[168:171], v[24:27]
v_exp_f32 v17, v17
v_mfma_f32_16x16x32_bf16 v[24:27], a[44:47], a[172:175], v[24:27]
v_cvt_pk_bf16_f32 v32, v16, v17
v_mov_b64 v[252:253], 0
v_mfma_f32_16x16x32_bf16 v[28:31], a[60:63], a[172:175], v[48:51]
v_exp_f32 v18, v18
v_mfma_f32_16x16x32_bf16 v[28:31], a[56:59], a[168:171], v[28:31]
buffer_load_dwordx4 v1, s[44:47], s54 offen offset:3072 sc1 lds
v_mfma_f32_16x16x32_bf16 v[28:31], a[52:55], a[164:167], v[28:31]
v_exp_f32 v19, v19
v_mfma_f32_16x16x32_bf16 v[28:31], a[48:51], a[160:163], v[28:31]
s_add_u32 m0, m0, 4096
v_cvt_pk_bf16_f32 v33, v18, v19
v_mov_b64 v[254:255], 0
v_mfma_f32_16x16x32_bf16 v[76:79], v[88:91], v[92:95], 0
s_mov_b32 s54, 110592
v_exp_f32 v20, v20
v_mfma_f32_16x16x32_bf16 v[160:163], a[64:67], v[92:95], 0
buffer_load_dwordx4 v1, s[44:47], s54 offen offset:0 sc1 lds
v_mfma_f32_16x16x32_bf16 v[160:163], a[96:99], v[108:111], v[160:163]
v_exp_f32 v21, v21
v_mfma_f32_16x16x32_bf16 v[164:167], a[100:103], v[108:111], 0
v_cvt_pk_bf16_f32 v34, v20, v21
v_mov_b64 v[84:85], 0
v_mfma_f32_16x16x32_bf16 v[164:167], a[68:71], v[92:95], v[164:167]
v_exp_f32 v22, v22
v_mfma_f32_16x16x32_bf16 v[168:171], a[72:75], v[92:95], 0
buffer_load_dwordx4 v1, s[44:47], s54 offen offset:1024 sc1 lds
v_mfma_f32_16x16x32_bf16 v[168:171], a[104:107], v[108:111], v[168:171]
v_exp_f32 v23, v23
v_mfma_f32_16x16x32_bf16 v[172:175], a[108:111], v[108:111], 0
v_cvt_pk_bf16_f32 v35, v22, v23
v_mov_b64 v[86:87], 0
v_mfma_f32_16x16x32_bf16 v[172:175], a[76:79], v[92:95], v[172:175]
v_mfma_f32_16x16x32_bf16 v[16:19], a[0:3], a[176:179], v[52:55]
v_exp_f32 v24, v24
v_mfma_f32_16x16x32_bf16 v[16:19], a[4:7], a[180:183], v[16:19]
ds_read_b128 a[0:3], v2 offset:16384
ds_read_b128 a[4:7], v2 offset:17408
v_mfma_f32_16x16x32_bf16 v[16:19], a[8:11], a[184:187], v[16:19]
v_exp_f32 v25, v25
v_mfma_f32_16x16x32_bf16 v[16:19], a[12:15], a[188:191], v[16:19]
ds_read_b128 a[8:11], v2 offset:18432
v_cvt_pk_bf16_f32 v36, v24, v25
v_mfma_f32_16x16x32_bf16 v[20:23], a[28:31], a[188:191], v[52:55]
v_exp_f32 v26, v26
v_mfma_f32_16x16x32_bf16 v[20:23], a[24:27], a[184:187], v[20:23]
buffer_store_dwordx4 v[124:127], v14, s[48:51], s23 offen sc1
v_mfma_f32_16x16x32_bf16 v[20:23], a[20:23], a[180:183], v[20:23]
s_add_u32 s53, s53, 32768
v_exp_f32 v27, v27
v_mfma_f32_16x16x32_bf16 v[20:23], a[16:19], a[176:179], v[20:23]
ds_read_b128 a[12:15], v2 offset:19456
v_cvt_pk_bf16_f32 v37, v26, v27
v_mfma_f32_16x16x32_bf16 v[76:79], v[88:91], v[108:111], v[76:79]
s_cmp_eq_u32 s53, 163840
v_exp_f32 v28, v28
v_mfma_f32_16x16x32_bf16 v[176:179], a[112:115], v[108:111], 0
ds_read_b128 a[28:31], v2 offset:23552
ds_read_b128 a[24:27], v2 offset:22528
v_mfma_f32_16x16x32_bf16 v[176:179], a[80:83], v[92:95], v[176:179]
s_cselect_b32 s53, 0, s53
v_exp_f32 v29, v29
v_mfma_f32_16x16x32_bf16 v[180:183], a[84:87], v[92:95], 0
s_mul_i32 s18, s32, 5
ds_read_b128 a[20:23], v2 offset:21504
v_cvt_pk_bf16_f32 v38, v28, v29
v_mfma_f32_16x16x32_bf16 v[180:183], a[116:119], v[108:111], v[180:183]
s_sub_u32 s18, s18, 10
v_exp_f32 v30, v30
v_mfma_f32_16x16x32_bf16 v[184:187], a[120:123], v[108:111], 0
buffer_load_dwordx4 v1, s[44:47], s54 offen offset:2048 sc1 lds
v_mfma_f32_16x16x32_bf16 v[184:187], a[88:91], v[92:95], v[184:187]
s_waitcnt vmcnt(19)
v_exp_f32 v31, v31
v_mfma_f32_16x16x32_bf16 v[188:191], a[92:95], v[92:95], 0
s_lshr_b32 s18, 0xdc00ec, s18
ds_read_b128 a[16:19], v2 offset:20480
v_cvt_pk_bf16_f32 v39, v30, v31
v_mfma_f32_16x16x32_bf16 v[188:191], a[124:127], v[108:111], v[188:191]
s_barrier
v_mfma_f32_16x16x32_bf16 v[24:27], a[32:35], a[176:179], v[52:55]
s_and_b32 s18, s18, 31
v_exp_f32 v16, v16
v_mfma_f32_16x16x32_bf16 v[24:27], a[36:39], a[180:183], v[24:27]
s_lshl_b32 s18, s18, 5
ds_read_b128 a[32:35], v2 offset:24576
ds_read_b128 a[36:39], v2 offset:25600
v_mfma_f32_16x16x32_bf16 v[24:27], a[40:43], a[184:187], v[24:27]
s_add_u32 s18, s18, s31
v_exp_f32 v17, v17
v_mfma_f32_16x16x32_bf16 v[24:27], a[44:47], a[188:191], v[24:27]
s_lshl2_add_u32 s18, s18, s30
ds_read_b128 a[40:43], v2 offset:26624
v_cvt_pk_bf16_f32 v92, v16, v17
v_mfma_f32_16x16x32_bf16 v[28:31], a[60:63], a[188:191], v[52:55]
s_lshl_b32 s18, s18, 10
v_exp_f32 v18, v18
v_mfma_f32_16x16x32_bf16 v[28:31], a[56:59], a[184:187], v[28:31]
buffer_load_dwordx4 v1, s[44:47], s54 offen offset:3072 sc1 lds
v_mfma_f32_16x16x32_bf16 v[28:31], a[52:55], a[180:183], v[28:31]
s_mov_b32 s54, 139264
v_exp_f32 v19, v19
v_mfma_f32_16x16x32_bf16 v[28:31], a[48:51], a[176:179], v[28:31]
s_cmp_ge_u32 s32, 5
s_cselect_b32 s20, s36, s40
s_cselect_b32 s21, s37, s41
s_cselect_b32 s22, s38, s42
ds_read_b128 a[44:47], v2 offset:27648
v_cvt_pk_bf16_f32 v93, v18, v19
v_mfma_f32_16x16x32_bf16 v[80:83], v[88:91], v[32:35], 0
s_cmp_ge_u32 s32, 2
s_cselect_b32 s22, s22, 0
v_exp_f32 v20, v20
v_mfma_f32_16x16x32_bf16 v[192:195], a[64:67], v[32:35], 0
s_mov_b32 s23, 0x20000
ds_read_b128 a[60:63], v2 offset:31744
ds_read_b128 a[56:59], v2 offset:30720
v_mfma_f32_16x16x32_bf16 v[192:195], a[96:99], v[36:39], v[192:195]
s_lshl_b32 s55, s32, 1
v_exp_f32 v21, v21
v_mfma_f32_16x16x32_bf16 v[196:199], a[100:103], v[36:39], 0
ds_read_b128 a[52:55], v2 offset:29696
v_cvt_pk_bf16_f32 v94, v20, v21
v_mfma_f32_16x16x32_bf16 v[196:199], a[68:71], v[32:35], v[196:199]
s_waitcnt lgkmcnt(7)
v_exp_f32 v22, v22
v_mfma_f32_16x16x32_bf16 v[200:203], a[72:75], v[32:35], 0
v_mfma_f32_16x16x32_bf16 v[200:203], a[104:107], v[36:39], v[200:203]
s_sub_u32 s55, s55, 1
v_exp_f32 v23, v23
v_mfma_f32_16x16x32_bf16 v[204:207], a[108:111], v[36:39], 0
ds_read_b128 a[48:51], v2 offset:28672
v_cvt_pk_bf16_f32 v95, v22, v23
v_mfma_f32_16x16x32_bf16 v[204:207], a[76:79], v[32:35], v[204:207]
s_cbranch_scc0 L_dual
v_cndmask_b32 v56, v3, v44, s[64:65]
v_cndmask_b32 v57, v3, v44, s[66:67]
v_cndmask_b32 v58, v3, v44, s[68:69]
v_cndmask_b32 v59, v3, v44, s[70:71]
v_cndmask_b32 v60, v3, v44, s[72:73]
v_cndmask_b32 v61, v3, v44, s[74:75]
v_cndmask_b32 v62, v3, v44, s[76:77]
v_cndmask_b32 v63, v3, v44, s[78:79]
v_cndmask_b32 v64, v3, v44, s[80:81]
v_cndmask_b32 v65, v3, v44, s[82:83]
v_cndmask_b32 v66, v3, v44, s[84:85]
v_cndmask_b32 v67, v3, v44, s[86:87]
v_cndmask_b32 v68, v3, v44, s[88:89]
v_cndmask_b32 v69, v3, v44, s[90:91]
v_cndmask_b32 v70, v3, v44, s[92:93]
v_cndmask_b32 v71, v3, v44, s[94:95]
s_branch L_diag_lo2
.p2align 3
L_dual:
v_mfma_f32_16x16x32_bf16 v[16:19], a[0:3], a[128:131], v[40:43]
v_exp_f32 v24, v24
v_mfma_f32_16x16x32_bf16 v[16:19], a[4:7], a[132:135], v[16:19]
v_mfma_f32_16x16x32_bf16 v[16:19], a[8:11], a[136:139], v[16:19]
v_exp_f32 v25, v25
v_mfma_f32_16x16x32_bf16 v[16:19], a[12:15], a[140:143], v[16:19]
v_cvt_pk_bf16_f32 v108, v24, v25
v_add_u32 v2, s52, v15
v_mfma_f32_16x16x32_bf16 v[20:23], a[28:31], a[140:143], v[40:43]
s_add_u32 m0, s53, s56
v_exp_f32 v26, v26
v_mfma_f32_16x16x32_bf16 v[20:23], a[24:27], a[136:139], v[20:23]
buffer_load_dwordx4 v1, s[44:47], s54 offen offset:0 sc1 lds
v_mfma_f32_16x16x32_bf16 v[20:23], a[20:23], a[132:135], v[20:23]
v_exp_f32 v27, v27
v_mfma_f32_16x16x32_bf16 v[20:23], a[16:19], a[128:131], v[20:23]
s_waitcnt lgkmcnt(0)
v_cvt_pk_bf16_f32 v109, v26, v27
v_mfma_f32_16x16x32_bf16 v[80:83], v[88:91], v[36:39], v[80:83]
s_add_u32 s52, s52, 32768
v_exp_f32 v28, v28
v_mfma_f32_16x16x32_bf16 v[208:211], a[112:115], v[36:39], v[208:211]
v_mfma_f32_16x16x32_bf16 v[208:211], a[80:83], v[32:35], v[208:211]
s_cmp_eq_u32 s52, 163840
v_exp_f32 v29, v29
v_mfma_f32_16x16x32_bf16 v[212:215], a[84:87], v[32:35], v[212:215]
v_cvt_pk_bf16_f32 v110, v28, v29
v_mfma_f32_16x16x32_bf16 v[212:215], a[116:119], v[36:39], v[212:215]
s_cselect_b32 s52, 0, s52
v_exp_f32 v30, v30
v_mfma_f32_16x16x32_bf16 v[216:219], a[120:123], v[36:39], v[216:219]
v_mfma_f32_16x16x32_bf16 v[216:219], a[88:91], v[32:35], v[216:219]
v_exp_f32 v31, v31
v_mfma_f32_16x16x32_bf16 v[220:223], a[92:95], v[32:35], v[220:223]
s_cmp_eq_u32 s54, s57
v_cvt_pk_bf16_f32 v111, v30, v31
v_mfma_f32_16x16x32_bf16 v[220:223], a[124:127], v[36:39], v[220:223]
L_t12:
s_cbranch_execz L_r2
s_cbranch_scc1 L_sh0_do
L_sh0:
v_mfma_f32_16x16x32_bf16 v[24:27], a[32:35], a[128:131], v[40:43]
s_add_u32 s53, s53, 32768
v_exp_f32 v16, v16
v_mfma_f32_16x16x32_bf16 v[24:27], a[36:39], a[132:135], v[24:27]
v_mfma_f32_16x16x32_bf16 v[24:27], a[40:43], a[136:139], v[24:27]
s_cmp_eq_u32 s53, 163840
v_exp_f32 v17, v17
v_mfma_f32_16x16x32_bf16 v[24:27], a[44:47], a[140:143], v[24:27]
v_cvt_pk_bf16_f32 v32, v16, v17
v_mfma_f32_16x16x32_bf16 v[28:31], a[60:63], a[140:143], v[40:43]
s_cselect_b32 s53, 0, s53
v_exp_f32 v18, v18
v_mfma_f32_16x16x32_bf16 v[28:31], a[56:59], a[136:139], v[28:31]
buffer_load_dwordx4 v1, s[44:47], s54 offen offset:1024 sc1 lds
v_mfma_f32_16x16x32_bf16 v[28:31], a[52:55], a[132:135], v[28:31]
v_exp_f32 v19, v19
v_mfma_f32_16x16x32_bf16 v[28:31], a[48:51], a[128:131], v[28:31]
v_cvt_pk_bf16_f32 v33, v18, v19
v_mfma_f32_16x16x32_bf16 v[84:87], v[88:91], v[92:95], v[84:87]
v_exp_f32 v20, v20
v_mfma_f32_16x16x32_bf16 v[224:227], a[64:67], v[92:95], v[224:227]
v_mfma_f32_16x16x32_bf16 v[224:227], a[96:99], v[108:111], v[224:227]
v_exp_f32 v21, v21
v_mfma_f32_16x16x32_bf16 v[228:231], a[100:103], v[108:111], v[228:231]
v_cvt_pk_bf16_f32 v34, v20, v21
v_mfma_f32_16x16x32_bf16 v[228:231], a[68:71], v[92:95], v[228:231]
v_exp_f32 v22, v22
v_mfma_f32_16x16x32_bf16 v[232:235], a[72:75], v[92:95], v[232:235]
buffer_load_dword v5, v15, s[20:23], s18 offen
v_mfma_f32_16x16x32_bf16 v[232:235], a[104:107], v[108:111], v[232:235]
s_add_u32 s18, s18, 0x20000
v_exp_f32 v23, v23
v_mfma_f32_16x16x32_bf16 v[236:239], a[108:111], v[108:111], v[236:239]
v_cvt_pk_bf16_f32 v35, v22, v23
v_mfma_f32_16x16x32_bf16 v[236:239], a[76:79], v[92:95], v[236:239]
v_mfma_f32_16x16x32_bf16 v[16:19], a[0:3], a[144:147], v[44:47]
v_exp_f32 v24, v24
v_mfma_f32_16x16x32_bf16 v[16:19], a[4:7], a[148:151], v[16:19]
ds_read_b128 a[64:67], v2 offset:0
ds_read_b128 a[96:99], v2 offset:8192
v_mfma_f32_16x16x32_bf16 v[16:19], a[8:11], a[152:155], v[16:19]
v_exp_f32 v25, v25
v_mfma_f32_16x16x32_bf16 v[16:19], a[12:15], a[156:159], v[16:19]
ds_read_b128 a[68:71], v2 offset:1024
v_cvt_pk_bf16_f32 v36, v24, v25
v_mfma_f32_16x16x32_bf16 v[20:23], a[28:31], a[156:159], v[44:47]
v_exp_f32 v26, v26
v_mfma_f32_16x16x32_bf16 v[20:23], a[24:27], a[152:155], v[20:23]
buffer_load_dwordx4 v1, s[44:47], s54 offen offset:2048 sc1 lds
v_mfma_f32_16x16x32_bf16 v[20:23], a[20:23], a[148:151], v[20:23]
v_exp_f32 v27, v27
v_mfma_f32_16x16x32_bf16 v[20:23], a[16:19], a[144:147], v[20:23]
ds_read_b128 a[100:103], v2 offset:9216
v_cvt_pk_bf16_f32 v37, v26, v27
v_mfma_f32_16x16x32_bf16 v[84:87], v[88:91], v[108:111], v[84:87]
v_exp_f32 v28, v28
v_mfma_f32_16x16x32_bf16 v[240:243], a[112:115], v[108:111], v[240:243]
ds_read_b128 a[72:75], v2 offset:2048
ds_read_b128 a[104:107], v2 offset:10240
v_mfma_f32_16x16x32_bf16 v[240:243], a[80:83], v[92:95], v[240:243]
v_exp_f32 v29, v29
v_mfma_f32_16x16x32_bf16 v[244:247], a[84:87], v[92:95], v[244:247]
ds_read_b128 a[76:79], v2 offset:3072
v_cvt_pk_bf16_f32 v38, v28, v29
v_mfma_f32_16x16x32_bf16 v[244:247], a[116:119], v[108:111], v[244:247]
v_exp_f32 v30, v30
v_mfma_f32_16x16x32_bf16 v[248:251], a[120:123], v[108:111], v[248:251]
v_mfma_f32_16x16x32_bf16 v[248:251], a[88:91], v[92:95], v[248:251]
v_exp_f32 v31, v31
v_mfma_f32_16x16x32_bf16 v[252:255], a[92:95], v[92:95], v[252:255]
ds_read_b128 a[108:111], v2 offset:11264
v_cvt_pk_bf16_f32 v39, v30, v31
v_mfma_f32_16x16x32_bf16 v[252:255], a[124:127], v[108:111], v[252:255]
v_mfma_f32_16x16x32_bf16 v[24:27], a[32:35], a[144:147], v[44:47]
v_exp_f32 v16, v16
v_mfma_f32_16x16x32_bf16 v[24:27], a[36:39], a[148:151], v[24:27]
ds_read_b128 a[80:83], v2 offset:4096
ds_read_b128 a[112:115], v2 offset:12288
v_mfma_f32_16x16x32_bf16 v[24:27], a[40:43], a[152:155], v[24:27]
v_exp_f32 v17, v17
v_mfma_f32_16x16x32_bf16 v[24:27], a[44:47], a[156:159], v[24:27]
ds_read_b128 a[84:87], v2 offset:5120
v_cvt_pk_bf16_f32 v92, v16, v17
v_mfma_f32_16x16x32_bf16 v[28:31], a[60:63], a[156:159], v[44:47]
v_exp_f32 v18, v18
v_mfma_f32_16x16x32_bf16 v[28:31], a[56:59], a[152:155], v[28:31]
buffer_load_dwordx4 v1, s[44:47], s54 offen offset:3072 sc1 lds
v_mfma_f32_16x16x32_bf16 v[28:31], a[52:55], a[148:151], v[28:31]
s_add_u32 m0, m0, 4096
v_exp_f32 v19, v19
v_mfma_f32_16x16x32_bf16 v[28:31], a[48:51], a[144:147], v[28:31]
s_waitcnt lgkmcnt(3)
ds_read_b128 a[116:119], v2 offset:13312
v_cvt_pk_bf16_f32 v93, v18, v19
v_mfma_f32_16x16x32_bf16 v[72:75], v[88:91], v[32:35], v[72:75]
s_add_u32 s54, s54, 4096
v_exp_f32 v20, v20
v_mfma_f32_16x16x32_bf16 v[128:131], a[64:67], v[32:35], v[128:131]
ds_read_b128 a[88:91], v2 offset:6144
ds_read_b128 a[120:123], v2 offset:14336
v_mfma_f32_16x16x32_bf16 v[128:131], a[96:99], v[36:39], v[128:131]
v_exp_f32 v21, v21
v_mfma_f32_16x16x32_bf16 v[132:135], a[100:103], v[36:39], v[132:135]
ds_read_b128 a[92:95], v2 offset:7168
v_cvt_pk_bf16_f32 v94, v20, v21
v_mfma_f32_16x16x32_bf16 v[132:135], a[68:71], v[32:35], v[132:135]
v_exp_f32 v22, v22
v_mfma_f32_16x16x32_bf16 v[136:139], a[72:75], v[32:35], v[136:139]
v_mfma_f32_16x16x32_bf16 v[136:139], a[104:107], v[36:39], v[136:139]
v_exp_f32 v23, v23
v_mfma_f32_16x16x32_bf16 v[140:143], a[108:111], v[36:39], v[140:143]
ds_read_b128 a[124:127], v2 offset:15360
v_cvt_pk_bf16_f32 v95, v22, v23
v_mfma_f32_16x16x32_bf16 v[140:143], a[76:79], v[32:35], v[140:143]
v_mfma_f32_16x16x32_bf16 v[16:19], a[0:3], a[160:163], v[48:51]
v_exp_f32 v24, v24
v_mfma_f32_16x16x32_bf16 v[16:19], a[4:7], a[164:167], v[16:19]
v_mfma_f32_16x16x32_bf16 v[16:19], a[8:11], a[168:171], v[16:19]
v_exp_f32 v25, v25
v_mfma_f32_16x16x32_bf16 v[16:19], a[12:15], a[172:175], v[16:19]
v_cvt_pk_bf16_f32 v108, v24, v25
v_mfma_f32_16x16x32_bf16 v[20:23], a[28:31], a[172:175], v[48:51]
v_exp_f32 v26, v26
v_mfma_f32_16x16x32_bf16 v[20:23], a[24:27], a[168:171], v[20:23]
buffer_load_dwordx4 v1, s[44:47], s54 offen offset:0 sc1 lds
v_mfma_f32_16x16x32_bf16 v[20:23], a[20:23], a[164:167], v[20:23]
v_exp_f32 v27, v27
v_mfma_f32_16x16x32_bf16 v[20:23], a[16:19], a[160:163], v[20:23]
s_waitcnt lgkmcnt(0)
v_cvt_pk_bf16_f32 v109, v26, v27
v_mfma_f32_16x16x32_bf16 v[72:75], v[88:91], v[36:39], v[72:75]
v_exp_f32 v28, v28
v_mfma_f32_16x16x32_bf16 v[144:147], a[112:115], v[36:39], v[144:147]
v_mfma_f32_16x16x32_bf16 v[144:147], a[80:83], v[32:35], v[144:147]
v_exp_f32 v29, v29
v_mfma_f32_16x16x32_bf16 v[148:151], a[84:87], v[32:35], v[148:151]
v_cvt_pk_bf16_f32 v110, v28, v29
v_mfma_f32_16x16x32_bf16 v[148:151], a[116:119], v[36:39], v[148:151]
v_exp_f32 v30, v30
v_mfma_f32_16x16x32_bf16 v[152:155], a[120:123], v[36:39], v[152:155]
v_mfma_f32_16x16x32_bf16 v[152:155], a[88:91], v[32:35], v[152:155]
v_exp_f32 v31, v31
v_mfma_f32_16x16x32_bf16 v[156:159], a[92:95], v[32:35], v[156:159]
v_cvt_pk_bf16_f32 v111, v30, v31
v_mfma_f32_16x16x32_bf16 v[156:159], a[124:127], v[36:39], v[156:159]
v_mfma_f32_16x16x32_bf16 v[24:27], a[32:35], a[160:163], v[48:51]
v_exp_f32 v16, v16
v_mfma_f32_16x16x32_bf16 v[24:27], a[36:39], a[164:167], v[24:27]
v_mfma_f32_16x16x32_bf16 v[24:27], a[40:43], a[168:171], v[24:27]
v_exp_f32 v17, v17
v_mfma_f32_16x16x32_bf16 v[24:27], a[44:47], a[172:175], v[24:27]
v_cvt_pk_bf16_f32 v32, v16, v17
v_mfma_f32_16x16x32_bf16 v[28:31], a[60:63], a[172:175], v[48:51]
v_exp_f32 v18, v18
v_mfma_f32_16x16x32_bf16 v[28:31], a[56:59], a[168:171], v[28:31]
buffer_load_dwordx4 v1, s[44:47], s54 offen offset:1024 sc1 lds
v_mfma_f32_16x16x32_bf16 v[28:31], a[52:55], a[164:167], v[28:31]
v_exp_f32 v19, v19
v_mfma_f32_16x16x32_bf16 v[28:31], a[48:51], a[160:163], v[28:31]
v_cvt_pk_bf16_f32 v33, v18, v19
v_mfma_f32_16x16x32_bf16 v[76:79], v[88:91], v[92:95], v[76:79]
v_exp_f32 v20, v20
v_mfma_f32_16x16x32_bf16 v[160:163], a[64:67], v[92:95], v[160:163]
v_mfma_f32_16x16x32_bf16 v[160:163], a[96:99], v[108:111], v[160:163]
v_exp_f32 v21, v21
v_mfma_f32_16x16x32_bf16 v[164:167], a[100:103], v[108:111], v[164:167]
v_cvt_pk_bf16_f32 v34, v20, v21
v_mfma_f32_16x16x32_bf16 v[164:167], a[68:71], v[92:95], v[164:167]
v_exp_f32 v22, v22
v_mfma_f32_16x16x32_bf16 v[168:171], a[72:75], v[92:95], v[168:171]
v_mfma_f32_16x16x32_bf16 v[168:171], a[104:107], v[108:111], v[168:171]
v_exp_f32 v23, v23
v_mfma_f32_16x16x32_bf16 v[172:175], a[108:111], v[108:111], v[172:175]
v_cvt_pk_bf16_f32 v35, v22, v23
v_mfma_f32_16x16x32_bf16 v[172:175], a[76:79], v[92:95], v[172:175]
v_mfma_f32_16x16x32_bf16 v[16:19], a[0:3], a[176:179], v[52:55]
v_exp_f32 v24, v24
v_mfma_f32_16x16x32_bf16 v[16:19], a[4:7], a[180:183], v[16:19]
ds_read_b128 a[0:3], v2 offset:16384
ds_read_b128 a[4:7], v2 offset:17408
v_mfma_f32_16x16x32_bf16 v[16:19], a[8:11], a[184:187], v[16:19]
v_exp_f32 v25, v25
v_mfma_f32_16x16x32_bf16 v[16:19], a[12:15], a[188:191], v[16:19]
ds_read_b128 a[8:11], v2 offset:18432
v_cvt_pk_bf16_f32 v36, v24, v25
v_mfma_f32_16x16x32_bf16 v[20:23], a[28:31], a[188:191], v[52:55]
v_exp_f32 v26, v26
v_mfma_f32_16x16x32_bf16 v[20:23], a[24:27], a[184:187], v[20:23]
buffer_load_dwordx4 v1, s[44:47], s54 offen offset:2048 sc1 lds
v_mfma_f32_16x16x32_bf16 v[20:23], a[20:23], a[180:183], v[20:23]
v_exp_f32 v27, v27
v_mfma_f32_16x16x32_bf16 v[20:23], a[16:19], a[176:179], v[20:23]
ds_read_b128 a[12:15], v2 offset:19456
v_cvt_pk_bf16_f32 v37, v26, v27
v_mfma_f32_16x16x32_bf16 v[76:79], v[88:91], v[108:111], v[76:79]
v_exp_f32 v28, v28
v_mfma_f32_16x16x32_bf16 v[176:179], a[112:115], v[108:111], v[176:179]
ds_read_b128 a[28:31], v2 offset:23552
ds_read_b128 a[24:27], v2 offset:22528
v_mfma_f32_16x16x32_bf16 v[176:179], a[80:83], v[92:95], v[176:179]
v_exp_f32 v29, v29
v_mfma_f32_16x16x32_bf16 v[180:183], a[84:87], v[92:95], v[180:183]
ds_read_b128 a[20:23], v2 offset:21504
v_cvt_pk_bf16_f32 v38, v28, v29
v_mfma_f32_16x16x32_bf16 v[180:183], a[116:119], v[108:111], v[180:183]
v_exp_f32 v30, v30
v_mfma_f32_16x16x32_bf16 v[184:187], a[120:123], v[108:111], v[184:187]
v_mfma_f32_16x16x32_bf16 v[184:187], a[88:91], v[92:95], v[184:187]
s_waitcnt vmcnt(16)
v_exp_f32 v31, v31
v_mfma_f32_16x16x32_bf16 v[188:191], a[92:95], v[92:95], v[188:191]
ds_read_b128 a[16:19], v2 offset:20480
v_cvt_pk_bf16_f32 v39, v30, v31
v_mfma_f32_16x16x32_bf16 v[188:191], a[124:127], v[108:111], v[188:191]
s_barrier
v_mfma_f32_16x16x32_bf16 v[24:27], a[32:35], a[176:179], v[52:55]
v_exp_f32 v16, v16
v_mfma_f32_16x16x32_bf16 v[24:27], a[36:39], a[180:183], v[24:27]
ds_read_b128 a[32:35], v2 offset:24576
ds_read_b128 a[36:39], v2 offset:25600
v_mfma_f32_16x16x32_bf16 v[24:27], a[40:43], a[184:187], v[24:27]
v_exp_f32 v17, v17
v_mfma_f32_16x16x32_bf16 v[24:27], a[44:47], a[188:191], v[24:27]
ds_read_b128 a[40:43], v2 offset:26624
v_cvt_pk_bf16_f32 v92, v16, v17
v_mfma_f32_16x16x32_bf16 v[28:31], a[60:63], a[188:191], v[52:55]
v_exp_f32 v18, v18
v_mfma_f32_16x16x32_bf16 v[28:31], a[56:59], a[184:187], v[28:31]
buffer_load_dwordx4 v1, s[44:47], s54 offen offset:3072 sc1 lds
v_mfma_f32_16x16x32_bf16 v[28:31], a[52:55], a[180:183], v[28:31]
s_add_u32 s54, s54, 28672
v_exp_f32 v19, v19
v_mfma_f32_16x16x32_bf16 v[28:31], a[48:51], a[176:179], v[28:31]
ds_read_b128 a[44:47], v2 offset:27648
v_cvt_pk_bf16_f32 v93, v18, v19
v_mfma_f32_16x16x32_bf16 v[80:83], v[88:91], v[32:35], v[80:83]
v_exp_f32 v20, v20
v_mfma_f32_16x16x32_bf16 v[192:195], a[64:67], v[32:35], v[192:195]
ds_read_b128 a[60:63], v2 offset:31744
ds_read_b128 a[56:59], v2 offset:30720
v_mfma_f32_16x16x32_bf16 v[192:195], a[96:99], v[36:39], v[192:195]
s_sub_u32 s55, s55, 1
v_exp_f32 v21, v21
v_mfma_f32_16x16x32_bf16 v[196:199], a[100:103], v[36:39], v[196:199]
ds_read_b128 a[52:55], v2 offset:29696
v_cvt_pk_bf16_f32 v94, v20, v21
v_mfma_f32_16x16x32_bf16 v[196:199], a[68:71], v[32:35], v[196:199]
s_waitcnt lgkmcnt(7)
v_exp_f32 v22, v22
v_mfma_f32_16x16x32_bf16 v[200:203], a[72:75], v[32:35], v[200:203]
v_mfma_f32_16x16x32_bf16 v[200:203], a[104:107], v[36:39], v[200:203]
s_cmp_lg_u32 s55, 0
v_exp_f32 v23, v23
v_mfma_f32_16x16x32_bf16 v[204:207], a[108:111], v[36:39], v[204:207]
ds_read_b128 a[48:51], v2 offset:28672
v_cvt_pk_bf16_f32 v95, v22, v23
v_mfma_f32_16x16x32_bf16 v[204:207], a[76:79], v[32:35], v[204:207]
s_cbranch_scc1 L_dual
L_diag_lo:
v_cndmask_b32 v56, v3, v40, s[64:65]
v_cndmask_b32 v57, v3, v40, s[66:67]
v_cndmask_b32 v58, v3, v40, s[68:69]
v_cndmask_b32 v59, v3, v40, s[70:71]
v_cndmask_b32 v60, v3, v40, s[72:73]
v_cndmask_b32 v61, v3, v40, s[74:75]
v_mfma_f32_16x16x32_bf16 v[16:19], a[0:3], a[128:131], v[56:59]
v_exp_f32 v24, v24
v_mfma_f32_16x16x32_bf16 v[16:19], a[4:7], a[132:135], v[16:19]
v_cndmask_b32 v62, v3, v40, s[76:77]
v_cndmask_b32 v63, v3, v40, s[78:79]
v_mfma_f32_16x16x32_bf16 v[16:19], a[8:11], a[136:139], v[16:19]
v_exp_f32 v25, v25
v_mfma_f32_16x16x32_bf16 v[16:19], a[12:15], a[140:143], v[16:19]
v_cvt_pk_bf16_f32 v108, v24, v25
v_add_u32 v2, s52, v15
v_mfma_f32_16x16x32_bf16 v[20:23], a[28:31], a[140:143], v[60:63]
s_add_u32 m0, s53, s56
v_exp_f32 v26, v26
v_mfma_f32_16x16x32_bf16 v[20:23], a[24:27], a[136:139], v[20:23]
buffer_load_dwordx4 v1, s[44:47], s54 offen offset:0 sc1 lds
v_mfma_f32_16x16x32_bf16 v[20:23], a[20:23], a[132:135], v[20:23]
v_exp_f32 v27, v27
v_mfma_f32_16x16x32_bf16 v[20:23], a[16:19], a[128:131], v[20:23]
s_waitcnt lgkmcnt(0)
v_cvt_pk_bf16_f32 v109, v26, v27
v_cndmask_b32 v64, v3, v40, s[80:81]
v_mfma_f32_16x16x32_bf16 v[80:83], v[88:91], v[36:39], v[80:83]
s_add_u32 s52, s52, 32768
v_exp_f32 v28, v28
v_mfma_f32_16x16x32_bf16 v[208:211], a[112:115], v[36:39], v[208:211]
v_cndmask_b32 v65, v3, v40, s[82:83]
v_cndmask_b32 v66, v3, v40, s[84:85]
v_mfma_f32_16x16x32_bf16 v[208:211], a[80:83], v[32:35], v[208:211]
s_cmp_eq_u32 s52, 163840
v_exp_f32 v29, v29
v_mfma_f32_16x16x32_bf16 v[212:215], a[84:87], v[32:35], v[212:215]
v_cvt_pk_bf16_f32 v110, v28, v29
v_cndmask_b32 v67, v3, v40, s[86:87]
v_mfma_f32_16x16x32_bf16 v[212:215], a[116:119], v[36:39], v[212:215]
s_cselect_b32 s52, 0, s52
v_exp_f32 v30, v30
v_mfma_f32_16x16x32_bf16 v[216:219], a[120:123], v[36:39], v[216:219]
v_cndmask_b32 v68, v3, v40, s[88:89]
v_cndmask_b32 v69, v3, v40, s[90:91]
v_mfma_f32_16x16x32_bf16 v[216:219], a[88:91], v[32:35], v[216:219]
v_exp_f32 v31, v31
v_mfma_f32_16x16x32_bf16 v[220:223], a[92:95], v[32:35], v[220:223]
v_cvt_pk_bf16_f32 v111, v30, v31
v_cndmask_b32 v70, v3, v40, s[92:93]
v_cndmask_b32 v71, v3, v40, s[94:95]
v_mfma_f32_16x16x32_bf16 v[220:223], a[124:127], v[36:39], v[220:223]
v_mfma_f32_16x16x32_bf16 v[24:27], a[32:35], a[128:131], v[64:67]
s_add_u32 s53, s53, 32768
v_exp_f32 v16, v16
v_mfma_f32_16x16x32_bf16 v[24:27], a[36:39], a[132:135], v[24:27]
v_mfma_f32_16x16x32_bf16 v[24:27], a[40:43], a[136:139], v[24:27]
s_cmp_eq_u32 s53, 163840
v_exp_f32 v17, v17
v_mfma_f32_16x16x32_bf16 v[24:27], a[44:47], a[140:143], v[24:27]
v_cvt_pk_bf16_f32 v32, v16, v17
v_mfma_f32_16x16x32_bf16 v[28:31], a[60:63], a[140:143], v[68:71]
s_cselect_b32 s53, 0, s53
v_exp_f32 v18, v18
v_mfma_f32_16x16x32_bf16 v[28:31], a[56:59], a[136:139], v[28:31]
buffer_load_dwordx4 v1, s[44:47], s54 offen offset:1024 sc1 lds
v_mfma_f32_16x16x32_bf16 v[28:31], a[52:55], a[132:135], v[28:31]
v_exp_f32 v19, v19
v_mfma_f32_16x16x32_bf16 v[28:31], a[48:51], a[128:131], v[28:31]
v_cvt_pk_bf16_f32 v33, v18, v19
v_mfma_f32_16x16x32_bf16 v[84:87], v[88:91], v[92:95], v[84:87]
v_exp_f32 v20, v20
v_mfma_f32_16x16x32_bf16 v[224:227], a[64:67], v[92:95], v[224:227]
v_mfma_f32_16x16x32_bf16 v[224:227], a[96:99], v[108:111], v[224:227]
v_exp_f32 v21, v21
v_mfma_f32_16x16x32_bf16 v[228:231], a[100:103], v[108:111], v[228:231]
v_cvt_pk_bf16_f32 v34, v20, v21
v_mfma_f32_16x16x32_bf16 v[228:231], a[68:71], v[92:95], v[228:231]
v_exp_f32 v22, v22
v_mfma_f32_16x16x32_bf16 v[232:235], a[72:75], v[92:95], v[232:235]
v_mfma_f32_16x16x32_bf16 v[232:235], a[104:107], v[108:111], v[232:235]
v_exp_f32 v23, v23
v_mfma_f32_16x16x32_bf16 v[236:239], a[108:111], v[108:111], v[236:239]
v_cvt_pk_bf16_f32 v35, v22, v23
v_mfma_f32_16x16x32_bf16 v[236:239], a[76:79], v[92:95], v[236:239]
v_mfma_f32_16x16x32_bf16 v[16:19], a[0:3], a[144:147], v[44:47]
v_exp_f32 v24, v24
v_mfma_f32_16x16x32_bf16 v[16:19], a[4:7], a[148:151], v[16:19]
ds_read_b128 a[64:67], v2 offset:0
ds_read_b128 a[96:99], v2 offset:8192
v_mfma_f32_16x16x32_bf16 v[16:19], a[8:11], a[152:155], v[16:19]
v_exp_f32 v25, v25
v_mfma_f32_16x16x32_bf16 v[16:19], a[12:15], a[156:159], v[16:19]
ds_read_b128 a[68:71], v2 offset:1024
v_cvt_pk_bf16_f32 v36, v24, v25
v_mfma_f32_16x16x32_bf16 v[20:23], a[28:31], a[156:159], v[44:47]
v_exp_f32 v26, v26
v_mfma_f32_16x16x32_bf16 v[20:23], a[24:27], a[152:155], v[20:23]
buffer_load_dwordx4 v1, s[44:47], s54 offen offset:2048 sc1 lds
v_mfma_f32_16x16x32_bf16 v[20:23], a[20:23], a[148:151], v[20:23]
v_exp_f32 v27, v27
v_mfma_f32_16x16x32_bf16 v[20:23], a[16:19], a[144:147], v[20:23]
ds_read_b128 a[100:103], v2 offset:9216
v_cvt_pk_bf16_f32 v37, v26, v27
v_mfma_f32_16x16x32_bf16 v[84:87], v[88:91], v[108:111], v[84:87]
v_exp_f32 v28, v28
v_mfma_f32_16x16x32_bf16 v[240:243], a[112:115], v[108:111], v[240:243]
ds_read_b128 a[72:75], v2 offset:2048
ds_read_b128 a[104:107], v2 offset:10240
v_mfma_f32_16x16x32_bf16 v[240:243], a[80:83], v[92:95], v[240:243]
v_exp_f32 v29, v29
v_mfma_f32_16x16x32_bf16 v[244:247], a[84:87], v[92:95], v[244:247]
ds_read_b128 a[76:79], v2 offset:3072
v_cvt_pk_bf16_f32 v38, v28, v29
v_mfma_f32_16x16x32_bf16 v[244:247], a[116:119], v[108:111], v[244:247]
v_exp_f32 v30, v30
v_mfma_f32_16x16x32_bf16 v[248:251], a[120:123], v[108:111], v[248:251]
v_mfma_f32_16x16x32_bf16 v[248:251], a[88:91], v[92:95], v[248:251]
v_exp_f32 v31, v31
v_mfma_f32_16x16x32_bf16 v[252:255], a[92:95], v[92:95], v[252:255]
ds_read_b128 a[108:111], v2 offset:11264
v_cvt_pk_bf16_f32 v39, v30, v31
v_mfma_f32_16x16x32_bf16 v[252:255], a[124:127], v[108:111], v[252:255]
v_mfma_f32_16x16x32_bf16 v[24:27], a[32:35], a[144:147], v[44:47]
v_exp_f32 v16, v16
v_mfma_f32_16x16x32_bf16 v[24:27], a[36:39], a[148:151], v[24:27]
ds_read_b128 a[80:83], v2 offset:4096
ds_read_b128 a[112:115], v2 offset:12288
v_mfma_f32_16x16x32_bf16 v[24:27], a[40:43], a[152:155], v[24:27]
v_exp_f32 v17, v17
v_mfma_f32_16x16x32_bf16 v[24:27], a[44:47], a[156:159], v[24:27]
ds_read_b128 a[84:87], v2 offset:5120
v_cvt_pk_bf16_f32 v92, v16, v17
v_mfma_f32_16x16x32_bf16 v[28:31], a[60:63], a[156:159], v[44:47]
v_exp_f32 v18, v18
v_mfma_f32_16x16x32_bf16 v[28:31], a[56:59], a[152:155], v[28:31]
buffer_load_dwordx4 v1, s[44:47], s54 offen offset:3072 sc1 lds
v_mfma_f32_16x16x32_bf16 v[28:31], a[52:55], a[148:151], v[28:31]
s_add_u32 m0, m0, 4096
v_exp_f32 v19, v19
v_mfma_f32_16x16x32_bf16 v[28:31], a[48:51], a[144:147], v[28:31]
s_waitcnt lgkmcnt(3)
ds_read_b128 a[116:119], v2 offset:13312
v_cvt_pk_bf16_f32 v93, v18, v19
v_mfma_f32_16x16x32_bf16 v[72:75], v[88:91], v[32:35], v[72:75]
s_add_u32 s54, s54, 4096
v_exp_f32 v20, v20
v_mfma_f32_16x16x32_bf16 v[128:131], a[64:67], v[32:35], v[128:131]
ds_read_b128 a[88:91], v2 offset:6144
ds_read_b128 a[120:123], v2 offset:14336
v_mfma_f32_16x16x32_bf16 v[128:131], a[96:99], v[36:39], v[128:131]
v_exp_f32 v21, v21
v_mfma_f32_16x16x32_bf16 v[132:135], a[100:103], v[36:39], v[132:135]
ds_read_b128 a[92:95], v2 offset:7168
v_cvt_pk_bf16_f32 v94, v20, v21
v_mfma_f32_16x16x32_bf16 v[132:135], a[68:71], v[32:35], v[132:135]
v_exp_f32 v22, v22
v_mfma_f32_16x16x32_bf16 v[136:139], a[72:75], v[32:35], v[136:139]
v_mfma_f32_16x16x32_bf16 v[136:139], a[104:107], v[36:39], v[136:139]
v_exp_f32 v23, v23
v_mfma_f32_16x16x32_bf16 v[140:143], a[108:111], v[36:39], v[140:143]
ds_read_b128 a[124:127], v2 offset:15360
v_cvt_pk_bf16_f32 v95, v22, v23
v_mfma_f32_16x16x32_bf16 v[140:143], a[76:79], v[32:35], v[140:143]
v_mfma_f32_16x16x32_bf16 v[16:19], a[0:3], a[160:163], v[48:51]
v_exp_f32 v24, v24
v_mfma_f32_16x16x32_bf16 v[16:19], a[4:7], a[164:167], v[16:19]
v_cndmask_b32 v56, v3, v44, s[64:65]
v_cndmask_b32 v57, v3, v44, s[66:67]
v_mfma_f32_16x16x32_bf16 v[16:19], a[8:11], a[168:171], v[16:19]
v_exp_f32 v25, v25
v_mfma_f32_16x16x32_bf16 v[16:19], a[12:15], a[172:175], v[16:19]
v_cvt_pk_bf16_f32 v108, v24, v25
v_cndmask_b32 v58, v3, v44, s[68:69]
v_mfma_f32_16x16x32_bf16 v[20:23], a[28:31], a[172:175], v[48:51]
v_exp_f32 v26, v26
v_mfma_f32_16x16x32_bf16 v[20:23], a[24:27], a[168:171], v[20:23]
buffer_load_dwordx4 v1, s[44:47], s54 offen offset:0 sc1 lds
v_mfma_f32_16x16x32_bf16 v[20:23], a[20:23], a[164:167], v[20:23]
v_exp_f32 v27, v27
v_mfma_f32_16x16x32_bf16 v[20:23], a[16:19], a[160:163], v[20:23]
s_waitcnt lgkmcnt(0)
v_cvt_pk_bf16_f32 v109, v26, v27
v_cndmask_b32 v59, v3, v44, s[70:71]
v_mfma_f32_16x16x32_bf16 v[72:75], v[88:91], v[36:39], v[72:75]
v_exp_f32 v28, v28
v_mfma_f32_16x16x32_bf16 v[144:147], a[112:115], v[36:39], v[144:147]
v_cndmask_b32 v60, v3, v44, s[72:73]
v_cndmask_b32 v61, v3, v44, s[74:75]
v_mfma_f32_16x16x32_bf16 v[144:147], a[80:83], v[32:35], v[144:147]
v_exp_f32 v29, v29
v_mfma_f32_16x16x32_bf16 v[148:151], a[84:87], v[32:35], v[148:151]
v_cvt_pk_bf16_f32 v110, v28, v29
v_cndmask_b32 v62, v3, v44, s[76:77]
v_mfma_f32_16x16x32_bf16 v[148:151], a[116:119], v[36:39], v[148:151]
v_exp_f32 v30, v30
v_mfma_f32_16x16x32_bf16 v[152:155], a[120:123], v[36:39], v[152:155]
v_mfma_f32_16x16x32_bf16 v[152:155], a[88:91], v[32:35], v[152:155]
v_exp_f32 v31, v31
v_mfma_f32_16x16x32_bf16 v[156:159], a[92:95], v[32:35], v[156:159]
v_cvt_pk_bf16_f32 v111, v30, v31
v_cndmask_b32 v63, v3, v44, s[78:79]
v_mfma_f32_16x16x32_bf16 v[156:159], a[124:127], v[36:39], v[156:159]
v_mfma_f32_16x16x32_bf16 v[24:27], a[32:35], a[160:163], v[48:51]
v_exp_f32 v16, v16
v_mfma_f32_16x16x32_bf16 v[24:27], a[36:39], a[164:167], v[24:27]
v_cndmask_b32 v64, v3, v44, s[80:81]
v_cndmask_b32 v65, v3, v44, s[82:83]
v_mfma_f32_16x16x32_bf16 v[24:27], a[40:43], a[168:171], v[24:27]
v_exp_f32 v17, v17
v_mfma_f32_16x16x32_bf16 v[24:27], a[44:47], a[172:175], v[24:27]
v_cvt_pk_bf16_f32 v32, v16, v17
v_cndmask_b32 v66, v3, v44, s[84:85]
v_mfma_f32_16x16x32_bf16 v[28:31], a[60:63], a[172:175], v[48:51]
v_exp_f32 v18, v18
v_mfma_f32_16x16x32_bf16 v[28:31], a[56:59], a[168:171], v[28:31]
buffer_load_dwordx4 v1, s[44:47], s54 offen offset:1024 sc1 lds
v_mfma_f32_16x16x32_bf16 v[28:31], a[52:55], a[164:167], v[28:31]
v_exp_f32 v19, v19
v_mfma_f32_16x16x32_bf16 v[28:31], a[48:51], a[160:163], v[28:31]
v_cvt_pk_bf16_f32 v33, v18, v19
v_cndmask_b32 v67, v3, v44, s[86:87]
v_mfma_f32_16x16x32_bf16 v[76:79], v[88:91], v[92:95], v[76:79]
v_exp_f32 v20, v20
v_mfma_f32_16x16x32_bf16 v[160:163], a[64:67], v[92:95], v[160:163]
v_cndmask_b32 v68, v3, v44, s[88:89]
v_cndmask_b32 v69, v3, v44, s[90:91]
v_mfma_f32_16x16x32_bf16 v[160:163], a[96:99], v[108:111], v[160:163]
v_exp_f32 v21, v21
v_mfma_f32_16x16x32_bf16 v[164:167], a[100:103], v[108:111], v[164:167]
v_cvt_pk_bf16_f32 v34, v20, v21
v_cndmask_b32 v70, v3, v44, s[92:93]
v_mfma_f32_16x16x32_bf16 v[164:167], a[68:71], v[92:95], v[164:167]
v_exp_f32 v22, v22
v_mfma_f32_16x16x32_bf16 v[168:171], a[72:75], v[92:95], v[168:171]
v_mfma_f32_16x16x32_bf16 v[168:171], a[104:107], v[108:111], v[168:171]
v_exp_f32 v23, v23
v_mfma_f32_16x16x32_bf16 v[172:175], a[108:111], v[108:111], v[172:175]
v_cvt_pk_bf16_f32 v35, v22, v23
v_cndmask_b32 v71, v3, v44, s[94:95]
v_mfma_f32_16x16x32_bf16 v[172:175], a[76:79], v[92:95], v[172:175]
v_mfma_f32_16x16x32_bf16 v[16:19], a[0:3], a[176:179], v[52:55]
v_exp_f32 v24, v24
v_mfma_f32_16x16x32_bf16 v[16:19], a[4:7], a[180:183], v[16:19]
ds_read_b128 a[0:3], v2 offset:16384
ds_read_b128 a[4:7], v2 offset:17408
v_mfma_f32_16x16x32_bf16 v[16:19], a[8:11], a[184:187], v[16:19]
v_exp_f32 v25, v25
v_mfma_f32_16x16x32_bf16 v[16:19], a[12:15], a[188:191], v[16:19]
ds_read_b128 a[8:11], v2 offset:18432
v_cvt_pk_bf16_f32 v36, v24, v25
v_mfma_f32_16x16x32_bf16 v[20:23], a[28:31], a[188:191], v[52:55]
v_exp_f32 v26, v26
v_mfma_f32_16x16x32_bf16 v[20:23], a[24:27], a[184:187], v[20:23]
buffer_load_dwordx4 v1, s[44:47], s54 offen offset:2048 sc1 lds
v_mfma_f32_16x16x32_bf16 v[20:23], a[20:23], a[180:183], v[20:23]
v_exp_f32 v27, v27
v_mfma_f32_16x16x32_bf16 v[20:23], a[16:19], a[176:179], v[20:23]
ds_read_b128 a[12:15], v2 offset:19456
v_cvt_pk_bf16_f32 v37, v26, v27
v_mfma_f32_16x16x32_bf16 v[76:79], v[88:91], v[108:111], v[76:79]
v_exp_f32 v28, v28
v_mfma_f32_16x16x32_bf16 v[176:179], a[112:115], v[108:111], v[176:179]
ds_read_b128 a[28:31], v2 offset:23552
ds_read_b128 a[24:27], v2 offset:22528
v_mfma_f32_16x16x32_bf16 v[176:179], a[80:83], v[92:95], v[176:179]
v_exp_f32 v29, v29
v_mfma_f32_16x16x32_bf16 v[180:183], a[84:87], v[92:95], v[180:183]
ds_read_b128 a[20:23], v2 offset:21504
v_cvt_pk_bf16_f32 v38, v28, v29
v_mfma_f32_16x16x32_bf16 v[180:183], a[116:119], v[108:111], v[180:183]
v_exp_f32 v30, v30
v_mfma_f32_16x16x32_bf16 v[184:187], a[120:123], v[108:111], v[184:187]
v_mfma_f32_16x16x32_bf16 v[184:187], a[88:91], v[92:95], v[184:187]
s_waitcnt vmcnt(15)
v_exp_f32 v31, v31
v_mfma_f32_16x16x32_bf16 v[188:191], a[92:95], v[92:95], v[188:191]
ds_read_b128 a[16:19], v2 offset:20480
v_cvt_pk_bf16_f32 v39, v30, v31
v_mfma_f32_16x16x32_bf16 v[188:191], a[124:127], v[108:111], v[188:191]
s_barrier
v_mfma_f32_16x16x32_bf16 v[24:27], a[32:35], a[176:179], v[52:55]
v_exp_f32 v16, v16
v_mfma_f32_16x16x32_bf16 v[24:27], a[36:39], a[180:183], v[24:27]
ds_read_b128 a[32:35], v2 offset:24576
ds_read_b128 a[36:39], v2 offset:25600
v_mfma_f32_16x16x32_bf16 v[24:27], a[40:43], a[184:187], v[24:27]
v_exp_f32 v17, v17
v_mfma_f32_16x16x32_bf16 v[24:27], a[44:47], a[188:191], v[24:27]
ds_read_b128 a[40:43], v2 offset:26624
v_cvt_pk_bf16_f32 v92, v16, v17
v_mfma_f32_16x16x32_bf16 v[28:31], a[60:63], a[188:191], v[52:55]
v_exp_f32 v18, v18
v_mfma_f32_16x16x32_bf16 v[28:31], a[56:59], a[184:187], v[28:31]
buffer_load_dwordx4 v1, s[44:47], s54 offen offset:3072 sc1 lds
v_mfma_f32_16x16x32_bf16 v[28:31], a[52:55], a[180:183], v[28:31]
s_add_u32 s54, s54, 28672
v_exp_f32 v19, v19
v_mfma_f32_16x16x32_bf16 v[28:31], a[48:51], a[176:179], v[28:31]
ds_read_b128 a[44:47], v2 offset:27648
v_cvt_pk_bf16_f32 v93, v18, v19
v_mfma_f32_16x16x32_bf16 v[80:83], v[88:91], v[32:35], v[80:83]
v_exp_f32 v20, v20
v_mfma_f32_16x16x32_bf16 v[192:195], a[64:67], v[32:35], v[192:195]
ds_read_b128 a[60:63], v2 offset:31744
ds_read_b128 a[56:59], v2 offset:30720
v_mfma_f32_16x16x32_bf16 v[192:195], a[96:99], v[36:39], v[192:195]
v_exp_f32 v21, v21
v_mfma_f32_16x16x32_bf16 v[196:199], a[100:103], v[36:39], v[196:199]
ds_read_b128 a[52:55], v2 offset:29696
v_cvt_pk_bf16_f32 v94, v20, v21
v_mfma_f32_16x16x32_bf16 v[196:199], a[68:71], v[32:35], v[196:199]
s_waitcnt lgkmcnt(7)
v_exp_f32 v22, v22
v_mfma_f32_16x16x32_bf16 v[200:203], a[72:75], v[32:35], v[200:203]
v_mfma_f32_16x16x32_bf16 v[200:203], a[104:107], v[36:39], v[200:203]
v_exp_f32 v23, v23
v_mfma_f32_16x16x32_bf16 v[204:207], a[108:111], v[36:39], v[204:207]
ds_read_b128 a[48:51], v2 offset:28672
v_cvt_pk_bf16_f32 v95, v22, v23
v_mfma_f32_16x16x32_bf16 v[204:207], a[76:79], v[32:35], v[204:207]
L_diag_lo2:
v_mfma_f32_16x16x32_bf16 v[16:19], a[0:3], a[144:147], v[56:59]
L_t13:
s_cbranch_execz L_r2
s_lshl_b32 s26, s34, 12
v_exp_f32 v24, v24
v_mfma_f32_16x16x32_bf16 v[16:19], a[4:7], a[148:151], v[16:19]
s_add_u32 s26, s26, 16384
v_mov_b64 v[104:105], -1
v_mov_b64 v[106:107], -1
v_mfma_f32_16x16x32_bf16 v[16:19], a[8:11], a[152:155], v[16:19]
s_lshl_b32 s35, s33, 13
v_exp_f32 v25, v25
v_mfma_f32_16x16x32_bf16 v[16:19], a[12:15], a[156:159], v[16:19]
v_cvt_pk_bf16_f32 v108, v24, v25
v_add_u32 v2, s52, v15
v_mfma_f32_16x16x32_bf16 v[20:23], a[28:31], a[156:159], v[60:63]
s_add_u32 m0, s53, s56
v_exp_f32 v26, v26
v_mfma_f32_16x16x32_bf16 v[20:23], a[24:27], a[152:155], v[20:23]
buffer_load_dwordx4 v1, s[44:47], s54 offen offset:0 sc1 lds
v_mfma_f32_16x16x32_bf16 v[20:23], a[20:23], a[148:151], v[20:23]
s_mul_i32 s63, s0, 24576
v_exp_f32 v27, v27
v_mfma_f32_16x16x32_bf16 v[20:23], a[16:19], a[144:147], v[20:23]
s_waitcnt lgkmcnt(0)
v_cvt_pk_bf16_f32 v109, v26, v27
v_add_u32 v113, s26, v10
v_mfma_f32_16x16x32_bf16 v[80:83], v[88:91], v[36:39], v[80:83]
s_add_u32 s52, s52, 32768
v_exp_f32 v28, v28
v_mfma_f32_16x16x32_bf16 v[208:211], a[112:115], v[36:39], v[208:211]
v_add_u32 v112, s35, v15
v_xor_b32 v114, 32, v113
v_mfma_f32_16x16x32_bf16 v[208:211], a[80:83], v[32:35], v[208:211]
s_cmp_eq_u32 s52, 163840
v_exp_f32 v29, v29
v_mfma_f32_16x16x32_bf16 v[212:215], a[84:87], v[32:35], v[212:215]
v_cvt_pk_bf16_f32 v110, v28, v29
v_xor_b32 v115, 64, v113
v_mfma_f32_16x16x32_bf16 v[212:215], a[116:119], v[36:39], v[212:215]
s_cselect_b32 s52, 0, s52
v_exp_f32 v30, v30
v_mfma_f32_16x16x32_bf16 v[216:219], a[120:123], v[36:39], v[216:219]
buffer_load_dwordx4 v1, s[44:47], s54 offen offset:1024 sc1 lds
v_mfma_f32_16x16x32_bf16 v[216:219], a[88:91], v[32:35], v[216:219]
s_add_u32 s63, s63, s14
v_exp_f32 v31, v31
v_mfma_f32_16x16x32_bf16 v[220:223], a[92:95], v[32:35], v[220:223]
s_cmp_eq_u32 s54, s57
v_cvt_pk_bf16_f32 v111, v30, v31
v_xor_b32 v116, 96, v113
v_mfma_f32_16x16x32_bf16 v[220:223], a[124:127], v[36:39], v[220:223]
s_cbranch_scc1 L_sh1_do
L_sh1:
v_mfma_f32_16x16x32_bf16 v[24:27], a[32:35], a[144:147], v[64:67]
s_add_u32 s53, s53, 32768
v_exp_f32 v16, v16
v_mfma_f32_16x16x32_bf16 v[24:27], a[36:39], a[148:151], v[24:27]
v_add_u32 v117, 0x10000, v112
v_add_u32 v118, 0x10000, v113
v_mfma_f32_16x16x32_bf16 v[24:27], a[40:43], a[152:155], v[24:27]
s_cmp_eq_u32 s53, 163840
v_exp_f32 v17, v17
v_mfma_f32_16x16x32_bf16 v[24:27], a[44:47], a[156:159], v[24:27]
v_cvt_pk_bf16_f32 v32, v16, v17
v_add_u32 v119, 0x10000, v114
v_mfma_f32_16x16x32_bf16 v[28:31], a[60:63], a[156:159], v[68:71]
s_cselect_b32 s53, 0, s53
v_exp_f32 v18, v18
v_mfma_f32_16x16x32_bf16 v[28:31], a[56:59], a[152:155], v[28:31]
buffer_load_dwordx4 v1, s[44:47], s54 offen offset:2048 sc1 lds
v_mfma_f32_16x16x32_bf16 v[28:31], a[52:55], a[148:151], v[28:31]
v_exp_f32 v19, v19
v_mfma_f32_16x16x32_bf16 v[28:31], a[48:51], a[144:147], v[28:31]
v_cvt_pk_bf16_f32 v33, v18, v19
v_add_u32 v120, 0x10000, v115
v_mfma_f32_16x16x32_bf16 v[84:87], v[88:91], v[92:95], v[84:87]
v_exp_f32 v20, v20
v_mfma_f32_16x16x32_bf16 v[224:227], a[64:67], v[92:95], v[224:227]
buffer_store_dwordx4 v[104:107], v15, s[8:11], s63 offen offset:0 sc1
v_mfma_f32_16x16x32_bf16 v[224:227], a[96:99], v[108:111], v[224:227]
v_exp_f32 v21, v21
v_mfma_f32_16x16x32_bf16 v[228:231], a[100:103], v[108:111], v[228:231]
v_cvt_pk_bf16_f32 v34, v20, v21
v_add_u32 v121, 0x10000, v116
v_mfma_f32_16x16x32_bf16 v[228:231], a[68:71], v[92:95], v[228:231]
v_exp_f32 v22, v22
v_mfma_f32_16x16x32_bf16 v[232:235], a[72:75], v[92:95], v[232:235]
buffer_load_dwordx4 v1, s[44:47], s54 offen offset:3072 sc1 lds
v_mfma_f32_16x16x32_bf16 v[232:235], a[104:107], v[108:111], v[232:235]
s_add_u32 m0, m0, 4096
v_exp_f32 v23, v23
v_mfma_f32_16x16x32_bf16 v[236:239], a[108:111], v[108:111], v[236:239]
s_add_u32 s54, s54, 4096
v_cvt_pk_bf16_f32 v35, v22, v23
v_add_u32 v122, 0x10000, v117
v_mfma_f32_16x16x32_bf16 v[236:239], a[76:79], v[92:95], v[236:239]
v_add_u32 v123, 0x10000, v118
v_add_u32 v124, 0x10000, v119
v_mfma_f32_16x16x32_bf16 v[16:19], a[0:3], a[160:163], v[48:51]
v_exp_f32 v24, v24
v_mfma_f32_16x16x32_bf16 v[16:19], a[4:7], a[164:167], v[16:19]
ds_read_b128 a[64:67], v2 offset:0
ds_read_b128 a[96:99], v2 offset:8192
v_mfma_f32_16x16x32_bf16 v[16:19], a[8:11], a[168:171], v[16:19]
v_exp_f32 v25, v25
v_mfma_f32_16x16x32_bf16 v[16:19], a[12:15], a[172:175], v[16:19]
ds_read_b128 a[68:71], v2 offset:1024
v_cvt_pk_bf16_f32 v36, v24, v25
v_mfma_f32_16x16x32_bf16 v[20:23], a[28:31], a[172:175], v[48:51]
v_exp_f32 v26, v26
v_mfma_f32_16x16x32_bf16 v[20:23], a[24:27], a[168:171], v[20:23]
buffer_load_dwordx4 v1, s[44:47], s54 offen offset:0 sc1 lds
v_mfma_f32_16x16x32_bf16 v[20:23], a[20:23], a[164:167], v[20:23]
v_exp_f32 v27, v27
v_mfma_f32_16x16x32_bf16 v[20:23], a[16:19], a[160:163], v[20:23]
ds_read_b128 a[100:103], v2 offset:9216
v_cvt_pk_bf16_f32 v37, v26, v27
v_mfma_f32_16x16x32_bf16 v[84:87], v[88:91], v[108:111], v[84:87]
v_exp_f32 v28, v28
v_mfma_f32_16x16x32_bf16 v[240:243], a[112:115], v[108:111], v[240:243]
ds_read_b128 a[72:75], v2 offset:2048
ds_read_b128 a[104:107], v2 offset:10240
v_mfma_f32_16x16x32_bf16 v[240:243], a[80:83], v[92:95], v[240:243]
v_exp_f32 v29, v29
v_mfma_f32_16x16x32_bf16 v[244:247], a[84:87], v[92:95], v[244:247]
ds_read_b128 a[76:79], v2 offset:3072
v_cvt_pk_bf16_f32 v38, v28, v29
v_mfma_f32_16x16x32_bf16 v[244:247], a[116:119], v[108:111], v[244:247]
v_exp_f32 v30, v30
v_mfma_f32_16x16x32_bf16 v[248:251], a[120:123], v[108:111], v[248:251]
buffer_store_dwordx4 v[104:107], v15, s[8:11], s63 offen offset:1024 sc1
v_mfma_f32_16x16x32_bf16 v[248:251], a[88:91], v[92:95], v[248:251]
v_exp_f32 v31, v31
v_mfma_f32_16x16x32_bf16 v[252:255], a[92:95], v[92:95], v[252:255]
s_add_u32 s63, s63, 8192
ds_read_b128 a[108:111], v2 offset:11264
v_cvt_pk_bf16_f32 v39, v30, v31
v_mfma_f32_16x16x32_bf16 v[252:255], a[124:127], v[108:111], v[252:255]
buffer_store_dwordx4 v[104:107], v15, s[8:11], s63 offen offset:0 sc1
v_mfma_f32_16x16x32_bf16 v[24:27], a[32:35], a[160:163], v[48:51]
v_exp_f32 v16, v16
v_mfma_f32_16x16x32_bf16 v[24:27], a[36:39], a[164:167], v[24:27]
ds_read_b128 a[80:83], v2 offset:4096
ds_read_b128 a[112:115], v2 offset:12288
v_mfma_f32_16x16x32_bf16 v[24:27], a[40:43], a[168:171], v[24:27]
v_exp_f32 v17, v17
v_mfma_f32_16x16x32_bf16 v[24:27], a[44:47], a[172:175], v[24:27]
ds_read_b128 a[84:87], v2 offset:5120
v_cvt_pk_bf16_f32 v92, v16, v17
v_mfma_f32_16x16x32_bf16 v[28:31], a[60:63], a[172:175], v[48:51]
v_exp_f32 v18, v18
v_mfma_f32_16x16x32_bf16 v[28:31], a[56:59], a[168:171], v[28:31]
buffer_load_dwordx4 v1, s[44:47], s54 offen offset:1024 sc1 lds
v_mfma_f32_16x16x32_bf16 v[28:31], a[52:55], a[164:167], v[28:31]
v_exp_f32 v19, v19
v_mfma_f32_16x16x32_bf16 v[28:31], a[48:51], a[160:163], v[28:31]
s_waitcnt lgkmcnt(3)
ds_read_b128 a[116:119], v2 offset:13312
v_cvt_pk_bf16_f32 v93, v18, v19
v_mfma_f32_16x16x32_bf16 v[76:79], v[88:91], v[32:35], v[76:79]
v_exp_f32 v20, v20
v_mfma_f32_16x16x32_bf16 v[160:163], a[64:67], v[32:35], v[160:163]
ds_read_b128 a[88:91], v2 offset:6144
ds_read_b128 a[120:123], v2 offset:14336
v_mfma_f32_16x16x32_bf16 v[160:163], a[96:99], v[36:39], v[160:163]
v_exp_f32 v21, v21
v_mfma_f32_16x16x32_bf16 v[164:167], a[100:103], v[36:39], v[164:167]
ds_read_b128 a[92:95], v2 offset:7168
v_cvt_pk_bf16_f32 v94, v20, v21
v_mfma_f32_16x16x32_bf16 v[164:167], a[68:71], v[32:35], v[164:167]
v_exp_f32 v22, v22
v_mfma_f32_16x16x32_bf16 v[168:171], a[72:75], v[32:35], v[168:171]
buffer_store_dwordx4 v[104:107], v15, s[8:11], s63 offen offset:1024 sc1
v_mfma_f32_16x16x32_bf16 v[168:171], a[104:107], v[36:39], v[168:171]
v_exp_f32 v23, v23
v_mfma_f32_16x16x32_bf16 v[172:175], a[108:111], v[36:39], v[172:175]
ds_read_b128 a[124:127], v2 offset:15360
v_cvt_pk_bf16_f32 v95, v22, v23
v_mfma_f32_16x16x32_bf16 v[172:175], a[76:79], v[32:35], v[172:175]
v_add_u32 v125, 0x10000, v120
v_add_u32 v126, 0x10000, v121
v_mfma_f32_16x16x32_bf16 v[16:19], a[0:3], a[176:179], v[52:55]
v_exp_f32 v24, v24
v_mfma_f32_16x16x32_bf16 v[16:19], a[4:7], a[180:183], v[16:19]
ds_read_b128 a[0:3], v2 offset:16384
ds_read_b128 a[4:7], v2 offset:17408
v_mfma_f32_16x16x32_bf16 v[16:19], a[8:11], a[184:187], v[16:19]
v_exp_f32 v25, v25
v_mfma_f32_16x16x32_bf16 v[16:19], a[12:15], a[188:191], v[16:19]
ds_read_b128 a[8:11], v2 offset:18432
v_cvt_pk_bf16_f32 v108, v24, v25
v_mfma_f32_16x16x32_bf16 v[20:23], a[28:31], a[188:191], v[52:55]
v_exp_f32 v26, v26
v_mfma_f32_16x16x32_bf16 v[20:23], a[24:27], a[184:187], v[20:23]
buffer_load_dwordx4 v1, s[44:47], s54 offen offset:2048 sc1 lds
v_mfma_f32_16x16x32_bf16 v[20:23], a[20:23], a[180:183], v[20:23]
v_exp_f32 v27, v27
v_mfma_f32_16x16x32_bf16 v[20:23], a[16:19], a[176:179], v[20:23]
s_waitcnt lgkmcnt(3)
ds_read_b128 a[12:15], v2 offset:19456
v_cvt_pk_bf16_f32 v109, v26, v27
v_mfma_f32_16x16x32_bf16 v[76:79], v[88:91], v[36:39], v[76:79]
v_exp_f32 v28, v28
v_mfma_f32_16x16x32_bf16 v[176:179], a[112:115], v[36:39], v[176:179]
ds_read_b128 a[28:31], v2 offset:23552
ds_read_b128 a[24:27], v2 offset:22528
v_mfma_f32_16x16x32_bf16 v[176:179], a[80:83], v[32:35], v[176:179]
v_exp_f32 v29, v29
v_mfma_f32_16x16x32_bf16 v[180:183], a[84:87], v[32:35], v[180:183]
ds_read_b128 a[20:23], v2 offset:21504
v_cvt_pk_bf16_f32 v110, v28, v29
v_mfma_f32_16x16x32_bf16 v[180:183], a[116:119], v[36:39], v[180:183]
s_add_u32 s63, s63, 8192
v_exp_f32 v30, v30
v_mfma_f32_16x16x32_bf16 v[184:187], a[120:123], v[36:39], v[184:187]
buffer_store_dwordx4 v[104:107], v15, s[8:11], s63 offen offset:0 sc1
v_mfma_f32_16x16x32_bf16 v[184:187], a[88:91], v[32:35], v[184:187]
s_waitcnt vmcnt(20)
v_exp_f32 v31, v31
v_mfma_f32_16x16x32_bf16 v[188:191], a[92:95], v[32:35], v[188:191]
ds_read_b128 a[16:19], v2 offset:20480
v_cvt_pk_bf16_f32 v111, v30, v31
v_mfma_f32_16x16x32_bf16 v[188:191], a[124:127], v[36:39], v[188:191]
s_barrier
v_mfma_f32_16x16x32_bf16 v[24:27], a[32:35], a[176:179], v[52:55]
v_exp_f32 v16, v16
v_mfma_f32_16x16x32_bf16 v[24:27], a[36:39], a[180:183], v[24:27]
ds_read_b128 a[32:35], v2 offset:24576
ds_read_b128 a[36:39], v2 offset:25600
v_mfma_f32_16x16x32_bf16 v[24:27], a[40:43], a[184:187], v[24:27]
v_exp_f32 v17, v17
v_mfma_f32_16x16x32_bf16 v[24:27], a[44:47], a[188:191], v[24:27]
ds_read_b128 a[40:43], v2 offset:26624
v_cvt_pk_bf16_f32 v32, v16, v17
v_mfma_f32_16x16x32_bf16 v[28:31], a[60:63], a[188:191], v[52:55]
v_exp_f32 v18, v18
v_mfma_f32_16x16x32_bf16 v[28:31], a[56:59], a[184:187], v[28:31]
buffer_load_dwordx4 v1, s[44:47], s54 offen offset:3072 sc1 lds
v_mfma_f32_16x16x32_bf16 v[28:31], a[52:55], a[180:183], v[28:31]
s_add_u32 s54, s54, 28672
v_exp_f32 v19, v19
v_mfma_f32_16x16x32_bf16 v[28:31], a[48:51], a[176:179], v[28:31]
ds_read_b128 a[44:47], v2 offset:27648
v_cvt_pk_bf16_f32 v33, v18, v19
v_mfma_f32_16x16x32_bf16 v[80:83], v[88:91], v[92:95], v[80:83]
v_exp_f32 v20, v20
v_mfma_f32_16x16x32_bf16 v[192:195], a[64:67], v[92:95], v[192:195]
ds_read_b128 a[60:63], v2 offset:31744
ds_read_b128 a[56:59], v2 offset:30720
v_mfma_f32_16x16x32_bf16 v[192:195], a[96:99], v[108:111], v[192:195]
v_exp_f32 v21, v21
v_mfma_f32_16x16x32_bf16 v[196:199], a[100:103], v[108:111], v[196:199]
ds_read_b128 a[52:55], v2 offset:29696
v_cvt_pk_bf16_f32 v34, v20, v21
v_mfma_f32_16x16x32_bf16 v[196:199], a[68:71], v[92:95], v[196:199]
s_waitcnt lgkmcnt(7)
v_exp_f32 v22, v22
v_mfma_f32_16x16x32_bf16 v[200:203], a[72:75], v[92:95], v[200:203]
buffer_store_dwordx4 v[104:107], v15, s[8:11], s63 offen offset:1024 sc1
v_mfma_f32_16x16x32_bf16 v[200:203], a[104:107], v[108:111], v[200:203]
v_exp_f32 v23, v23
v_mfma_f32_16x16x32_bf16 v[204:207], a[108:111], v[108:111], v[204:207]
ds_read_b128 a[48:51], v2 offset:28672
v_cvt_pk_bf16_f32 v35, v22, v23
v_mfma_f32_16x16x32_bf16 v[204:207], a[76:79], v[92:95], v[204:207]
v_add_u32 v2, s52, v15
v_lshrrev_b32 v14, 9, v15
v_lshl_add_u32 v127, v14, 8, s35
v_bfe_u32 v14, v15, 8, 1
v_lshl_add_u32 v127, v14, 3, v127
v_and_b32 v14, 0xf0, v15
v_add_u32 v127, v127, v14
v_add_u32 v14, 0x20000, v127
v_rcp_f32 v96, v72
v_rcp_f32 v98, v76
s_lshl_b32 s26, s31, 12
s_add_u32 s26, s26, 57344
s_lshl_b32 s35, s32, 3
s_add_u32 s35, s35, s30
v_mov_b32 v97, v96
s_mul_i32 s35, s35, 188416
s_add_u32 s35, s35, s26
v_pk_mul_f32 v[128:129], v[128:129], v[96:97]
v_pk_mul_f32 v[130:131], v[130:131], v[96:97]
v_pk_mul_f32 v[132:133], v[132:133], v[96:97]
v_pk_mul_f32 v[134:135], v[134:135], v[96:97]
v_cvt_pk_bf16_f32 v128, v128, v129
v_cvt_pk_bf16_f32 v129, v130, v131
v_cvt_pk_bf16_f32 v130, v132, v133
v_cvt_pk_bf16_f32 v131, v134, v135
buffer_store_dwordx4 v[128:131], v15, s[48:51], s35 offen offset:0 sc1
v_pk_mul_f32 v[136:137], v[136:137], v[96:97]
v_pk_mul_f32 v[138:139], v[138:139], v[96:97]
v_pk_mul_f32 v[140:141], v[140:141], v[96:97]
v_pk_mul_f32 v[142:143], v[142:143], v[96:97]
v_cvt_pk_bf16_f32 v136, v136, v137
v_cvt_pk_bf16_f32 v137, v138, v139
v_cvt_pk_bf16_f32 v138, v140, v141
v_cvt_pk_bf16_f32 v139, v142, v143
buffer_store_dwordx4 v[136:139], v15, s[48:51], s35 offen offset:1024 sc1
v_pk_mul_f32 v[144:145], v[144:145], v[96:97]
v_pk_mul_f32 v[146:147], v[146:147], v[96:97]
v_pk_mul_f32 v[148:149], v[148:149], v[96:97]
v_pk_mul_f32 v[150:151], v[150:151], v[96:97]
v_cvt_pk_bf16_f32 v144, v144, v145
v_cvt_pk_bf16_f32 v145, v146, v147
v_cvt_pk_bf16_f32 v146, v148, v149
v_cvt_pk_bf16_f32 v147, v150, v151
buffer_store_dwordx4 v[144:147], v15, s[48:51], s35 offen offset:2048 sc1
v_pk_mul_f32 v[152:153], v[152:153], v[96:97]
v_pk_mul_f32 v[154:155], v[154:155], v[96:97]
v_pk_mul_f32 v[156:157], v[156:157], v[96:97]
v_pk_mul_f32 v[158:159], v[158:159], v[96:97]
v_cvt_pk_bf16_f32 v152, v152, v153
v_cvt_pk_bf16_f32 v153, v154, v155
v_cvt_pk_bf16_f32 v154, v156, v157
v_cvt_pk_bf16_f32 v155, v158, v159
buffer_store_dwordx4 v[152:155], v15, s[48:51], s35 offen offset:3072 sc1
s_lshl_b32 s35, s32, 3
s_add_u32 s35, s35, s30
s_add_u32 s35, s35, 4
v_mov_b32 v99, v98
s_mul_i32 s35, s35, 188416
s_add_u32 s35, s35, s26
v_pk_mul_f32 v[160:161], v[160:161], v[98:99]
v_pk_mul_f32 v[162:163], v[162:163], v[98:99]
v_pk_mul_f32 v[164:165], v[164:165], v[98:99]
v_pk_mul_f32 v[166:167], v[166:167], v[98:99]
v_cvt_pk_bf16_f32 v160, v160, v161
v_cvt_pk_bf16_f32 v161, v162, v163
v_cvt_pk_bf16_f32 v162, v164, v165
v_cvt_pk_bf16_f32 v163, v166, v167
buffer_store_dwordx4 v[160:163], v15, s[48:51], s35 offen offset:0 sc1
v_pk_mul_f32 v[168:169], v[168:169], v[98:99]
v_pk_mul_f32 v[170:171], v[170:171], v[98:99]
v_pk_mul_f32 v[172:173], v[172:173], v[98:99]
v_pk_mul_f32 v[174:175], v[174:175], v[98:99]
v_cvt_pk_bf16_f32 v168, v168, v169
v_cvt_pk_bf16_f32 v169, v170, v171
v_cvt_pk_bf16_f32 v170, v172, v173
v_cvt_pk_bf16_f32 v171, v174, v175
buffer_store_dwordx4 v[168:171], v15, s[48:51], s35 offen offset:1024 sc1
v_pk_mul_f32 v[176:177], v[176:177], v[98:99]
v_pk_mul_f32 v[178:179], v[178:179], v[98:99]
v_pk_mul_f32 v[180:181], v[180:181], v[98:99]
v_pk_mul_f32 v[182:183], v[182:183], v[98:99]
v_cvt_pk_bf16_f32 v176, v176, v177
v_cvt_pk_bf16_f32 v177, v178, v179
v_cvt_pk_bf16_f32 v178, v180, v181
v_cvt_pk_bf16_f32 v179, v182, v183
buffer_store_dwordx4 v[176:179], v15, s[48:51], s35 offen offset:2048 sc1
v_pk_mul_f32 v[184:185], v[184:185], v[98:99]
v_pk_mul_f32 v[186:187], v[186:187], v[98:99]
v_pk_mul_f32 v[188:189], v[188:189], v[98:99]
v_pk_mul_f32 v[190:191], v[190:191], v[98:99]
v_cvt_pk_bf16_f32 v184, v184, v185
v_cvt_pk_bf16_f32 v185, v186, v187
v_cvt_pk_bf16_f32 v186, v188, v189
v_cvt_pk_bf16_f32 v187, v190, v191
buffer_store_dwordx4 v[184:187], v15, s[48:51], s35 offen offset:3072 sc1
v_mfma_f32_16x16x32_bf16 v[132:135], v[88:91], v[128:131], 0
v_cndmask_b32 v56, v3, v48, s[64:65]
v_cndmask_b32 v57, v3, v48, s[66:67]
v_mfma_f32_16x16x32_bf16 v[132:135], v[88:91], v[136:139], v[132:135]
v_cndmask_b32 v58, v3, v48, s[68:69]
v_cndmask_b32 v59, v3, v48, s[70:71]
v_mfma_f32_16x16x32_bf16 v[132:135], v[88:91], v[144:147], v[132:135]
v_cndmask_b32 v60, v3, v48, s[72:73]
v_cndmask_b32 v61, v3, v48, s[74:75]
v_mfma_f32_16x16x32_bf16 v[132:135], v[88:91], v[152:155], v[132:135]
v_cndmask_b32 v62, v3, v48, s[76:77]
v_cndmask_b32 v63, v3, v48, s[78:79]
v_mfma_f32_16x16x32_bf16 v[164:167], v[88:91], v[160:163], 0
v_cndmask_b32 v64, v3, v48, s[80:81]
v_cndmask_b32 v65, v3, v48, s[82:83]
v_mfma_f32_16x16x32_bf16 v[164:167], v[88:91], v[168:171], v[164:167]
v_cndmask_b32 v66, v3, v48, s[84:85]
v_cndmask_b32 v67, v3, v48, s[86:87]
v_mfma_f32_16x16x32_bf16 v[164:167], v[88:91], v[176:179], v[164:167]
v_cndmask_b32 v68, v3, v48, s[88:89]
v_cndmask_b32 v69, v3, v48, s[90:91]
v_mfma_f32_16x16x32_bf16 v[164:167], v[88:91], v[184:187], v[164:167]
v_cndmask_b32 v70, v3, v48, s[92:93]
v_cndmask_b32 v71, v3, v48, s[94:95]
s_mov_b64 exec, 0
s_cmp_eq_u32 s30, 0
s_cbranch_scc1 L_t14
s_cmp_eq_u32 s30, 1
s_cbranch_scc1 L_t15
s_cmp_eq_u32 s30, 2
s_cbranch_scc1 L_t16
s_cmp_eq_u32 s30, 3
s_cbranch_scc1 L_t17
L_r3:
s_mov_b64 exec, -1
s_mov_b64 exec, 0
s_cmp_eq_u32 s30, 0
s_cbranch_scc1 L_t18
L_r4:
s_mov_b64 exec, -1
v_add_f32 v133, v133, v72
v_cmp_nge_f32 vcc, 0x7b800000, v133
s_cbranch_vccnz L_slow0
L_slow0_done:
v_add_f32 v165, v165, v76
v_cmp_nge_f32 vcc, 0x7b800000, v165
s_cbranch_vccnz L_slow1
L_slow1_done:
v_cndmask_b32 v128, v3, v52, s[64:65]
v_cndmask_b32 v129, v3, v52, s[66:67]
v_cndmask_b32 v130, v3, v52, s[68:69]
v_cndmask_b32 v131, v3, v52, s[70:71]
v_cndmask_b32 v132, v3, v52, s[72:73]
v_cndmask_b32 v133, v3, v52, s[74:75]
v_cndmask_b32 v134, v3, v52, s[76:77]
v_cndmask_b32 v135, v3, v52, s[78:79]
v_cndmask_b32 v136, v3, v52, s[80:81]
v_cndmask_b32 v137, v3, v52, s[82:83]
v_cndmask_b32 v138, v3, v52, s[84:85]
v_cndmask_b32 v139, v3, v52, s[86:87]
v_cndmask_b32 v140, v3, v52, s[88:89]
v_cndmask_b32 v141, v3, v52, s[90:91]
v_cndmask_b32 v142, v3, v52, s[92:93]
v_cndmask_b32 v143, v3, v52, s[94:95]
s_bfe_u32 s1, s2, 0x30003
s_lshr_b32 s6, s2, 6
s_lshl_b32 s60, s6, 0
s_xor_b32 s61, s1, s60
s_and_b32 s61, s61, 3
s_lshl_b32 s55, s32, 1
s_sub_u32 s55, 14, s55
s_cmp_eq_u32 s55, 0
s_cbranch_scc1 L_diag_hi
.p2align 3
L_single:
v_mfma_f32_16x16x32_bf16 v[16:19], a[0:3], a[160:163], v[48:51]
v_exp_f32 v24, v24
v_mfma_f32_16x16x32_bf16 v[16:19], a[4:7], a[164:167], v[16:19]
ds_read_b128 a[192:195], v2 offset:16384
ds_read_b128 a[196:199], v2 offset:17408
v_mfma_f32_16x16x32_bf16 v[16:19], a[8:11], a[168:171], v[16:19]
v_exp_f32 v25, v25
v_mfma_f32_16x16x32_bf16 v[16:19], a[12:15], a[172:175], v[16:19]
ds_read_b128 a[200:203], v2 offset:18432
v_cvt_pk_bf16_f32 v36, v24, v25
v_mfma_f32_16x16x32_bf16 v[20:23], a[28:31], a[172:175], v[48:51]
s_add_u32 m0, s53, s56
v_exp_f32 v26, v26
v_mfma_f32_16x16x32_bf16 v[20:23], a[24:27], a[168:171], v[20:23]
buffer_load_dwordx4 v1, s[44:47], s54 offen offset:0 sc1 lds
v_mfma_f32_16x16x32_bf16 v[20:23], a[20:23], a[164:167], v[20:23]
v_exp_f32 v27, v27
v_mfma_f32_16x16x32_bf16 v[20:23], a[16:19], a[160:163], v[20:23]
s_waitcnt lgkmcnt(3)
ds_read_b128 a[204:207], v2 offset:19456
v_cvt_pk_bf16_f32 v37, v26, v27
v_mfma_f32_16x16x32_bf16 v[80:83], v[88:91], v[108:111], v[80:83]
s_add_u32 s52, s52, 32768
v_exp_f32 v28, v28
v_mfma_f32_16x16x32_bf16 v[208:211], a[112:115], v[108:111], v[208:211]
ds_read_b128 a[220:223], v2 offset:23552
ds_read_b128 a[216:219], v2 offset:22528
v_mfma_f32_16x16x32_bf16 v[208:211], a[80:83], v[92:95], v[208:211]
s_cmp_eq_u32 s52, 163840
v_exp_f32 v29, v29
v_mfma_f32_16x16x32_bf16 v[212:215], a[84:87], v[92:95], v[212:215]
ds_read_b128 a[212:215], v2 offset:21504
v_cvt_pk_bf16_f32 v38, v28, v29
v_mfma_f32_16x16x32_bf16 v[212:215], a[116:119], v[108:111], v[212:215]
s_cselect_b32 s52, 0, s52
v_exp_f32 v30, v30
v_mfma_f32_16x16x32_bf16 v[216:219], a[120:123], v[108:111], v[216:219]
buffer_load_dwordx4 v1, s[44:47], s54 offen offset:1024 sc1 lds
v_mfma_f32_16x16x32_bf16 v[216:219], a[88:91], v[92:95], v[216:219]
v_exp_f32 v31, v31
v_mfma_f32_16x16x32_bf16 v[220:223], a[92:95], v[92:95], v[220:223]
ds_read_b128 a[208:211], v2 offset:20480
v_cvt_pk_bf16_f32 v39, v30, v31
v_mfma_f32_16x16x32_bf16 v[220:223], a[124:127], v[108:111], v[220:223]
v_mfma_f32_16x16x32_bf16 v[24:27], a[32:35], a[160:163], v[48:51]
s_add_u32 s53, s53, 32768
v_exp_f32 v16, v16
v_mfma_f32_16x16x32_bf16 v[24:27], a[36:39], a[164:167], v[24:27]
ds_read_b128 a[224:227], v2 offset:24576
ds_read_b128 a[228:231], v2 offset:25600
v_mfma_f32_16x16x32_bf16 v[24:27], a[40:43], a[168:171], v[24:27]
s_cmp_eq_u32 s53, 163840
v_exp_f32 v17, v17
v_mfma_f32_16x16x32_bf16 v[24:27], a[44:47], a[172:175], v[24:27]
ds_read_b128 a[232:235], v2 offset:26624
v_cvt_pk_bf16_f32 v92, v16, v17
v_mfma_f32_16x16x32_bf16 v[28:31], a[60:63], a[172:175], v[48:51]
s_cselect_b32 s53, 0, s53
v_exp_f32 v18, v18
v_mfma_f32_16x16x32_bf16 v[28:31], a[56:59], a[168:171], v[28:31]
buffer_load_dwordx4 v1, s[44:47], s54 offen offset:2048 sc1 lds
v_mfma_f32_16x16x32_bf16 v[28:31], a[52:55], a[164:167], v[28:31]
v_exp_f32 v19, v19
v_mfma_f32_16x16x32_bf16 v[28:31], a[48:51], a[160:163], v[28:31]
ds_read_b128 a[236:239], v2 offset:27648
v_cvt_pk_bf16_f32 v93, v18, v19
v_mfma_f32_16x16x32_bf16 v[84:87], v[88:91], v[32:35], v[84:87]
v_exp_f32 v20, v20
v_mfma_f32_16x16x32_bf16 v[224:227], a[64:67], v[32:35], v[224:227]
ds_read_b128 a[252:255], v2 offset:31744
ds_read_b128 a[248:251], v2 offset:30720
v_mfma_f32_16x16x32_bf16 v[224:227], a[96:99], v[36:39], v[224:227]
v_exp_f32 v21, v21
v_mfma_f32_16x16x32_bf16 v[228:231], a[100:103], v[36:39], v[228:231]
ds_read_b128 a[244:247], v2 offset:29696
v_cvt_pk_bf16_f32 v94, v20, v21
v_mfma_f32_16x16x32_bf16 v[228:231], a[68:71], v[32:35], v[228:231]
v_exp_f32 v22, v22
v_mfma_f32_16x16x32_bf16 v[232:235], a[72:75], v[32:35], v[232:235]
buffer_load_dwordx4 v1, s[44:47], s54 offen offset:3072 sc1 lds
v_mfma_f32_16x16x32_bf16 v[232:235], a[104:107], v[36:39], v[232:235]
s_add_u32 m0, m0, 4096
v_exp_f32 v23, v23
v_mfma_f32_16x16x32_bf16 v[236:239], a[108:111], v[36:39], v[236:239]
s_add_u32 s54, s54, 4096
ds_read_b128 a[240:243], v2 offset:28672
v_cvt_pk_bf16_f32 v95, v22, v23
v_mfma_f32_16x16x32_bf16 v[236:239], a[76:79], v[32:35], v[236:239]
v_add_u32 v13, s52, v15
v_mfma_f32_16x16x32_bf16 v[16:19], a[0:3], a[176:179], v[52:55]
v_exp_f32 v24, v24
v_mfma_f32_16x16x32_bf16 v[16:19], a[4:7], a[180:183], v[16:19]
ds_read_b128 a[64:67], v2 offset:0
ds_read_b128 a[96:99], v2 offset:8192
v_mfma_f32_16x16x32_bf16 v[16:19], a[8:11], a[184:187], v[16:19]
v_exp_f32 v25, v25
v_mfma_f32_16x16x32_bf16 v[16:19], a[12:15], a[188:191], v[16:19]
ds_read_b128 a[68:71], v2 offset:1024
v_cvt_pk_bf16_f32 v108, v24, v25
v_mfma_f32_16x16x32_bf16 v[20:23], a[28:31], a[188:191], v[52:55]
v_exp_f32 v26, v26
v_mfma_f32_16x16x32_bf16 v[20:23], a[24:27], a[184:187], v[20:23]
buffer_load_dwordx4 v1, s[44:47], s54 offen offset:0 sc1 lds
v_mfma_f32_16x16x32_bf16 v[20:23], a[20:23], a[180:183], v[20:23]
v_exp_f32 v27, v27
v_mfma_f32_16x16x32_bf16 v[20:23], a[16:19], a[176:179], v[20:23]
ds_read_b128 a[100:103], v2 offset:9216
v_cvt_pk_bf16_f32 v109, v26, v27
v_mfma_f32_16x16x32_bf16 v[84:87], v[88:91], v[36:39], v[84:87]
v_exp_f32 v28, v28
v_mfma_f32_16x16x32_bf16 v[240:243], a[112:115], v[36:39], v[240:243]
ds_read_b128 a[72:75], v2 offset:2048
ds_read_b128 a[104:107], v2 offset:10240
v_mfma_f32_16x16x32_bf16 v[240:243], a[80:83], v[32:35], v[240:243]
v_exp_f32 v29, v29
v_mfma_f32_16x16x32_bf16 v[244:247], a[84:87], v[32:35], v[244:247]
ds_read_b128 a[76:79], v2 offset:3072
v_cvt_pk_bf16_f32 v110, v28, v29
v_mfma_f32_16x16x32_bf16 v[244:247], a[116:119], v[36:39], v[244:247]
v_exp_f32 v30, v30
v_mfma_f32_16x16x32_bf16 v[248:251], a[120:123], v[36:39], v[248:251]
buffer_load_dwordx4 v1, s[44:47], s54 offen offset:1024 sc1 lds
v_mfma_f32_16x16x32_bf16 v[248:251], a[88:91], v[32:35], v[248:251]
s_waitcnt vmcnt(14)
v_exp_f32 v31, v31
v_mfma_f32_16x16x32_bf16 v[252:255], a[92:95], v[32:35], v[252:255]
ds_read_b128 a[108:111], v2 offset:11264
v_cvt_pk_bf16_f32 v111, v30, v31
v_mfma_f32_16x16x32_bf16 v[252:255], a[124:127], v[36:39], v[252:255]
s_barrier
v_mfma_f32_16x16x32_bf16 v[24:27], a[32:35], a[176:179], v[52:55]
v_exp_f32 v16, v16
v_mfma_f32_16x16x32_bf16 v[24:27], a[36:39], a[180:183], v[24:27]
ds_read_b128 a[80:83], v2 offset:4096
ds_read_b128 a[112:115], v2 offset:12288
v_mfma_f32_16x16x32_bf16 v[24:27], a[40:43], a[184:187], v[24:27]
v_exp_f32 v17, v17
v_mfma_f32_16x16x32_bf16 v[24:27], a[44:47], a[188:191], v[24:27]
ds_read_b128 a[84:87], v2 offset:5120
v_cvt_pk_bf16_f32 v32, v16, v17
v_mfma_f32_16x16x32_bf16 v[28:31], a[60:63], a[188:191], v[52:55]
v_exp_f32 v18, v18
v_mfma_f32_16x16x32_bf16 v[28:31], a[56:59], a[184:187], v[28:31]
buffer_load_dwordx4 v1, s[44:47], s54 offen offset:2048 sc1 lds
v_mfma_f32_16x16x32_bf16 v[28:31], a[52:55], a[180:183], v[28:31]
v_exp_f32 v19, v19
v_mfma_f32_16x16x32_bf16 v[28:31], a[48:51], a[176:179], v[28:31]
s_waitcnt lgkmcnt(3)
ds_read_b128 a[116:119], v2 offset:13312
v_cvt_pk_bf16_f32 v33, v18, v19
v_mfma_f32_16x16x32_bf16 v[80:83], v[88:91], v[92:95], v[80:83]
v_exp_f32 v20, v20
v_mfma_f32_16x16x32_bf16 v[192:195], a[64:67], v[92:95], v[192:195]
ds_read_b128 a[88:91], v2 offset:6144
ds_read_b128 a[120:123], v2 offset:14336
v_mfma_f32_16x16x32_bf16 v[192:195], a[96:99], v[108:111], v[192:195]
v_exp_f32 v21, v21
v_mfma_f32_16x16x32_bf16 v[196:199], a[100:103], v[108:111], v[196:199]
ds_read_b128 a[92:95], v2 offset:7168
v_cvt_pk_bf16_f32 v34, v20, v21
v_mfma_f32_16x16x32_bf16 v[196:199], a[68:71], v[92:95], v[196:199]
L_t14:
s_cbranch_execz L_r3
v_exp_f32 v22, v22
v_mfma_f32_16x16x32_bf16 v[200:203], a[72:75], v[92:95], v[200:203]
buffer_load_dwordx4 v1, s[44:47], s54 offen offset:3072 sc1 lds
v_mfma_f32_16x16x32_bf16 v[200:203], a[104:107], v[108:111], v[200:203]
s_add_u32 s54, s54, 28672
v_exp_f32 v23, v23
v_mfma_f32_16x16x32_bf16 v[204:207], a[108:111], v[108:111], v[204:207]
ds_read_b128 a[124:127], v2 offset:15360
v_cvt_pk_bf16_f32 v35, v22, v23
v_mfma_f32_16x16x32_bf16 v[204:207], a[76:79], v[92:95], v[204:207]
v_mfma_f32_16x16x32_bf16 v[16:19], a[192:195], a[160:163], v[48:51]
v_exp_f32 v24, v24
v_mfma_f32_16x16x32_bf16 v[16:19], a[196:199], a[164:167], v[16:19]
ds_read_b128 a[0:3], v13 offset:16384
ds_read_b128 a[4:7], v13 offset:17408
v_mfma_f32_16x16x32_bf16 v[16:19], a[200:203], a[168:171], v[16:19]
v_exp_f32 v25, v25
v_mfma_f32_16x16x32_bf16 v[16:19], a[204:207], a[172:175], v[16:19]
ds_read_b128 a[8:11], v13 offset:18432
v_cvt_pk_bf16_f32 v36, v24, v25
v_mfma_f32_16x16x32_bf16 v[20:23], a[220:223], a[172:175], v[48:51]
s_add_u32 m0, s53, s56
v_exp_f32 v26, v26
v_mfma_f32_16x16x32_bf16 v[20:23], a[216:219], a[168:171], v[20:23]
buffer_load_dwordx4 v1, s[44:47], s54 offen offset:0 sc1 lds
v_mfma_f32_16x16x32_bf16 v[20:23], a[212:215], a[164:167], v[20:23]
v_exp_f32 v27, v27
v_mfma_f32_16x16x32_bf16 v[20:23], a[208:211], a[160:163], v[20:23]
s_waitcnt lgkmcnt(3)
ds_read_b128 a[12:15], v13 offset:19456
v_cvt_pk_bf16_f32 v37, v26, v27
v_mfma_f32_16x16x32_bf16 v[80:83], v[88:91], v[108:111], v[80:83]
s_add_u32 s52, s52, 32768
v_exp_f32 v28, v28
v_mfma_f32_16x16x32_bf16 v[208:211], a[112:115], v[108:111], v[208:211]
ds_read_b128 a[28:31], v13 offset:23552
ds_read_b128 a[24:27], v13 offset:22528
v_mfma_f32_16x16x32_bf16 v[208:211], a[80:83], v[92:95], v[208:211]
s_cmp_eq_u32 s52, 163840
v_exp_f32 v29, v29
v_mfma_f32_16x16x32_bf16 v[212:215], a[84:87], v[92:95], v[212:215]
ds_read_b128 a[20:23], v13 offset:21504
v_cvt_pk_bf16_f32 v38, v28, v29
v_mfma_f32_16x16x32_bf16 v[212:215], a[116:119], v[108:111], v[212:215]
s_cselect_b32 s52, 0, s52
v_exp_f32 v30, v30
v_mfma_f32_16x16x32_bf16 v[216:219], a[120:123], v[108:111], v[216:219]
buffer_load_dwordx4 v1, s[44:47], s54 offen offset:1024 sc1 lds
v_mfma_f32_16x16x32_bf16 v[216:219], a[88:91], v[92:95], v[216:219]
v_exp_f32 v31, v31
v_mfma_f32_16x16x32_bf16 v[220:223], a[92:95], v[92:95], v[220:223]
s_cmp_eq_u32 s54, s57
ds_read_b128 a[16:19], v13 offset:20480
v_cvt_pk_bf16_f32 v39, v30, v31
v_mfma_f32_16x16x32_bf16 v[220:223], a[124:127], v[108:111], v[220:223]
s_cbranch_scc1 L_sh2_do
L_sh2:
v_mfma_f32_16x16x32_bf16 v[24:27], a[224:227], a[160:163], v[48:51]
s_add_u32 s53, s53, 32768
v_exp_f32 v16, v16
v_mfma_f32_16x16x32_bf16 v[24:27], a[228:231], a[164:167], v[24:27]
ds_read_b128 a[32:35], v13 offset:24576
ds_read_b128 a[36:39], v13 offset:25600
v_mfma_f32_16x16x32_bf16 v[24:27], a[232:235], a[168:171], v[24:27]
s_cmp_eq_u32 s53, 163840
v_exp_f32 v17, v17
v_mfma_f32_16x16x32_bf16 v[24:27], a[236:239], a[172:175], v[24:27]
ds_read_b128 a[40:43], v13 offset:26624
v_cvt_pk_bf16_f32 v92, v16, v17
v_mfma_f32_16x16x32_bf16 v[28:31], a[252:255], a[172:175], v[48:51]
s_cselect_b32 s53, 0, s53
v_exp_f32 v18, v18
v_mfma_f32_16x16x32_bf16 v[28:31], a[248:251], a[168:171], v[28:31]
buffer_load_dwordx4 v1, s[44:47], s54 offen offset:2048 sc1 lds
v_mfma_f32_16x16x32_bf16 v[28:31], a[244:247], a[164:167], v[28:31]
v_exp_f32 v19, v19
v_mfma_f32_16x16x32_bf16 v[28:31], a[240:243], a[160:163], v[28:31]
ds_read_b128 a[44:47], v13 offset:27648
v_cvt_pk_bf16_f32 v93, v18, v19
v_mfma_f32_16x16x32_bf16 v[84:87], v[88:91], v[32:35], v[84:87]
v_exp_f32 v20, v20
v_mfma_f32_16x16x32_bf16 v[224:227], a[64:67], v[32:35], v[224:227]
ds_read_b128 a[60:63], v13 offset:31744
ds_read_b128 a[56:59], v13 offset:30720
v_mfma_f32_16x16x32_bf16 v[224:227], a[96:99], v[36:39], v[224:227]
v_exp_f32 v21, v21
v_mfma_f32_16x16x32_bf16 v[228:231], a[100:103], v[36:39], v[228:231]
ds_read_b128 a[52:55], v13 offset:29696
v_cvt_pk_bf16_f32 v94, v20, v21
v_mfma_f32_16x16x32_bf16 v[228:231], a[68:71], v[32:35], v[228:231]
v_exp_f32 v22, v22
v_mfma_f32_16x16x32_bf16 v[232:235], a[72:75], v[32:35], v[232:235]
buffer_load_dwordx4 v1, s[44:47], s54 offen offset:3072 sc1 lds
v_mfma_f32_16x16x32_bf16 v[232:235], a[104:107], v[36:39], v[232:235]
s_add_u32 m0, m0, 4096
v_exp_f32 v23, v23
v_mfma_f32_16x16x32_bf16 v[236:239], a[108:111], v[36:39], v[236:239]
s_add_u32 s54, s54, 4096
ds_read_b128 a[48:51], v13 offset:28672
v_cvt_pk_bf16_f32 v95, v22, v23
v_mfma_f32_16x16x32_bf16 v[236:239], a[76:79], v[32:35], v[236:239]
v_add_u32 v2, s52, v15
v_mfma_f32_16x16x32_bf16 v[16:19], a[192:195], a[176:179], v[52:55]
v_exp_f32 v24, v24
v_mfma_f32_16x16x32_bf16 v[16:19], a[196:199], a[180:183], v[16:19]
ds_read_b128 a[64:67], v13 offset:0
ds_read_b128 a[96:99], v13 offset:8192
v_mfma_f32_16x16x32_bf16 v[16:19], a[200:203], a[184:187], v[16:19]
v_exp_f32 v25, v25
v_mfma_f32_16x16x32_bf16 v[16:19], a[204:207], a[188:191], v[16:19]
ds_read_b128 a[68:71], v13 offset:1024
v_cvt_pk_bf16_f32 v108, v24, v25
v_mfma_f32_16x16x32_bf16 v[20:23], a[220:223], a[188:191], v[52:55]
v_exp_f32 v26, v26
v_mfma_f32_16x16x32_bf16 v[20:23], a[216:219], a[184:187], v[20:23]
buffer_load_dwordx4 v1, s[44:47], s54 offen offset:0 sc1 lds
v_mfma_f32_16x16x32_bf16 v[20:23], a[212:215], a[180:183], v[20:23]
v_exp_f32 v27, v27
v_mfma_f32_16x16x32_bf16 v[20:23], a[208:211], a[176:179], v[20:23]
ds_read_b128 a[100:103], v13 offset:9216
v_cvt_pk_bf16_f32 v109, v26, v27
v_mfma_f32_16x16x32_bf16 v[84:87], v[88:91], v[36:39], v[84:87]
v_exp_f32 v28, v28
v_mfma_f32_16x16x32_bf16 v[240:243], a[112:115], v[36:39], v[240:243]
ds_read_b128 a[72:75], v13 offset:2048
ds_read_b128 a[104:107], v13 offset:10240
v_mfma_f32_16x16x32_bf16 v[240:243], a[80:83], v[32:35], v[240:243]
v_exp_f32 v29, v29
v_mfma_f32_16x16x32_bf16 v[244:247], a[84:87], v[32:35], v[244:247]
ds_read_b128 a[76:79], v13 offset:3072
v_cvt_pk_bf16_f32 v110, v28, v29
v_mfma_f32_16x16x32_bf16 v[244:247], a[116:119], v[36:39], v[244:247]
v_exp_f32 v30, v30
v_mfma_f32_16x16x32_bf16 v[248:251], a[120:123], v[36:39], v[248:251]
buffer_load_dwordx4 v1, s[44:47], s54 offen offset:1024 sc1 lds
v_mfma_f32_16x16x32_bf16 v[248:251], a[88:91], v[32:35], v[248:251]
s_waitcnt vmcnt(14)
v_exp_f32 v31, v31
v_mfma_f32_16x16x32_bf16 v[252:255], a[92:95], v[32:35], v[252:255]
ds_read_b128 a[108:111], v13 offset:11264
v_cvt_pk_bf16_f32 v111, v30, v31
v_mfma_f32_16x16x32_bf16 v[252:255], a[124:127], v[36:39], v[252:255]
s_barrier
v_mfma_f32_16x16x32_bf16 v[24:27], a[224:227], a[176:179], v[52:55]
v_exp_f32 v16, v16
v_mfma_f32_16x16x32_bf16 v[24:27], a[228:231], a[180:183], v[24:27]
ds_read_b128 a[80:83], v13 offset:4096
ds_read_b128 a[112:115], v13 offset:12288
v_mfma_f32_16x16x32_bf16 v[24:27], a[232:235], a[184:187], v[24:27]
v_exp_f32 v17, v17
v_mfma_f32_16x16x32_bf16 v[24:27], a[236:239], a[188:191], v[24:27]
ds_read_b128 a[84:87], v13 offset:5120
v_cvt_pk_bf16_f32 v32, v16, v17
v_mfma_f32_16x16x32_bf16 v[28:31], a[252:255], a[188:191], v[52:55]
v_exp_f32 v18, v18
v_mfma_f32_16x16x32_bf16 v[28:31], a[248:251], a[184:187], v[28:31]
buffer_load_dwordx4 v1, s[44:47], s54 offen offset:2048 sc1 lds
v_mfma_f32_16x16x32_bf16 v[28:31], a[244:247], a[180:183], v[28:31]
v_exp_f32 v19, v19
v_mfma_f32_16x16x32_bf16 v[28:31], a[240:243], a[176:179], v[28:31]
s_waitcnt lgkmcnt(3)
ds_read_b128 a[116:119], v13 offset:13312
v_cvt_pk_bf16_f32 v33, v18, v19
v_mfma_f32_16x16x32_bf16 v[80:83], v[88:91], v[92:95], v[80:83]
v_exp_f32 v20, v20
v_mfma_f32_16x16x32_bf16 v[192:195], a[64:67], v[92:95], v[192:195]
ds_read_b128 a[88:91], v13 offset:6144
ds_read_b128 a[120:123], v13 offset:14336
v_mfma_f32_16x16x32_bf16 v[192:195], a[96:99], v[108:111], v[192:195]
s_sub_u32 s55, s55, 1
v_exp_f32 v21, v21
v_mfma_f32_16x16x32_bf16 v[196:199], a[100:103], v[108:111], v[196:199]
ds_read_b128 a[92:95], v13 offset:7168
v_cvt_pk_bf16_f32 v34, v20, v21
v_mfma_f32_16x16x32_bf16 v[196:199], a[68:71], v[92:95], v[196:199]
v_exp_f32 v22, v22
v_mfma_f32_16x16x32_bf16 v[200:203], a[72:75], v[92:95], v[200:203]
buffer_load_dwordx4 v1, s[44:47], s54 offen offset:3072 sc1 lds
v_mfma_f32_16x16x32_bf16 v[200:203], a[104:107], v[108:111], v[200:203]
s_add_u32 s54, s54, 28672
v_exp_f32 v23, v23
v_mfma_f32_16x16x32_bf16 v[204:207], a[108:111], v[108:111], v[204:207]
s_cmp_lg_u32 s55, 0
ds_read_b128 a[124:127], v13 offset:15360
v_cvt_pk_bf16_f32 v35, v22, v23
v_mfma_f32_16x16x32_bf16 v[204:207], a[76:79], v[92:95], v[204:207]
s_cbranch_scc1 L_single
L_diag_hi:
v_mfma_f32_16x16x32_bf16 v[16:19], a[0:3], a[160:163], v[56:59]
s_and_b32 s35, s15, 0xff80
v_exp_f32 v24, v24
v_mfma_f32_16x16x32_bf16 v[16:19], a[4:7], a[164:167], v[16:19]
s_add_u32 s35, s35, 8192
ds_read_b128 a[192:195], v2 offset:16384
ds_read_b128 a[196:199], v2 offset:17408
v_mfma_f32_16x16x32_bf16 v[16:19], a[8:11], a[168:171], v[16:19]
v_exp_f32 v25, v25
v_bfe_u32 v8, v15, 4, 5
v_mfma_f32_16x16x32_bf16 v[16:19], a[12:15], a[172:175], v[16:19]
s_mov_b32 s60, 0
ds_read_b128 a[200:203], v2 offset:18432
v_cvt_pk_bf16_f32 v36, v24, v25
v_mfma_f32_16x16x32_bf16 v[20:23], a[28:31], a[172:175], v[60:63]
v_exp_f32 v26, v26
v_lshl_add_u32 v8, v8, 2, s35
v_mfma_f32_16x16x32_bf16 v[20:23], a[24:27], a[168:171], v[20:23]
global_load_dword v7, v8, s[16:17] sc1
v_mfma_f32_16x16x32_bf16 v[20:23], a[20:23], a[164:167], v[20:23]
s_add_u32 m0, s58, 16384
v_exp_f32 v27, v27
v_mfma_f32_16x16x32_bf16 v[20:23], a[16:19], a[160:163], v[20:23]
s_waitcnt lgkmcnt(3)
ds_read_b128 a[204:207], v2 offset:19456
v_cvt_pk_bf16_f32 v37, v26, v27
v_mfma_f32_16x16x32_bf16 v[80:83], v[88:91], v[108:111], v[80:83]
s_add_u32 s52, s52, 32768
v_exp_f32 v28, v28
v_mfma_f32_16x16x32_bf16 v[208:211], a[112:115], v[108:111], v[208:211]
s_add_u32 s18, s60, s7
ds_read_b128 a[220:223], v2 offset:23552
ds_read_b128 a[216:219], v2 offset:22528
v_mfma_f32_16x16x32_bf16 v[208:211], a[80:83], v[92:95], v[208:211]
s_cmp_eq_u32 s52, 163840
v_exp_f32 v29, v29
v_mfma_f32_16x16x32_bf16 v[212:215], a[84:87], v[92:95], v[212:215]
ds_read_b128 a[212:215], v2 offset:21504
v_cvt_pk_bf16_f32 v38, v28, v29
v_mfma_f32_16x16x32_bf16 v[212:215], a[116:119], v[108:111], v[212:215]
s_cselect_b32 s52, 0, s52
v_exp_f32 v30, v30
v_mfma_f32_16x16x32_bf16 v[216:219], a[120:123], v[108:111], v[216:219]
buffer_load_dwordx4 v9, s[40:43], s18 offen offset:0 lds
v_mfma_f32_16x16x32_bf16 v[216:219], a[88:91], v[92:95], v[216:219]
v_exp_f32 v31, v31
v_mfma_f32_16x16x32_bf16 v[220:223], a[92:95], v[92:95], v[220:223]
s_add_u32 s19, s18, 7168
ds_read_b128 a[208:211], v2 offset:20480
v_cvt_pk_bf16_f32 v39, v30, v31
v_mfma_f32_16x16x32_bf16 v[220:223], a[124:127], v[108:111], v[220:223]
buffer_load_dwordx4 v9, s[40:43], s19 offen offset:1024 lds
v_mfma_f32_16x16x32_bf16 v[24:27], a[32:35], a[160:163], v[64:67]
v_exp_f32 v16, v16
v_mfma_f32_16x16x32_bf16 v[24:27], a[36:39], a[164:167], v[24:27]
ds_read_b128 a[224:227], v2 offset:24576
ds_read_b128 a[228:231], v2 offset:25600
v_mfma_f32_16x16x32_bf16 v[24:27], a[40:43], a[168:171], v[24:27]
v_exp_f32 v17, v17
v_mfma_f32_16x16x32_bf16 v[24:27], a[44:47], a[172:175], v[24:27]
ds_read_b128 a[232:235], v2 offset:26624
v_cvt_pk_bf16_f32 v92, v16, v17
v_mfma_f32_16x16x32_bf16 v[28:31], a[60:63], a[172:175], v[68:71]
s_add_u32 s20, s18, 14336
v_exp_f32 v18, v18
v_mfma_f32_16x16x32_bf16 v[28:31], a[56:59], a[168:171], v[28:31]
buffer_load_dwordx4 v9, s[40:43], s20 offen offset:2048 lds
v_mfma_f32_16x16x32_bf16 v[28:31], a[52:55], a[164:167], v[28:31]
v_exp_f32 v19, v19
v_mfma_f32_16x16x32_bf16 v[28:31], a[48:51], a[160:163], v[28:31]
ds_read_b128 a[236:239], v2 offset:27648
v_cvt_pk_bf16_f32 v93, v18, v19
v_mfma_f32_16x16x32_bf16 v[84:87], v[88:91], v[32:35], v[84:87]
v_exp_f32 v20, v20
v_mfma_f32_16x16x32_bf16 v[224:227], a[64:67], v[32:35], v[224:227]
ds_read_b128 a[252:255], v2 offset:31744
ds_read_b128 a[248:251], v2 offset:30720
v_mfma_f32_16x16x32_bf16 v[224:227], a[96:99], v[36:39], v[224:227]
v_exp_f32 v21, v21
v_mfma_f32_16x16x32_bf16 v[228:231], a[100:103], v[36:39], v[228:231]
ds_read_b128 a[244:247], v2 offset:29696
v_cvt_pk_bf16_f32 v94, v20, v21
v_mfma_f32_16x16x32_bf16 v[228:231], a[68:71], v[32:35], v[228:231]
s_add_u32 s21, s18, 21504
v_exp_f32 v22, v22
v_mfma_f32_16x16x32_bf16 v[232:235], a[72:75], v[32:35], v[232:235]
buffer_load_dwordx4 v9, s[40:43], s21 offen offset:3072 lds
v_mfma_f32_16x16x32_bf16 v[232:235], a[104:107], v[36:39], v[232:235]
v_exp_f32 v23, v23
v_mfma_f32_16x16x32_bf16 v[236:239], a[108:111], v[36:39], v[236:239]
ds_read_b128 a[240:243], v2 offset:28672
v_cvt_pk_bf16_f32 v95, v22, v23
v_mfma_f32_16x16x32_bf16 v[236:239], a[76:79], v[32:35], v[236:239]
s_waitcnt vmcnt(4)
v_cmp_ne_u32 vcc, s3, v7
s_cbranch_vccnz L_h_spin
L_h:
v_mfma_f32_16x16x32_bf16 v[16:19], a[0:3], a[176:179], v[52:55]
s_add_u32 s35, s27, 12288
v_exp_f32 v24, v24
v_mfma_f32_16x16x32_bf16 v[16:19], a[4:7], a[180:183], v[16:19]
ds_read_b128 a[64:67], v2 offset:0
ds_read_b128 a[96:99], v2 offset:8192
v_mfma_f32_16x16x32_bf16 v[16:19], a[8:11], a[184:187], v[16:19]
s_mov_b32 s59, 0
v_exp_f32 v25, v25
v_mfma_f32_16x16x32_bf16 v[16:19], a[12:15], a[188:191], v[16:19]
s_add_u32 m0, s58, 0
ds_read_b128 a[68:71], v2 offset:1024
v_cvt_pk_bf16_f32 v108, v24, v25
v_mfma_f32_16x16x32_bf16 v[20:23], a[28:31], a[188:191], v[52:55]
s_add_u32 s22, s12, s59
v_exp_f32 v26, v26
v_mfma_f32_16x16x32_bf16 v[20:23], a[24:27], a[184:187], v[20:23]
buffer_load_dwordx4 v15, s[48:51], s22 offen offset:0 sc1 lds
v_mfma_f32_16x16x32_bf16 v[20:23], a[20:23], a[180:183], v[20:23]
v_exp_f32 v27, v27
v_mfma_f32_16x16x32_bf16 v[20:23], a[16:19], a[176:179], v[20:23]
ds_read_b128 a[100:103], v2 offset:9216
v_cvt_pk_bf16_f32 v109, v26, v27
v_mfma_f32_16x16x32_bf16 v[84:87], v[88:91], v[36:39], v[84:87]
v_exp_f32 v28, v28
v_mfma_f32_16x16x32_bf16 v[240:243], a[112:115], v[36:39], v[240:243]
ds_read_b128 a[72:75], v2 offset:2048
ds_read_b128 a[104:107], v2 offset:10240
v_mfma_f32_16x16x32_bf16 v[240:243], a[80:83], v[32:35], v[240:243]
v_exp_f32 v29, v29
v_mfma_f32_16x16x32_bf16 v[244:247], a[84:87], v[32:35], v[244:247]
ds_read_b128 a[76:79], v2 offset:3072
v_cvt_pk_bf16_f32 v110, v28, v29
v_mfma_f32_16x16x32_bf16 v[244:247], a[116:119], v[36:39], v[244:247]
v_exp_f32 v30, v30
v_mfma_f32_16x16x32_bf16 v[248:251], a[120:123], v[36:39], v[248:251]
buffer_load_dwordx4 v15, s[48:51], s22 offen offset:1024 sc1 lds
v_mfma_f32_16x16x32_bf16 v[248:251], a[88:91], v[32:35], v[248:251]
v_exp_f32 v31, v31
v_mfma_f32_16x16x32_bf16 v[252:255], a[92:95], v[32:35], v[252:255]
ds_read_b128 a[108:111], v2 offset:11264
v_cvt_pk_bf16_f32 v111, v30, v31
v_mfma_f32_16x16x32_bf16 v[252:255], a[124:127], v[36:39], v[252:255]
s_barrier
v_mov_b32 v7, s3
v_mov_b32 v8, s35
v_mfma_f32_16x16x32_bf16 v[24:27], a[32:35], a[176:179], v[52:55]
v_exp_f32 v16, v16
v_mfma_f32_16x16x32_bf16 v[24:27], a[36:39], a[180:183], v[24:27]
ds_read_b128 a[80:83], v2 offset:4096
ds_read_b128 a[112:115], v2 offset:12288
v_mfma_f32_16x16x32_bf16 v[24:27], a[40:43], a[184:187], v[24:27]
s_cmp_lg_u32 s30, 0
s_cbranch_scc1 L_sig_lo
s_mov_b64 exec, 1
global_store_dword v8, v7, s[16:17] sc1
s_mov_b64 exec, -1
L_sig_lo:
v_exp_f32 v17, v17
v_mfma_f32_16x16x32_bf16 v[24:27], a[44:47], a[188:191], v[24:27]
ds_read_b128 a[84:87], v2 offset:5120
v_cvt_pk_bf16_f32 v32, v16, v17
v_mfma_f32_16x16x32_bf16 v[28:31], a[60:63], a[188:191], v[52:55]
s_add_u32 s23, s13, s59
v_exp_f32 v18, v18
v_mfma_f32_16x16x32_bf16 v[28:31], a[56:59], a[184:187], v[28:31]
buffer_load_dwordx4 v15, s[48:51], s23 offen offset:2048 sc1 lds
v_mfma_f32_16x16x32_bf16 v[28:31], a[52:55], a[180:183], v[28:31]
v_exp_f32 v19, v19
v_mfma_f32_16x16x32_bf16 v[28:31], a[48:51], a[176:179], v[28:31]
s_waitcnt lgkmcnt(3)
ds_read_b128 a[116:119], v2 offset:13312
v_cvt_pk_bf16_f32 v33, v18, v19
v_mfma_f32_16x16x32_bf16 v[80:83], v[88:91], v[92:95], v[80:83]
v_exp_f32 v20, v20
v_mfma_f32_16x16x32_bf16 v[192:195], a[64:67], v[92:95], v[192:195]
ds_read_b128 a[88:91], v2 offset:6144
ds_read_b128 a[120:123], v2 offset:14336
v_mfma_f32_16x16x32_bf16 v[192:195], a[96:99], v[108:111], v[192:195]
v_exp_f32 v21, v21
v_mfma_f32_16x16x32_bf16 v[196:199], a[100:103], v[108:111], v[196:199]
ds_read_b128 a[92:95], v2 offset:7168
v_cvt_pk_bf16_f32 v34, v20, v21
v_mfma_f32_16x16x32_bf16 v[196:199], a[68:71], v[92:95], v[196:199]
v_exp_f32 v22, v22
v_mfma_f32_16x16x32_bf16 v[200:203], a[72:75], v[92:95], v[200:203]
buffer_load_dwordx4 v15, s[48:51], s23 offen offset:3072 sc1 lds
v_mfma_f32_16x16x32_bf16 v[200:203], a[104:107], v[108:111], v[200:203]
v_exp_f32 v23, v23
v_mfma_f32_16x16x32_bf16 v[204:207], a[108:111], v[108:111], v[204:207]
ds_read_b128 a[124:127], v2 offset:15360
v_cvt_pk_bf16_f32 v35, v22, v23
v_mfma_f32_16x16x32_bf16 v[204:207], a[76:79], v[92:95], v[204:207]
v_add_u32 v2, s52, v15
v_mfma_f32_16x16x32_bf16 v[16:19], a[192:195], a[176:179], v[128:131]
v_exp_f32 v24, v24
v_mfma_f32_16x16x32_bf16 v[16:19], a[196:199], a[180:183], v[16:19]
ds_read_b128 a[0:3], v2 offset:0
ds_read_b128 a[32:35], v2 offset:8192
v_mfma_f32_16x16x32_bf16 v[16:19], a[200:203], a[184:187], v[16:19]
s_mov_b32 s60, 65536
v_exp_f32 v25, v25
v_mfma_f32_16x16x32_bf16 v[16:19], a[204:207], a[188:191], v[16:19]
s_add_u32 m0, s58, 49152
ds_read_b128 a[4:7], v2 offset:1024
v_cvt_pk_bf16_f32 v36, v24, v25
v_mfma_f32_16x16x32_bf16 v[20:23], a[220:223], a[188:191], v[132:135]
s_add_u32 s18, s60, s7
v_exp_f32 v26, v26
v_mfma_f32_16x16x32_bf16 v[20:23], a[216:219], a[184:187], v[20:23]
buffer_load_dwordx4 v9, s[40:43], s18 offen offset:0 lds
v_mfma_f32_16x16x32_bf16 v[20:23], a[212:215], a[180:183], v[20:23]
v_exp_f32 v27, v27
v_mfma_f32_16x16x32_bf16 v[20:23], a[208:211], a[176:179], v[20:23]
s_waitcnt lgkmcnt(3)
ds_read_b128 a[36:39], v2 offset:9216
v_cvt_pk_bf16_f32 v37, v26, v27
v_mfma_f32_16x16x32_bf16 v[80:83], v[88:91], v[108:111], v[80:83]
v_exp_f32 v28, v28
v_mfma_f32_16x16x32_bf16 v[208:211], a[112:115], v[108:111], v[208:211]
ds_read_b128 a[8:11], v2 offset:2048
ds_read_b128 a[40:43], v2 offset:10240
v_mfma_f32_16x16x32_bf16 v[208:211], a[80:83], v[92:95], v[208:211]
v_exp_f32 v29, v29
v_mfma_f32_16x16x32_bf16 v[212:215], a[84:87], v[92:95], v[212:215]
ds_read_b128 a[12:15], v2 offset:3072
v_cvt_pk_bf16_f32 v38, v28, v29
v_mfma_f32_16x16x32_bf16 v[212:215], a[116:119], v[108:111], v[212:215]
s_add_u32 s19, s18, 7168
v_exp_f32 v30, v30
v_mfma_f32_16x16x32_bf16 v[216:219], a[120:123], v[108:111], v[216:219]
buffer_load_dwordx4 v9, s[40:43], s19 offen offset:1024 lds
v_mfma_f32_16x16x32_bf16 v[216:219], a[88:91], v[92:95], v[216:219]
v_exp_f32 v31, v31
v_mfma_f32_16x16x32_bf16 v[220:223], a[92:95], v[92:95], v[220:223]
s_add_u32 s20, s18, 14336
ds_read_b128 a[44:47], v2 offset:11264
v_cvt_pk_bf16_f32 v39, v30, v31
v_mfma_f32_16x16x32_bf16 v[220:223], a[124:127], v[108:111], v[220:223]
buffer_load_dwordx4 v9, s[40:43], s20 offen offset:2048 lds
v_mfma_f32_16x16x32_bf16 v[24:27], a[224:227], a[176:179], v[136:139]
v_exp_f32 v16, v16
v_mfma_f32_16x16x32_bf16 v[24:27], a[228:231], a[180:183], v[24:27]
ds_read_b128 a[16:19], v2 offset:4096
ds_read_b128 a[48:51], v2 offset:12288
v_mfma_f32_16x16x32_bf16 v[24:27], a[232:235], a[184:187], v[24:27]
v_exp_f32 v17, v17
v_mfma_f32_16x16x32_bf16 v[24:27], a[236:239], a[188:191], v[24:27]
ds_read_b128 a[20:23], v2 offset:5120
v_cvt_pk_bf16_f32 v92, v16, v17
v_mfma_f32_16x16x32_bf16 v[28:31], a[252:255], a[188:191], v[140:143]
s_add_u32 s21, s18, 21504
v_exp_f32 v18, v18
v_mfma_f32_16x16x32_bf16 v[28:31], a[248:251], a[184:187], v[28:31]
buffer_load_dwordx4 v9, s[40:43], s21 offen offset:3072 lds
v_mfma_f32_16x16x32_bf16 v[28:31], a[244:247], a[180:183], v[28:31]
v_exp_f32 v19, v19
v_mfma_f32_16x16x32_bf16 v[28:31], a[240:243], a[176:179], v[28:31]
ds_read_b128 a[52:55], v2 offset:13312
v_cvt_pk_bf16_f32 v93, v18, v19
v_mfma_f32_16x16x32_bf16 v[84:87], v[88:91], v[32:35], v[84:87]
v_exp_f32 v20, v20
v_mfma_f32_16x16x32_bf16 v[224:227], a[64:67], v[32:35], v[224:227]
ds_read_b128 a[24:27], v2 offset:6144
ds_read_b128 a[56:59], v2 offset:14336
v_mfma_f32_16x16x32_bf16 v[224:227], a[96:99], v[36:39], v[224:227]
s_mov_b32 s59, 2048
v_exp_f32 v21, v21
v_mfma_f32_16x16x32_bf16 v[228:231], a[100:103], v[36:39], v[228:231]
s_add_u32 m0, s58, 32768
ds_read_b128 a[28:31], v2 offset:7168
v_cvt_pk_bf16_f32 v94, v20, v21
v_mfma_f32_16x16x32_bf16 v[228:231], a[68:71], v[32:35], v[228:231]
s_add_u32 s22, s12, s59
v_exp_f32 v22, v22
v_mfma_f32_16x16x32_bf16 v[232:235], a[72:75], v[32:35], v[232:235]
buffer_load_dwordx4 v15, s[48:51], s22 offen offset:0 sc1 lds
v_mfma_f32_16x16x32_bf16 v[232:235], a[104:107], v[36:39], v[232:235]
v_exp_f32 v23, v23
v_mfma_f32_16x16x32_bf16 v[236:239], a[108:111], v[36:39], v[236:239]
ds_read_b128 a[60:63], v2 offset:15360
v_cvt_pk_bf16_f32 v95, v22, v23
v_mfma_f32_16x16x32_bf16 v[236:239], a[76:79], v[32:35], v[236:239]
buffer_load_dwordx4 v15, s[48:51], s22 offen offset:1024 sc1 lds
v_rcp_f32 v96, v80
s_lshl_b32 s26, s31, 12
s_add_u32 s26, s26, 57344
s_sub_u32 s35, 15, s32
s_lshl_b32 s35, s35, 3
s_add_u32 s35, s35, s30
v_mov_b32 v97, v96
s_mul_i32 s35, s35, 188416
s_add_u32 s35, s35, s26
v_pk_mul_f32 v[192:193], v[192:193], v[96:97]
v_pk_mul_f32 v[194:195], v[194:195], v[96:97]
v_pk_mul_f32 v[196:197], v[196:197], v[96:97]
v_pk_mul_f32 v[198:199], v[198:199], v[96:97]
v_cvt_pk_bf16_f32 v192, v192, v193
v_cvt_pk_bf16_f32 v193, v194, v195
v_cvt_pk_bf16_f32 v194, v196, v197
v_cvt_pk_bf16_f32 v195, v198, v199
buffer_store_dwordx4 v[192:195], v15, s[48:51], s35 offen offset:0 sc1
s_add_u32 s23, s13, s59
buffer_load_dwordx4 v15, s[48:51], s23 offen offset:2048 sc1 lds
v_pk_mul_f32 v[200:201], v[200:201], v[96:97]
v_pk_mul_f32 v[202:203], v[202:203], v[96:97]
v_pk_mul_f32 v[204:205], v[204:205], v[96:97]
v_pk_mul_f32 v[206:207], v[206:207], v[96:97]
v_cvt_pk_bf16_f32 v200, v200, v201
v_cvt_pk_bf16_f32 v201, v202, v203
v_cvt_pk_bf16_f32 v202, v204, v205
v_cvt_pk_bf16_f32 v203, v206, v207
buffer_store_dwordx4 v[200:203], v15, s[48:51], s35 offen offset:1024 sc1
buffer_load_dwordx4 v15, s[48:51], s23 offen offset:3072 sc1 lds
v_pk_mul_f32 v[208:209], v[208:209], v[96:97]
v_pk_mul_f32 v[210:211], v[210:211], v[96:97]
v_pk_mul_f32 v[212:213], v[212:213], v[96:97]
v_pk_mul_f32 v[214:215], v[214:215], v[96:97]
v_cvt_pk_bf16_f32 v208, v208, v209
v_cvt_pk_bf16_f32 v209, v210, v211
v_cvt_pk_bf16_f32 v210, v212, v213
v_cvt_pk_bf16_f32 v211, v214, v215
buffer_store_dwordx4 v[208:211], v15, s[48:51], s35 offen offset:2048 sc1
s_mov_b32 s60, 131072
s_add_u32 m0, s58, 147456
s_add_u32 s18, s60, s7
buffer_load_dwordx4 v9, s[40:43], s18 offen offset:0 lds
v_pk_mul_f32 v[216:217], v[216:217], v[96:97]
v_pk_mul_f32 v[218:219], v[218:219], v[96:97]
v_pk_mul_f32 v[220:221], v[220:221], v[96:97]
v_pk_mul_f32 v[222:223], v[222:223], v[96:97]
v_cvt_pk_bf16_f32 v216, v216, v217
v_cvt_pk_bf16_f32 v217, v218, v219
v_cvt_pk_bf16_f32 v218, v220, v221
v_cvt_pk_bf16_f32 v219, v222, v223
buffer_store_dwordx4 v[216:219], v15, s[48:51], s35 offen offset:3072 sc1
v_mfma_f32_16x16x32_bf16 v[196:199], v[88:91], v[192:195], 0
v_exp_f32 v24, v24
v_mfma_f32_16x16x32_bf16 v[196:199], v[88:91], v[200:203], v[196:199]
v_exp_f32 v25, v25
v_mfma_f32_16x16x32_bf16 v[196:199], v[88:91], v[208:211], v[196:199]
v_cvt_pk_bf16_f32 v108, v24, v25
v_mfma_f32_16x16x32_bf16 v[196:199], v[88:91], v[216:219], v[196:199]
v_exp_f32 v26, v26
v_exp_f32 v27, v27
s_nop 0
v_cvt_pk_bf16_f32 v109, v26, v27
v_mfma_f32_16x16x32_bf16 v[84:87], v[88:91], v[36:39], v[84:87]
s_add_u32 s19, s18, 7168
v_exp_f32 v28, v28
v_mfma_f32_16x16x32_bf16 v[240:243], a[112:115], v[36:39], v[240:243]
buffer_load_dwordx4 v9, s[40:43], s19 offen offset:1024 lds
v_mfma_f32_16x16x32_bf16 v[240:243], a[80:83], v[32:35], v[240:243]
v_exp_f32 v29, v29
v_mfma_f32_16x16x32_bf16 v[244:247], a[84:87], v[32:35], v[244:247]
v_cvt_pk_bf16_f32 v110, v28, v29
v_add_f32 v197, v197, v80
v_cmp_nge_f32 vcc, 0x7b800000, v197
s_cbranch_vccnz L_slow2
L_slow2_done:
v_mfma_f32_16x16x32_bf16 v[244:247], a[116:119], v[36:39], v[244:247]
s_add_u32 s20, s18, 14336
v_exp_f32 v30, v30
v_mfma_f32_16x16x32_bf16 v[248:251], a[120:123], v[36:39], v[248:251]
buffer_load_dwordx4 v9, s[40:43], s20 offen offset:2048 lds
v_mfma_f32_16x16x32_bf16 v[248:251], a[88:91], v[32:35], v[248:251]
v_exp_f32 v31, v31
v_mfma_f32_16x16x32_bf16 v[252:255], a[92:95], v[32:35], v[252:255]
s_add_u32 s21, s18, 21504
v_cvt_pk_bf16_f32 v111, v30, v31
v_mfma_f32_16x16x32_bf16 v[252:255], a[124:127], v[36:39], v[252:255]
buffer_load_dwordx4 v9, s[40:43], s21 offen offset:3072 lds
s_waitcnt vmcnt(16) lgkmcnt(0)
s_barrier
v_mfma_f32_16x16x32_bf16 v[84:87], v[88:91], v[92:95], v[84:87]
s_mov_b32 s59, 4096
v_mfma_f32_16x16x32_bf16 v[224:227], a[0:3], v[92:95], v[224:227]
s_add_u32 m0, s58, 131072
ds_read_b64_tr_b16 a[64:65], v113 offset:0
ds_read_b64_tr_b16 a[66:67], v113 offset:2048
v_mfma_f32_16x16x32_bf16 v[224:227], a[32:35], v[108:111], v[224:227]
s_add_u32 s22, s12, s59
v_mfma_f32_16x16x32_bf16 v[228:231], a[36:39], v[108:111], v[228:231]
buffer_load_dwordx4 v15, s[48:51], s22 offen offset:0 sc1 lds
v_mfma_f32_16x16x32_bf16 v[228:231], a[4:7], v[92:95], v[228:231]
ds_read_b128 a[80:83], v112 offset:0
v_mfma_f32_16x16x32_bf16 v[232:235], a[8:11], v[92:95], v[232:235]
ds_read_b64_tr_b16 a[68:69], v114 offset:0
ds_read_b64_tr_b16 a[70:71], v114 offset:2048
v_mfma_f32_16x16x32_bf16 v[232:235], a[40:43], v[108:111], v[232:235]
v_mfma_f32_16x16x32_bf16 v[236:239], a[44:47], v[108:111], v[236:239]
buffer_load_dwordx4 v15, s[48:51], s22 offen offset:1024 sc1 lds
v_mfma_f32_16x16x32_bf16 v[236:239], a[12:15], v[92:95], v[236:239]
ds_read_b128 a[84:87], v112 offset:2048
ds_read_b64_tr_b16 a[72:73], v115 offset:0
v_mfma_f32_16x16x32_bf16 v[84:87], v[88:91], v[108:111], v[84:87]
ds_read_b64_tr_b16 a[74:75], v115 offset:2048
ds_read_b128 a[88:91], v112 offset:4096
v_mfma_f32_16x16x32_bf16 v[240:243], a[48:51], v[108:111], v[240:243]
s_add_u32 s23, s13, s59
v_mfma_f32_16x16x32_bf16 v[240:243], a[16:19], v[92:95], v[240:243]
L_t15:
s_cbranch_execz L_r3
buffer_load_dwordx4 v15, s[48:51], s23 offen offset:2048 sc1 lds
v_mfma_f32_16x16x32_bf16 v[244:247], a[20:23], v[92:95], v[244:247]
ds_read_b64_tr_b16 a[76:77], v116 offset:0
v_mfma_f32_16x16x32_bf16 v[244:247], a[52:55], v[108:111], v[244:247]
ds_read_b64_tr_b16 a[78:79], v116 offset:2048
ds_read_b128 a[92:95], v112 offset:6144
v_mfma_f32_16x16x32_bf16 v[248:251], a[56:59], v[108:111], v[248:251]
v_mfma_f32_16x16x32_bf16 v[248:251], a[24:27], v[92:95], v[248:251]
buffer_load_dwordx4 v15, s[48:51], s23 offen offset:3072 sc1 lds
v_mfma_f32_16x16x32_bf16 v[252:255], a[28:31], v[92:95], v[252:255]
ds_read_b64_tr_b16 a[96:97], v113 offset:8192
v_mfma_f32_16x16x32_bf16 v[252:255], a[60:63], v[108:111], v[252:255]
ds_read_b64_tr_b16 a[98:99], v113 offset:10240
ds_read_b128 a[112:115], v112 offset:1024
ds_read_b64_tr_b16 a[100:101], v114 offset:8192
ds_read_b64_tr_b16 a[102:103], v114 offset:10240
ds_read_b128 a[116:119], v112 offset:3072
ds_read_b64_tr_b16 a[104:105], v115 offset:8192
ds_read_b64_tr_b16 a[106:107], v115 offset:10240
v_rcp_f32 v98, v84
s_lshl_b32 s26, s31, 12
s_add_u32 s26, s26, 57344
s_sub_u32 s35, 15, s32
s_lshl_b32 s35, s35, 3
s_add_u32 s35, s35, s30
s_add_u32 s35, s35, 4
v_mov_b32 v99, v98
s_mul_i32 s35, s35, 188416
s_add_u32 s35, s35, s26
v_pk_mul_f32 v[224:225], v[224:225], v[98:99]
v_pk_mul_f32 v[226:227], v[226:227], v[98:99]
v_pk_mul_f32 v[228:229], v[228:229], v[98:99]
v_pk_mul_f32 v[230:231], v[230:231], v[98:99]
v_cvt_pk_bf16_f32 v224, v224, v225
v_cvt_pk_bf16_f32 v225, v226, v227
v_cvt_pk_bf16_f32 v226, v228, v229
v_cvt_pk_bf16_f32 v227, v230, v231
buffer_store_dwordx4 v[224:227], v15, s[48:51], s35 offen offset:0 sc1
v_pk_mul_f32 v[232:233], v[232:233], v[98:99]
v_pk_mul_f32 v[234:235], v[234:235], v[98:99]
v_pk_mul_f32 v[236:237], v[236:237], v[98:99]
v_pk_mul_f32 v[238:239], v[238:239], v[98:99]
v_cvt_pk_bf16_f32 v232, v232, v233
v_cvt_pk_bf16_f32 v233, v234, v235
v_cvt_pk_bf16_f32 v234, v236, v237
v_cvt_pk_bf16_f32 v235, v238, v239
buffer_store_dwordx4 v[232:235], v15, s[48:51], s35 offen offset:1024 sc1
v_pk_mul_f32 v[240:241], v[240:241], v[98:99]
v_pk_mul_f32 v[242:243], v[242:243], v[98:99]
v_pk_mul_f32 v[244:245], v[244:245], v[98:99]
v_pk_mul_f32 v[246:247], v[246:247], v[98:99]
v_cvt_pk_bf16_f32 v240, v240, v241
v_cvt_pk_bf16_f32 v241, v242, v243
v_cvt_pk_bf16_f32 v242, v244, v245
v_cvt_pk_bf16_f32 v243, v246, v247
buffer_store_dwordx4 v[240:243], v15, s[48:51], s35 offen offset:2048 sc1
v_pk_mul_f32 v[248:249], v[248:249], v[98:99]
v_pk_mul_f32 v[250:251], v[250:251], v[98:99]
v_pk_mul_f32 v[252:253], v[252:253], v[98:99]
v_pk_mul_f32 v[254:255], v[254:255], v[98:99]
v_cvt_pk_bf16_f32 v248, v248, v249
v_cvt_pk_bf16_f32 v249, v250, v251
v_cvt_pk_bf16_f32 v250, v252, v253
v_cvt_pk_bf16_f32 v251, v254, v255
buffer_store_dwordx4 v[248:251], v15, s[48:51], s35 offen offset:3072 sc1
v_mfma_f32_16x16x32_bf16 v[228:231], v[88:91], v[224:227], 0
ds_read_b128 a[120:123], v112 offset:5120
v_mfma_f32_16x16x32_bf16 v[228:231], v[88:91], v[232:235], v[228:231]
ds_read_b64_tr_b16 a[108:109], v116 offset:8192
v_mfma_f32_16x16x32_bf16 v[228:231], v[88:91], v[240:243], v[228:231]
ds_read_b64_tr_b16 a[110:111], v116 offset:10240
v_mfma_f32_16x16x32_bf16 v[228:231], v[88:91], v[248:251], v[228:231]
ds_read_b128 a[124:127], v112 offset:7168
s_add_u32 s35, s27, 16384
v_mov_b32 v7, s3
v_mov_b32 v8, s35
s_waitcnt vmcnt(14) lgkmcnt(0)
s_nop 2
v_add_f32 v229, v229, v84
v_cmp_nge_f32 vcc, 0x7b800000, v229
s_cbranch_vccnz L_slow3
L_slow3_done:
s_barrier
v_mfma_f32_16x16x32_bf16 v[16:19], a[64:67], a[80:83], 0
s_mov_b32 s60, 196608
s_add_u32 m0, s58, 81920
s_add_u32 s18, s60, s7
v_mfma_f32_16x16x32_bf16 v[16:19], a[96:99], a[112:115], v[16:19]
buffer_load_dwordx4 v9, s[40:43], s18 offen offset:0 lds
v_mfma_f32_16x16x32_bf16 v[20:23], a[100:103], a[112:115], 0
ds_read_b64_tr_b16 a[0:1], v113 offset:32768
ds_read_b64_tr_b16 a[2:3], v113 offset:34816
v_mfma_f32_16x16x32_bf16 v[20:23], a[68:71], a[80:83], v[20:23]
s_add_u32 s19, s18, 7168
ds_read_b128 a[16:19], v112 offset:32768
ds_read_b64_tr_b16 a[4:5], v114 offset:32768
v_mfma_f32_16x16x32_bf16 v[24:27], a[72:75], a[80:83], 0
ds_read_b64_tr_b16 a[6:7], v114 offset:34816
ds_read_b128 a[20:23], v112 offset:34816
v_mfma_f32_16x16x32_bf16 v[24:27], a[104:107], a[112:115], v[24:27]
buffer_load_dwordx4 v9, s[40:43], s19 offen offset:1024 lds
v_mfma_f32_16x16x32_bf16 v[28:31], a[108:111], a[112:115], 0
ds_read_b64_tr_b16 a[8:9], v115 offset:32768
ds_read_b64_tr_b16 a[10:11], v115 offset:34816
v_mfma_f32_16x16x32_bf16 v[28:31], a[76:79], a[80:83], v[28:31]
s_add_u32 s20, s18, 14336
v_mfma_f32_16x16x32_bf16 v[44:47], a[76:79], a[84:87], 0
ds_read_b128 a[24:27], v112 offset:36864
ds_read_b64_tr_b16 a[12:13], v116 offset:32768
v_mfma_f32_16x16x32_bf16 v[44:47], a[108:111], a[116:119], v[44:47]
buffer_load_dwordx4 v9, s[40:43], s20 offen offset:2048 lds
v_mfma_f32_16x16x32_bf16 v[40:43], a[104:107], a[116:119], 0
ds_read_b64_tr_b16 a[14:15], v116 offset:34816
ds_read_b128 a[28:31], v112 offset:38912
v_mfma_f32_16x16x32_bf16 v[40:43], a[72:75], a[84:87], v[40:43]
s_add_u32 s21, s18, 21504
v_mfma_f32_16x16x32_bf16 v[36:39], a[68:71], a[84:87], 0
ds_read_b64_tr_b16 a[32:33], v113 offset:40960
ds_read_b64_tr_b16 a[34:35], v113 offset:43008
v_mfma_f32_16x16x32_bf16 v[36:39], a[100:103], a[116:119], v[36:39]
buffer_load_dwordx4 v9, s[40:43], s21 offen offset:3072 lds
v_mfma_f32_16x16x32_bf16 v[32:35], a[96:99], a[116:119], 0
ds_read_b128 a[48:51], v112 offset:33792
ds_read_b64_tr_b16 a[36:37], v114 offset:40960
v_mfma_f32_16x16x32_bf16 v[32:35], a[64:67], a[84:87], v[32:35]
s_mov_b32 s59, 6144
s_add_u32 m0, s58, 65536
s_add_u32 s22, s12, s59
v_mfma_f32_16x16x32_bf16 v[48:51], a[64:67], a[88:91], 0
ds_read_b64_tr_b16 a[38:39], v114 offset:43008
ds_read_b128 a[52:55], v112 offset:35840
v_mfma_f32_16x16x32_bf16 v[48:51], a[96:99], a[120:123], v[48:51]
buffer_load_dwordx4 v15, s[48:51], s22 offen offset:0 sc1 lds
v_mfma_f32_16x16x32_bf16 v[52:55], a[100:103], a[120:123], 0
ds_read_b64_tr_b16 a[40:41], v115 offset:40960
ds_read_b64_tr_b16 a[42:43], v115 offset:43008
v_mfma_f32_16x16x32_bf16 v[52:55], a[68:71], a[88:91], v[52:55]
v_mfma_f32_16x16x32_bf16 v[56:59], a[72:75], a[88:91], 0
ds_read_b128 a[56:59], v112 offset:37888
ds_read_b64_tr_b16 a[44:45], v116 offset:40960
v_mfma_f32_16x16x32_bf16 v[56:59], a[104:107], a[120:123], v[56:59]
buffer_load_dwordx4 v15, s[48:51], s22 offen offset:1024 sc1 lds
v_mfma_f32_16x16x32_bf16 v[60:63], a[108:111], a[120:123], 0
ds_read_b64_tr_b16 a[46:47], v116 offset:43008
ds_read_b128 a[60:63], v112 offset:39936
v_mfma_f32_16x16x32_bf16 v[60:63], a[76:79], a[88:91], v[60:63]
s_add_u32 s23, s13, s59
v_mfma_f32_16x16x32_bf16 v[76:79], a[76:79], a[92:95], 0
s_bitcmp1_b32 s2, 0
s_cselect_b32 s35, 0, 4096
v_mfma_f32_16x16x32_bf16 v[76:79], a[108:111], a[124:127], v[76:79]
buffer_load_dwordx4 v15, s[48:51], s23 offen offset:2048 sc1 lds
v_mfma_f32_16x16x32_bf16 v[72:75], a[104:107], a[124:127], 0
s_add_u32 s35, s35, s15
s_add_u32 s35, s35, 12288
v_mfma_f32_16x16x32_bf16 v[72:75], a[72:75], a[92:95], v[72:75]
v_mfma_f32_16x16x32_bf16 v[68:71], a[68:71], a[92:95], 0
s_mul_i32 s26, s0, 18432
s_add_u32 s26, s26, 57344
v_mfma_f32_16x16x32_bf16 v[68:71], a[100:103], a[124:127], v[68:71]
buffer_load_dwordx4 v15, s[48:51], s23 offen offset:3072 sc1 lds
v_mfma_f32_16x16x32_bf16 v[64:67], a[96:99], a[124:127], 0
v_mfma_f32_16x16x32_bf16 v[64:67], a[64:67], a[92:95], v[64:67]
s_waitcnt vmcnt(8) lgkmcnt(0)
s_barrier
s_cmp_lg_u32 s30, 0
s_cbranch_scc1 L_sig_hi
s_mov_b64 exec, 1
global_store_dword v8, v7, s[16:17] sc1
s_mov_b64 exec, -1
L_sig_hi:
v_bfe_u32 v8, v15, 4, 2
v_lshl_add_u32 v8, v8, 2, s35
v_mfma_f32_16x16x32_bf16 v[16:19], a[0:3], a[16:19], v[16:19]
s_mov_b32 s60, 262144
s_add_u32 m0, s58, 16384
s_add_u32 s18, s60, s7
v_mfma_f32_16x16x32_bf16 v[16:19], a[32:35], a[48:51], v[16:19]
buffer_load_dwordx4 v9, s[40:43], s18 offen offset:0 lds
v_mfma_f32_16x16x32_bf16 v[20:23], a[36:39], a[48:51], v[20:23]
ds_read_b64_tr_b16 a[64:65], v123 offset:0
ds_read_b64_tr_b16 a[66:67], v123 offset:2048
v_mfma_f32_16x16x32_bf16 v[20:23], a[4:7], a[16:19], v[20:23]
s_add_u32 s19, s18, 7168
ds_read_b128 a[80:83], v122 offset:0
ds_read_b64_tr_b16 a[68:69], v124 offset:0
v_mfma_f32_16x16x32_bf16 v[24:27], a[8:11], a[16:19], v[24:27]
ds_read_b64_tr_b16 a[70:71], v124 offset:2048
ds_read_b128 a[84:87], v122 offset:2048
v_mfma_f32_16x16x32_bf16 v[24:27], a[40:43], a[48:51], v[24:27]
buffer_load_dwordx4 v9, s[40:43], s19 offen offset:1024 lds
v_mfma_f32_16x16x32_bf16 v[28:31], a[44:47], a[48:51], v[28:31]
ds_read_b64_tr_b16 a[72:73], v125 offset:0
ds_read_b64_tr_b16 a[74:75], v125 offset:2048
v_mfma_f32_16x16x32_bf16 v[28:31], a[12:15], a[16:19], v[28:31]
s_add_u32 s20, s18, 14336
v_mfma_f32_16x16x32_bf16 v[44:47], a[12:15], a[20:23], v[44:47]
ds_read_b128 a[88:91], v122 offset:4096
ds_read_b64_tr_b16 a[76:77], v126 offset:0
v_mfma_f32_16x16x32_bf16 v[44:47], a[44:47], a[52:55], v[44:47]
buffer_load_dwordx4 v9, s[40:43], s20 offen offset:2048 lds
v_mfma_f32_16x16x32_bf16 v[40:43], a[40:43], a[52:55], v[40:43]
ds_read_b64_tr_b16 a[78:79], v126 offset:2048
ds_read_b128 a[92:95], v122 offset:6144
v_mfma_f32_16x16x32_bf16 v[40:43], a[8:11], a[20:23], v[40:43]
s_add_u32 s21, s18, 21504
v_mfma_f32_16x16x32_bf16 v[36:39], a[4:7], a[20:23], v[36:39]
ds_read_b64_tr_b16 a[96:97], v123 offset:8192
ds_read_b64_tr_b16 a[98:99], v123 offset:10240
v_mfma_f32_16x16x32_bf16 v[36:39], a[36:39], a[52:55], v[36:39]
buffer_load_dwordx4 v9, s[40:43], s21 offen offset:3072 lds
v_mfma_f32_16x16x32_bf16 v[32:35], a[32:35], a[52:55], v[32:35]
ds_read_b128 a[112:115], v122 offset:1024
ds_read_b64_tr_b16 a[100:101], v124 offset:8192
v_mfma_f32_16x16x32_bf16 v[32:35], a[0:3], a[20:23], v[32:35]
s_mov_b32 s59, 8192
s_add_u32 m0, s58, 0
s_add_u32 s22, s12, s59
v_mfma_f32_16x16x32_bf16 v[48:51], a[0:3], a[24:27], v[48:51]
ds_read_b64_tr_b16 a[102:103], v124 offset:10240
ds_read_b128 a[116:119], v122 offset:3072
v_mfma_f32_16x16x32_bf16 v[48:51], a[32:35], a[56:59], v[48:51]
buffer_load_dwordx4 v15, s[48:51], s22 offen offset:0 sc1 lds
v_mfma_f32_16x16x32_bf16 v[52:55], a[36:39], a[56:59], v[52:55]
ds_read_b64_tr_b16 a[104:105], v125 offset:8192
ds_read_b64_tr_b16 a[106:107], v125 offset:10240
v_mfma_f32_16x16x32_bf16 v[52:55], a[4:7], a[24:27], v[52:55]
v_mfma_f32_16x16x32_bf16 v[56:59], a[8:11], a[24:27], v[56:59]
ds_read_b128 a[120:123], v122 offset:5120
ds_read_b64_tr_b16 a[108:109], v126 offset:8192
v_mfma_f32_16x16x32_bf16 v[56:59], a[40:43], a[56:59], v[56:59]
buffer_load_dwordx4 v15, s[48:51], s22 offen offset:1024 sc1 lds
v_mfma_f32_16x16x32_bf16 v[60:63], a[44:47], a[56:59], v[60:63]
ds_read_b64_tr_b16 a[110:111], v126 offset:10240
ds_read_b128 a[124:127], v122 offset:7168
v_mfma_f32_16x16x32_bf16 v[60:63], a[12:15], a[24:27], v[60:63]
s_add_u32 s23, s13, s59
v_mfma_f32_16x16x32_bf16 v[76:79], a[12:15], a[28:31], v[76:79]
s_mov_b32 s44, s4
s_mov_b32 s45, s5
s_mov_b32 s46, 0x200000
v_mfma_f32_16x16x32_bf16 v[76:79], a[44:47], a[60:63], v[76:79]
buffer_load_dwordx4 v15, s[48:51], s23 offen offset:2048 sc1 lds
v_mfma_f32_16x16x32_bf16 v[72:75], a[40:43], a[60:63], v[72:75]
v_mfma_f32_16x16x32_bf16 v[72:75], a[8:11], a[28:31], v[72:75]
v_mfma_f32_16x16x32_bf16 v[68:71], a[4:7], a[28:31], v[68:71]
v_mfma_f32_16x16x32_bf16 v[68:71], a[36:39], a[60:63], v[68:71]
buffer_load_dwordx4 v15, s[48:51], s23 offen offset:3072 sc1 lds
v_mfma_f32_16x16x32_bf16 v[64:67], a[32:35], a[60:63], v[64:67]
v_mfma_f32_16x16x32_bf16 v[64:67], a[0:3], a[28:31], v[64:67]
s_waitcnt vmcnt(8) lgkmcnt(0)
s_barrier
v_mfma_f32_16x16x32_bf16 v[16:19], a[64:67], a[80:83], v[16:19]
s_mov_b32 s60, 327680
s_add_u32 m0, s58, 49152
s_add_u32 s18, s60, s7
v_mfma_f32_16x16x32_bf16 v[16:19], a[96:99], a[112:115], v[16:19]
buffer_load_dwordx4 v9, s[40:43], s18 offen offset:0 lds
v_mfma_f32_16x16x32_bf16 v[20:23], a[100:103], a[112:115], v[20:23]
ds_read_b64_tr_b16 a[0:1], v118 offset:0
ds_read_b64_tr_b16 a[2:3], v118 offset:2048
v_mfma_f32_16x16x32_bf16 v[20:23], a[68:71], a[80:83], v[20:23]
s_add_u32 s19, s18, 7168
ds_read_b128 a[16:19], v117 offset:0
ds_read_b64_tr_b16 a[4:5], v119 offset:0
v_mfma_f32_16x16x32_bf16 v[24:27], a[72:75], a[80:83], v[24:27]
ds_read_b64_tr_b16 a[6:7], v119 offset:2048
ds_read_b128 a[20:23], v117 offset:2048
v_mfma_f32_16x16x32_bf16 v[24:27], a[104:107], a[112:115], v[24:27]
buffer_load_dwordx4 v9, s[40:43], s19 offen offset:1024 lds
v_mfma_f32_16x16x32_bf16 v[28:31], a[108:111], a[112:115], v[28:31]
ds_read_b64_tr_b16 a[8:9], v120 offset:0
ds_read_b64_tr_b16 a[10:11], v120 offset:2048
v_mfma_f32_16x16x32_bf16 v[28:31], a[76:79], a[80:83], v[28:31]
s_add_u32 s20, s18, 14336
v_mfma_f32_16x16x32_bf16 v[44:47], a[76:79], a[84:87], v[44:47]
ds_read_b128 a[24:27], v117 offset:4096
ds_read_b64_tr_b16 a[12:13], v121 offset:0
v_mfma_f32_16x16x32_bf16 v[44:47], a[108:111], a[116:119], v[44:47]
buffer_load_dwordx4 v9, s[40:43], s20 offen offset:2048 lds
v_mfma_f32_16x16x32_bf16 v[40:43], a[104:107], a[116:119], v[40:43]
ds_read_b64_tr_b16 a[14:15], v121 offset:2048
ds_read_b128 a[28:31], v117 offset:6144
v_mfma_f32_16x16x32_bf16 v[40:43], a[72:75], a[84:87], v[40:43]
s_add_u32 s21, s18, 21504
v_mfma_f32_16x16x32_bf16 v[36:39], a[68:71], a[84:87], v[36:39]
ds_read_b64_tr_b16 a[32:33], v118 offset:8192
ds_read_b64_tr_b16 a[34:35], v118 offset:10240
v_mfma_f32_16x16x32_bf16 v[36:39], a[100:103], a[116:119], v[36:39]
buffer_load_dwordx4 v9, s[40:43], s21 offen offset:3072 lds
v_mfma_f32_16x16x32_bf16 v[32:35], a[96:99], a[116:119], v[32:35]
ds_read_b128 a[48:51], v117 offset:1024
ds_read_b64_tr_b16 a[36:37], v119 offset:8192
v_mfma_f32_16x16x32_bf16 v[32:35], a[64:67], a[84:87], v[32:35]
s_mov_b32 s59, 10240
s_add_u32 m0, s58, 32768
s_add_u32 s22, s12, s59
v_mfma_f32_16x16x32_bf16 v[48:51], a[64:67], a[88:91], v[48:51]
ds_read_b64_tr_b16 a[38:39], v119 offset:10240
ds_read_b128 a[52:55], v117 offset:3072
v_mfma_f32_16x16x32_bf16 v[48:51], a[96:99], a[120:123], v[48:51]
buffer_load_dwordx4 v15, s[48:51], s22 offen offset:0 sc1 lds
v_mfma_f32_16x16x32_bf16 v[52:55], a[100:103], a[120:123], v[52:55]
ds_read_b64_tr_b16 a[40:41], v120 offset:8192
ds_read_b64_tr_b16 a[42:43], v120 offset:10240
v_mfma_f32_16x16x32_bf16 v[52:55], a[68:71], a[88:91], v[52:55]
v_mfma_f32_16x16x32_bf16 v[56:59], a[72:75], a[88:91], v[56:59]
ds_read_b128 a[56:59], v117 offset:5120
ds_read_b64_tr_b16 a[44:45], v121 offset:8192
v_mfma_f32_16x16x32_bf16 v[56:59], a[104:107], a[120:123], v[56:59]
buffer_load_dwordx4 v15, s[48:51], s22 offen offset:1024 sc1 lds
v_mfma_f32_16x16x32_bf16 v[60:63], a[108:111], a[120:123], v[60:63]
ds_read_b64_tr_b16 a[46:47], v121 offset:10240
ds_read_b128 a[60:63], v117 offset:7168
v_mfma_f32_16x16x32_bf16 v[60:63], a[76:79], a[88:91], v[60:63]
s_add_u32 s23, s13, s59
v_mfma_f32_16x16x32_bf16 v[76:79], a[76:79], a[92:95], v[76:79]
v_mfma_f32_16x16x32_bf16 v[76:79], a[108:111], a[124:127], v[76:79]
buffer_load_dwordx4 v15, s[48:51], s23 offen offset:2048 sc1 lds
v_mfma_f32_16x16x32_bf16 v[72:75], a[104:107], a[124:127], v[72:75]
v_mfma_f32_16x16x32_bf16 v[72:75], a[72:75], a[92:95], v[72:75]
v_mfma_f32_16x16x32_bf16 v[68:71], a[68:71], a[92:95], v[68:71]
v_mfma_f32_16x16x32_bf16 v[68:71], a[100:103], a[124:127], v[68:71]
buffer_load_dwordx4 v15, s[48:51], s23 offen offset:3072 sc1 lds
v_mfma_f32_16x16x32_bf16 v[64:67], a[96:99], a[124:127], v[64:67]
v_mfma_f32_16x16x32_bf16 v[64:67], a[64:67], a[92:95], v[64:67]
s_waitcnt vmcnt(8) lgkmcnt(0)
s_barrier
v_mfma_f32_16x16x32_bf16 v[16:19], a[0:3], a[16:19], v[16:19]
s_mov_b32 s60, 393216
s_add_u32 m0, s58, 147456
s_add_u32 s18, s60, s7
v_mfma_f32_16x16x32_bf16 v[16:19], a[32:35], a[48:51], v[16:19]
buffer_load_dwordx4 v9, s[40:43], s18 offen offset:0 lds
v_mfma_f32_16x16x32_bf16 v[20:23], a[36:39], a[48:51], v[20:23]
ds_read_b64_tr_b16 a[64:65], v113 offset:0
ds_read_b64_tr_b16 a[66:67], v113 offset:2048
v_mfma_f32_16x16x32_bf16 v[20:23], a[4:7], a[16:19], v[20:23]
s_add_u32 s19, s18, 7168
ds_read_b64 a[80:81], v127 offset:0
ds_read_b64 a[82:83], v127 offset:512
v_mfma_f32_16x16x32_bf16 v[24:27], a[8:11], a[16:19], v[24:27]
ds_read_b64_tr_b16 a[68:69], v114 offset:0
ds_read_b64_tr_b16 a[70:71], v114 offset:2048
v_mfma_f32_16x16x32_bf16 v[24:27], a[40:43], a[48:51], v[24:27]
buffer_load_dwordx4 v9, s[40:43], s19 offen offset:1024 lds
v_mfma_f32_16x16x32_bf16 v[28:31], a[44:47], a[48:51], v[28:31]
ds_read_b64 a[84:85], v127 offset:2048
ds_read_b64 a[86:87], v127 offset:2560
v_mfma_f32_16x16x32_bf16 v[28:31], a[12:15], a[16:19], v[28:31]
s_add_u32 s20, s18, 14336
ds_read_b64_tr_b16 a[72:73], v115 offset:0
ds_read_b64_tr_b16 a[74:75], v115 offset:2048
v_mfma_f32_16x16x32_bf16 v[44:47], a[12:15], a[20:23], v[44:47]
ds_read_b64 a[88:89], v127 offset:4096
ds_read_b64 a[90:91], v127 offset:4608
v_mfma_f32_16x16x32_bf16 v[44:47], a[44:47], a[52:55], v[44:47]
buffer_load_dwordx4 v9, s[40:43], s20 offen offset:2048 lds
v_mfma_f32_16x16x32_bf16 v[40:43], a[40:43], a[52:55], v[40:43]
ds_read_b64_tr_b16 a[76:77], v116 offset:0
ds_read_b64_tr_b16 a[78:79], v116 offset:2048
v_mfma_f32_16x16x32_bf16 v[40:43], a[8:11], a[20:23], v[40:43]
s_add_u32 s21, s18, 21504
ds_read_b64 a[92:93], v127 offset:6144
ds_read_b64 a[94:95], v127 offset:6656
v_mfma_f32_16x16x32_bf16 v[36:39], a[4:7], a[20:23], v[36:39]
ds_read_b64_tr_b16 a[96:97], v113 offset:8192
ds_read_b64_tr_b16 a[98:99], v113 offset:10240
v_mfma_f32_16x16x32_bf16 v[36:39], a[36:39], a[52:55], v[36:39]
buffer_load_dwordx4 v9, s[40:43], s21 offen offset:3072 lds
v_mfma_f32_16x16x32_bf16 v[32:35], a[32:35], a[52:55], v[32:35]
ds_read_b64 a[112:113], v127 offset:1024
ds_read_b64 a[114:115], v127 offset:1536
v_mfma_f32_16x16x32_bf16 v[32:35], a[0:3], a[20:23], v[32:35]
s_mov_b32 s59, 12288
s_add_u32 m0, s58, 131072
s_add_u32 s22, s12, s59
v_mfma_f32_16x16x32_bf16 v[48:51], a[0:3], a[24:27], v[48:51]
ds_read_b64_tr_b16 a[100:101], v114 offset:8192
ds_read_b64_tr_b16 a[102:103], v114 offset:10240
v_mfma_f32_16x16x32_bf16 v[48:51], a[32:35], a[56:59], v[48:51]
buffer_load_dwordx4 v15, s[48:51], s22 offen offset:0 sc1 lds
v_mfma_f32_16x16x32_bf16 v[52:55], a[36:39], a[56:59], v[52:55]
ds_read_b64 a[116:117], v127 offset:3072
ds_read_b64 a[118:119], v127 offset:3584
v_mfma_f32_16x16x32_bf16 v[52:55], a[4:7], a[24:27], v[52:55]
ds_read_b64_tr_b16 a[104:105], v115 offset:8192
ds_read_b64_tr_b16 a[106:107], v115 offset:10240
v_mfma_f32_16x16x32_bf16 v[56:59], a[8:11], a[24:27], v[56:59]
ds_read_b64 a[120:121], v127 offset:5120
ds_read_b64 a[122:123], v127 offset:5632
v_mfma_f32_16x16x32_bf16 v[56:59], a[40:43], a[56:59], v[56:59]
buffer_load_dwordx4 v15, s[48:51], s22 offen offset:1024 sc1 lds
v_mfma_f32_16x16x32_bf16 v[60:63], a[44:47], a[56:59], v[60:63]
ds_read_b64_tr_b16 a[108:109], v116 offset:8192
ds_read_b64_tr_b16 a[110:111], v116 offset:10240
v_mfma_f32_16x16x32_bf16 v[60:63], a[12:15], a[24:27], v[60:63]
s_add_u32 s23, s13, s59
ds_read_b64 a[124:125], v127 offset:7168
ds_read_b64 a[126:127], v127 offset:7680
v_mfma_f32_16x16x32_bf16 v[76:79], a[12:15], a[28:31], v[76:79]
v_mfma_f32_16x16x32_bf16 v[76:79], a[44:47], a[60:63], v[76:79]
buffer_load_dwordx4 v15, s[48:51], s23 offen offset:2048 sc1 lds
v_mfma_f32_16x16x32_bf16 v[72:75], a[40:43], a[60:63], v[72:75]
v_mfma_f32_16x16x32_bf16 v[72:75], a[8:11], a[28:31], v[72:75]
v_mfma_f32_16x16x32_bf16 v[68:71], a[4:7], a[28:31], v[68:71]
v_mfma_f32_16x16x32_bf16 v[68:71], a[36:39], a[60:63], v[68:71]
buffer_load_dwordx4 v15, s[48:51], s23 offen offset:3072 sc1 lds
v_mfma_f32_16x16x32_bf16 v[64:67], a[32:35], a[60:63], v[64:67]
v_mfma_f32_16x16x32_bf16 v[64:67], a[0:3], a[28:31], v[64:67]
s_waitcnt vmcnt(8) lgkmcnt(0)
s_barrier
global_load_dword v7, v8, s[16:17] sc1
v_mfma_f32_16x16x32_bf16 v[16:19], a[64:67], a[80:83], v[16:19]
s_lshl_b32 s6, s61, 16
s_xor_b32 s60, s6, 0
s_lshl_b32 s7, s0, 20
s_add_u32 m0, s58, 81920
s_add_u32 s18, s60, s7
v_mfma_f32_16x16x32_bf16 v[16:19], a[96:99], a[112:115], v[16:19]
buffer_load_dwordx4 v9, s[36:39], s18 offen offset:0 lds
v_mfma_f32_16x16x32_bf16 v[20:23], a[100:103], a[112:115], v[20:23]
ds_read_b64_tr_b16 a[0:1], v113 offset:32768
ds_read_b64_tr_b16 a[2:3], v113 offset:34816
v_mfma_f32_16x16x32_bf16 v[20:23], a[68:71], a[80:83], v[20:23]
s_add_u32 s19, s18, 7168
ds_read_b64 a[16:17], v127 offset:32768
ds_read_b64 a[18:19], v127 offset:33280
v_mfma_f32_16x16x32_bf16 v[24:27], a[72:75], a[80:83], v[24:27]
ds_read_b64_tr_b16 a[4:5], v114 offset:32768
ds_read_b64_tr_b16 a[6:7], v114 offset:34816
v_mfma_f32_16x16x32_bf16 v[24:27], a[104:107], a[112:115], v[24:27]
buffer_load_dwordx4 v9, s[36:39], s19 offen offset:1024 lds
v_mfma_f32_16x16x32_bf16 v[28:31], a[108:111], a[112:115], v[28:31]
ds_read_b64 a[20:21], v127 offset:34816
ds_read_b64 a[22:23], v127 offset:35328
v_mfma_f32_16x16x32_bf16 v[28:31], a[76:79], a[80:83], v[28:31]
s_add_u32 s20, s18, 14336
ds_read_b64_tr_b16 a[8:9], v115 offset:32768
ds_read_b64_tr_b16 a[10:11], v115 offset:34816
v_mfma_f32_16x16x32_bf16 v[44:47], a[76:79], a[84:87], v[44:47]
ds_read_b64 a[24:25], v127 offset:36864
ds_read_b64 a[26:27], v127 offset:37376
v_mfma_f32_16x16x32_bf16 v[44:47], a[108:111], a[116:119], v[44:47]
buffer_load_dwordx4 v9, s[36:39], s20 offen offset:2048 lds
v_mfma_f32_16x16x32_bf16 v[40:43], a[104:107], a[116:119], v[40:43]
ds_read_b64_tr_b16 a[12:13], v116 offset:32768
ds_read_b64_tr_b16 a[14:15], v116 offset:34816
v_mfma_f32_16x16x32_bf16 v[40:43], a[72:75], a[84:87], v[40:43]
s_add_u32 s21, s18, 21504
ds_read_b64 a[28:29], v127 offset:38912
ds_read_b64 a[30:31], v127 offset:39424
v_mfma_f32_16x16x32_bf16 v[36:39], a[68:71], a[84:87], v[36:39]
ds_read_b64_tr_b16 a[32:33], v113 offset:40960
ds_read_b64_tr_b16 a[34:35], v113 offset:43008
v_mfma_f32_16x16x32_bf16 v[36:39], a[100:103], a[116:119], v[36:39]
buffer_load_dwordx4 v9, s[36:39], s21 offen offset:3072 lds
v_mfma_f32_16x16x32_bf16 v[32:35], a[96:99], a[116:119], v[32:35]
ds_read_b64 a[48:49], v127 offset:33792
ds_read_b64 a[50:51], v127 offset:34304
v_mfma_f32_16x16x32_bf16 v[32:35], a[64:67], a[84:87], v[32:35]
s_xor_b32 s60, s6, 65536
s_add_u32 m0, s58, 16384
s_add_u32 s18, s60, s7
v_mfma_f32_16x16x32_bf16 v[48:51], a[64:67], a[88:91], v[48:51]
ds_read_b64_tr_b16 a[36:37], v114 offset:40960
ds_read_b64_tr_b16 a[38:39], v114 offset:43008
v_mfma_f32_16x16x32_bf16 v[48:51], a[96:99], a[120:123], v[48:51]
buffer_load_dwordx4 v9, s[36:39], s18 offen offset:0 lds
v_mfma_f32_16x16x32_bf16 v[52:55], a[100:103], a[120:123], v[52:55]
ds_read_b64 a[52:53], v127 offset:35840
ds_read_b64 a[54:55], v127 offset:36352
v_mfma_f32_16x16x32_bf16 v[52:55], a[68:71], a[88:91], v[52:55]
s_add_u32 s19, s18, 7168
ds_read_b64_tr_b16 a[40:41], v115 offset:40960
ds_read_b64_tr_b16 a[42:43], v115 offset:43008
v_mfma_f32_16x16x32_bf16 v[56:59], a[72:75], a[88:91], v[56:59]
ds_read_b64 a[56:57], v127 offset:37888
ds_read_b64 a[58:59], v127 offset:38400
v_mfma_f32_16x16x32_bf16 v[56:59], a[104:107], a[120:123], v[56:59]
buffer_load_dwordx4 v9, s[36:39], s19 offen offset:1024 lds
v_mfma_f32_16x16x32_bf16 v[60:63], a[108:111], a[120:123], v[60:63]
ds_read_b64_tr_b16 a[44:45], v116 offset:40960
ds_read_b64_tr_b16 a[46:47], v116 offset:43008
v_mfma_f32_16x16x32_bf16 v[60:63], a[76:79], a[88:91], v[60:63]
s_add_u32 s20, s18, 14336
ds_read_b64 a[60:61], v127 offset:39936
ds_read_b64 a[62:63], v127 offset:40448
v_mfma_f32_16x16x32_bf16 v[76:79], a[76:79], a[92:95], v[76:79]
s_add_u32 s12, s12, s26
v_mfma_f32_16x16x32_bf16 v[76:79], a[108:111], a[124:127], v[76:79]
buffer_load_dwordx4 v9, s[36:39], s20 offen offset:2048 lds
v_mfma_f32_16x16x32_bf16 v[72:75], a[104:107], a[124:127], v[72:75]
s_add_u32 s13, s13, s26
v_mfma_f32_16x16x32_bf16 v[72:75], a[72:75], a[92:95], v[72:75]
s_add_u32 s21, s18, 21504
v_mfma_f32_16x16x32_bf16 v[68:71], a[68:71], a[92:95], v[68:71]
v_mfma_f32_16x16x32_bf16 v[68:71], a[100:103], a[124:127], v[68:71]
buffer_load_dwordx4 v9, s[36:39], s21 offen offset:3072 lds
v_mfma_f32_16x16x32_bf16 v[64:67], a[96:99], a[124:127], v[64:67]
v_mfma_f32_16x16x32_bf16 v[64:67], a[64:67], a[92:95], v[64:67]
s_waitcnt vmcnt(8) lgkmcnt(0)
s_barrier
v_cmp_ne_u32 vcc, s3, v7
s_cbranch_vccnz L_ctx_spin
L_ctx:
s_lshl_b32 s1, s61, 11
s_xor_b32 s59, s1, 0
s_add_u32 m0, s58, 65536
s_add_u32 s22, s12, s59
buffer_load_dwordx4 v15, s[48:51], s22 offen offset:0 sc1 lds
buffer_load_dwordx4 v15, s[48:51], s22 offen offset:1024 sc1 lds
s_add_u32 s23, s13, s59
buffer_load_dwordx4 v15, s[48:51], s23 offen offset:2048 sc1 lds
buffer_load_dwordx4 v15, s[48:51], s23 offen offset:3072 sc1 lds
s_xor_b32 s59, s1, 2048
s_add_u32 m0, s58, 0
s_add_u32 s22, s12, s59
buffer_load_dwordx4 v15, s[48:51], s22 offen offset:0 sc1 lds
buffer_load_dwordx4 v15, s[48:51], s22 offen offset:1024 sc1 lds
s_add_u32 s23, s13, s59
buffer_load_dwordx4 v15, s[48:51], s23 offen offset:2048 sc1 lds
buffer_load_dwordx4 v15, s[48:51], s23 offen offset:3072 sc1 lds
v_mfma_f32_16x16x32_bf16 v[16:19], a[0:3], a[16:19], v[16:19]
s_xor_b32 s59, s1, 4096
s_add_u32 m0, s58, 32768
s_add_u32 s22, s12, s59
v_mfma_f32_16x16x32_bf16 v[16:19], a[32:35], a[48:51], v[16:19]
buffer_load_dwordx4 v15, s[48:51], s22 offen offset:0 sc1 lds
v_mfma_f32_16x16x32_bf16 v[20:23], a[36:39], a[48:51], v[20:23]
ds_read_b64_tr_b16 a[64:65], v123 offset:0
ds_read_b64_tr_b16 a[66:67], v123 offset:2048
v_mfma_f32_16x16x32_bf16 v[20:23], a[4:7], a[16:19], v[20:23]
ds_read_b64 a[80:81], v14 offset:0
ds_read_b64 a[82:83], v14 offset:512
v_mfma_f32_16x16x32_bf16 v[24:27], a[8:11], a[16:19], v[24:27]
ds_read_b64_tr_b16 a[68:69], v124 offset:0
ds_read_b64_tr_b16 a[70:71], v124 offset:2048
v_mfma_f32_16x16x32_bf16 v[24:27], a[40:43], a[48:51], v[24:27]
buffer_load_dwordx4 v15, s[48:51], s22 offen offset:1024 sc1 lds
v_mfma_f32_16x16x32_bf16 v[28:31], a[44:47], a[48:51], v[28:31]
ds_read_b64 a[84:85], v14 offset:2048
ds_read_b64 a[86:87], v14 offset:2560
v_mfma_f32_16x16x32_bf16 v[28:31], a[12:15], a[16:19], v[28:31]
s_add_u32 s23, s13, s59
ds_read_b64_tr_b16 a[72:73], v125 offset:0
ds_read_b64_tr_b16 a[74:75], v125 offset:2048
v_mfma_f32_16x16x32_bf16 v[44:47], a[12:15], a[20:23], v[44:47]
L_t16:
s_cbranch_execz L_r3
ds_read_b64 a[88:89], v14 offset:4096
ds_read_b64 a[90:91], v14 offset:4608
v_mfma_f32_16x16x32_bf16 v[44:47], a[44:47], a[52:55], v[44:47]
buffer_load_dwordx4 v15, s[48:51], s23 offen offset:2048 sc1 lds
v_mfma_f32_16x16x32_bf16 v[40:43], a[40:43], a[52:55], v[40:43]
ds_read_b64_tr_b16 a[76:77], v126 offset:0
ds_read_b64_tr_b16 a[78:79], v126 offset:2048
v_mfma_f32_16x16x32_bf16 v[40:43], a[8:11], a[20:23], v[40:43]
ds_read_b64 a[92:93], v14 offset:6144
ds_read_b64 a[94:95], v14 offset:6656
v_mfma_f32_16x16x32_bf16 v[36:39], a[4:7], a[20:23], v[36:39]
ds_read_b64_tr_b16 a[96:97], v123 offset:8192
ds_read_b64_tr_b16 a[98:99], v123 offset:10240
v_mfma_f32_16x16x32_bf16 v[36:39], a[36:39], a[52:55], v[36:39]
buffer_load_dwordx4 v15, s[48:51], s23 offen offset:3072 sc1 lds
v_mfma_f32_16x16x32_bf16 v[32:35], a[32:35], a[52:55], v[32:35]
ds_read_b64 a[112:113], v14 offset:1024
ds_read_b64 a[114:115], v14 offset:1536
v_mfma_f32_16x16x32_bf16 v[32:35], a[0:3], a[20:23], v[32:35]
s_xor_b32 s60, s6, 131072
s_add_u32 m0, s58, 49152
s_add_u32 s18, s60, s7
v_mfma_f32_16x16x32_bf16 v[48:51], a[0:3], a[24:27], v[48:51]
ds_read_b64_tr_b16 a[100:101], v124 offset:8192
ds_read_b64_tr_b16 a[102:103], v124 offset:10240
v_mfma_f32_16x16x32_bf16 v[48:51], a[32:35], a[56:59], v[48:51]
buffer_load_dwordx4 v9, s[36:39], s18 offen offset:0 lds
v_mfma_f32_16x16x32_bf16 v[52:55], a[36:39], a[56:59], v[52:55]
ds_read_b64 a[116:117], v14 offset:3072
ds_read_b64 a[118:119], v14 offset:3584
v_mfma_f32_16x16x32_bf16 v[52:55], a[4:7], a[24:27], v[52:55]
s_add_u32 s19, s18, 7168
ds_read_b64_tr_b16 a[104:105], v125 offset:8192
ds_read_b64_tr_b16 a[106:107], v125 offset:10240
v_mfma_f32_16x16x32_bf16 v[56:59], a[8:11], a[24:27], v[56:59]
ds_read_b64 a[120:121], v14 offset:5120
ds_read_b64 a[122:123], v14 offset:5632
v_mfma_f32_16x16x32_bf16 v[56:59], a[40:43], a[56:59], v[56:59]
buffer_load_dwordx4 v9, s[36:39], s19 offen offset:1024 lds
v_mfma_f32_16x16x32_bf16 v[60:63], a[44:47], a[56:59], v[60:63]
ds_read_b64_tr_b16 a[108:109], v126 offset:8192
ds_read_b64_tr_b16 a[110:111], v126 offset:10240
v_mfma_f32_16x16x32_bf16 v[60:63], a[12:15], a[24:27], v[60:63]
s_add_u32 s20, s18, 14336
ds_read_b64 a[124:125], v14 offset:7168
ds_read_b64 a[126:127], v14 offset:7680
v_mfma_f32_16x16x32_bf16 v[76:79], a[12:15], a[28:31], v[76:79]
v_mfma_f32_16x16x32_bf16 v[76:79], a[44:47], a[60:63], v[76:79]
buffer_load_dwordx4 v9, s[36:39], s20 offen offset:2048 lds
v_mfma_f32_16x16x32_bf16 v[72:75], a[40:43], a[60:63], v[72:75]
v_mfma_f32_16x16x32_bf16 v[72:75], a[8:11], a[28:31], v[72:75]
s_add_u32 s21, s18, 21504
v_mfma_f32_16x16x32_bf16 v[68:71], a[4:7], a[28:31], v[68:71]
v_mfma_f32_16x16x32_bf16 v[68:71], a[36:39], a[60:63], v[68:71]
buffer_load_dwordx4 v9, s[36:39], s21 offen offset:3072 lds
v_mfma_f32_16x16x32_bf16 v[64:67], a[32:35], a[60:63], v[64:67]
v_mfma_f32_16x16x32_bf16 v[64:67], a[0:3], a[28:31], v[64:67]
s_waitcnt vmcnt(12) lgkmcnt(0)
s_barrier
v_mfma_f32_16x16x32_bf16 v[16:19], a[64:67], a[80:83], v[16:19]
s_xor_b32 s59, s1, 6144
s_add_u32 m0, s58, 131072
s_add_u32 s22, s12, s59
v_mfma_f32_16x16x32_bf16 v[16:19], a[96:99], a[112:115], v[16:19]
buffer_load_dwordx4 v15, s[48:51], s22 offen offset:0 sc1 lds
v_mfma_f32_16x16x32_bf16 v[20:23], a[100:103], a[112:115], v[20:23]
ds_read_b64_tr_b16 a[0:1], v118 offset:0
ds_read_b64_tr_b16 a[2:3], v118 offset:2048
v_mfma_f32_16x16x32_bf16 v[20:23], a[68:71], a[80:83], v[20:23]
ds_read_b128 a[16:19], v117 offset:0
ds_read_b64_tr_b16 a[4:5], v119 offset:0
v_mfma_f32_16x16x32_bf16 v[24:27], a[72:75], a[80:83], v[24:27]
ds_read_b64_tr_b16 a[6:7], v119 offset:2048
ds_read_b128 a[20:23], v117 offset:2048
v_mfma_f32_16x16x32_bf16 v[24:27], a[104:107], a[112:115], v[24:27]
buffer_load_dwordx4 v15, s[48:51], s22 offen offset:1024 sc1 lds
v_mfma_f32_16x16x32_bf16 v[28:31], a[108:111], a[112:115], v[28:31]
ds_read_b64_tr_b16 a[8:9], v120 offset:0
ds_read_b64_tr_b16 a[10:11], v120 offset:2048
v_mfma_f32_16x16x32_bf16 v[28:31], a[76:79], a[80:83], v[28:31]
s_add_u32 s23, s13, s59
v_mfma_f32_16x16x32_bf16 v[44:47], a[76:79], a[84:87], v[44:47]
ds_read_b128 a[24:27], v117 offset:4096
ds_read_b64_tr_b16 a[12:13], v121 offset:0
v_mfma_f32_16x16x32_bf16 v[44:47], a[108:111], a[116:119], v[44:47]
buffer_load_dwordx4 v15, s[48:51], s23 offen offset:2048 sc1 lds
v_mfma_f32_16x16x32_bf16 v[40:43], a[104:107], a[116:119], v[40:43]
ds_read_b64_tr_b16 a[14:15], v121 offset:2048
ds_read_b128 a[28:31], v117 offset:6144
v_mfma_f32_16x16x32_bf16 v[40:43], a[72:75], a[84:87], v[40:43]
v_mfma_f32_16x16x32_bf16 v[36:39], a[68:71], a[84:87], v[36:39]
ds_read_b64_tr_b16 a[32:33], v118 offset:8192
ds_read_b64_tr_b16 a[34:35], v118 offset:10240
v_mfma_f32_16x16x32_bf16 v[36:39], a[100:103], a[116:119], v[36:39]
buffer_load_dwordx4 v15, s[48:51], s23 offen offset:3072 sc1 lds
v_mfma_f32_16x16x32_bf16 v[32:35], a[96:99], a[116:119], v[32:35]
ds_read_b128 a[48:51], v117 offset:1024
ds_read_b64_tr_b16 a[36:37], v119 offset:8192
v_mfma_f32_16x16x32_bf16 v[32:35], a[64:67], a[84:87], v[32:35]
s_xor_b32 s60, s6, 196608
s_add_u32 m0, s58, 147456
s_add_u32 s18, s60, s7
v_mfma_f32_16x16x32_bf16 v[48:51], a[64:67], a[88:91], v[48:51]
ds_read_b64_tr_b16 a[38:39], v119 offset:10240
ds_read_b128 a[52:55], v117 offset:3072
v_mfma_f32_16x16x32_bf16 v[48:51], a[96:99], a[120:123], v[48:51]
buffer_load_dwordx4 v9, s[36:39], s18 offen offset:0 lds
v_mfma_f32_16x16x32_bf16 v[52:55], a[100:103], a[120:123], v[52:55]
ds_read_b64_tr_b16 a[40:41], v120 offset:8192
ds_read_b64_tr_b16 a[42:43], v120 offset:10240
v_mfma_f32_16x16x32_bf16 v[52:55], a[68:71], a[88:91], v[52:55]
s_add_u32 s19, s18, 7168
v_mfma_f32_16x16x32_bf16 v[56:59], a[72:75], a[88:91], v[56:59]
ds_read_b128 a[56:59], v117 offset:5120
ds_read_b64_tr_b16 a[44:45], v121 offset:8192
v_mfma_f32_16x16x32_bf16 v[56:59], a[104:107], a[120:123], v[56:59]
buffer_load_dwordx4 v9, s[36:39], s19 offen offset:1024 lds
v_mfma_f32_16x16x32_bf16 v[60:63], a[108:111], a[120:123], v[60:63]
ds_read_b64_tr_b16 a[46:47], v121 offset:10240
ds_read_b128 a[60:63], v117 offset:7168
v_mfma_f32_16x16x32_bf16 v[60:63], a[76:79], a[88:91], v[60:63]
s_add_u32 s20, s18, 14336
v_mfma_f32_16x16x32_bf16 v[76:79], a[76:79], a[92:95], v[76:79]
v_mfma_f32_16x16x32_bf16 v[76:79], a[108:111], a[124:127], v[76:79]
buffer_load_dwordx4 v9, s[36:39], s20 offen offset:2048 lds
v_mfma_f32_16x16x32_bf16 v[72:75], a[104:107], a[124:127], v[72:75]
v_mfma_f32_16x16x32_bf16 v[72:75], a[72:75], a[92:95], v[72:75]
s_add_u32 s21, s18, 21504
v_mfma_f32_16x16x32_bf16 v[68:71], a[68:71], a[92:95], v[68:71]
v_mfma_f32_16x16x32_bf16 v[68:71], a[100:103], a[124:127], v[68:71]
buffer_load_dwordx4 v9, s[36:39], s21 offen offset:3072 lds
v_mfma_f32_16x16x32_bf16 v[64:67], a[96:99], a[124:127], v[64:67]
v_mfma_f32_16x16x32_bf16 v[64:67], a[64:67], a[92:95], v[64:67]
s_waitcnt vmcnt(16) lgkmcnt(0)
s_barrier
v_mfma_f32_16x16x32_bf16 v[16:19], a[0:3], a[16:19], v[16:19]
s_xor_b32 s59, s1, 8192
s_add_u32 m0, s58, 65536
s_add_u32 s22, s12, s59
v_mfma_f32_16x16x32_bf16 v[16:19], a[32:35], a[48:51], v[16:19]
buffer_load_dwordx4 v15, s[48:51], s22 offen offset:0 sc1 lds
v_mfma_f32_16x16x32_bf16 v[20:23], a[36:39], a[48:51], v[20:23]
ds_read_b64_tr_b16 a[64:65], v113 offset:0
ds_read_b64_tr_b16 a[66:67], v113 offset:2048
v_mfma_f32_16x16x32_bf16 v[20:23], a[4:7], a[16:19], v[20:23]
ds_read_b128 a[80:83], v112 offset:0
ds_read_b64_tr_b16 a[68:69], v114 offset:0
v_mfma_f32_16x16x32_bf16 v[24:27], a[8:11], a[16:19], v[24:27]
ds_read_b64_tr_b16 a[70:71], v114 offset:2048
ds_read_b128 a[84:87], v112 offset:2048
v_mfma_f32_16x16x32_bf16 v[24:27], a[40:43], a[48:51], v[24:27]
buffer_load_dwordx4 v15, s[48:51], s22 offen offset:1024 sc1 lds
v_mfma_f32_16x16x32_bf16 v[28:31], a[44:47], a[48:51], v[28:31]
ds_read_b64_tr_b16 a[72:73], v115 offset:0
ds_read_b64_tr_b16 a[74:75], v115 offset:2048
v_mfma_f32_16x16x32_bf16 v[28:31], a[12:15], a[16:19], v[28:31]
s_add_u32 s23, s13, s59
v_mfma_f32_16x16x32_bf16 v[44:47], a[12:15], a[20:23], v[44:47]
ds_read_b128 a[88:91], v112 offset:4096
ds_read_b64_tr_b16 a[76:77], v116 offset:0
v_mfma_f32_16x16x32_bf16 v[44:47], a[44:47], a[52:55], v[44:47]
buffer_load_dwordx4 v15, s[48:51], s23 offen offset:2048 sc1 lds
v_mfma_f32_16x16x32_bf16 v[40:43], a[40:43], a[52:55], v[40:43]
ds_read_b64_tr_b16 a[78:79], v116 offset:2048
ds_read_b128 a[92:95], v112 offset:6144
v_mfma_f32_16x16x32_bf16 v[40:43], a[8:11], a[20:23], v[40:43]
v_mfma_f32_16x16x32_bf16 v[36:39], a[4:7], a[20:23], v[36:39]
ds_read_b64_tr_b16 a[96:97], v113 offset:8192
ds_read_b64_tr_b16 a[98:99], v113 offset:10240
v_mfma_f32_16x16x32_bf16 v[36:39], a[36:39], a[52:55], v[36:39]
buffer_load_dwordx4 v15, s[48:51], s23 offen offset:3072 sc1 lds
v_mfma_f32_16x16x32_bf16 v[32:35], a[32:35], a[52:55], v[32:35]
ds_read_b128 a[112:115], v112 offset:1024
ds_read_b64_tr_b16 a[100:101], v114 offset:8192
v_mfma_f32_16x16x32_bf16 v[32:35], a[0:3], a[20:23], v[32:35]
s_xor_b32 s60, s6, 262144
s_add_u32 m0, s58, 81920
s_add_u32 s18, s60, s7
v_mfma_f32_16x16x32_bf16 v[48:51], a[0:3], a[24:27], v[48:51]
ds_read_b64_tr_b16 a[102:103], v114 offset:10240
ds_read_b128 a[116:119], v112 offset:3072
v_mfma_f32_16x16x32_bf16 v[48:51], a[32:35], a[56:59], v[48:51]
buffer_load_dwordx4 v9, s[36:39], s18 offen offset:0 lds
v_mfma_f32_16x16x32_bf16 v[52:55], a[36:39], a[56:59], v[52:55]
ds_read_b64_tr_b16 a[104:105], v115 offset:8192
ds_read_b64_tr_b16 a[106:107], v115 offset:10240
v_mfma_f32_16x16x32_bf16 v[52:55], a[4:7], a[24:27], v[52:55]
s_add_u32 s19, s18, 7168
v_mfma_f32_16x16x32_bf16 v[56:59], a[8:11], a[24:27], v[56:59]
ds_read_b128 a[120:123], v112 offset:5120
ds_read_b64_tr_b16 a[108:109], v116 offset:8192
v_mfma_f32_16x16x32_bf16 v[56:59], a[40:43], a[56:59], v[56:59]
buffer_load_dwordx4 v9, s[36:39], s19 offen offset:1024 lds
v_mfma_f32_16x16x32_bf16 v[60:63], a[44:47], a[56:59], v[60:63]
ds_read_b64_tr_b16 a[110:111], v116 offset:10240
ds_read_b128 a[124:127], v112 offset:7168
v_mfma_f32_16x16x32_bf16 v[60:63], a[12:15], a[24:27], v[60:63]
s_add_u32 s20, s18, 14336
v_mfma_f32_16x16x32_bf16 v[76:79], a[12:15], a[28:31], v[76:79]
v_mfma_f32_16x16x32_bf16 v[76:79], a[44:47], a[60:63], v[76:79]
buffer_load_dwordx4 v9, s[36:39], s20 offen offset:2048 lds
v_mfma_f32_16x16x32_bf16 v[72:75], a[40:43], a[60:63], v[72:75]
v_mfma_f32_16x16x32_bf16 v[72:75], a[8:11], a[28:31], v[72:75]
s_add_u32 s21, s18, 21504
v_mfma_f32_16x16x32_bf16 v[68:71], a[4:7], a[28:31], v[68:71]
v_mfma_f32_16x16x32_bf16 v[68:71], a[36:39], a[60:63], v[68:71]
buffer_load_dwordx4 v9, s[36:39], s21 offen offset:3072 lds
v_mfma_f32_16x16x32_bf16 v[64:67], a[32:35], a[60:63], v[64:67]
v_mfma_f32_16x16x32_bf16 v[64:67], a[0:3], a[28:31], v[64:67]
s_waitcnt vmcnt(16) lgkmcnt(0)
s_barrier
v_mfma_f32_16x16x32_bf16 v[16:19], a[64:67], a[80:83], v[16:19]
s_xor_b32 s59, s1, 10240
s_add_u32 m0, s58, 0
s_add_u32 s22, s12, s59
v_mfma_f32_16x16x32_bf16 v[16:19], a[96:99], a[112:115], v[16:19]
buffer_load_dwordx4 v15, s[48:51], s22 offen offset:0 sc1 lds
v_mfma_f32_16x16x32_bf16 v[20:23], a[100:103], a[112:115], v[20:23]
ds_read_b64_tr_b16 a[0:1], v113 offset:32768
ds_read_b64_tr_b16 a[2:3], v113 offset:34816
v_mfma_f32_16x16x32_bf16 v[20:23], a[68:71], a[80:83], v[20:23]
ds_read_b128 a[16:19], v112 offset:32768
ds_read_b64_tr_b16 a[4:5], v114 offset:32768
v_mfma_f32_16x16x32_bf16 v[24:27], a[72:75], a[80:83], v[24:27]
ds_read_b64_tr_b16 a[6:7], v114 offset:34816
ds_read_b128 a[20:23], v112 offset:34816
v_mfma_f32_16x16x32_bf16 v[24:27], a[104:107], a[112:115], v[24:27]
buffer_load_dwordx4 v15, s[48:51], s22 offen offset:1024 sc1 lds
v_mfma_f32_16x16x32_bf16 v[28:31], a[108:111], a[112:115], v[28:31]
ds_read_b64_tr_b16 a[8:9], v115 offset:32768
ds_read_b64_tr_b16 a[10:11], v115 offset:34816
v_mfma_f32_16x16x32_bf16 v[28:31], a[76:79], a[80:83], v[28:31]
s_add_u32 s23, s13, s59
v_mfma_f32_16x16x32_bf16 v[44:47], a[76:79], a[84:87], v[44:47]
ds_read_b128 a[24:27], v112 offset:36864
ds_read_b64_tr_b16 a[12:13], v116 offset:32768
v_mfma_f32_16x16x32_bf16 v[44:47], a[108:111], a[116:119], v[44:47]
buffer_load_dwordx4 v15, s[48:51], s23 offen offset:2048 sc1 lds
v_mfma_f32_16x16x32_bf16 v[40:43], a[104:107], a[116:119], v[40:43]
ds_read_b64_tr_b16 a[14:15], v116 offset:34816
ds_read_b128 a[28:31], v112 offset:38912
v_mfma_f32_16x16x32_bf16 v[40:43], a[72:75], a[84:87], v[40:43]
v_mfma_f32_16x16x32_bf16 v[36:39], a[68:71], a[84:87], v[36:39]
ds_read_b64_tr_b16 a[32:33], v113 offset:40960
ds_read_b64_tr_b16 a[34:35], v113 offset:43008
v_mfma_f32_16x16x32_bf16 v[36:39], a[100:103], a[116:119], v[36:39]
buffer_load_dwordx4 v15, s[48:51], s23 offen offset:3072 sc1 lds
v_mfma_f32_16x16x32_bf16 v[32:35], a[96:99], a[116:119], v[32:35]
ds_read_b128 a[48:51], v112 offset:33792
ds_read_b64_tr_b16 a[36:37], v114 offset:40960
v_mfma_f32_16x16x32_bf16 v[32:35], a[64:67], a[84:87], v[32:35]
s_xor_b32 s60, s6, 327680
s_add_u32 m0, s58, 16384
s_add_u32 s18, s60, s7
v_mfma_f32_16x16x32_bf16 v[48:51], a[64:67], a[88:91], v[48:51]
ds_read_b64_tr_b16 a[38:39], v114 offset:43008
ds_read_b128 a[52:55], v112 offset:35840
v_mfma_f32_16x16x32_bf16 v[48:51], a[96:99], a[120:123], v[48:51]
buffer_load_dwordx4 v9, s[36:39], s18 offen offset:0 lds
v_mfma_f32_16x16x32_bf16 v[52:55], a[100:103], a[120:123], v[52:55]
ds_read_b64_tr_b16 a[40:41], v115 offset:40960
ds_read_b64_tr_b16 a[42:43], v115 offset:43008
v_mfma_f32_16x16x32_bf16 v[52:55], a[68:71], a[88:91], v[52:55]
s_add_u32 s19, s18, 7168
v_mfma_f32_16x16x32_bf16 v[56:59], a[72:75], a[88:91], v[56:59]
ds_read_b128 a[56:59], v112 offset:37888
ds_read_b64_tr_b16 a[44:45], v116 offset:40960
v_mfma_f32_16x16x32_bf16 v[56:59], a[104:107], a[120:123], v[56:59]
buffer_load_dwordx4 v9, s[36:39], s19 offen offset:1024 lds
v_mfma_f32_16x16x32_bf16 v[60:63], a[108:111], a[120:123], v[60:63]
ds_read_b64_tr_b16 a[46:47], v116 offset:43008
ds_read_b128 a[60:63], v112 offset:39936
v_mfma_f32_16x16x32_bf16 v[60:63], a[76:79], a[88:91], v[60:63]
s_add_u32 s20, s18, 14336
v_mfma_f32_16x16x32_bf16 v[76:79], a[76:79], a[92:95], v[76:79]
v_mfma_f32_16x16x32_bf16 v[76:79], a[108:111], a[124:127], v[76:79]
buffer_load_dwordx4 v9, s[36:39], s20 offen offset:2048 lds
v_mfma_f32_16x16x32_bf16 v[72:75], a[104:107], a[124:127], v[72:75]
v_xor_b32 v8, 16, v8
v_mfma_f32_16x16x32_bf16 v[72:75], a[72:75], a[92:95], v[72:75]
s_add_u32 s21, s18, 21504
global_load_dword v7, v8, s[16:17] sc1
v_mfma_f32_16x16x32_bf16 v[68:71], a[68:71], a[92:95], v[68:71]
v_mfma_f32_16x16x32_bf16 v[68:71], a[100:103], a[124:127], v[68:71]
buffer_load_dwordx4 v9, s[36:39], s21 offen offset:3072 lds
v_mfma_f32_16x16x32_bf16 v[64:67], a[96:99], a[124:127], v[64:67]
v_mfma_f32_16x16x32_bf16 v[64:67], a[64:67], a[92:95], v[64:67]
s_waitcnt vmcnt(17) lgkmcnt(0)
s_barrier
v_mfma_f32_16x16x32_bf16 v[16:19], a[0:3], a[16:19], v[16:19]
s_xor_b32 s59, s1, 12288
s_add_u32 m0, s58, 32768
s_add_u32 s22, s12, s59
v_mfma_f32_16x16x32_bf16 v[16:19], a[32:35], a[48:51], v[16:19]
buffer_load_dwordx4 v15, s[48:51], s22 offen offset:0 sc1 lds
v_mfma_f32_16x16x32_bf16 v[20:23], a[36:39], a[48:51], v[20:23]
ds_read_b64_tr_b16 a[64:65], v123 offset:0
ds_read_b64_tr_b16 a[66:67], v123 offset:2048
v_mfma_f32_16x16x32_bf16 v[20:23], a[4:7], a[16:19], v[20:23]
ds_read_b128 a[80:83], v122 offset:0
ds_read_b64_tr_b16 a[68:69], v124 offset:0
v_mfma_f32_16x16x32_bf16 v[24:27], a[8:11], a[16:19], v[24:27]
ds_read_b64_tr_b16 a[70:71], v124 offset:2048
ds_read_b128 a[84:87], v122 offset:2048
v_mfma_f32_16x16x32_bf16 v[24:27], a[40:43], a[48:51], v[24:27]
buffer_load_dwordx4 v15, s[48:51], s22 offen offset:1024 sc1 lds
v_mfma_f32_16x16x32_bf16 v[28:31], a[44:47], a[48:51], v[28:31]
ds_read_b64_tr_b16 a[72:73], v125 offset:0
ds_read_b64_tr_b16 a[74:75], v125 offset:2048
v_mfma_f32_16x16x32_bf16 v[28:31], a[12:15], a[16:19], v[28:31]
s_add_u32 s23, s13, s59
v_mfma_f32_16x16x32_bf16 v[44:47], a[12:15], a[20:23], v[44:47]
ds_read_b128 a[88:91], v122 offset:4096
ds_read_b64_tr_b16 a[76:77], v126 offset:0
v_mfma_f32_16x16x32_bf16 v[44:47], a[44:47], a[52:55], v[44:47]
buffer_load_dwordx4 v15, s[48:51], s23 offen offset:2048 sc1 lds
v_mfma_f32_16x16x32_bf16 v[40:43], a[40:43], a[52:55], v[40:43]
ds_read_b64_tr_b16 a[78:79], v126 offset:2048
ds_read_b128 a[92:95], v122 offset:6144
v_mfma_f32_16x16x32_bf16 v[40:43], a[8:11], a[20:23], v[40:43]
v_mfma_f32_16x16x32_bf16 v[36:39], a[4:7], a[20:23], v[36:39]
ds_read_b64_tr_b16 a[96:97], v123 offset:8192
ds_read_b64_tr_b16 a[98:99], v123 offset:10240
v_mfma_f32_16x16x32_bf16 v[36:39], a[36:39], a[52:55], v[36:39]
buffer_load_dwordx4 v15, s[48:51], s23 offen offset:3072 sc1 lds
v_mfma_f32_16x16x32_bf16 v[32:35], a[32:35], a[52:55], v[32:35]
ds_read_b128 a[112:115], v122 offset:1024
ds_read_b64_tr_b16 a[100:101], v124 offset:8192
v_mfma_f32_16x16x32_bf16 v[32:35], a[0:3], a[20:23], v[32:35]
s_xor_b32 s60, s6, 393216
s_add_u32 m0, s58, 49152
s_add_u32 s18, s60, s7
v_mfma_f32_16x16x32_bf16 v[48:51], a[0:3], a[24:27], v[48:51]
ds_read_b64_tr_b16 a[102:103], v124 offset:10240
ds_read_b128 a[116:119], v122 offset:3072
v_mfma_f32_16x16x32_bf16 v[48:51], a[32:35], a[56:59], v[48:51]
buffer_load_dwordx4 v9, s[36:39], s18 offen offset:0 lds
v_mfma_f32_16x16x32_bf16 v[52:55], a[36:39], a[56:59], v[52:55]
ds_read_b64_tr_b16 a[104:105], v125 offset:8192
ds_read_b64_tr_b16 a[106:107], v125 offset:10240
v_mfma_f32_16x16x32_bf16 v[52:55], a[4:7], a[24:27], v[52:55]
s_add_u32 s19, s18, 7168
v_mfma_f32_16x16x32_bf16 v[56:59], a[8:11], a[24:27], v[56:59]
ds_read_b128 a[120:123], v122 offset:5120
ds_read_b64_tr_b16 a[108:109], v126 offset:8192
v_mfma_f32_16x16x32_bf16 v[56:59], a[40:43], a[56:59], v[56:59]
buffer_load_dwordx4 v9, s[36:39], s19 offen offset:1024 lds
v_mfma_f32_16x16x32_bf16 v[60:63], a[44:47], a[56:59], v[60:63]
ds_read_b64_tr_b16 a[110:111], v126 offset:10240
ds_read_b128 a[124:127], v122 offset:7168
v_mfma_f32_16x16x32_bf16 v[60:63], a[12:15], a[24:27], v[60:63]
s_add_u32 s20, s18, 14336
v_mfma_f32_16x16x32_bf16 v[76:79], a[12:15], a[28:31], v[76:79]
v_mfma_f32_16x16x32_bf16 v[76:79], a[44:47], a[60:63], v[76:79]
buffer_load_dwordx4 v9, s[36:39], s20 offen offset:2048 lds
v_mfma_f32_16x16x32_bf16 v[72:75], a[40:43], a[60:63], v[72:75]
v_mfma_f32_16x16x32_bf16 v[72:75], a[8:11], a[28:31], v[72:75]
s_add_u32 s21, s18, 21504
v_mfma_f32_16x16x32_bf16 v[68:71], a[4:7], a[28:31], v[68:71]
v_mfma_f32_16x16x32_bf16 v[68:71], a[36:39], a[60:63], v[68:71]
buffer_load_dwordx4 v9, s[36:39], s21 offen offset:3072 lds
v_mfma_f32_16x16x32_bf16 v[64:67], a[32:35], a[60:63], v[64:67]
v_mfma_f32_16x16x32_bf16 v[64:67], a[0:3], a[28:31], v[64:67]
s_waitcnt vmcnt(17) lgkmcnt(0)
s_barrier
v_mfma_f32_16x16x32_bf16 v[16:19], a[64:67], a[80:83], v[16:19]
s_xor_b32 s59, s1, 14336
s_add_u32 m0, s58, 131072
s_add_u32 s22, s12, s59
v_mfma_f32_16x16x32_bf16 v[16:19], a[96:99], a[112:115], v[16:19]
buffer_load_dwordx4 v15, s[48:51], s22 offen offset:0 sc1 lds
v_mfma_f32_16x16x32_bf16 v[20:23], a[100:103], a[112:115], v[20:23]
ds_read_b64_tr_b16 a[0:1], v118 offset:0
ds_read_b64_tr_b16 a[2:3], v118 offset:2048
v_mfma_f32_16x16x32_bf16 v[20:23], a[68:71], a[80:83], v[20:23]
ds_read_b128 a[16:19], v117 offset:0
ds_read_b64_tr_b16 a[4:5], v119 offset:0
v_mfma_f32_16x16x32_bf16 v[24:27], a[72:75], a[80:83], v[24:27]
ds_read_b64_tr_b16 a[6:7], v119 offset:2048
ds_read_b128 a[20:23], v117 offset:2048
v_mfma_f32_16x16x32_bf16 v[24:27], a[104:107], a[112:115], v[24:27]
buffer_load_dwordx4 v15, s[48:51], s22 offen offset:1024 sc1 lds
v_mfma_f32_16x16x32_bf16 v[28:31], a[108:111], a[112:115], v[28:31]
ds_read_b64_tr_b16 a[8:9], v120 offset:0
ds_read_b64_tr_b16 a[10:11], v120 offset:2048
v_mfma_f32_16x16x32_bf16 v[28:31], a[76:79], a[80:83], v[28:31]
s_add_u32 s23, s13, s59
v_mfma_f32_16x16x32_bf16 v[44:47], a[76:79], a[84:87], v[44:47]
ds_read_b128 a[24:27], v117 offset:4096
ds_read_b64_tr_b16 a[12:13], v121 offset:0
v_mfma_f32_16x16x32_bf16 v[44:47], a[108:111], a[116:119], v[44:47]
buffer_load_dwordx4 v15, s[48:51], s23 offen offset:2048 sc1 lds
v_mfma_f32_16x16x32_bf16 v[40:43], a[104:107], a[116:119], v[40:43]
ds_read_b64_tr_b16 a[14:15], v121 offset:2048
ds_read_b128 a[28:31], v117 offset:6144
v_mfma_f32_16x16x32_bf16 v[40:43], a[72:75], a[84:87], v[40:43]
v_mfma_f32_16x16x32_bf16 v[36:39], a[68:71], a[84:87], v[36:39]
ds_read_b64_tr_b16 a[32:33], v118 offset:8192
ds_read_b64_tr_b16 a[34:35], v118 offset:10240
v_mfma_f32_16x16x32_bf16 v[36:39], a[100:103], a[116:119], v[36:39]
buffer_load_dwordx4 v15, s[48:51], s23 offen offset:3072 sc1 lds
v_mfma_f32_16x16x32_bf16 v[32:35], a[96:99], a[116:119], v[32:35]
ds_read_b128 a[48:51], v117 offset:1024
ds_read_b64_tr_b16 a[36:37], v119 offset:8192
v_mfma_f32_16x16x32_bf16 v[32:35], a[64:67], a[84:87], v[32:35]
s_xor_b32 s60, s6, 458752
s_add_u32 m0, s58, 147456
s_add_u32 s18, s60, s7
v_mfma_f32_16x16x32_bf16 v[48:51], a[64:67], a[88:91], v[48:51]
ds_read_b64_tr_b16 a[38:39], v119 offset:10240
ds_read_b128 a[52:55], v117 offset:3072
v_mfma_f32_16x16x32_bf16 v[48:51], a[96:99], a[120:123], v[48:51]
buffer_load_dwordx4 v9, s[36:39], s18 offen offset:0 lds
v_mfma_f32_16x16x32_bf16 v[52:55], a[100:103], a[120:123], v[52:55]
ds_read_b64_tr_b16 a[40:41], v120 offset:8192
ds_read_b64_tr_b16 a[42:43], v120 offset:10240
v_mfma_f32_16x16x32_bf16 v[52:55], a[68:71], a[88:91], v[52:55]
s_add_u32 s19, s18, 7168
v_mfma_f32_16x16x32_bf16 v[56:59], a[72:75], a[88:91], v[56:59]
ds_read_b128 a[56:59], v117 offset:5120
ds_read_b64_tr_b16 a[44:45], v121 offset:8192
v_mfma_f32_16x16x32_bf16 v[56:59], a[104:107], a[120:123], v[56:59]
buffer_load_dwordx4 v9, s[36:39], s19 offen offset:1024 lds
v_mfma_f32_16x16x32_bf16 v[60:63], a[108:111], a[120:123], v[60:63]
ds_read_b64_tr_b16 a[46:47], v121 offset:10240
ds_read_b128 a[60:63], v117 offset:7168
v_mfma_f32_16x16x32_bf16 v[60:63], a[76:79], a[88:91], v[60:63]
s_add_u32 s20, s18, 14336
v_mfma_f32_16x16x32_bf16 v[76:79], a[76:79], a[92:95], v[76:79]
v_mfma_f32_16x16x32_bf16 v[76:79], a[108:111], a[124:127], v[76:79]
buffer_load_dwordx4 v9, s[36:39], s20 offen offset:2048 lds
v_mfma_f32_16x16x32_bf16 v[72:75], a[104:107], a[124:127], v[72:75]
v_mfma_f32_16x16x32_bf16 v[72:75], a[72:75], a[92:95], v[72:75]
s_add_u32 s21, s18, 21504
v_mfma_f32_16x16x32_bf16 v[68:71], a[68:71], a[92:95], v[68:71]
v_mfma_f32_16x16x32_bf16 v[68:71], a[100:103], a[124:127], v[68:71]
buffer_load_dwordx4 v9, s[36:39], s21 offen offset:3072 lds
v_mfma_f32_16x16x32_bf16 v[64:67], a[96:99], a[124:127], v[64:67]
v_mfma_f32_16x16x32_bf16 v[64:67], a[64:67], a[92:95], v[64:67]
s_waitcnt vmcnt(16) lgkmcnt(0)
s_barrier
v_cmp_ne_u32 vcc, s3, v7
s_cbranch_vccnz L_ctx2_spin
L_ctx2:
v_mfma_f32_16x16x32_bf16 v[16:19], a[0:3], a[16:19], v[16:19]
s_xor_b32 s59, s1, 16384
s_add_u32 m0, s58, 65536
s_add_u32 s22, s12, s59
v_mfma_f32_16x16x32_bf16 v[16:19], a[32:35], a[48:51], v[16:19]
buffer_load_dwordx4 v15, s[48:51], s22 offen offset:0 sc1 lds
v_mfma_f32_16x16x32_bf16 v[20:23], a[36:39], a[48:51], v[20:23]
ds_read_b64_tr_b16 a[64:65], v113 offset:0
ds_read_b64_tr_b16 a[66:67], v113 offset:2048
v_mfma_f32_16x16x32_bf16 v[20:23], a[4:7], a[16:19], v[20:23]
ds_read_b128 a[80:83], v112 offset:0
ds_read_b64_tr_b16 a[68:69], v114 offset:0
v_mfma_f32_16x16x32_bf16 v[24:27], a[8:11], a[16:19], v[24:27]
ds_read_b64_tr_b16 a[70:71], v114 offset:2048
ds_read_b128 a[84:87], v112 offset:2048
v_mfma_f32_16x16x32_bf16 v[24:27], a[40:43], a[48:51], v[24:27]
buffer_load_dwordx4 v15, s[48:51], s22 offen offset:1024 sc1 lds
v_mfma_f32_16x16x32_bf16 v[28:31], a[44:47], a[48:51], v[28:31]
ds_read_b64_tr_b16 a[72:73], v115 offset:0
ds_read_b64_tr_b16 a[74:75], v115 offset:2048
v_mfma_f32_16x16x32_bf16 v[28:31], a[12:15], a[16:19], v[28:31]
s_add_u32 s23, s13, s59
v_mfma_f32_16x16x32_bf16 v[44:47], a[12:15], a[20:23], v[44:47]
ds_read_b128 a[88:91], v112 offset:4096
ds_read_b64_tr_b16 a[76:77], v116 offset:0
v_mfma_f32_16x16x32_bf16 v[44:47], a[44:47], a[52:55], v[44:47]
buffer_load_dwordx4 v15, s[48:51], s23 offen offset:2048 sc1 lds
v_mfma_f32_16x16x32_bf16 v[40:43], a[40:43], a[52:55], v[40:43]
ds_read_b64_tr_b16 a[78:79], v116 offset:2048
ds_read_b128 a[92:95], v112 offset:6144
v_mfma_f32_16x16x32_bf16 v[40:43], a[8:11], a[20:23], v[40:43]
v_mfma_f32_16x16x32_bf16 v[36:39], a[4:7], a[20:23], v[36:39]
ds_read_b64_tr_b16 a[96:97], v113 offset:8192
ds_read_b64_tr_b16 a[98:99], v113 offset:10240
v_mfma_f32_16x16x32_bf16 v[36:39], a[36:39], a[52:55], v[36:39]
buffer_load_dwordx4 v15, s[48:51], s23 offen offset:3072 sc1 lds
v_mfma_f32_16x16x32_bf16 v[32:35], a[32:35], a[52:55], v[32:35]
ds_read_b128 a[112:115], v112 offset:1024
ds_read_b64_tr_b16 a[100:101], v114 offset:8192
v_mfma_f32_16x16x32_bf16 v[32:35], a[0:3], a[20:23], v[32:35]
s_xor_b32 s60, s6, 524288
s_add_u32 m0, s58, 81920
s_add_u32 s18, s60, s7
v_mfma_f32_16x16x32_bf16 v[48:51], a[0:3], a[24:27], v[48:51]
ds_read_b64_tr_b16 a[102:103], v114 offset:10240
ds_read_b128 a[116:119], v112 offset:3072
v_mfma_f32_16x16x32_bf16 v[48:51], a[32:35], a[56:59], v[48:51]
buffer_load_dwordx4 v9, s[36:39], s18 offen offset:0 lds
v_mfma_f32_16x16x32_bf16 v[52:55], a[36:39], a[56:59], v[52:55]
ds_read_b64_tr_b16 a[104:105], v115 offset:8192
ds_read_b64_tr_b16 a[106:107], v115 offset:10240
v_mfma_f32_16x16x32_bf16 v[52:55], a[4:7], a[24:27], v[52:55]
s_add_u32 s19, s18, 7168
v_mfma_f32_16x16x32_bf16 v[56:59], a[8:11], a[24:27], v[56:59]
ds_read_b128 a[120:123], v112 offset:5120
ds_read_b64_tr_b16 a[108:109], v116 offset:8192
v_mfma_f32_16x16x32_bf16 v[56:59], a[40:43], a[56:59], v[56:59]
buffer_load_dwordx4 v9, s[36:39], s19 offen offset:1024 lds
v_mfma_f32_16x16x32_bf16 v[60:63], a[44:47], a[56:59], v[60:63]
ds_read_b64_tr_b16 a[110:111], v116 offset:10240
ds_read_b128 a[124:127], v112 offset:7168
v_mfma_f32_16x16x32_bf16 v[60:63], a[12:15], a[24:27], v[60:63]
s_add_u32 s20, s18, 14336
v_mfma_f32_16x16x32_bf16 v[76:79], a[12:15], a[28:31], v[76:79]
v_mfma_f32_16x16x32_bf16 v[76:79], a[44:47], a[60:63], v[76:79]
buffer_load_dwordx4 v9, s[36:39], s20 offen offset:2048 lds
v_mfma_f32_16x16x32_bf16 v[72:75], a[40:43], a[60:63], v[72:75]
v_mfma_f32_16x16x32_bf16 v[72:75], a[8:11], a[28:31], v[72:75]
s_add_u32 s21, s18, 21504
v_mfma_f32_16x16x32_bf16 v[68:71], a[4:7], a[28:31], v[68:71]
v_mfma_f32_16x16x32_bf16 v[68:71], a[36:39], a[60:63], v[68:71]
buffer_load_dwordx4 v9, s[36:39], s21 offen offset:3072 lds
v_mfma_f32_16x16x32_bf16 v[64:67], a[32:35], a[60:63], v[64:67]
v_mfma_f32_16x16x32_bf16 v[64:67], a[0:3], a[28:31], v[64:67]
s_waitcnt vmcnt(16) lgkmcnt(0)
s_barrier
v_mfma_f32_16x16x32_bf16 v[16:19], a[64:67], a[80:83], v[16:19]
s_xor_b32 s59, s1, 18432
s_add_u32 m0, s58, 0
s_add_u32 s22, s12, s59
v_mfma_f32_16x16x32_bf16 v[16:19], a[96:99], a[112:115], v[16:19]
buffer_load_dwordx4 v15, s[48:51], s22 offen offset:0 sc1 lds
v_mfma_f32_16x16x32_bf16 v[20:23], a[100:103], a[112:115], v[20:23]
ds_read_b64_tr_b16 a[0:1], v113 offset:32768
ds_read_b64_tr_b16 a[2:3], v113 offset:34816
v_mfma_f32_16x16x32_bf16 v[20:23], a[68:71], a[80:83], v[20:23]
L_t17:
s_cbranch_execz L_r3
ds_read_b128 a[16:19], v112 offset:32768
ds_read_b64_tr_b16 a[4:5], v114 offset:32768
v_mfma_f32_16x16x32_bf16 v[24:27], a[72:75], a[80:83], v[24:27]
ds_read_b64_tr_b16 a[6:7], v114 offset:34816
ds_read_b128 a[20:23], v112 offset:34816
v_mfma_f32_16x16x32_bf16 v[24:27], a[104:107], a[112:115], v[24:27]
buffer_load_dwordx4 v15, s[48:51], s22 offen offset:1024 sc1 lds
v_mfma_f32_16x16x32_bf16 v[28:31], a[108:111], a[112:115], v[28:31]
ds_read_b64_tr_b16 a[8:9], v115 offset:32768
ds_read_b64_tr_b16 a[10:11], v115 offset:34816
v_mfma_f32_16x16x32_bf16 v[28:31], a[76:79], a[80:83], v[28:31]
s_add_u32 s23, s13, s59
v_mfma_f32_16x16x32_bf16 v[44:47], a[76:79], a[84:87], v[44:47]
ds_read_b128 a[24:27], v112 offset:36864
ds_read_b64_tr_b16 a[12:13], v116 offset:32768
v_mfma_f32_16x16x32_bf16 v[44:47], a[108:111], a[116:119], v[44:47]
buffer_load_dwordx4 v15, s[48:51], s23 offen offset:2048 sc1 lds
v_mfma_f32_16x16x32_bf16 v[40:43], a[104:107], a[116:119], v[40:43]
ds_read_b64_tr_b16 a[14:15], v116 offset:34816
ds_read_b128 a[28:31], v112 offset:38912
v_mfma_f32_16x16x32_bf16 v[40:43], a[72:75], a[84:87], v[40:43]
v_mfma_f32_16x16x32_bf16 v[36:39], a[68:71], a[84:87], v[36:39]
ds_read_b64_tr_b16 a[32:33], v113 offset:40960
ds_read_b64_tr_b16 a[34:35], v113 offset:43008
v_mfma_f32_16x16x32_bf16 v[36:39], a[100:103], a[116:119], v[36:39]
buffer_load_dwordx4 v15, s[48:51], s23 offen offset:3072 sc1 lds
v_mfma_f32_16x16x32_bf16 v[32:35], a[96:99], a[116:119], v[32:35]
ds_read_b128 a[48:51], v112 offset:33792
ds_read_b64_tr_b16 a[36:37], v114 offset:40960
v_mfma_f32_16x16x32_bf16 v[32:35], a[64:67], a[84:87], v[32:35]
s_xor_b32 s60, s6, 589824
s_add_u32 m0, s58, 16384
s_add_u32 s18, s60, s7
v_mfma_f32_16x16x32_bf16 v[48:51], a[64:67], a[88:91], v[48:51]
ds_read_b64_tr_b16 a[38:39], v114 offset:43008
ds_read_b128 a[52:55], v112 offset:35840
v_mfma_f32_16x16x32_bf16 v[48:51], a[96:99], a[120:123], v[48:51]
buffer_load_dwordx4 v9, s[36:39], s18 offen offset:0 lds
v_mfma_f32_16x16x32_bf16 v[52:55], a[100:103], a[120:123], v[52:55]
ds_read_b64_tr_b16 a[40:41], v115 offset:40960
ds_read_b64_tr_b16 a[42:43], v115 offset:43008
v_mfma_f32_16x16x32_bf16 v[52:55], a[68:71], a[88:91], v[52:55]
s_add_u32 s19, s18, 7168
v_mfma_f32_16x16x32_bf16 v[56:59], a[72:75], a[88:91], v[56:59]
ds_read_b128 a[56:59], v112 offset:37888
ds_read_b64_tr_b16 a[44:45], v116 offset:40960
v_mfma_f32_16x16x32_bf16 v[56:59], a[104:107], a[120:123], v[56:59]
buffer_load_dwordx4 v9, s[36:39], s19 offen offset:1024 lds
v_mfma_f32_16x16x32_bf16 v[60:63], a[108:111], a[120:123], v[60:63]
ds_read_b64_tr_b16 a[46:47], v116 offset:43008
ds_read_b128 a[60:63], v112 offset:39936
v_mfma_f32_16x16x32_bf16 v[60:63], a[76:79], a[88:91], v[60:63]
s_add_u32 s20, s18, 14336
v_mfma_f32_16x16x32_bf16 v[76:79], a[76:79], a[92:95], v[76:79]
v_mfma_f32_16x16x32_bf16 v[76:79], a[108:111], a[124:127], v[76:79]
buffer_load_dwordx4 v9, s[36:39], s20 offen offset:2048 lds
v_mfma_f32_16x16x32_bf16 v[72:75], a[104:107], a[124:127], v[72:75]
v_mfma_f32_16x16x32_bf16 v[72:75], a[72:75], a[92:95], v[72:75]
s_add_u32 s21, s18, 21504
v_mfma_f32_16x16x32_bf16 v[68:71], a[68:71], a[92:95], v[68:71]
v_mfma_f32_16x16x32_bf16 v[68:71], a[100:103], a[124:127], v[68:71]
buffer_load_dwordx4 v9, s[36:39], s21 offen offset:3072 lds
v_mfma_f32_16x16x32_bf16 v[64:67], a[96:99], a[124:127], v[64:67]
v_mfma_f32_16x16x32_bf16 v[64:67], a[64:67], a[92:95], v[64:67]
s_waitcnt vmcnt(16) lgkmcnt(0)
s_barrier
v_mfma_f32_16x16x32_bf16 v[16:19], a[0:3], a[16:19], v[16:19]
s_xor_b32 s59, s1, 20480
s_add_u32 m0, s58, 32768
s_add_u32 s22, s12, s59
v_mfma_f32_16x16x32_bf16 v[16:19], a[32:35], a[48:51], v[16:19]
buffer_load_dwordx4 v15, s[48:51], s22 offen offset:0 sc1 lds
v_mfma_f32_16x16x32_bf16 v[20:23], a[36:39], a[48:51], v[20:23]
ds_read_b64_tr_b16 a[64:65], v123 offset:0
ds_read_b64_tr_b16 a[66:67], v123 offset:2048
v_mfma_f32_16x16x32_bf16 v[20:23], a[4:7], a[16:19], v[20:23]
ds_read_b128 a[80:83], v122 offset:0
ds_read_b64_tr_b16 a[68:69], v124 offset:0
v_mfma_f32_16x16x32_bf16 v[24:27], a[8:11], a[16:19], v[24:27]
ds_read_b64_tr_b16 a[70:71], v124 offset:2048
ds_read_b128 a[84:87], v122 offset:2048
v_mfma_f32_16x16x32_bf16 v[24:27], a[40:43], a[48:51], v[24:27]
buffer_load_dwordx4 v15, s[48:51], s22 offen offset:1024 sc1 lds
v_mfma_f32_16x16x32_bf16 v[28:31], a[44:47], a[48:51], v[28:31]
ds_read_b64_tr_b16 a[72:73], v125 offset:0
ds_read_b64_tr_b16 a[74:75], v125 offset:2048
v_mfma_f32_16x16x32_bf16 v[28:31], a[12:15], a[16:19], v[28:31]
s_add_u32 s23, s13, s59
v_mfma_f32_16x16x32_bf16 v[44:47], a[12:15], a[20:23], v[44:47]
ds_read_b128 a[88:91], v122 offset:4096
ds_read_b64_tr_b16 a[76:77], v126 offset:0
v_mfma_f32_16x16x32_bf16 v[44:47], a[44:47], a[52:55], v[44:47]
buffer_load_dwordx4 v15, s[48:51], s23 offen offset:2048 sc1 lds
v_mfma_f32_16x16x32_bf16 v[40:43], a[40:43], a[52:55], v[40:43]
ds_read_b64_tr_b16 a[78:79], v126 offset:2048
ds_read_b128 a[92:95], v122 offset:6144
v_mfma_f32_16x16x32_bf16 v[40:43], a[8:11], a[20:23], v[40:43]
v_mfma_f32_16x16x32_bf16 v[36:39], a[4:7], a[20:23], v[36:39]
ds_read_b64_tr_b16 a[96:97], v123 offset:8192
ds_read_b64_tr_b16 a[98:99], v123 offset:10240
v_mfma_f32_16x16x32_bf16 v[36:39], a[36:39], a[52:55], v[36:39]
buffer_load_dwordx4 v15, s[48:51], s23 offen offset:3072 sc1 lds
v_mfma_f32_16x16x32_bf16 v[32:35], a[32:35], a[52:55], v[32:35]
ds_read_b128 a[112:115], v122 offset:1024
ds_read_b64_tr_b16 a[100:101], v124 offset:8192
v_mfma_f32_16x16x32_bf16 v[32:35], a[0:3], a[20:23], v[32:35]
s_xor_b32 s60, s6, 655360
s_add_u32 m0, s58, 49152
s_add_u32 s18, s60, s7
v_mfma_f32_16x16x32_bf16 v[48:51], a[0:3], a[24:27], v[48:51]
ds_read_b64_tr_b16 a[102:103], v124 offset:10240
ds_read_b128 a[116:119], v122 offset:3072
v_mfma_f32_16x16x32_bf16 v[48:51], a[32:35], a[56:59], v[48:51]
buffer_load_dwordx4 v9, s[36:39], s18 offen offset:0 lds
v_mfma_f32_16x16x32_bf16 v[52:55], a[36:39], a[56:59], v[52:55]
ds_read_b64_tr_b16 a[104:105], v125 offset:8192
ds_read_b64_tr_b16 a[106:107], v125 offset:10240
v_mfma_f32_16x16x32_bf16 v[52:55], a[4:7], a[24:27], v[52:55]
s_add_u32 s19, s18, 7168
v_mfma_f32_16x16x32_bf16 v[56:59], a[8:11], a[24:27], v[56:59]
ds_read_b128 a[120:123], v122 offset:5120
ds_read_b64_tr_b16 a[108:109], v126 offset:8192
v_mfma_f32_16x16x32_bf16 v[56:59], a[40:43], a[56:59], v[56:59]
buffer_load_dwordx4 v9, s[36:39], s19 offen offset:1024 lds
v_mfma_f32_16x16x32_bf16 v[60:63], a[44:47], a[56:59], v[60:63]
ds_read_b64_tr_b16 a[110:111], v126 offset:10240
ds_read_b128 a[124:127], v122 offset:7168
v_mfma_f32_16x16x32_bf16 v[60:63], a[12:15], a[24:27], v[60:63]
s_add_u32 s20, s18, 14336
v_mfma_f32_16x16x32_bf16 v[76:79], a[12:15], a[28:31], v[76:79]
v_mfma_f32_16x16x32_bf16 v[76:79], a[44:47], a[60:63], v[76:79]
buffer_load_dwordx4 v9, s[36:39], s20 offen offset:2048 lds
v_mfma_f32_16x16x32_bf16 v[72:75], a[40:43], a[60:63], v[72:75]
v_mfma_f32_16x16x32_bf16 v[72:75], a[8:11], a[28:31], v[72:75]
s_add_u32 s21, s18, 21504
v_mfma_f32_16x16x32_bf16 v[68:71], a[4:7], a[28:31], v[68:71]
v_mfma_f32_16x16x32_bf16 v[68:71], a[36:39], a[60:63], v[68:71]
buffer_load_dwordx4 v9, s[36:39], s21 offen offset:3072 lds
v_mfma_f32_16x16x32_bf16 v[64:67], a[32:35], a[60:63], v[64:67]
v_mfma_f32_16x16x32_bf16 v[64:67], a[0:3], a[28:31], v[64:67]
s_waitcnt vmcnt(16) lgkmcnt(0)
s_barrier
v_mfma_f32_16x16x32_bf16 v[16:19], a[64:67], a[80:83], v[16:19]
s_xor_b32 s59, s1, 22528
s_add_u32 m0, s58, 131072
s_add_u32 s22, s12, s59
v_mfma_f32_16x16x32_bf16 v[16:19], a[96:99], a[112:115], v[16:19]
buffer_load_dwordx4 v15, s[48:51], s22 offen offset:0 sc1 lds
v_mfma_f32_16x16x32_bf16 v[20:23], a[100:103], a[112:115], v[20:23]
ds_read_b64_tr_b16 a[0:1], v118 offset:0
ds_read_b64_tr_b16 a[2:3], v118 offset:2048
v_mfma_f32_16x16x32_bf16 v[20:23], a[68:71], a[80:83], v[20:23]
ds_read_b128 a[16:19], v117 offset:0
ds_read_b64_tr_b16 a[4:5], v119 offset:0
v_mfma_f32_16x16x32_bf16 v[24:27], a[72:75], a[80:83], v[24:27]
ds_read_b64_tr_b16 a[6:7], v119 offset:2048
ds_read_b128 a[20:23], v117 offset:2048
v_mfma_f32_16x16x32_bf16 v[24:27], a[104:107], a[112:115], v[24:27]
buffer_load_dwordx4 v15, s[48:51], s22 offen offset:1024 sc1 lds
v_mfma_f32_16x16x32_bf16 v[28:31], a[108:111], a[112:115], v[28:31]
ds_read_b64_tr_b16 a[8:9], v120 offset:0
ds_read_b64_tr_b16 a[10:11], v120 offset:2048
v_mfma_f32_16x16x32_bf16 v[28:31], a[76:79], a[80:83], v[28:31]
s_add_u32 s23, s13, s59
v_mfma_f32_16x16x32_bf16 v[44:47], a[76:79], a[84:87], v[44:47]
ds_read_b128 a[24:27], v117 offset:4096
ds_read_b64_tr_b16 a[12:13], v121 offset:0
v_mfma_f32_16x16x32_bf16 v[44:47], a[108:111], a[116:119], v[44:47]
buffer_load_dwordx4 v15, s[48:51], s23 offen offset:2048 sc1 lds
v_mfma_f32_16x16x32_bf16 v[40:43], a[104:107], a[116:119], v[40:43]
ds_read_b64_tr_b16 a[14:15], v121 offset:2048
ds_read_b128 a[28:31], v117 offset:6144
v_mfma_f32_16x16x32_bf16 v[40:43], a[72:75], a[84:87], v[40:43]
v_mfma_f32_16x16x32_bf16 v[36:39], a[68:71], a[84:87], v[36:39]
ds_read_b64_tr_b16 a[32:33], v118 offset:8192
ds_read_b64_tr_b16 a[34:35], v118 offset:10240
v_mfma_f32_16x16x32_bf16 v[36:39], a[100:103], a[116:119], v[36:39]
buffer_load_dwordx4 v15, s[48:51], s23 offen offset:3072 sc1 lds
v_mfma_f32_16x16x32_bf16 v[32:35], a[96:99], a[116:119], v[32:35]
ds_read_b128 a[48:51], v117 offset:1024
ds_read_b64_tr_b16 a[36:37], v119 offset:8192
v_mfma_f32_16x16x32_bf16 v[32:35], a[64:67], a[84:87], v[32:35]
s_xor_b32 s60, s6, 720896
s_add_u32 m0, s58, 147456
s_add_u32 s18, s60, s7
v_mfma_f32_16x16x32_bf16 v[48:51], a[64:67], a[88:91], v[48:51]
ds_read_b64_tr_b16 a[38:39], v119 offset:10240
ds_read_b128 a[52:55], v117 offset:3072
v_mfma_f32_16x16x32_bf16 v[48:51], a[96:99], a[120:123], v[48:51]
buffer_load_dwordx4 v9, s[36:39], s18 offen offset:0 lds
v_mfma_f32_16x16x32_bf16 v[52:55], a[100:103], a[120:123], v[52:55]
ds_read_b64_tr_b16 a[40:41], v120 offset:8192
ds_read_b64_tr_b16 a[42:43], v120 offset:10240
v_mfma_f32_16x16x32_bf16 v[52:55], a[68:71], a[88:91], v[52:55]
s_add_u32 s19, s18, 7168
v_mfma_f32_16x16x32_bf16 v[56:59], a[72:75], a[88:91], v[56:59]
ds_read_b128 a[56:59], v117 offset:5120
ds_read_b64_tr_b16 a[44:45], v121 offset:8192
v_mfma_f32_16x16x32_bf16 v[56:59], a[104:107], a[120:123], v[56:59]
buffer_load_dwordx4 v9, s[36:39], s19 offen offset:1024 lds
v_mfma_f32_16x16x32_bf16 v[60:63], a[108:111], a[120:123], v[60:63]
ds_read_b64_tr_b16 a[46:47], v121 offset:10240
ds_read_b128 a[60:63], v117 offset:7168
v_mfma_f32_16x16x32_bf16 v[60:63], a[76:79], a[88:91], v[60:63]
s_add_u32 s20, s18, 14336
v_mfma_f32_16x16x32_bf16 v[76:79], a[76:79], a[92:95], v[76:79]
s_lshl_b32 s35, s0, 5
s_sub_u32 s35, s27, s35
s_add_u32 s35, s35, 12288
v_mfma_f32_16x16x32_bf16 v[76:79], a[108:111], a[124:127], v[76:79]
buffer_load_dwordx4 v9, s[36:39], s20 offen offset:2048 lds
v_mfma_f32_16x16x32_bf16 v[72:75], a[104:107], a[124:127], v[72:75]
v_and_b32 v8, 96, v15
v_add_u32 v8, s35, v8
v_mfma_f32_16x16x32_bf16 v[72:75], a[72:75], a[92:95], v[72:75]
s_add_u32 s21, s18, 21504
global_load_dword v7, v8, s[16:17] sc1
v_mfma_f32_16x16x32_bf16 v[68:71], a[68:71], a[92:95], v[68:71]
v_mfma_f32_16x16x32_bf16 v[68:71], a[100:103], a[124:127], v[68:71]
buffer_load_dwordx4 v9, s[36:39], s21 offen offset:3072 lds
v_mfma_f32_16x16x32_bf16 v[64:67], a[96:99], a[124:127], v[64:67]
v_mfma_f32_16x16x32_bf16 v[64:67], a[64:67], a[92:95], v[64:67]
s_waitcnt vmcnt(17) lgkmcnt(0)
s_barrier
v_mfma_f32_16x16x32_bf16 v[16:19], a[0:3], a[16:19], v[16:19]
s_xor_b32 s59, s1, 24576
s_add_u32 m0, s58, 65536
s_add_u32 s22, s12, s59
v_mfma_f32_16x16x32_bf16 v[16:19], a[32:35], a[48:51], v[16:19]
buffer_load_dwordx4 v15, s[48:51], s22 offen offset:0 sc1 lds
v_mfma_f32_16x16x32_bf16 v[20:23], a[36:39], a[48:51], v[20:23]
ds_read_b64_tr_b16 a[64:65], v113 offset:0
ds_read_b64_tr_b16 a[66:67], v113 offset:2048
v_mfma_f32_16x16x32_bf16 v[20:23], a[4:7], a[16:19], v[20:23]
ds_read_b128 a[80:83], v112 offset:0
ds_read_b64_tr_b16 a[68:69], v114 offset:0
v_mfma_f32_16x16x32_bf16 v[24:27], a[8:11], a[16:19], v[24:27]
ds_read_b64_tr_b16 a[70:71], v114 offset:2048
ds_read_b128 a[84:87], v112 offset:2048
v_mfma_f32_16x16x32_bf16 v[24:27], a[40:43], a[48:51], v[24:27]
buffer_load_dwordx4 v15, s[48:51], s22 offen offset:1024 sc1 lds
v_mfma_f32_16x16x32_bf16 v[28:31], a[44:47], a[48:51], v[28:31]
ds_read_b64_tr_b16 a[72:73], v115 offset:0
ds_read_b64_tr_b16 a[74:75], v115 offset:2048
v_mfma_f32_16x16x32_bf16 v[28:31], a[12:15], a[16:19], v[28:31]
s_add_u32 s23, s13, s59
v_mfma_f32_16x16x32_bf16 v[44:47], a[12:15], a[20:23], v[44:47]
ds_read_b128 a[88:91], v112 offset:4096
ds_read_b64_tr_b16 a[76:77], v116 offset:0
v_mfma_f32_16x16x32_bf16 v[44:47], a[44:47], a[52:55], v[44:47]
buffer_load_dwordx4 v15, s[48:51], s23 offen offset:2048 sc1 lds
v_mfma_f32_16x16x32_bf16 v[40:43], a[40:43], a[52:55], v[40:43]
ds_read_b64_tr_b16 a[78:79], v116 offset:2048
ds_read_b128 a[92:95], v112 offset:6144
v_mfma_f32_16x16x32_bf16 v[40:43], a[8:11], a[20:23], v[40:43]
v_mfma_f32_16x16x32_bf16 v[36:39], a[4:7], a[20:23], v[36:39]
ds_read_b64_tr_b16 a[96:97], v113 offset:8192
ds_read_b64_tr_b16 a[98:99], v113 offset:10240
v_mfma_f32_16x16x32_bf16 v[36:39], a[36:39], a[52:55], v[36:39]
buffer_load_dwordx4 v15, s[48:51], s23 offen offset:3072 sc1 lds
v_mfma_f32_16x16x32_bf16 v[32:35], a[32:35], a[52:55], v[32:35]
ds_read_b128 a[112:115], v112 offset:1024
ds_read_b64_tr_b16 a[100:101], v114 offset:8192
v_mfma_f32_16x16x32_bf16 v[32:35], a[0:3], a[20:23], v[32:35]
s_xor_b32 s60, s6, 786432
s_add_u32 m0, s58, 81920
s_add_u32 s18, s60, s7
v_mfma_f32_16x16x32_bf16 v[48:51], a[0:3], a[24:27], v[48:51]
ds_read_b64_tr_b16 a[102:103], v114 offset:10240
ds_read_b128 a[116:119], v112 offset:3072
v_mfma_f32_16x16x32_bf16 v[48:51], a[32:35], a[56:59], v[48:51]
buffer_load_dwordx4 v9, s[36:39], s18 offen offset:0 lds
v_mfma_f32_16x16x32_bf16 v[52:55], a[36:39], a[56:59], v[52:55]
ds_read_b64_tr_b16 a[104:105], v115 offset:8192
ds_read_b64_tr_b16 a[106:107], v115 offset:10240
v_mfma_f32_16x16x32_bf16 v[52:55], a[4:7], a[24:27], v[52:55]
s_add_u32 s19, s18, 7168
v_mfma_f32_16x16x32_bf16 v[56:59], a[8:11], a[24:27], v[56:59]
ds_read_b128 a[120:123], v112 offset:5120
ds_read_b64_tr_b16 a[108:109], v116 offset:8192
v_mfma_f32_16x16x32_bf16 v[56:59], a[40:43], a[56:59], v[56:59]
buffer_load_dwordx4 v9, s[36:39], s19 offen offset:1024 lds
v_mfma_f32_16x16x32_bf16 v[60:63], a[44:47], a[56:59], v[60:63]
ds_read_b64_tr_b16 a[110:111], v116 offset:10240
ds_read_b128 a[124:127], v112 offset:7168
v_mfma_f32_16x16x32_bf16 v[60:63], a[12:15], a[24:27], v[60:63]
s_add_u32 s20, s18, 14336
v_mfma_f32_16x16x32_bf16 v[76:79], a[12:15], a[28:31], v[76:79]
v_mfma_f32_16x16x32_bf16 v[76:79], a[44:47], a[60:63], v[76:79]
buffer_load_dwordx4 v9, s[36:39], s20 offen offset:2048 lds
v_mfma_f32_16x16x32_bf16 v[72:75], a[40:43], a[60:63], v[72:75]
v_mfma_f32_16x16x32_bf16 v[72:75], a[8:11], a[28:31], v[72:75]
s_add_u32 s21, s18, 21504
v_mfma_f32_16x16x32_bf16 v[68:71], a[4:7], a[28:31], v[68:71]
v_mfma_f32_16x16x32_bf16 v[68:71], a[36:39], a[60:63], v[68:71]
buffer_load_dwordx4 v9, s[36:39], s21 offen offset:3072 lds
v_mfma_f32_16x16x32_bf16 v[64:67], a[32:35], a[60:63], v[64:67]
v_mfma_f32_16x16x32_bf16 v[64:67], a[0:3], a[28:31], v[64:67]
s_waitcnt vmcnt(17) lgkmcnt(0)
s_barrier
v_mfma_f32_16x16x32_bf16 v[16:19], a[64:67], a[80:83], v[16:19]
s_xor_b32 s59, s1, 26624
s_add_u32 m0, s58, 0
s_add_u32 s22, s12, s59
v_mfma_f32_16x16x32_bf16 v[16:19], a[96:99], a[112:115], v[16:19]
buffer_load_dwordx4 v15, s[48:51], s22 offen offset:0 sc1 lds
v_mfma_f32_16x16x32_bf16 v[20:23], a[100:103], a[112:115], v[20:23]
ds_read_b64_tr_b16 a[0:1], v113 offset:32768
ds_read_b64_tr_b16 a[2:3], v113 offset:34816
v_mfma_f32_16x16x32_bf16 v[20:23], a[68:71], a[80:83], v[20:23]
ds_read_b128 a[16:19], v112 offset:32768
ds_read_b64_tr_b16 a[4:5], v114 offset:32768
v_mfma_f32_16x16x32_bf16 v[24:27], a[72:75], a[80:83], v[24:27]
ds_read_b64_tr_b16 a[6:7], v114 offset:34816
ds_read_b128 a[20:23], v112 offset:34816
v_mfma_f32_16x16x32_bf16 v[24:27], a[104:107], a[112:115], v[24:27]
buffer_load_dwordx4 v15, s[48:51], s22 offen offset:1024 sc1 lds
v_mfma_f32_16x16x32_bf16 v[28:31], a[108:111], a[112:115], v[28:31]
ds_read_b64_tr_b16 a[8:9], v115 offset:32768
ds_read_b64_tr_b16 a[10:11], v115 offset:34816
v_mfma_f32_16x16x32_bf16 v[28:31], a[76:79], a[80:83], v[28:31]
s_add_u32 s23, s13, s59
v_mfma_f32_16x16x32_bf16 v[44:47], a[76:79], a[84:87], v[44:47]
ds_read_b128 a[24:27], v112 offset:36864
ds_read_b64_tr_b16 a[12:13], v116 offset:32768
v_mfma_f32_16x16x32_bf16 v[44:47], a[108:111], a[116:119], v[44:47]
buffer_load_dwordx4 v15, s[48:51], s23 offen offset:2048 sc1 lds
v_mfma_f32_16x16x32_bf16 v[40:43], a[104:107], a[116:119], v[40:43]
ds_read_b64_tr_b16 a[14:15], v116 offset:34816
ds_read_b128 a[28:31], v112 offset:38912
v_mfma_f32_16x16x32_bf16 v[40:43], a[72:75], a[84:87], v[40:43]
v_mfma_f32_16x16x32_bf16 v[36:39], a[68:71], a[84:87], v[36:39]
ds_read_b64_tr_b16 a[32:33], v113 offset:40960
ds_read_b64_tr_b16 a[34:35], v113 offset:43008
v_mfma_f32_16x16x32_bf16 v[36:39], a[100:103], a[116:119], v[36:39]
buffer_load_dwordx4 v15, s[48:51], s23 offen offset:3072 sc1 lds
v_mfma_f32_16x16x32_bf16 v[32:35], a[96:99], a[116:119], v[32:35]
ds_read_b128 a[48:51], v112 offset:33792
ds_read_b64_tr_b16 a[36:37], v114 offset:40960
v_mfma_f32_16x16x32_bf16 v[32:35], a[64:67], a[84:87], v[32:35]
s_xor_b32 s60, s6, 851968
s_add_u32 m0, s58, 16384
s_add_u32 s18, s60, s7
v_mfma_f32_16x16x32_bf16 v[48:51], a[64:67], a[88:91], v[48:51]
ds_read_b64_tr_b16 a[38:39], v114 offset:43008
ds_read_b128 a[52:55], v112 offset:35840
v_mfma_f32_16x16x32_bf16 v[48:51], a[96:99], a[120:123], v[48:51]
buffer_load_dwordx4 v9, s[36:39], s18 offen offset:0 lds
v_mfma_f32_16x16x32_bf16 v[52:55], a[100:103], a[120:123], v[52:55]
ds_read_b64_tr_b16 a[40:41], v115 offset:40960
ds_read_b64_tr_b16 a[42:43], v115 offset:43008
v_mfma_f32_16x16x32_bf16 v[52:55], a[68:71], a[88:91], v[52:55]
s_add_u32 s19, s18, 7168
v_mfma_f32_16x16x32_bf16 v[56:59], a[72:75], a[88:91], v[56:59]
ds_read_b128 a[56:59], v112 offset:37888
ds_read_b64_tr_b16 a[44:45], v116 offset:40960
v_mfma_f32_16x16x32_bf16 v[56:59], a[104:107], a[120:123], v[56:59]
buffer_load_dwordx4 v9, s[36:39], s19 offen offset:1024 lds
v_mfma_f32_16x16x32_bf16 v[60:63], a[108:111], a[120:123], v[60:63]
ds_read_b64_tr_b16 a[46:47], v116 offset:43008
ds_read_b128 a[60:63], v112 offset:39936
v_mfma_f32_16x16x32_bf16 v[60:63], a[76:79], a[88:91], v[60:63]
s_add_u32 s20, s18, 14336
v_mfma_f32_16x16x32_bf16 v[76:79], a[76:79], a[92:95], v[76:79]
v_mfma_f32_16x16x32_bf16 v[76:79], a[108:111], a[124:127], v[76:79]
buffer_load_dwordx4 v9, s[36:39], s20 offen offset:2048 lds
v_mfma_f32_16x16x32_bf16 v[72:75], a[104:107], a[124:127], v[72:75]
v_mfma_f32_16x16x32_bf16 v[72:75], a[72:75], a[92:95], v[72:75]
s_add_u32 s21, s18, 21504
v_mfma_f32_16x16x32_bf16 v[68:71], a[68:71], a[92:95], v[68:71]
v_mfma_f32_16x16x32_bf16 v[68:71], a[100:103], a[124:127], v[68:71]
buffer_load_dwordx4 v9, s[36:39], s21 offen offset:3072 lds
v_mfma_f32_16x16x32_bf16 v[64:67], a[96:99], a[124:127], v[64:67]
v_mfma_f32_16x16x32_bf16 v[64:67], a[64:67], a[92:95], v[64:67]
s_waitcnt vmcnt(16) lgkmcnt(0)
s_barrier
v_mfma_f32_16x16x32_bf16 v[16:19], a[0:3], a[16:19], v[16:19]
s_xor_b32 s59, s1, 28672
s_add_u32 m0, s58, 32768
s_add_u32 s22, s12, s59
v_mfma_f32_16x16x32_bf16 v[16:19], a[32:35], a[48:51], v[16:19]
buffer_load_dwordx4 v15, s[48:51], s22 offen offset:0 sc1 lds
v_mfma_f32_16x16x32_bf16 v[20:23], a[36:39], a[48:51], v[20:23]
ds_read_b64_tr_b16 a[64:65], v123 offset:0
ds_read_b64_tr_b16 a[66:67], v123 offset:2048
v_mfma_f32_16x16x32_bf16 v[20:23], a[4:7], a[16:19], v[20:23]
ds_read_b128 a[80:83], v122 offset:0
ds_read_b64_tr_b16 a[68:69], v124 offset:0
v_mfma_f32_16x16x32_bf16 v[24:27], a[8:11], a[16:19], v[24:27]
ds_read_b64_tr_b16 a[70:71], v124 offset:2048
ds_read_b128 a[84:87], v122 offset:2048
v_mfma_f32_16x16x32_bf16 v[24:27], a[40:43], a[48:51], v[24:27]
buffer_load_dwordx4 v15, s[48:51], s22 offen offset:1024 sc1 lds
v_mfma_f32_16x16x32_bf16 v[28:31], a[44:47], a[48:51], v[28:31]
ds_read_b64_tr_b16 a[72:73], v125 offset:0
ds_read_b64_tr_b16 a[74:75], v125 offset:2048
v_mfma_f32_16x16x32_bf16 v[28:31], a[12:15], a[16:19], v[28:31]
s_add_u32 s23, s13, s59
v_mfma_f32_16x16x32_bf16 v[44:47], a[12:15], a[20:23], v[44:47]
ds_read_b128 a[88:91], v122 offset:4096
ds_read_b64_tr_b16 a[76:77], v126 offset:0
v_mfma_f32_16x16x32_bf16 v[44:47], a[44:47], a[52:55], v[44:47]
buffer_load_dwordx4 v15, s[48:51], s23 offen offset:2048 sc1 lds
v_mfma_f32_16x16x32_bf16 v[40:43], a[40:43], a[52:55], v[40:43]
ds_read_b64_tr_b16 a[78:79], v126 offset:2048
ds_read_b128 a[92:95], v122 offset:6144
v_mfma_f32_16x16x32_bf16 v[40:43], a[8:11], a[20:23], v[40:43]
v_mfma_f32_16x16x32_bf16 v[36:39], a[4:7], a[20:23], v[36:39]
ds_read_b64_tr_b16 a[96:97], v123 offset:8192
ds_read_b64_tr_b16 a[98:99], v123 offset:10240
v_mfma_f32_16x16x32_bf16 v[36:39], a[36:39], a[52:55], v[36:39]
buffer_load_dwordx4 v15, s[48:51], s23 offen offset:3072 sc1 lds
v_mfma_f32_16x16x32_bf16 v[32:35], a[32:35], a[52:55], v[32:35]
ds_read_b128 a[112:115], v122 offset:1024
ds_read_b64_tr_b16 a[100:101], v124 offset:8192
v_mfma_f32_16x16x32_bf16 v[32:35], a[0:3], a[20:23], v[32:35]
s_xor_b32 s60, s6, 917504
s_add_u32 m0, s58, 49152
s_add_u32 s18, s60, s7
v_mfma_f32_16x16x32_bf16 v[48:51], a[0:3], a[24:27], v[48:51]
ds_read_b64_tr_b16 a[102:103], v124 offset:10240
ds_read_b128 a[116:119], v122 offset:3072
v_mfma_f32_16x16x32_bf16 v[48:51], a[32:35], a[56:59], v[48:51]
buffer_load_dwordx4 v9, s[36:39], s18 offen offset:0 lds
v_mfma_f32_16x16x32_bf16 v[52:55], a[36:39], a[56:59], v[52:55]
ds_read_b64_tr_b16 a[104:105], v125 offset:8192
ds_read_b64_tr_b16 a[106:107], v125 offset:10240
v_mfma_f32_16x16x32_bf16 v[52:55], a[4:7], a[24:27], v[52:55]
s_add_u32 s19, s18, 7168
v_mfma_f32_16x16x32_bf16 v[56:59], a[8:11], a[24:27], v[56:59]
ds_read_b128 a[120:123], v122 offset:5120
ds_read_b64_tr_b16 a[108:109], v126 offset:8192
v_mfma_f32_16x16x32_bf16 v[56:59], a[40:43], a[56:59], v[56:59]
buffer_load_dwordx4 v9, s[36:39], s19 offen offset:1024 lds
v_mfma_f32_16x16x32_bf16 v[60:63], a[44:47], a[56:59], v[60:63]
ds_read_b64_tr_b16 a[110:111], v126 offset:10240
ds_read_b128 a[124:127], v122 offset:7168
v_mfma_f32_16x16x32_bf16 v[60:63], a[12:15], a[24:27], v[60:63]
s_add_u32 s20, s18, 14336
v_mfma_f32_16x16x32_bf16 v[76:79], a[12:15], a[28:31], v[76:79]
v_mfma_f32_16x16x32_bf16 v[76:79], a[44:47], a[60:63], v[76:79]
buffer_load_dwordx4 v9, s[36:39], s20 offen offset:2048 lds
v_mfma_f32_16x16x32_bf16 v[72:75], a[40:43], a[60:63], v[72:75]
v_mfma_f32_16x16x32_bf16 v[72:75], a[8:11], a[28:31], v[72:75]
s_add_u32 s21, s18, 21504
v_mfma_f32_16x16x32_bf16 v[68:71], a[4:7], a[28:31], v[68:71]
v_mfma_f32_16x16x32_bf16 v[68:71], a[36:39], a[60:63], v[68:71]
buffer_load_dwordx4 v9, s[36:39], s21 offen offset:3072 lds
v_mfma_f32_16x16x32_bf16 v[64:67], a[32:35], a[60:63], v[64:67]
v_mfma_f32_16x16x32_bf16 v[64:67], a[0:3], a[28:31], v[64:67]
s_waitcnt vmcnt(16) lgkmcnt(0)
s_barrier
v_cmp_ne_u32 vcc, s3, v7
s_cbranch_vccnz L_mark_spin
L_mark:
v_mfma_f32_16x16x32_bf16 v[16:19], a[64:67], a[80:83], v[16:19]
s_xor_b32 s59, s1, 30720
s_add_u32 m0, s58, 131072
s_add_u32 s22, s12, s59
v_mfma_f32_16x16x32_bf16 v[16:19], a[96:99], a[112:115], v[16:19]
buffer_load_dwordx4 v15, s[48:51], s22 offen offset:0 sc1 lds
v_mfma_f32_16x16x32_bf16 v[20:23], a[100:103], a[112:115], v[20:23]
ds_read_b64_tr_b16 a[0:1], v118 offset:0
ds_read_b64_tr_b16 a[2:3], v118 offset:2048
v_mfma_f32_16x16x32_bf16 v[20:23], a[68:71], a[80:83], v[20:23]
ds_read_b128 a[16:19], v117 offset:0
ds_read_b64_tr_b16 a[4:5], v119 offset:0
v_mfma_f32_16x16x32_bf16 v[24:27], a[72:75], a[80:83], v[24:27]
ds_read_b64_tr_b16 a[6:7], v119 offset:2048
ds_read_b128 a[20:23], v117 offset:2048
v_mfma_f32_16x16x32_bf16 v[24:27], a[104:107], a[112:115], v[24:27]
buffer_load_dwordx4 v15, s[48:51], s22 offen offset:1024 sc1 lds
v_mfma_f32_16x16x32_bf16 v[28:31], a[108:111], a[112:115], v[28:31]
ds_read_b64_tr_b16 a[8:9], v120 offset:0
ds_read_b64_tr_b16 a[10:11], v120 offset:2048
v_mfma_f32_16x16x32_bf16 v[28:31], a[76:79], a[80:83], v[28:31]
s_add_u32 s23, s13, s59
v_mfma_f32_16x16x32_bf16 v[44:47], a[76:79], a[84:87], v[44:47]
ds_read_b128 a[24:27], v117 offset:4096
ds_read_b64_tr_b16 a[12:13], v121 offset:0
v_mfma_f32_16x16x32_bf16 v[44:47], a[108:111], a[116:119], v[44:47]
buffer_load_dwordx4 v15, s[48:51], s23 offen offset:2048 sc1 lds
v_mfma_f32_16x16x32_bf16 v[40:43], a[104:107], a[116:119], v[40:43]
ds_read_b64_tr_b16 a[14:15], v121 offset:2048
ds_read_b128 a[28:31], v117 offset:6144
v_mfma_f32_16x16x32_bf16 v[40:43], a[72:75], a[84:87], v[40:43]
v_mfma_f32_16x16x32_bf16 v[36:39], a[68:71], a[84:87], v[36:39]
ds_read_b64_tr_b16 a[32:33], v118 offset:8192
ds_read_b64_tr_b16 a[34:35], v118 offset:10240
v_mfma_f32_16x16x32_bf16 v[36:39], a[100:103], a[116:119], v[36:39]
buffer_load_dwordx4 v15, s[48:51], s23 offen offset:3072 sc1 lds
v_mfma_f32_16x16x32_bf16 v[32:35], a[96:99], a[116:119], v[32:35]
ds_read_b128 a[48:51], v117 offset:1024
ds_read_b64_tr_b16 a[36:37], v119 offset:8192
v_mfma_f32_16x16x32_bf16 v[32:35], a[64:67], a[84:87], v[32:35]
s_xor_b32 s60, s6, 983040
s_add_u32 m0, s58, 147456
s_add_u32 s18, s60, s7
v_mfma_f32_16x16x32_bf16 v[48:51], a[64:67], a[88:91], v[48:51]
ds_read_b64_tr_b16 a[38:39], v119 offset:10240
ds_read_b128 a[52:55], v117 offset:3072
v_mfma_f32_16x16x32_bf16 v[48:51], a[96:99], a[120:123], v[48:51]
buffer_load_dwordx4 v9, s[36:39], s18 offen offset:0 lds
v_mfma_f32_16x16x32_bf16 v[52:55], a[100:103], a[120:123], v[52:55]
ds_read_b64_tr_b16 a[40:41], v120 offset:8192
ds_read_b64_tr_b16 a[42:43], v120 offset:10240
v_mfma_f32_16x16x32_bf16 v[52:55], a[68:71], a[88:91], v[52:55]
s_add_u32 s19, s18, 7168
v_mfma_f32_16x16x32_bf16 v[56:59], a[72:75], a[88:91], v[56:59]
ds_read_b128 a[56:59], v117 offset:5120
ds_read_b64_tr_b16 a[44:45], v121 offset:8192
v_mfma_f32_16x16x32_bf16 v[56:59], a[104:107], a[120:123], v[56:59]
buffer_load_dwordx4 v9, s[36:39], s19 offen offset:1024 lds
v_mfma_f32_16x16x32_bf16 v[60:63], a[108:111], a[120:123], v[60:63]
ds_read_b64_tr_b16 a[46:47], v121 offset:10240
ds_read_b128 a[60:63], v117 offset:7168
v_mfma_f32_16x16x32_bf16 v[60:63], a[76:79], a[88:91], v[60:63]
s_add_u32 s20, s18, 14336
v_mfma_f32_16x16x32_bf16 v[76:79], a[76:79], a[92:95], v[76:79]
v_mfma_f32_16x16x32_bf16 v[76:79], a[108:111], a[124:127], v[76:79]
buffer_load_dwordx4 v9, s[36:39], s20 offen offset:2048 lds
v_mfma_f32_16x16x32_bf16 v[72:75], a[104:107], a[124:127], v[72:75]
v_mfma_f32_16x16x32_bf16 v[72:75], a[72:75], a[92:95], v[72:75]
s_add_u32 s21, s18, 21504
v_mfma_f32_16x16x32_bf16 v[68:71], a[68:71], a[92:95], v[68:71]
v_mfma_f32_16x16x32_bf16 v[68:71], a[100:103], a[124:127], v[68:71]
buffer_load_dwordx4 v9, s[36:39], s21 offen offset:3072 lds
v_mfma_f32_16x16x32_bf16 v[64:67], a[96:99], a[124:127], v[64:67]
v_mfma_f32_16x16x32_bf16 v[64:67], a[64:67], a[92:95], v[64:67]
s_waitcnt vmcnt(16) lgkmcnt(0)
s_barrier
v_mfma_f32_16x16x32_bf16 v[44:47], a[12:15], a[20:23], v[44:47]
ds_read_b64_tr_b16 a[64:65], v113 offset:0
ds_read_b64_tr_b16 a[66:67], v113 offset:2048
v_mfma_f32_16x16x32_bf16 v[44:47], a[44:47], a[52:55], v[44:47]
L_t18:
s_cbranch_execz L_r4
v_mfma_f32_16x16x32_bf16 v[40:43], a[40:43], a[52:55], v[40:43]
ds_read_b128 a[80:83], v112 offset:0
ds_read_b64_tr_b16 a[68:69], v114 offset:0
v_mfma_f32_16x16x32_bf16 v[40:43], a[8:11], a[20:23], v[40:43]
ds_read_b64_tr_b16 a[70:71], v114 offset:2048
ds_read_b128 a[84:87], v112 offset:2048
v_mfma_f32_16x16x32_bf16 v[36:39], a[4:7], a[20:23], v[36:39]
ds_read_b64_tr_b16 a[72:73], v115 offset:0
ds_read_b64_tr_b16 a[74:75], v115 offset:2048
v_mfma_f32_16x16x32_bf16 v[36:39], a[36:39], a[52:55], v[36:39]
v_mfma_f32_16x16x32_bf16 v[32:35], a[32:35], a[52:55], v[32:35]
ds_read_b128 a[88:91], v112 offset:4096
ds_read_b64_tr_b16 a[76:77], v116 offset:0
v_mfma_f32_16x16x32_bf16 v[32:35], a[0:3], a[20:23], v[32:35]
ds_read_b64_tr_b16 a[78:79], v116 offset:2048
ds_read_b128 a[92:95], v112 offset:6144
v_mfma_f32_16x16x32_bf16 v[48:51], a[0:3], a[24:27], v[48:51]
ds_read_b64_tr_b16 a[96:97], v113 offset:8192
ds_read_b64_tr_b16 a[98:99], v113 offset:10240
v_mfma_f32_16x16x32_bf16 v[48:51], a[32:35], a[56:59], v[48:51]
v_mfma_f32_16x16x32_bf16 v[52:55], a[36:39], a[56:59], v[52:55]
ds_read_b128 a[112:115], v112 offset:1024
ds_read_b64_tr_b16 a[100:101], v114 offset:8192
v_mfma_f32_16x16x32_bf16 v[52:55], a[4:7], a[24:27], v[52:55]
ds_read_b64_tr_b16 a[102:103], v114 offset:10240
ds_read_b128 a[116:119], v112 offset:3072
v_mfma_f32_16x16x32_bf16 v[56:59], a[8:11], a[24:27], v[56:59]
ds_read_b64_tr_b16 a[104:105], v115 offset:8192
ds_read_b64_tr_b16 a[106:107], v115 offset:10240
v_mfma_f32_16x16x32_bf16 v[56:59], a[40:43], a[56:59], v[56:59]
v_mfma_f32_16x16x32_bf16 v[60:63], a[44:47], a[56:59], v[60:63]
ds_read_b128 a[120:123], v112 offset:5120
ds_read_b64_tr_b16 a[108:109], v116 offset:8192
v_mfma_f32_16x16x32_bf16 v[60:63], a[12:15], a[24:27], v[60:63]
ds_read_b64_tr_b16 a[110:111], v116 offset:10240
ds_read_b128 a[124:127], v112 offset:7168
v_mfma_f32_16x16x32_bf16 v[76:79], a[12:15], a[28:31], v[76:79]
v_mfma_f32_16x16x32_bf16 v[76:79], a[44:47], a[60:63], v[76:79]
v_mfma_f32_16x16x32_bf16 v[72:75], a[40:43], a[60:63], v[72:75]
v_mfma_f32_16x16x32_bf16 v[72:75], a[8:11], a[28:31], v[72:75]
v_mfma_f32_16x16x32_bf16 v[68:71], a[4:7], a[28:31], v[68:71]
v_mfma_f32_16x16x32_bf16 v[68:71], a[36:39], a[60:63], v[68:71]
v_mfma_f32_16x16x32_bf16 v[64:67], a[32:35], a[60:63], v[64:67]
v_mfma_f32_16x16x32_bf16 v[64:67], a[0:3], a[28:31], v[64:67]
s_waitcnt vmcnt(8) lgkmcnt(0)
s_barrier
v_mfma_f32_16x16x32_bf16 v[44:47], a[76:79], a[84:87], v[44:47]
ds_read_b64_tr_b16 a[128:129], v113 offset:32768
ds_read_b64_tr_b16 a[130:131], v113 offset:34816
v_mfma_f32_16x16x32_bf16 v[44:47], a[108:111], a[116:119], v[44:47]
buffer_load_dwordx2 v[96:97], v12, s[44:47], 0 offen offset:0
v_mfma_f32_16x16x32_bf16 v[40:43], a[104:107], a[116:119], v[40:43]
ds_read_b128 a[144:147], v112 offset:32768
ds_read_b64_tr_b16 a[132:133], v114 offset:32768
v_mfma_f32_16x16x32_bf16 v[40:43], a[72:75], a[84:87], v[40:43]
ds_read_b64_tr_b16 a[134:135], v114 offset:34816
ds_read_b128 a[148:151], v112 offset:34816
v_mfma_f32_16x16x32_bf16 v[36:39], a[68:71], a[84:87], v[36:39]
ds_read_b64_tr_b16 a[136:137], v115 offset:32768
ds_read_b64_tr_b16 a[138:139], v115 offset:34816
v_mfma_f32_16x16x32_bf16 v[36:39], a[100:103], a[116:119], v[36:39]
buffer_load_dwordx2 v[98:99], v12, s[44:47], 0 offen offset:32
v_mfma_f32_16x16x32_bf16 v[32:35], a[96:99], a[116:119], v[32:35]
ds_read_b128 a[152:155], v112 offset:36864
ds_read_b64_tr_b16 a[140:141], v116 offset:32768
v_mfma_f32_16x16x32_bf16 v[32:35], a[64:67], a[84:87], v[32:35]
ds_read_b64_tr_b16 a[142:143], v116 offset:34816
ds_read_b128 a[156:159], v112 offset:38912
v_mfma_f32_16x16x32_bf16 v[48:51], a[64:67], a[88:91], v[48:51]
ds_read_b64_tr_b16 a[160:161], v113 offset:40960
ds_read_b64_tr_b16 a[162:163], v113 offset:43008
v_mfma_f32_16x16x32_bf16 v[48:51], a[96:99], a[120:123], v[48:51]
buffer_load_dwordx2 v[100:101], v12, s[44:47], 0 offen offset:64
v_mfma_f32_16x16x32_bf16 v[52:55], a[100:103], a[120:123], v[52:55]
ds_read_b128 a[176:179], v112 offset:33792
ds_read_b64_tr_b16 a[164:165], v114 offset:40960
v_mfma_f32_16x16x32_bf16 v[52:55], a[68:71], a[88:91], v[52:55]
ds_read_b64_tr_b16 a[166:167], v114 offset:43008
ds_read_b128 a[180:183], v112 offset:35840
v_mfma_f32_16x16x32_bf16 v[56:59], a[72:75], a[88:91], v[56:59]
ds_read_b64_tr_b16 a[168:169], v115 offset:40960
ds_read_b64_tr_b16 a[170:171], v115 offset:43008
v_mfma_f32_16x16x32_bf16 v[56:59], a[104:107], a[120:123], v[56:59]
buffer_load_dwordx2 v[102:103], v12, s[44:47], 0 offen offset:96
v_mfma_f32_16x16x32_bf16 v[60:63], a[108:111], a[120:123], v[60:63]
ds_read_b128 a[184:187], v112 offset:37888
ds_read_b64_tr_b16 a[172:173], v116 offset:40960
v_mfma_f32_16x16x32_bf16 v[60:63], a[76:79], a[88:91], v[60:63]
ds_read_b64_tr_b16 a[174:175], v116 offset:43008
ds_read_b128 a[188:191], v112 offset:39936
v_mfma_f32_16x16x32_bf16 v[76:79], a[76:79], a[92:95], v[76:79]
v_mfma_f32_16x16x32_bf16 v[76:79], a[108:111], a[124:127], v[76:79]
v_mfma_f32_16x16x32_bf16 v[72:75], a[104:107], a[124:127], v[72:75]
v_mfma_f32_16x16x32_bf16 v[72:75], a[72:75], a[92:95], v[72:75]
v_mfma_f32_16x16x32_bf16 v[68:71], a[68:71], a[92:95], v[68:71]
v_mfma_f32_16x16x32_bf16 v[68:71], a[100:103], a[124:127], v[68:71]
v_mfma_f32_16x16x32_bf16 v[64:67], a[96:99], a[124:127], v[64:67]
s_mul_i32 s63, s0, 24576
s_add_u32 s63, s63, s14
v_mfma_f32_16x16x32_bf16 v[64:67], a[64:67], a[92:95], v[64:67]
s_waitcnt vmcnt(4) lgkmcnt(0)
s_barrier
v_mfma_f32_16x16x32_bf16 v[44:47], a[140:143], a[148:151], v[44:47]
ds_read_b64_tr_b16 a[192:193], v123 offset:0
ds_read_b64_tr_b16 a[194:195], v123 offset:2048
v_mfma_f32_16x16x32_bf16 v[44:47], a[172:175], a[180:183], v[44:47]
v_mfma_f32_16x16x32_bf16 v[40:43], a[168:171], a[180:183], v[40:43]
ds_read_b128 a[208:211], v122 offset:0
ds_read_b64_tr_b16 a[196:197], v124 offset:0
v_mfma_f32_16x16x32_bf16 v[40:43], a[136:139], a[148:151], v[40:43]
ds_read_b64_tr_b16 a[198:199], v124 offset:2048
ds_read_b128 a[212:215], v122 offset:2048
v_mfma_f32_16x16x32_bf16 v[36:39], a[132:135], a[148:151], v[36:39]
ds_read_b64_tr_b16 a[200:201], v125 offset:0
ds_read_b64_tr_b16 a[202:203], v125 offset:2048
v_mfma_f32_16x16x32_bf16 v[36:39], a[164:167], a[180:183], v[36:39]
v_mfma_f32_16x16x32_bf16 v[32:35], a[160:163], a[180:183], v[32:35]
ds_read_b128 a[216:219], v122 offset:4096
ds_read_b64_tr_b16 a[204:205], v126 offset:0
v_mfma_f32_16x16x32_bf16 v[32:35], a[128:131], a[148:151], v[32:35]
ds_read_b64_tr_b16 a[206:207], v126 offset:2048
ds_read_b128 a[220:223], v122 offset:6144
v_mfma_f32_16x16x32_bf16 v[48:51], a[128:131], a[152:155], v[48:51]
ds_read_b64_tr_b16 a[224:225], v123 offset:8192
ds_read_b64_tr_b16 a[226:227], v123 offset:10240
v_mfma_f32_16x16x32_bf16 v[48:51], a[160:163], a[184:187], v[48:51]
v_mfma_f32_16x16x32_bf16 v[52:55], a[164:167], a[184:187], v[52:55]
ds_read_b128 a[240:243], v122 offset:1024
ds_read_b64_tr_b16 a[228:229], v124 offset:8192
v_mfma_f32_16x16x32_bf16 v[52:55], a[132:135], a[152:155], v[52:55]
ds_read_b64_tr_b16 a[230:231], v124 offset:10240
ds_read_b128 a[244:247], v122 offset:3072
v_mfma_f32_16x16x32_bf16 v[56:59], a[136:139], a[152:155], v[56:59]
ds_read_b64_tr_b16 a[232:233], v125 offset:8192
ds_read_b64_tr_b16 a[234:235], v125 offset:10240
v_mfma_f32_16x16x32_bf16 v[56:59], a[168:171], a[184:187], v[56:59]
v_mfma_f32_16x16x32_bf16 v[60:63], a[172:175], a[184:187], v[60:63]
ds_read_b128 a[248:251], v122 offset:5120
ds_read_b64_tr_b16 a[236:237], v126 offset:8192
v_mfma_f32_16x16x32_bf16 v[60:63], a[140:143], a[152:155], v[60:63]
ds_read_b64_tr_b16 a[238:239], v126 offset:10240
ds_read_b128 a[252:255], v122 offset:7168
v_mfma_f32_16x16x32_bf16 v[76:79], a[140:143], a[156:159], v[76:79]
v_mfma_f32_16x16x32_bf16 v[76:79], a[172:175], a[188:191], v[76:79]
v_mfma_f32_16x16x32_bf16 v[72:75], a[168:171], a[188:191], v[72:75]
v_mfma_f32_16x16x32_bf16 v[72:75], a[136:139], a[156:159], v[72:75]
v_mfma_f32_16x16x32_bf16 v[68:71], a[132:135], a[156:159], v[68:71]
v_mfma_f32_16x16x32_bf16 v[68:71], a[164:167], a[188:191], v[68:71]
v_mfma_f32_16x16x32_bf16 v[64:67], a[160:163], a[188:191], v[64:67]
v_mfma_f32_16x16x32_bf16 v[64:67], a[128:131], a[156:159], v[64:67]
s_waitcnt lgkmcnt(0)
v_mfma_f32_16x16x32_bf16 v[32:35], a[192:195], a[212:215], v[32:35]
v_mfma_f32_16x16x32_bf16 v[32:35], a[224:227], a[244:247], v[32:35]
v_mfma_f32_16x16x32_bf16 v[36:39], a[228:231], a[244:247], v[36:39]
v_mfma_f32_16x16x32_bf16 v[36:39], a[196:199], a[212:215], v[36:39]
v_mfma_f32_16x16x32_bf16 v[40:43], a[200:203], a[212:215], v[40:43]
s_add_u32 s35, s0, 1
v_mfma_f32_16x16x32_bf16 v[40:43], a[232:235], a[244:247], v[40:43]
s_and_b32 s35, s35, 3
v_mfma_f32_16x16x32_bf16 v[44:47], a[236:239], a[244:247], v[44:47]
s_mul_i32 s35, s35, 24576
v_mfma_f32_16x16x32_bf16 v[44:47], a[204:207], a[212:215], v[44:47]
s_add_u32 s35, s35, s14
v_mfma_f32_16x16x32_bf16 v[48:51], a[192:195], a[216:219], v[48:51]
s_add_u32 s19, s35, 0
v_cvt_pk_bf16_f32 v32, v32, v33
v_cvt_pk_bf16_f32 v33, v34, v35
v_cvt_pk_bf16_f32 v34, v36, v37
v_mfma_f32_16x16x32_bf16 v[48:51], a[224:227], a[248:251], v[48:51]
s_add_u32 s35, s0, 2
v_cvt_pk_bf16_f32 v35, v38, v39
v_min_u32 v32, -2, v32
v_min_u32 v33, -2, v33
v_mfma_f32_16x16x32_bf16 v[52:55], a[228:231], a[248:251], v[52:55]
s_and_b32 s35, s35, 3
v_min_u32 v34, -2, v34
v_min_u32 v35, -2, v35
v_mfma_f32_16x16x32_bf16 v[52:55], a[196:199], a[216:219], v[52:55]
s_mul_i32 s35, s35, 24576
buffer_store_dwordx4 v[32:35], v15, s[8:11], s19 offen offset:0 sc1
v_mfma_f32_16x16x32_bf16 v[56:59], a[200:203], a[216:219], v[56:59]
s_add_u32 s35, s35, s14
v_cvt_pk_bf16_f32 v40, v40, v41
v_cvt_pk_bf16_f32 v41, v42, v43
v_cvt_pk_bf16_f32 v42, v44, v45
v_mfma_f32_16x16x32_bf16 v[56:59], a[232:235], a[248:251], v[56:59]
s_add_u32 s20, s35, 8192
v_cvt_pk_bf16_f32 v43, v46, v47
v_min_u32 v40, -2, v40
v_min_u32 v41, -2, v41
v_mfma_f32_16x16x32_bf16 v[60:63], a[236:239], a[248:251], v[60:63]
s_add_u32 s35, s0, 3
v_min_u32 v42, -2, v42
v_min_u32 v43, -2, v43
v_mfma_f32_16x16x32_bf16 v[60:63], a[204:207], a[216:219], v[60:63]
s_and_b32 s35, s35, 3
buffer_store_dwordx4 v[40:43], v15, s[8:11], s19 offen offset:1024 sc1
v_mfma_f32_16x16x32_bf16 v[64:67], a[192:195], a[220:223], v[64:67]
s_mul_i32 s35, s35, 24576
v_cvt_pk_bf16_f32 v48, v48, v49
v_cvt_pk_bf16_f32 v49, v50, v51
v_cvt_pk_bf16_f32 v50, v52, v53
v_mfma_f32_16x16x32_bf16 v[64:67], a[224:227], a[252:255], v[64:67]
s_add_u32 s35, s35, s14
v_cvt_pk_bf16_f32 v51, v54, v55
v_min_u32 v48, -2, v48
v_min_u32 v49, -2, v49
v_mfma_f32_16x16x32_bf16 v[68:71], a[228:231], a[252:255], v[68:71]
s_add_u32 s21, s35, 16384
v_min_u32 v50, -2, v50
v_min_u32 v51, -2, v51
v_mfma_f32_16x16x32_bf16 v[68:71], a[196:199], a[220:223], v[68:71]
buffer_store_dwordx4 v[48:51], v15, s[8:11], s20 offen offset:0 sc1
v_mfma_f32_16x16x32_bf16 v[72:75], a[200:203], a[220:223], v[72:75]
v_cvt_pk_bf16_f32 v56, v56, v57
v_cvt_pk_bf16_f32 v57, v58, v59
v_cvt_pk_bf16_f32 v58, v60, v61
v_mfma_f32_16x16x32_bf16 v[72:75], a[232:235], a[252:255], v[72:75]
v_cvt_pk_bf16_f32 v59, v62, v63
v_min_u32 v56, -2, v56
v_min_u32 v57, -2, v57
v_mfma_f32_16x16x32_bf16 v[76:79], a[236:239], a[252:255], v[76:79]
v_min_u32 v58, -2, v58
v_min_u32 v59, -2, v59
v_mfma_f32_16x16x32_bf16 v[76:79], a[204:207], a[220:223], v[76:79]
buffer_store_dwordx4 v[56:59], v15, s[8:11], s20 offen offset:1024 sc1
v_mfma_f32_16x16x32_bf16 v[16:19], a[0:3], a[16:19], v[16:19]
v_cvt_pk_bf16_f32 v64, v64, v65
v_cvt_pk_bf16_f32 v65, v66, v67
v_cvt_pk_bf16_f32 v66, v68, v69
v_mfma_f32_16x16x32_bf16 v[16:19], a[32:35], a[48:51], v[16:19]
v_cvt_pk_bf16_f32 v67, v70, v71
v_min_u32 v64, -2, v64
v_min_u32 v65, -2, v65
v_mfma_f32_16x16x32_bf16 v[16:19], a[64:67], a[80:83], v[16:19]
v_min_u32 v66, -2, v66
v_min_u32 v67, -2, v67
v_mfma_f32_16x16x32_bf16 v[16:19], a[96:99], a[112:115], v[16:19]
buffer_store_dwordx4 v[64:67], v15, s[8:11], s21 offen offset:0 sc1
v_mfma_f32_16x16x32_bf16 v[16:19], a[128:131], a[144:147], v[16:19]
v_cvt_pk_bf16_f32 v72, v72, v73
v_cvt_pk_bf16_f32 v73, v74, v75
v_cvt_pk_bf16_f32 v74, v76, v77
v_mfma_f32_16x16x32_bf16 v[16:19], a[160:163], a[176:179], v[16:19]
v_cvt_pk_bf16_f32 v75, v78, v79
v_min_u32 v72, -2, v72
v_min_u32 v73, -2, v73
v_mfma_f32_16x16x32_bf16 v[16:19], a[192:195], a[208:211], v[16:19]
v_min_u32 v74, -2, v74
v_min_u32 v75, -2, v75
v_mfma_f32_16x16x32_bf16 v[16:19], a[224:227], a[240:243], v[16:19]
buffer_store_dwordx4 v[72:75], v15, s[8:11], s21 offen offset:1024 sc1
v_mfma_f32_16x16x32_bf16 v[20:23], a[228:231], a[240:243], v[20:23]
s_add_u32 s22, s63, 0
v_mfma_f32_16x16x32_bf16 v[20:23], a[196:199], a[208:211], v[20:23]
buffer_load_dwordx4 v[128:131], v15, s[8:11], s22 offen offset:0 sc1
v_mfma_f32_16x16x32_bf16 v[20:23], a[164:167], a[176:179], v[20:23]
v_mfma_f32_16x16x32_bf16 v[20:23], a[132:135], a[144:147], v[20:23]
buffer_load_dwordx4 v[132:135], v15, s[8:11], s22 offen offset:1024 sc1
v_mfma_f32_16x16x32_bf16 v[20:23], a[100:103], a[112:115], v[20:23]
s_add_u32 s22, s63, 8192
v_mfma_f32_16x16x32_bf16 v[20:23], a[68:71], a[80:83], v[20:23]
buffer_load_dwordx4 v[136:139], v15, s[8:11], s22 offen offset:0 sc1
v_mfma_f32_16x16x32_bf16 v[20:23], a[36:39], a[48:51], v[20:23]
v_mfma_f32_16x16x32_bf16 v[20:23], a[4:7], a[16:19], v[20:23]
buffer_load_dwordx4 v[140:143], v15, s[8:11], s22 offen offset:1024 sc1
v_mfma_f32_16x16x32_bf16 v[24:27], a[8:11], a[16:19], v[24:27]
s_add_u32 s22, s63, 16384
v_mfma_f32_16x16x32_bf16 v[24:27], a[40:43], a[48:51], v[24:27]
buffer_load_dwordx4 v[144:147], v15, s[8:11], s22 offen offset:0 sc1
v_mfma_f32_16x16x32_bf16 v[24:27], a[72:75], a[80:83], v[24:27]
v_mfma_f32_16x16x32_bf16 v[24:27], a[104:107], a[112:115], v[24:27]
buffer_load_dwordx4 v[148:151], v15, s[8:11], s22 offen offset:1024 sc1
v_mfma_f32_16x16x32_bf16 v[24:27], a[136:139], a[144:147], v[24:27]
v_mfma_f32_16x16x32_bf16 v[24:27], a[168:171], a[176:179], v[24:27]
v_mfma_f32_16x16x32_bf16 v[24:27], a[200:203], a[208:211], v[24:27]
v_mfma_f32_16x16x32_bf16 v[24:27], a[232:235], a[240:243], v[24:27]
v_mfma_f32_16x16x32_bf16 v[28:31], a[236:239], a[240:243], v[28:31]
v_mfma_f32_16x16x32_bf16 v[28:31], a[204:207], a[208:211], v[28:31]
v_mfma_f32_16x16x32_bf16 v[28:31], a[172:175], a[176:179], v[28:31]
v_mfma_f32_16x16x32_bf16 v[28:31], a[140:143], a[144:147], v[28:31]
v_mfma_f32_16x16x32_bf16 v[28:31], a[108:111], a[112:115], v[28:31]
v_mfma_f32_16x16x32_bf16 v[28:31], a[76:79], a[80:83], v[28:31]
v_mfma_f32_16x16x32_bf16 v[28:31], a[44:47], a[48:51], v[28:31]
v_mfma_f32_16x16x32_bf16 v[28:31], a[12:15], a[16:19], v[28:31]
s_waitcnt vmcnt(12)
v_lshlrev_b32 v104, 16, v96
v_and_b32 v105, 0xffff0000, v96
v_lshlrev_b32 v106, 16, v97
v_and_b32 v107, 0xffff0000, v97
v_lshlrev_b32 v108, 16, v98
v_and_b32 v109, 0xffff0000, v98
v_lshlrev_b32 v110, 16, v99
v_and_b32 v111, 0xffff0000, v99
v_lshlrev_b32 v112, 16, v100
v_and_b32 v113, 0xffff0000, v100
v_lshlrev_b32 v114, 16, v101
v_and_b32 v115, 0xffff0000, v101
v_lshlrev_b32 v116, 16, v102
v_and_b32 v117, 0xffff0000, v102
v_lshlrev_b32 v118, 16, v103
v_and_b32 v119, 0xffff0000, v103
v_pk_add_f32 v[16:17], v[16:17], v[104:105]
v_pk_add_f32 v[18:19], v[18:19], v[106:107]
v_pk_add_f32 v[20:21], v[20:21], v[108:109]
v_pk_add_f32 v[22:23], v[22:23], v[110:111]
v_pk_add_f32 v[24:25], v[24:25], v[112:113]
v_pk_add_f32 v[26:27], v[26:27], v[114:115]
v_pk_add_f32 v[28:29], v[28:29], v[116:117]
v_pk_add_f32 v[30:31], v[30:31], v[118:119]
s_mov_b32 s44, s24
s_mov_b32 s45, s25
s_mov_b32 s46, 2097152
s_mov_b32 s47, 0x20000
s_mov_b32 s100, 0x80000
s_waitcnt vmcnt(4)
L_in0:
v_max3_u32 v96, v128, v129, v130
v_max3_u32 v97, v131, v132, v133
v_max3_u32 v96, v96, v134, v135
v_max_u32 v96, v96, v97
v_cmp_eq_u32 vcc, -1, v96
s_cbranch_vccnz L_in0_again
L_in0_done:
v_lshlrev_b32 v104, 16, v128
v_and_b32 v105, 0xffff0000, v128
v_lshlrev_b32 v106, 16, v129
v_and_b32 v107, 0xffff0000, v129
v_lshlrev_b32 v108, 16, v130
v_and_b32 v109, 0xffff0000, v130
v_lshlrev_b32 v110, 16, v131
v_and_b32 v111, 0xffff0000, v131
v_lshlrev_b32 v112, 16, v132
v_and_b32 v113, 0xffff0000, v132
v_lshlrev_b32 v114, 16, v133
v_and_b32 v115, 0xffff0000, v133
v_lshlrev_b32 v116, 16, v134
v_and_b32 v117, 0xffff0000, v134
v_lshlrev_b32 v118, 16, v135
v_and_b32 v119, 0xffff0000, v135
v_pk_add_f32 v[16:17], v[16:17], v[104:105]
v_pk_add_f32 v[18:19], v[18:19], v[106:107]
v_pk_add_f32 v[20:21], v[20:21], v[108:109]
v_pk_add_f32 v[22:23], v[22:23], v[110:111]
v_pk_add_f32 v[24:25], v[24:25], v[112:113]
v_pk_add_f32 v[26:27], v[26:27], v[114:115]
v_pk_add_f32 v[28:29], v[28:29], v[116:117]
v_pk_add_f32 v[30:31], v[30:31], v[118:119]
s_waitcnt vmcnt(2)
L_in1:
v_max3_u32 v96, v136, v137, v138
v_max3_u32 v97, v139, v140, v141
v_max3_u32 v96, v96, v142, v143
v_max_u32 v96, v96, v97
v_cmp_eq_u32 vcc, -1, v96
s_cbranch_vccnz L_in1_again
L_in1_done:
v_lshlrev_b32 v104, 16, v136
v_and_b32 v105, 0xffff0000, v136
v_lshlrev_b32 v106, 16, v137
v_and_b32 v107, 0xffff0000, v137
v_lshlrev_b32 v108, 16, v138
v_and_b32 v109, 0xffff0000, v138
v_lshlrev_b32 v110, 16, v139
v_and_b32 v111, 0xffff0000, v139
v_lshlrev_b32 v112, 16, v140
v_and_b32 v113, 0xffff0000, v140
v_lshlrev_b32 v114, 16, v141
v_and_b32 v115, 0xffff0000, v141
v_lshlrev_b32 v116, 16, v142
v_and_b32 v117, 0xffff0000, v142
v_lshlrev_b32 v118, 16, v143
v_and_b32 v119, 0xffff0000, v143
v_pk_add_f32 v[16:17], v[16:17], v[104:105]
v_pk_add_f32 v[18:19], v[18:19], v[106:107]
v_pk_add_f32 v[20:21], v[20:21], v[108:109]
v_pk_add_f32 v[22:23], v[22:23], v[110:111]
v_pk_add_f32 v[24:25], v[24:25], v[112:113]
v_pk_add_f32 v[26:27], v[26:27], v[114:115]
v_pk_add_f32 v[28:29], v[28:29], v[116:117]
v_pk_add_f32 v[30:31], v[30:31], v[118:119]
s_waitcnt vmcnt(0)
L_in2:
v_max3_u32 v96, v144, v145, v146
v_max3_u32 v97, v147, v148, v149
v_max3_u32 v96, v96, v150, v151
v_max_u32 v96, v96, v97
v_cmp_eq_u32 vcc, -1, v96
s_cbranch_vccnz L_in2_again
L_in2_done:
v_lshlrev_b32 v104, 16, v144
v_and_b32 v105, 0xffff0000, v144
v_lshlrev_b32 v106, 16, v145
v_and_b32 v107, 0xffff0000, v145
v_lshlrev_b32 v108, 16, v146
v_and_b32 v109, 0xffff0000, v146
v_lshlrev_b32 v110, 16, v147
v_and_b32 v111, 0xffff0000, v147
v_lshlrev_b32 v112, 16, v148
v_and_b32 v113, 0xffff0000, v148
v_lshlrev_b32 v114, 16, v149
v_and_b32 v115, 0xffff0000, v149
v_lshlrev_b32 v116, 16, v150
v_and_b32 v117, 0xffff0000, v150
v_lshlrev_b32 v118, 16, v151
v_and_b32 v119, 0xffff0000, v151
v_pk_add_f32 v[16:17], v[16:17], v[104:105]
v_pk_add_f32 v[18:19], v[18:19], v[106:107]
v_pk_add_f32 v[20:21], v[20:21], v[108:109]
v_pk_add_f32 v[22:23], v[22:23], v[110:111]
v_pk_add_f32 v[24:25], v[24:25], v[112:113]
v_pk_add_f32 v[26:27], v[26:27], v[114:115]
v_pk_add_f32 v[28:29], v[28:29], v[116:117]
v_pk_add_f32 v[30:31], v[30:31], v[118:119]
v_cvt_pk_bf16_f32 v96, v16, v17
v_cvt_pk_bf16_f32 v97, v18, v19
v_cvt_pk_bf16_f32 v98, v20, v21
v_cvt_pk_bf16_f32 v99, v22, v23
v_cvt_pk_bf16_f32 v100, v24, v25
v_cvt_pk_bf16_f32 v101, v26, v27
v_cvt_pk_bf16_f32 v102, v28, v29
v_cvt_pk_bf16_f32 v103, v30, v31
v_bfe_u32 v104, v15, 8, 1
v_mad_u32_u24 v104, v104, 24, v12
v_permlane16_swap_b32 v96, v98
v_permlane16_swap_b32 v97, v99
v_permlane16_swap_b32 v100, v102
v_permlane16_swap_b32 v101, v103
buffer_store_dwordx4 v[96:99], v104, s[44:47], 0 offen offset:0
buffer_store_dwordx4 v[100:103], v104, s[44:47], 0 offen offset:64
s_or_b32 s35, s2, s30
s_cbranch_scc1 L_tag
v_mov_b32 v7, s3
v_mov_b32 v8, 0
s_mov_b64 exec, 1
global_store_dword v8, v7, s[16:17] sc1
s_mov_b64 exec, -1
L_tag:
s_endpgm
L_in0_again:
s_sub_u32 s100, s100, 1
s_cbranch_scc1 L_in0_out
s_add_u32 s22, s63, 0
buffer_load_dwordx4 v[128:131], v15, s[8:11], s22 offen offset:0 sc1
buffer_load_dwordx4 v[132:135], v15, s[8:11], s22 offen offset:1024 sc1
s_add_u32 s22, s63, 8192
buffer_load_dwordx4 v[136:139], v15, s[8:11], s22 offen offset:0 sc1
buffer_load_dwordx4 v[140:143], v15, s[8:11], s22 offen offset:1024 sc1
s_add_u32 s22, s63, 16384
buffer_load_dwordx4 v[144:147], v15, s[8:11], s22 offen offset:0 sc1
buffer_load_dwordx4 v[148:151], v15, s[8:11], s22 offen offset:1024 sc1
s_waitcnt vmcnt(4)
s_branch L_in0
L_in0_out:
s_mov_b32 s100, 0
s_branch L_in0_done
L_in1_again:
s_sub_u32 s100, s100, 1
s_cbranch_scc1 L_in1_out
s_add_u32 s22, s63, 8192
buffer_load_dwordx4 v[136:139], v15, s[8:11], s22 offen offset:0 sc1
buffer_load_dwordx4 v[140:143], v15, s[8:11], s22 offen offset:1024 sc1
s_add_u32 s22, s63, 16384
buffer_load_dwordx4 v[144:147], v15, s[8:11], s22 offen offset:0 sc1
buffer_load_dwordx4 v[148:151], v15, s[8:11], s22 offen offset:1024 sc1
s_waitcnt vmcnt(2)
s_branch L_in1
L_in1_out:
s_mov_b32 s100, 0
s_branch L_in1_done
L_in2_again:
s_sub_u32 s100, s100, 1
s_cbranch_scc1 L_in2_out
s_add_u32 s22, s63, 16384
buffer_load_dwordx4 v[144:147], v15, s[8:11], s22 offen offset:0 sc1
buffer_load_dwordx4 v[148:151], v15, s[8:11], s22 offen offset:1024 sc1
s_waitcnt vmcnt(0)
s_branch L_in2
L_in2_out:
s_mov_b32 s100, 0
s_branch L_in2_done
L_xn_spin:
s_mov_b32 s100, 0x80000
L_xn_again:
global_load_dword v7, v8, s[16:17] sc1
s_sub_u32 s100, s100, 1
s_cbranch_scc1 L_xn_out
s_waitcnt vmcnt(0)
v_cmp_ne_u32 vcc, s3, v7
s_cbranch_vccnz L_xn_again
L_xn_out:
s_waitcnt vmcnt(0)
s_branch L_xn
L_kv0_spin:
s_mov_b32 s100, 0x80000
L_kv0_again:
global_load_dword v7, v8, s[16:17] sc1
s_sub_u32 s100, s100, 1
s_cbranch_scc1 L_kv0_out
s_waitcnt vmcnt(0)
v_cmp_ne_u32 vcc, s3, v7
s_cbranch_vccnz L_kv0_again
L_kv0_out:
s_waitcnt vmcnt(0)
s_branch L_kv0
L_kv1_spin:
s_mov_b32 s100, 0x80000
L_kv1_again:
global_load_dword v7, v8, s[16:17] sc1
s_sub_u32 s100, s100, 1
s_cbranch_scc1 L_kv1_out
s_waitcnt vmcnt(0)
v_cmp_ne_u32 vcc, s3, v7
s_cbranch_vccnz L_kv1_again
L_kv1_out:
s_waitcnt vmcnt(0)
s_branch L_kv1
L_sh0_do:
s_mov_b64 exec, 1
global_store_dword v8, v7, s[16:17] sc1
s_mov_b64 exec, -1
s_branch L_sh0
L_sh1_do:
s_mov_b64 exec, 1
global_store_dword v8, v7, s[16:17] sc1
s_mov_b64 exec, -1
s_branch L_sh1
L_sh2_do:
s_mov_b64 exec, 1
global_store_dword v8, v7, s[16:17] sc1
s_mov_b64 exec, -1
s_branch L_sh2
L_h_spin:
s_mov_b32 s100, 0x80000
L_h_again:
global_load_dword v7, v8, s[16:17] sc1
s_sub_u32 s100, s100, 1
s_cbranch_scc1 L_h_out
s_waitcnt vmcnt(0)
v_cmp_ne_u32 vcc, s3, v7
s_cbranch_vccnz L_h_again
L_h_out:
s_waitcnt vmcnt(0)
s_branch L_h
L_ctx_spin:
s_mov_b32 s100, 0x80000
L_ctx_again:
global_load_dword v7, v8, s[16:17] sc1
s_sub_u32 s100, s100, 1
s_cbranch_scc1 L_ctx_out
s_waitcnt vmcnt(0)
v_cmp_ne_u32 vcc, s3, v7
s_cbranch_vccnz L_ctx_again
L_ctx_out:
s_waitcnt vmcnt(0)
s_branch L_ctx
L_ctx2_spin:
s_mov_b32 s100, 0x80000
L_ctx2_again:
global_load_dword v7, v8, s[16:17] sc1
s_sub_u32 s100, s100, 1
s_cbranch_scc1 L_ctx2_out
s_waitcnt vmcnt(0)
v_cmp_ne_u32 vcc, s3, v7
s_cbranch_vccnz L_ctx2_again
L_ctx2_out:
s_waitcnt vmcnt(0)
s_branch L_ctx2
L_mark_spin:
s_mov_b32 s100, 0x80000
L_mark_again:
global_load_dword v7, v8, s[16:17] sc1
s_sub_u32 s100, s100, 1
s_cbranch_scc1 L_mark_out
s_waitcnt vmcnt(0)
v_cmp_ne_u32 vcc, s3, v7
s_cbranch_vccnz L_mark_again
L_mark_out:
s_waitcnt vmcnt(0)
s_branch L_mark
L_slow0:
s_lshl_b32 s99, s32, 3
s_add_u32 s99, s99, s30
s_lshl_b32 s98, s99, 4
v_bfe_u32 v106, v15, 4, 4
v_lshrrev_b32 v107, 8, v15
v_lshlrev_b32 v107, 2, v107
v_sub_u32 v106, v106, v107
v_add_u32 v106, s98, v106
s_lshr_b32 s99, s99, 1
s_add_u32 s99, s99, 1
s_lshl_b32 s99, s99, 14
s_mov_b32 s98, 0
v_mov_b32 v104, v3
v_mov_b64 v[128:129], 0
v_mov_b64 v[130:131], 0
v_mov_b64 v[132:133], 0
v_mov_b64 v[134:135], 0
v_mov_b64 v[136:137], 0
v_mov_b64 v[138:139], 0
v_mov_b64 v[140:141], 0
v_mov_b64 v[142:143], 0
v_mov_b64 v[144:145], 0
v_mov_b64 v[146:147], 0
v_mov_b64 v[148:149], 0
v_mov_b64 v[150:151], 0
v_mov_b64 v[152:153], 0
v_mov_b64 v[154:155], 0
v_mov_b64 v[156:157], 0
v_mov_b64 v[158:159], 0
v_mov_b64 v[72:73], 0
v_mov_b64 v[74:75], 0
L_slow0_loop:
s_add_u32 s101, s98, 0
buffer_load_dwordx4 a[192:195], v15, s[44:47], s101 offen offset:0 sc1
buffer_load_dwordx4 a[196:199], v15, s[44:47], s101 offen offset:1024 sc1
buffer_load_dwordx4 a[200:203], v15, s[44:47], s101 offen offset:2048 sc1
buffer_load_dwordx4 a[204:207], v15, s[44:47], s101 offen offset:3072 sc1
s_add_u32 s101, s98, 4096
buffer_load_dwordx4 a[208:211], v15, s[44:47], s101 offen offset:0 sc1
buffer_load_dwordx4 a[212:215], v15, s[44:47], s101 offen offset:1024 sc1
buffer_load_dwordx4 a[216:219], v15, s[44:47], s101 offen offset:2048 sc1
buffer_load_dwordx4 a[220:223], v15, s[44:47], s101 offen offset:3072 sc1
s_add_u32 s101, s98, 8192
buffer_load_dwordx4 a[224:227], v15, s[44:47], s101 offen offset:0 sc1
buffer_load_dwordx4 a[228:231], v15, s[44:47], s101 offen offset:1024 sc1
buffer_load_dwordx4 a[232:235], v15, s[44:47], s101 offen offset:2048 sc1
buffer_load_dwordx4 a[236:239], v15, s[44:47], s101 offen offset:3072 sc1
s_add_u32 s101, s98, 12288
buffer_load_dwordx4 a[240:243], v15, s[44:47], s101 offen offset:0 sc1
buffer_load_dwordx4 a[244:247], v15, s[44:47], s101 offen offset:1024 sc1
buffer_load_dwordx4 a[248:251], v15, s[44:47], s101 offen offset:2048 sc1
buffer_load_dwordx4 a[252:255], v15, s[44:47], s101 offen offset:3072 sc1
s_waitcnt vmcnt(0)
v_mfma_f32_16x16x32_bf16 v[96:99], a[192:195], a[128:131], 0
v_mfma_f32_16x16x32_bf16 v[100:103], a[208:211], a[128:131], 0
v_mfma_f32_16x16x32_bf16 v[96:99], a[196:199], a[132:135], v[96:99]
v_mfma_f32_16x16x32_bf16 v[100:103], a[212:215], a[132:135], v[100:103]
v_mfma_f32_16x16x32_bf16 v[96:99], a[200:203], a[136:139], v[96:99]
v_mfma_f32_16x16x32_bf16 v[100:103], a[216:219], a[136:139], v[100:103]
v_mfma_f32_16x16x32_bf16 v[96:99], a[204:207], a[140:143], v[96:99]
v_mfma_f32_16x16x32_bf16 v[100:103], a[220:223], a[140:143], v[100:103]
s_nop 7
v_cmp_le_i32 vcc, 0, v106
s_nop 1
v_cndmask_b32 v96, v3, v96, vcc
v_cmp_le_i32 vcc, 1, v106
s_nop 1
v_cndmask_b32 v97, v3, v97, vcc
v_cmp_le_i32 vcc, 2, v106
s_nop 1
v_cndmask_b32 v98, v3, v98, vcc
v_cmp_le_i32 vcc, 3, v106
s_nop 1
v_cndmask_b32 v99, v3, v99, vcc
v_cmp_le_i32 vcc, 16, v106
s_nop 1
v_cndmask_b32 v100, v3, v100, vcc
v_cmp_le_i32 vcc, 17, v106
s_nop 1
v_cndmask_b32 v101, v3, v101, vcc
v_cmp_le_i32 vcc, 18, v106
s_nop 1
v_cndmask_b32 v102, v3, v102, vcc
v_cmp_le_i32 vcc, 19, v106
s_nop 1
v_cndmask_b32 v103, v3, v103, vcc
v_max3_f32 v107, v104, v96, v97
v_max3_f32 v107, v107, v98, v99
v_max3_f32 v107, v107, v100, v101
v_max3_f32 v107, v107, v102, v103
v_mov_b32 v105, v107
s_nop 1
v_permlane32_swap_b32 v107, v105
v_max_f32 v107, v107, v105
v_mov_b32 v105, v107
s_nop 1
v_permlane16_swap_b32 v107, v105
v_max_f32 v107, v107, v105
v_sub_f32 v105, v104, v107
v_mov_b32 v104, v107
v_exp_f32 v105, v105
v_sub_f32 v96, v96, v104
v_sub_f32 v97, v97, v104
v_sub_f32 v98, v98, v104
v_sub_f32 v99, v99, v104
v_sub_f32 v100, v100, v104
v_sub_f32 v101, v101, v104
v_sub_f32 v102, v102, v104
v_sub_f32 v103, v103, v104
v_exp_f32 v96, v96
v_exp_f32 v97, v97
v_exp_f32 v98, v98
v_exp_f32 v99, v99
v_exp_f32 v100, v100
v_exp_f32 v101, v101
v_exp_f32 v102, v102
v_exp_f32 v103, v103
v_mul_f32 v128, v128, v105
v_mul_f32 v129, v129, v105
v_mul_f32 v130, v130, v105
v_mul_f32 v131, v131, v105
v_mul_f32 v132, v132, v105
v_mul_f32 v133, v133, v105
v_mul_f32 v134, v134, v105
v_mul_f32 v135, v135, v105
v_mul_f32 v136, v136, v105
v_mul_f32 v137, v137, v105
v_mul_f32 v138, v138, v105
v_mul_f32 v139, v139, v105
v_mul_f32 v140, v140, v105
v_mul_f32 v141, v141, v105
v_mul_f32 v142, v142, v105
v_mul_f32 v143, v143, v105
v_mul_f32 v144, v144, v105
v_mul_f32 v145, v145, v105
v_mul_f32 v146, v146, v105
v_mul_f32 v147, v147, v105
v_mul_f32 v148, v148, v105
v_mul_f32 v149, v149, v105
v_mul_f32 v150, v150, v105
v_mul_f32 v151, v151, v105
v_mul_f32 v152, v152, v105
v_mul_f32 v153, v153, v105
v_mul_f32 v154, v154, v105
v_mul_f32 v155, v155, v105
v_mul_f32 v156, v156, v105
v_mul_f32 v157, v157, v105
v_mul_f32 v158, v158, v105
v_mul_f32 v159, v159, v105
v_mul_f32 v72, v72, v105
v_mul_f32 v73, v73, v105
v_mul_f32 v74, v74, v105
v_mul_f32 v75, v75, v105
v_cvt_pk_bf16_f32 v96, v96, v97
v_cvt_pk_bf16_f32 v97, v98, v99
v_cvt_pk_bf16_f32 v98, v100, v101
v_cvt_pk_bf16_f32 v99, v102, v103
v_subrev_u32 v106, 32, v106
s_nop 1
v_mfma_f32_16x16x32_bf16 v[72:75], v[88:91], v[96:99], v[72:75]
v_mfma_f32_16x16x32_bf16 v[128:131], a[224:227], v[96:99], v[128:131]
v_mfma_f32_16x16x32_bf16 v[132:135], a[228:231], v[96:99], v[132:135]
v_mfma_f32_16x16x32_bf16 v[136:139], a[232:235], v[96:99], v[136:139]
v_mfma_f32_16x16x32_bf16 v[140:143], a[236:239], v[96:99], v[140:143]
v_mfma_f32_16x16x32_bf16 v[144:147], a[240:243], v[96:99], v[144:147]
v_mfma_f32_16x16x32_bf16 v[148:151], a[244:247], v[96:99], v[148:151]
v_mfma_f32_16x16x32_bf16 v[152:155], a[248:251], v[96:99], v[152:155]
v_mfma_f32_16x16x32_bf16 v[156:159], a[252:255], v[96:99], v[156:159]
s_nop 7
s_add_u32 s98, s98, 16384
s_cmp_lt_u32 s98, s99
s_cbranch_scc1 L_slow0_loop
v_rcp_f32 v96, v72
s_lshl_b32 s99, s31, 12
s_add_u32 s99, s99, 57344
s_lshl_b32 s98, s32, 3
s_add_u32 s98, s98, s30
v_mov_b32 v97, v96
s_mul_i32 s98, s98, 188416
s_add_u32 s98, s98, s99
v_pk_mul_f32 v[128:129], v[128:129], v[96:97]
v_pk_mul_f32 v[130:131], v[130:131], v[96:97]
v_pk_mul_f32 v[132:133], v[132:133], v[96:97]
v_pk_mul_f32 v[134:135], v[134:135], v[96:97]
v_cvt_pk_bf16_f32 v128, v128, v129
v_cvt_pk_bf16_f32 v129, v130, v131
v_cvt_pk_bf16_f32 v130, v132, v133
v_cvt_pk_bf16_f32 v131, v134, v135
buffer_store_dwordx4 v[128:131], v15, s[48:51], s98 offen offset:0 sc1
v_pk_mul_f32 v[136:137], v[136:137], v[96:97]
v_pk_mul_f32 v[138:139], v[138:139], v[96:97]
v_pk_mul_f32 v[140:141], v[140:141], v[96:97]
v_pk_mul_f32 v[142:143], v[142:143], v[96:97]
v_cvt_pk_bf16_f32 v136, v136, v137
v_cvt_pk_bf16_f32 v137, v138, v139
v_cvt_pk_bf16_f32 v138, v140, v141
v_cvt_pk_bf16_f32 v139, v142, v143
buffer_store_dwordx4 v[136:139], v15, s[48:51], s98 offen offset:1024 sc1
v_pk_mul_f32 v[144:145], v[144:145], v[96:97]
v_pk_mul_f32 v[146:147], v[146:147], v[96:97]
v_pk_mul_f32 v[148:149], v[148:149], v[96:97]
v_pk_mul_f32 v[150:151], v[150:151], v[96:97]
v_cvt_pk_bf16_f32 v144, v144, v145
v_cvt_pk_bf16_f32 v145, v146, v147
v_cvt_pk_bf16_f32 v146, v148, v149
v_cvt_pk_bf16_f32 v147, v150, v151
buffer_store_dwordx4 v[144:147], v15, s[48:51], s98 offen offset:2048 sc1
v_pk_mul_f32 v[152:153], v[152:153], v[96:97]
v_pk_mul_f32 v[154:155], v[154:155], v[96:97]
v_pk_mul_f32 v[156:157], v[156:157], v[96:97]
v_pk_mul_f32 v[158:159], v[158:159], v[96:97]
v_cvt_pk_bf16_f32 v152, v152, v153
v_cvt_pk_bf16_f32 v153, v154, v155
v_cvt_pk_bf16_f32 v154, v156, v157
v_cvt_pk_bf16_f32 v155, v158, v159
buffer_store_dwordx4 v[152:155], v15, s[48:51], s98 offen offset:3072 sc1
s_waitcnt vmcnt(0)
s_branch L_slow0_done
L_slow1:
s_lshl_b32 s99, s32, 3
s_add_u32 s99, s99, s30
s_add_u32 s99, s99, 4
s_lshl_b32 s98, s99, 4
v_bfe_u32 v106, v15, 4, 4
v_lshrrev_b32 v107, 8, v15
v_lshlrev_b32 v107, 2, v107
v_sub_u32 v106, v106, v107
v_add_u32 v106, s98, v106
s_lshr_b32 s99, s99, 1
s_add_u32 s99, s99, 1
s_lshl_b32 s99, s99, 14
s_mov_b32 s98, 0
v_mov_b32 v104, v3
v_mov_b64 v[160:161], 0
v_mov_b64 v[162:163], 0
v_mov_b64 v[164:165], 0
v_mov_b64 v[166:167], 0
v_mov_b64 v[168:169], 0
v_mov_b64 v[170:171], 0
v_mov_b64 v[172:173], 0
v_mov_b64 v[174:175], 0
v_mov_b64 v[176:177], 0
v_mov_b64 v[178:179], 0
v_mov_b64 v[180:181], 0
v_mov_b64 v[182:183], 0
v_mov_b64 v[184:185], 0
v_mov_b64 v[186:187], 0
v_mov_b64 v[188:189], 0
v_mov_b64 v[190:191], 0
v_mov_b64 v[76:77], 0
v_mov_b64 v[78:79], 0
L_slow1_loop:
s_add_u32 s101, s98, 0
buffer_load_dwordx4 a[192:195], v15, s[44:47], s101 offen offset:0 sc1
buffer_load_dwordx4 a[196:199], v15, s[44:47], s101 offen offset:1024 sc1
buffer_load_dwordx4 a[200:203], v15, s[44:47], s101 offen offset:2048 sc1
buffer_load_dwordx4 a[204:207], v15, s[44:47], s101 offen offset:3072 sc1
s_add_u32 s101, s98, 4096
buffer_load_dwordx4 a[208:211], v15, s[44:47], s101 offen offset:0 sc1
buffer_load_dwordx4 a[212:215], v15, s[44:47], s101 offen offset:1024 sc1
buffer_load_dwordx4 a[216:219], v15, s[44:47], s101 offen offset:2048 sc1
buffer_load_dwordx4 a[220:223], v15, s[44:47], s101 offen offset:3072 sc1
s_add_u32 s101, s98, 8192
buffer_load_dwordx4 a[224:227], v15, s[44:47], s101 offen offset:0 sc1
buffer_load_dwordx4 a[228:231], v15, s[44:47], s101 offen offset:1024 sc1
buffer_load_dwordx4 a[232:235], v15, s[44:47], s101 offen offset:2048 sc1
buffer_load_dwordx4 a[236:239], v15, s[44:47], s101 offen offset:3072 sc1
s_add_u32 s101, s98, 12288
buffer_load_dwordx4 a[240:243], v15, s[44:47], s101 offen offset:0 sc1
buffer_load_dwordx4 a[244:247], v15, s[44:47], s101 offen offset:1024 sc1
buffer_load_dwordx4 a[248:251], v15, s[44:47], s101 offen offset:2048 sc1
buffer_load_dwordx4 a[252:255], v15, s[44:47], s101 offen offset:3072 sc1
s_waitcnt vmcnt(0)
v_mfma_f32_16x16x32_bf16 v[96:99], a[192:195], a[144:147], 0
v_mfma_f32_16x16x32_bf16 v[100:103], a[208:211], a[144:147], 0
v_mfma_f32_16x16x32_bf16 v[96:99], a[196:199], a[148:151], v[96:99]
v_mfma_f32_16x16x32_bf16 v[100:103], a[212:215], a[148:151], v[100:103]
v_mfma_f32_16x16x32_bf16 v[96:99], a[200:203], a[152:155], v[96:99]
v_mfma_f32_16x16x32_bf16 v[100:103], a[216:219], a[152:155], v[100:103]
v_mfma_f32_16x16x32_bf16 v[96:99], a[204:207], a[156:159], v[96:99]
v_mfma_f32_16x16x32_bf16 v[100:103], a[220:223], a[156:159], v[100:103]
s_nop 7
v_cmp_le_i32 vcc, 0, v106
s_nop 1
v_cndmask_b32 v96, v3, v96, vcc
v_cmp_le_i32 vcc, 1, v106
s_nop 1
v_cndmask_b32 v97, v3, v97, vcc
v_cmp_le_i32 vcc, 2, v106
s_nop 1
v_cndmask_b32 v98, v3, v98, vcc
v_cmp_le_i32 vcc, 3, v106
s_nop 1
v_cndmask_b32 v99, v3, v99, vcc
v_cmp_le_i32 vcc, 16, v106
s_nop 1
v_cndmask_b32 v100, v3, v100, vcc
v_cmp_le_i32 vcc, 17, v106
s_nop 1
v_cndmask_b32 v101, v3, v101, vcc
v_cmp_le_i32 vcc, 18, v106
s_nop 1
v_cndmask_b32 v102, v3, v102, vcc
v_cmp_le_i32 vcc, 19, v106
s_nop 1
v_cndmask_b32 v103, v3, v103, vcc
v_max3_f32 v107, v104, v96, v97
v_max3_f32 v107, v107, v98, v99
v_max3_f32 v107, v107, v100, v101
v_max3_f32 v107, v107, v102, v103
v_mov_b32 v105, v107
s_nop 1
v_permlane32_swap_b32 v107, v105
v_max_f32 v107, v107, v105
v_mov_b32 v105, v107
s_nop 1
v_permlane16_swap_b32 v107, v105
v_max_f32 v107, v107, v105
v_sub_f32 v105, v104, v107
v_mov_b32 v104, v107
v_exp_f32 v105, v105
v_sub_f32 v96, v96, v104
v_sub_f32 v97, v97, v104
v_sub_f32 v98, v98, v104
v_sub_f32 v99, v99, v104
v_sub_f32 v100, v100, v104
v_sub_f32 v101, v101, v104
v_sub_f32 v102, v102, v104
v_sub_f32 v103, v103, v104
v_exp_f32 v96, v96
v_exp_f32 v97, v97
v_exp_f32 v98, v98
v_exp_f32 v99, v99
v_exp_f32 v100, v100
v_exp_f32 v101, v101
v_exp_f32 v102, v102
v_exp_f32 v103, v103
v_mul_f32 v160, v160, v105
v_mul_f32 v161, v161, v105
v_mul_f32 v162, v162, v105
v_mul_f32 v163, v163, v105
v_mul_f32 v164, v164, v105
v_mul_f32 v165, v165, v105
v_mul_f32 v166, v166, v105
v_mul_f32 v167, v167, v105
v_mul_f32 v168, v168, v105
v_mul_f32 v169, v169, v105
v_mul_f32 v170, v170, v105
v_mul_f32 v171, v171, v105
v_mul_f32 v172, v172, v105
v_mul_f32 v173, v173, v105
v_mul_f32 v174, v174, v105
v_mul_f32 v175, v175, v105
v_mul_f32 v176, v176, v105
v_mul_f32 v177, v177, v105
v_mul_f32 v178, v178, v105
v_mul_f32 v179, v179, v105
v_mul_f32 v180, v180, v105
v_mul_f32 v181, v181, v105
v_mul_f32 v182, v182, v105
v_mul_f32 v183, v183, v105
v_mul_f32 v184, v184, v105
v_mul_f32 v185, v185, v105
v_mul_f32 v186, v186, v105
v_mul_f32 v187, v187, v105
v_mul_f32 v188, v188, v105
v_mul_f32 v189, v189, v105
v_mul_f32 v190, v190, v105
v_mul_f32 v191, v191, v105
v_mul_f32 v76, v76, v105
v_mul_f32 v77, v77, v105
v_mul_f32 v78, v78, v105
v_mul_f32 v79, v79, v105
v_cvt_pk_bf16_f32 v96, v96, v97
v_cvt_pk_bf16_f32 v97, v98, v99
v_cvt_pk_bf16_f32 v98, v100, v101
v_cvt_pk_bf16_f32 v99, v102, v103
v_subrev_u32 v106, 32, v106
s_nop 1
v_mfma_f32_16x16x32_bf16 v[76:79], v[88:91], v[96:99], v[76:79]
v_mfma_f32_16x16x32_bf16 v[160:163], a[224:227], v[96:99], v[160:163]
v_mfma_f32_16x16x32_bf16 v[164:167], a[228:231], v[96:99], v[164:167]
v_mfma_f32_16x16x32_bf16 v[168:171], a[232:235], v[96:99], v[168:171]
v_mfma_f32_16x16x32_bf16 v[172:175], a[236:239], v[96:99], v[172:175]
v_mfma_f32_16x16x32_bf16 v[176:179], a[240:243], v[96:99], v[176:179]
v_mfma_f32_16x16x32_bf16 v[180:183], a[244:247], v[96:99], v[180:183]
v_mfma_f32_16x16x32_bf16 v[184:187], a[248:251], v[96:99], v[184:187]
v_mfma_f32_16x16x32_bf16 v[188:191], a[252:255], v[96:99], v[188:191]
s_nop 7
s_add_u32 s98, s98, 16384
s_cmp_lt_u32 s98, s99
s_cbranch_scc1 L_slow1_loop
v_rcp_f32 v98, v76
s_lshl_b32 s99, s31, 12
s_add_u32 s99, s99, 57344
s_lshl_b32 s98, s32, 3
s_add_u32 s98, s98, s30
s_add_u32 s98, s98, 4
v_mov_b32 v99, v98
s_mul_i32 s98, s98, 188416
s_add_u32 s98, s98, s99
v_pk_mul_f32 v[160:161], v[160:161], v[98:99]
v_pk_mul_f32 v[162:163], v[162:163], v[98:99]
v_pk_mul_f32 v[164:165], v[164:165], v[98:99]
v_pk_mul_f32 v[166:167], v[166:167], v[98:99]
v_cvt_pk_bf16_f32 v160, v160, v161
v_cvt_pk_bf16_f32 v161, v162, v163
v_cvt_pk_bf16_f32 v162, v164, v165
v_cvt_pk_bf16_f32 v163, v166, v167
buffer_store_dwordx4 v[160:163], v15, s[48:51], s98 offen offset:0 sc1
v_pk_mul_f32 v[168:169], v[168:169], v[98:99]
v_pk_mul_f32 v[170:171], v[170:171], v[98:99]
v_pk_mul_f32 v[172:173], v[172:173], v[98:99]
v_pk_mul_f32 v[174:175], v[174:175], v[98:99]
v_cvt_pk_bf16_f32 v168, v168, v169
v_cvt_pk_bf16_f32 v169, v170, v171
v_cvt_pk_bf16_f32 v170, v172, v173
v_cvt_pk_bf16_f32 v171, v174, v175
buffer_store_dwordx4 v[168:171], v15, s[48:51], s98 offen offset:1024 sc1
v_pk_mul_f32 v[176:177], v[176:177], v[98:99]
v_pk_mul_f32 v[178:179], v[178:179], v[98:99]
v_pk_mul_f32 v[180:181], v[180:181], v[98:99]
v_pk_mul_f32 v[182:183], v[182:183], v[98:99]
v_cvt_pk_bf16_f32 v176, v176, v177
v_cvt_pk_bf16_f32 v177, v178, v179
v_cvt_pk_bf16_f32 v178, v180, v181
v_cvt_pk_bf16_f32 v179, v182, v183
buffer_store_dwordx4 v[176:179], v15, s[48:51], s98 offen offset:2048 sc1
v_pk_mul_f32 v[184:185], v[184:185], v[98:99]
v_pk_mul_f32 v[186:187], v[186:187], v[98:99]
v_pk_mul_f32 v[188:189], v[188:189], v[98:99]
v_pk_mul_f32 v[190:191], v[190:191], v[98:99]
v_cvt_pk_bf16_f32 v184, v184, v185
v_cvt_pk_bf16_f32 v185, v186, v187
v_cvt_pk_bf16_f32 v186, v188, v189
v_cvt_pk_bf16_f32 v187, v190, v191
buffer_store_dwordx4 v[184:187], v15, s[48:51], s98 offen offset:3072 sc1
s_waitcnt vmcnt(0)
s_branch L_slow1_done
L_slow2:
s_sub_u32 s99, 15, s32
s_lshl_b32 s99, s99, 3
s_add_u32 s99, s99, s30
s_lshl_b32 s98, s99, 4
v_bfe_u32 v106, v15, 4, 4
v_lshrrev_b32 v107, 8, v15
v_lshlrev_b32 v107, 2, v107
v_sub_u32 v106, v106, v107
v_add_u32 v106, s98, v106
s_lshr_b32 s99, s99, 1
s_add_u32 s99, s99, 1
s_lshl_b32 s99, s99, 14
s_mov_b32 s98, 0
v_mov_b32 v104, v3
v_mov_b64 v[192:193], 0
v_mov_b64 v[194:195], 0
v_mov_b64 v[196:197], 0
v_mov_b64 v[198:199], 0
v_mov_b64 v[200:201], 0
v_mov_b64 v[202:203], 0
v_mov_b64 v[204:205], 0
v_mov_b64 v[206:207], 0
v_mov_b64 v[208:209], 0
v_mov_b64 v[210:211], 0
v_mov_b64 v[212:213], 0
v_mov_b64 v[214:215], 0
v_mov_b64 v[216:217], 0
v_mov_b64 v[218:219], 0
v_mov_b64 v[220:221], 0
v_mov_b64 v[222:223], 0
v_mov_b64 v[80:81], 0
v_mov_b64 v[82:83], 0
L_slow2_loop:
s_add_u32 s101, s98, 0
buffer_load_dwordx4 a[192:195], v15, s[44:47], s101 offen offset:0 sc1
buffer_load_dwordx4 a[196:199], v15, s[44:47], s101 offen offset:1024 sc1
buffer_load_dwordx4 a[200:203], v15, s[44:47], s101 offen offset:2048 sc1
buffer_load_dwordx4 a[204:207], v15, s[44:47], s101 offen offset:3072 sc1
s_add_u32 s101, s98, 4096
buffer_load_dwordx4 a[208:211], v15, s[44:47], s101 offen offset:0 sc1
buffer_load_dwordx4 a[212:215], v15, s[44:47], s101 offen offset:1024 sc1
buffer_load_dwordx4 a[216:219], v15, s[44:47], s101 offen offset:2048 sc1
buffer_load_dwordx4 a[220:223], v15, s[44:47], s101 offen offset:3072 sc1
s_add_u32 s101, s98, 8192
buffer_load_dwordx4 a[224:227], v15, s[44:47], s101 offen offset:0 sc1
buffer_load_dwordx4 a[228:231], v15, s[44:47], s101 offen offset:1024 sc1
buffer_load_dwordx4 a[232:235], v15, s[44:47], s101 offen offset:2048 sc1
buffer_load_dwordx4 a[236:239], v15, s[44:47], s101 offen offset:3072 sc1
s_add_u32 s101, s98, 12288
buffer_load_dwordx4 a[240:243], v15, s[44:47], s101 offen offset:0 sc1
buffer_load_dwordx4 a[244:247], v15, s[44:47], s101 offen offset:1024 sc1
buffer_load_dwordx4 a[248:251], v15, s[44:47], s101 offen offset:2048 sc1
buffer_load_dwordx4 a[252:255], v15, s[44:47], s101 offen offset:3072 sc1
s_waitcnt vmcnt(0)
v_mfma_f32_16x16x32_bf16 v[96:99], a[192:195], a[160:163], 0
v_mfma_f32_16x16x32_bf16 v[100:103], a[208:211], a[160:163], 0
v_mfma_f32_16x16x32_bf16 v[96:99], a[196:199], a[164:167], v[96:99]
v_mfma_f32_16x16x32_bf16 v[100:103], a[212:215], a[164:167], v[100:103]
v_mfma_f32_16x16x32_bf16 v[96:99], a[200:203], a[168:171], v[96:99]
v_mfma_f32_16x16x32_bf16 v[100:103], a[216:219], a[168:171], v[100:103]
v_mfma_f32_16x16x32_bf16 v[96:99], a[204:207], a[172:175], v[96:99]
v_mfma_f32_16x16x32_bf16 v[100:103], a[220:223], a[172:175], v[100:103]
s_nop 7
v_cmp_le_i32 vcc, 0, v106
s_nop 1
v_cndmask_b32 v96, v3, v96, vcc
v_cmp_le_i32 vcc, 1, v106
s_nop 1
v_cndmask_b32 v97, v3, v97, vcc
v_cmp_le_i32 vcc, 2, v106
s_nop 1
v_cndmask_b32 v98, v3, v98, vcc
v_cmp_le_i32 vcc, 3, v106
s_nop 1
v_cndmask_b32 v99, v3, v99, vcc
v_cmp_le_i32 vcc, 16, v106
s_nop 1
v_cndmask_b32 v100, v3, v100, vcc
v_cmp_le_i32 vcc, 17, v106
s_nop 1
v_cndmask_b32 v101, v3, v101, vcc
v_cmp_le_i32 vcc, 18, v106
s_nop 1
v_cndmask_b32 v102, v3, v102, vcc
v_cmp_le_i32 vcc, 19, v106
s_nop 1
v_cndmask_b32 v103, v3, v103, vcc
v_max3_f32 v107, v104, v96, v97
v_max3_f32 v107, v107, v98, v99
v_max3_f32 v107, v107, v100, v101
v_max3_f32 v107, v107, v102, v103
v_mov_b32 v105, v107
s_nop 1
v_permlane32_swap_b32 v107, v105
v_max_f32 v107, v107, v105
v_mov_b32 v105, v107
s_nop 1
v_permlane16_swap_b32 v107, v105
v_max_f32 v107, v107, v105
v_sub_f32 v105, v104, v107
v_mov_b32 v104, v107
v_exp_f32 v105, v105
v_sub_f32 v96, v96, v104
v_sub_f32 v97, v97, v104
v_sub_f32 v98, v98, v104
v_sub_f32 v99, v99, v104
v_sub_f32 v100, v100, v104
v_sub_f32 v101, v101, v104
v_sub_f32 v102, v102, v104
v_sub_f32 v103, v103, v104
v_exp_f32 v96, v96
v_exp_f32 v97, v97
v_exp_f32 v98, v98
v_exp_f32 v99, v99
v_exp_f32 v100, v100
v_exp_f32 v101, v101
v_exp_f32 v102, v102
v_exp_f32 v103, v103
v_mul_f32 v192, v192, v105
v_mul_f32 v193, v193, v105
v_mul_f32 v194, v194, v105
v_mul_f32 v195, v195, v105
v_mul_f32 v196, v196, v105
v_mul_f32 v197, v197, v105
v_mul_f32 v198, v198, v105
v_mul_f32 v199, v199, v105
v_mul_f32 v200, v200, v105
v_mul_f32 v201, v201, v105
v_mul_f32 v202, v202, v105
v_mul_f32 v203, v203, v105
v_mul_f32 v204, v204, v105
v_mul_f32 v205, v205, v105
v_mul_f32 v206, v206, v105
v_mul_f32 v207, v207, v105
v_mul_f32 v208, v208, v105
v_mul_f32 v209, v209, v105
v_mul_f32 v210, v210, v105
v_mul_f32 v211, v211, v105
v_mul_f32 v212, v212, v105
v_mul_f32 v213, v213, v105
v_mul_f32 v214, v214, v105
v_mul_f32 v215, v215, v105
v_mul_f32 v216, v216, v105
v_mul_f32 v217, v217, v105
v_mul_f32 v218, v218, v105
v_mul_f32 v219, v219, v105
v_mul_f32 v220, v220, v105
v_mul_f32 v221, v221, v105
v_mul_f32 v222, v222, v105
v_mul_f32 v223, v223, v105
v_mul_f32 v80, v80, v105
v_mul_f32 v81, v81, v105
v_mul_f32 v82, v82, v105
v_mul_f32 v83, v83, v105
v_cvt_pk_bf16_f32 v96, v96, v97
v_cvt_pk_bf16_f32 v97, v98, v99
v_cvt_pk_bf16_f32 v98, v100, v101
v_cvt_pk_bf16_f32 v99, v102, v103
v_subrev_u32 v106, 32, v106
s_nop 1
v_mfma_f32_16x16x32_bf16 v[80:83], v[88:91], v[96:99], v[80:83]
v_mfma_f32_16x16x32_bf16 v[192:195], a[224:227], v[96:99], v[192:195]
v_mfma_f32_16x16x32_bf16 v[196:199], a[228:231], v[96:99], v[196:199]
v_mfma_f32_16x16x32_bf16 v[200:203], a[232:235], v[96:99], v[200:203]
v_mfma_f32_16x16x32_bf16 v[204:207], a[236:239], v[96:99], v[204:207]
v_mfma_f32_16x16x32_bf16 v[208:211], a[240:243], v[96:99], v[208:211]
v_mfma_f32_16x16x32_bf16 v[212:215], a[244:247], v[96:99], v[212:215]
v_mfma_f32_16x16x32_bf16 v[216:219], a[248:251], v[96:99], v[216:219]
v_mfma_f32_16x16x32_bf16 v[220:223], a[252:255], v[96:99], v[220:223]
s_nop 7
s_add_u32 s98, s98, 16384
s_cmp_lt_u32 s98, s99
s_cbranch_scc1 L_slow2_loop
v_rcp_f32 v96, v80
s_lshl_b32 s99, s31, 12
s_add_u32 s99, s99, 57344
s_sub_u32 s98, 15, s32
s_lshl_b32 s98, s98, 3
s_add_u32 s98, s98, s30
v_mov_b32 v97, v96
s_mul_i32 s98, s98, 188416
s_add_u32 s98, s98, s99
v_pk_mul_f32 v[192:193], v[192:193], v[96:97]
v_pk_mul_f32 v[194:195], v[194:195], v[96:97]
v_pk_mul_f32 v[196:197], v[196:197], v[96:97]
v_pk_mul_f32 v[198:199], v[198:199], v[96:97]
v_cvt_pk_bf16_f32 v192, v192, v193
v_cvt_pk_bf16_f32 v193, v194, v195
v_cvt_pk_bf16_f32 v194, v196, v197
v_cvt_pk_bf16_f32 v195, v198, v199
buffer_store_dwordx4 v[192:195], v15, s[48:51], s98 offen offset:0 sc1
v_pk_mul_f32 v[200:201], v[200:201], v[96:97]
v_pk_mul_f32 v[202:203], v[202:203], v[96:97]
v_pk_mul_f32 v[204:205], v[204:205], v[96:97]
v_pk_mul_f32 v[206:207], v[206:207], v[96:97]
v_cvt_pk_bf16_f32 v200, v200, v201
v_cvt_pk_bf16_f32 v201, v202, v203
v_cvt_pk_bf16_f32 v202, v204, v205
v_cvt_pk_bf16_f32 v203, v206, v207
buffer_store_dwordx4 v[200:203], v15, s[48:51], s98 offen offset:1024 sc1
v_pk_mul_f32 v[208:209], v[208:209], v[96:97]
v_pk_mul_f32 v[210:211], v[210:211], v[96:97]
v_pk_mul_f32 v[212:213], v[212:213], v[96:97]
v_pk_mul_f32 v[214:215], v[214:215], v[96:97]
v_cvt_pk_bf16_f32 v208, v208, v209
v_cvt_pk_bf16_f32 v209, v210, v211
v_cvt_pk_bf16_f32 v210, v212, v213
v_cvt_pk_bf16_f32 v211, v214, v215
buffer_store_dwordx4 v[208:211], v15, s[48:51], s98 offen offset:2048 sc1
v_pk_mul_f32 v[216:217], v[216:217], v[96:97]
v_pk_mul_f32 v[218:219], v[218:219], v[96:97]
v_pk_mul_f32 v[220:221], v[220:221], v[96:97]
v_pk_mul_f32 v[222:223], v[222:223], v[96:97]
v_cvt_pk_bf16_f32 v216, v216, v217
v_cvt_pk_bf16_f32 v217, v218, v219
v_cvt_pk_bf16_f32 v218, v220, v221
v_cvt_pk_bf16_f32 v219, v222, v223
buffer_store_dwordx4 v[216:219], v15, s[48:51], s98 offen offset:3072 sc1
s_waitcnt vmcnt(0)
s_branch L_slow2_done
L_slow3:
s_sub_u32 s99, 15, s32
s_lshl_b32 s99, s99, 3
s_add_u32 s99, s99, s30
s_add_u32 s99, s99, 4
s_lshl_b32 s98, s99, 4
v_bfe_u32 v106, v15, 4, 4
v_lshrrev_b32 v107, 8, v15
v_lshlrev_b32 v107, 2, v107
v_sub_u32 v106, v106, v107
v_add_u32 v106, s98, v106
s_lshr_b32 s99, s99, 1
s_add_u32 s99, s99, 1
s_lshl_b32 s99, s99, 14
s_mov_b32 s98, 0
v_mov_b32 v104, v3
v_mov_b64 v[224:225], 0
v_mov_b64 v[226:227], 0
v_mov_b64 v[228:229], 0
v_mov_b64 v[230:231], 0
v_mov_b64 v[232:233], 0
v_mov_b64 v[234:235], 0
v_mov_b64 v[236:237], 0
v_mov_b64 v[238:239], 0
v_mov_b64 v[240:241], 0
v_mov_b64 v[242:243], 0
v_mov_b64 v[244:245], 0
v_mov_b64 v[246:247], 0
v_mov_b64 v[248:249], 0
v_mov_b64 v[250:251], 0
v_mov_b64 v[252:253], 0
v_mov_b64 v[254:255], 0
v_mov_b64 v[84:85], 0
v_mov_b64 v[86:87], 0
L_slow3_loop:
s_add_u32 s101, s98, 0
buffer_load_dwordx4 a[192:195], v15, s[44:47], s101 offen offset:0 sc1
buffer_load_dwordx4 a[196:199], v15, s[44:47], s101 offen offset:1024 sc1
buffer_load_dwordx4 a[200:203], v15, s[44:47], s101 offen offset:2048 sc1
buffer_load_dwordx4 a[204:207], v15, s[44:47], s101 offen offset:3072 sc1
s_add_u32 s101, s98, 4096
buffer_load_dwordx4 a[208:211], v15, s[44:47], s101 offen offset:0 sc1
buffer_load_dwordx4 a[212:215], v15, s[44:47], s101 offen offset:1024 sc1
buffer_load_dwordx4 a[216:219], v15, s[44:47], s101 offen offset:2048 sc1
buffer_load_dwordx4 a[220:223], v15, s[44:47], s101 offen offset:3072 sc1
s_add_u32 s101, s98, 8192
buffer_load_dwordx4 a[224:227], v15, s[44:47], s101 offen offset:0 sc1
buffer_load_dwordx4 a[228:231], v15, s[44:47], s101 offen offset:1024 sc1
buffer_load_dwordx4 a[232:235], v15, s[44:47], s101 offen offset:2048 sc1
buffer_load_dwordx4 a[236:239], v15, s[44:47], s101 offen offset:3072 sc1
s_add_u32 s101, s98, 12288
buffer_load_dwordx4 a[240:243], v15, s[44:47], s101 offen offset:0 sc1
buffer_load_dwordx4 a[244:247], v15, s[44:47], s101 offen offset:1024 sc1
buffer_load_dwordx4 a[248:251], v15, s[44:47], s101 offen offset:2048 sc1
buffer_load_dwordx4 a[252:255], v15, s[44:47], s101 offen offset:3072 sc1
s_waitcnt vmcnt(0)
v_mfma_f32_16x16x32_bf16 v[96:99], a[192:195], a[176:179], 0
v_mfma_f32_16x16x32_bf16 v[100:103], a[208:211], a[176:179], 0
v_mfma_f32_16x16x32_bf16 v[96:99], a[196:199], a[180:183], v[96:99]
v_mfma_f32_16x16x32_bf16 v[100:103], a[212:215], a[180:183], v[100:103]
v_mfma_f32_16x16x32_bf16 v[96:99], a[200:203], a[184:187], v[96:99]
v_mfma_f32_16x16x32_bf16 v[100:103], a[216:219], a[184:187], v[100:103]
v_mfma_f32_16x16x32_bf16 v[96:99], a[204:207], a[188:191], v[96:99]
v_mfma_f32_16x16x32_bf16 v[100:103], a[220:223], a[188:191], v[100:103]
s_nop 7
v_cmp_le_i32 vcc, 0, v106
s_nop 1
v_cndmask_b32 v96, v3, v96, vcc
v_cmp_le_i32 vcc, 1, v106
s_nop 1
v_cndmask_b32 v97, v3, v97, vcc
v_cmp_le_i32 vcc, 2, v106
s_nop 1
v_cndmask_b32 v98, v3, v98, vcc
v_cmp_le_i32 vcc, 3, v106
s_nop 1
v_cndmask_b32 v99, v3, v99, vcc
v_cmp_le_i32 vcc, 16, v106
s_nop 1
v_cndmask_b32 v100, v3, v100, vcc
v_cmp_le_i32 vcc, 17, v106
s_nop 1
v_cndmask_b32 v101, v3, v101, vcc
v_cmp_le_i32 vcc, 18, v106
s_nop 1
v_cndmask_b32 v102, v3, v102, vcc
v_cmp_le_i32 vcc, 19, v106
s_nop 1
v_cndmask_b32 v103, v3, v103, vcc
v_max3_f32 v107, v104, v96, v97
v_max3_f32 v107, v107, v98, v99
v_max3_f32 v107, v107, v100, v101
v_max3_f32 v107, v107, v102, v103
v_mov_b32 v105, v107
s_nop 1
v_permlane32_swap_b32 v107, v105
v_max_f32 v107, v107, v105
v_mov_b32 v105, v107
s_nop 1
v_permlane16_swap_b32 v107, v105
v_max_f32 v107, v107, v105
v_sub_f32 v105, v104, v107
v_mov_b32 v104, v107
v_exp_f32 v105, v105
v_sub_f32 v96, v96, v104
v_sub_f32 v97, v97, v104
v_sub_f32 v98, v98, v104
v_sub_f32 v99, v99, v104
v_sub_f32 v100, v100, v104
v_sub_f32 v101, v101, v104
v_sub_f32 v102, v102, v104
v_sub_f32 v103, v103, v104
v_exp_f32 v96, v96
v_exp_f32 v97, v97
v_exp_f32 v98, v98
v_exp_f32 v99, v99
v_exp_f32 v100, v100
v_exp_f32 v101, v101
v_exp_f32 v102, v102
v_exp_f32 v103, v103
v_mul_f32 v224, v224, v105
v_mul_f32 v225, v225, v105
v_mul_f32 v226, v226, v105
v_mul_f32 v227, v227, v105
v_mul_f32 v228, v228, v105
v_mul_f32 v229, v229, v105
v_mul_f32 v230, v230, v105
v_mul_f32 v231, v231, v105
v_mul_f32 v232, v232, v105
v_mul_f32 v233, v233, v105
v_mul_f32 v234, v234, v105
v_mul_f32 v235, v235, v105
v_mul_f32 v236, v236, v105
v_mul_f32 v237, v237, v105
v_mul_f32 v238, v238, v105
v_mul_f32 v239, v239, v105
v_mul_f32 v240, v240, v105
v_mul_f32 v241, v241, v105
v_mul_f32 v242, v242, v105
v_mul_f32 v243, v243, v105
v_mul_f32 v244, v244, v105
v_mul_f32 v245, v245, v105
v_mul_f32 v246, v246, v105
v_mul_f32 v247, v247, v105
v_mul_f32 v248, v248, v105
v_mul_f32 v249, v249, v105
v_mul_f32 v250, v250, v105
v_mul_f32 v251, v251, v105
v_mul_f32 v252, v252, v105
v_mul_f32 v253, v253, v105
v_mul_f32 v254, v254, v105
v_mul_f32 v255, v255, v105
v_mul_f32 v84, v84, v105
v_mul_f32 v85, v85, v105
v_mul_f32 v86, v86, v105
v_mul_f32 v87, v87, v105
v_cvt_pk_bf16_f32 v96, v96, v97
v_cvt_pk_bf16_f32 v97, v98, v99
v_cvt_pk_bf16_f32 v98, v100, v101
v_cvt_pk_bf16_f32 v99, v102, v103
v_subrev_u32 v106, 32, v106
s_nop 1
v_mfma_f32_16x16x32_bf16 v[84:87], v[88:91], v[96:99], v[84:87]
v_mfma_f32_16x16x32_bf16 v[224:227], a[224:227], v[96:99], v[224:227]
v_mfma_f32_16x16x32_bf16 v[228:231], a[228:231], v[96:99], v[228:231]
v_mfma_f32_16x16x32_bf16 v[232:235], a[232:235], v[96:99], v[232:235]
v_mfma_f32_16x16x32_bf16 v[236:239], a[236:239], v[96:99], v[236:239]
v_mfma_f32_16x16x32_bf16 v[240:243], a[240:243], v[96:99], v[240:243]
v_mfma_f32_16x16x32_bf16 v[244:247], a[244:247], v[96:99], v[244:247]
v_mfma_f32_16x16x32_bf16 v[248:251], a[248:251], v[96:99], v[248:251]
v_mfma_f32_16x16x32_bf16 v[252:255], a[252:255], v[96:99], v[252:255]
s_nop 7
s_add_u32 s98, s98, 16384
s_cmp_lt_u32 s98, s99
s_cbranch_scc1 L_slow3_loop
v_rcp_f32 v98, v84
s_lshl_b32 s99, s31, 12
s_add_u32 s99, s99, 57344
s_sub_u32 s98, 15, s32
s_lshl_b32 s98, s98, 3
s_add_u32 s98, s98, s30
s_add_u32 s98, s98, 4
v_mov_b32 v99, v98
s_mul_i32 s98, s98, 188416
s_add_u32 s98, s98, s99
v_pk_mul_f32 v[224:225], v[224:225], v[98:99]
v_pk_mul_f32 v[226:227], v[226:227], v[98:99]
v_pk_mul_f32 v[228:229], v[228:229], v[98:99]
v_pk_mul_f32 v[230:231], v[230:231], v[98:99]
v_cvt_pk_bf16_f32 v224, v224, v225
v_cvt_pk_bf16_f32 v225, v226, v227
v_cvt_pk_bf16_f32 v226, v228, v229
v_cvt_pk_bf16_f32 v227, v230, v231
buffer_store_dwordx4 v[224:227], v15, s[48:51], s98 offen offset:0 sc1
v_pk_mul_f32 v[232:233], v[232:233], v[98:99]
v_pk_mul_f32 v[234:235], v[234:235], v[98:99]
v_pk_mul_f32 v[236:237], v[236:237], v[98:99]
v_pk_mul_f32 v[238:239], v[238:239], v[98:99]
v_cvt_pk_bf16_f32 v232, v232, v233
v_cvt_pk_bf16_f32 v233, v234, v235
v_cvt_pk_bf16_f32 v234, v236, v237
v_cvt_pk_bf16_f32 v235, v238, v239
buffer_store_dwordx4 v[232:235], v15, s[48:51], s98 offen offset:1024 sc1
v_pk_mul_f32 v[240:241], v[240:241], v[98:99]
v_pk_mul_f32 v[242:243], v[242:243], v[98:99]
v_pk_mul_f32 v[244:245], v[244:245], v[98:99]
v_pk_mul_f32 v[246:247], v[246:247], v[98:99]
v_cvt_pk_bf16_f32 v240, v240, v241
v_cvt_pk_bf16_f32 v241, v242, v243
v_cvt_pk_bf16_f32 v242, v244, v245
v_cvt_pk_bf16_f32 v243, v246, v247
buffer_store_dwordx4 v[240:243], v15, s[48:51], s98 offen offset:2048 sc1
v_pk_mul_f32 v[248:249], v[248:249], v[98:99]
v_pk_mul_f32 v[250:251], v[250:251], v[98:99]
v_pk_mul_f32 v[252:253], v[252:253], v[98:99]
v_pk_mul_f32 v[254:255], v[254:255], v[98:99]
v_cvt_pk_bf16_f32 v248, v248, v249
v_cvt_pk_bf16_f32 v249, v250, v251
v_cvt_pk_bf16_f32 v250, v252, v253
v_cvt_pk_bf16_f32 v251, v254, v255
buffer_store_dwordx4 v[248:251], v15, s[48:51], s98 offen offset:3072 sc1
s_waitcnt vmcnt(0)
s_branch L_slow3_done
L_end:
s_endpgm
.section .rodata,"a"
.p2align 6
.amdhsa_kernel parallel_sum__compressed_kv_cla__glu_gated_geglu__prompt_kernel
  .amdhsa_next_free_vgpr 512
  .amdhsa_next_free_sgpr 102
  .amdhsa_accum_offset 256
  .amdhsa_group_segment_fixed_size 0
  .amdhsa_kernarg_size 104
  .amdhsa_user_sgpr_count 2
  .amdhsa_user_sgpr_kernarg_segment_ptr 1
  .amdhsa_system_sgpr_workgroup_id_x 1
.end_amdhsa_kernel
```
